```python
import torch

def _softmax(x, axis=-1):
    return torch.softmax(x, dim=axis)
def _gelu(x):
    return torch.nn.functional.gelu(x, approximate="tanh")
def _silu(x):
    return torch.nn.functional.silu(x)
def _sigmoid(x):
    return torch.sigmoid(x)
def _layernorm(x, axis=-1, eps=1e-5):
    m = x.mean(dim=axis, keepdim=True)
    v = x.var(dim=axis, keepdim=True, unbiased=False)
    return (x - m) / torch.sqrt(v + eps)
def _scatter_add(tgt, idx, src, axis=0):
    return tgt.clone().index_add_(axis, idx, src)
def _segment_sum(src, seg, n):
    out = torch.zeros((n,) + src.shape[1:], dtype=src.dtype)
    return out.index_add_(0, seg, src)
def _pad(x, pw):
    flat = tuple(v for pair in reversed(pw) for v in pair)
    return torch.nn.functional.pad(x, flat)

kernel_name = 'concat_heads__mha_block_cached__gqa_block_cached__near_ridge'

def setup_inputs():

    _w = (lambda a: (lambda t: t.to(torch.bfloat16) if t.is_floating_point() else t)(torch.as_tensor(a)))
    def _A_setup():
        B, Sq, D = 8, 160, 576
        H, Sk, Dh = 32, 512, 128
        return {
            "x": _w((lambda *s: torch.randn(*s, dtype=torch.bfloat16) * 0.8)(B, Sq, D)),
            "k_cache": _w((lambda *s: torch.randn(*s, dtype=torch.bfloat16) * 0.8)(B, H, Sk, Dh)),
            "v_cache": _w((lambda *s: torch.randn(*s, dtype=torch.bfloat16) * 0.05)(B, H, Sk, Dh)),
            "wq": _w((lambda *s: torch.randn(*s, dtype=torch.bfloat16) * 0.8)(D, H * Dh) * (D ** -0.5)),
            "wo": _w((lambda *s: torch.randn(*s, dtype=torch.bfloat16) * 0.05)(H * Dh, D) * ((H * Dh) ** -0.5)),
        }
    _A_in = _A_setup()

    def _B_setup():
        B, Sq, D = 8, 160, 576
        Hq, Hkv, Sk, Dh = 32, 32, 512, 128
        assert Hq % Hkv == 0, (Hq, Hkv)
        return {
            "x": _w((lambda *s: torch.randn(*s, dtype=torch.bfloat16) * 0.8)(B, Sq, D)),
            "k_cache": _w((lambda *s: torch.randn(*s, dtype=torch.bfloat16) * 0.8)(B, Hkv, Sk, Dh)),
            "v_cache": _w((lambda *s: torch.randn(*s, dtype=torch.bfloat16) * 0.05)(B, Hkv, Sk, Dh)),
            "wq": _w((lambda *s: torch.randn(*s, dtype=torch.bfloat16) * 0.8)(D, Hq * Dh) * (D ** -0.5)),
            "wo": _w((lambda *s: torch.randn(*s, dtype=torch.bfloat16) * 0.05)(Hq * Dh, D) * ((Hq * Dh) ** -0.5)),
        }
    _B_in = _B_setup()

    return {
        "A_x": _A_in["x"],
        "A_k_cache": _A_in["k_cache"],
        "A_v_cache": _A_in["v_cache"],
        "A_wq": _A_in["wq"],
        "A_wo": _A_in["wo"],
        "B_x": _B_in["x"],
        "B_k_cache": _B_in["k_cache"],
        "B_v_cache": _B_in["v_cache"],
        "B_wq": _B_in["wq"],
        "B_wo": _B_in["wo"],
    }

def reference(A_x, A_k_cache, A_v_cache, A_wq, A_wo, B_x, B_k_cache, B_v_cache, B_wq, B_wo):
    def _A_ref(x, k_cache, v_cache, wq, wo):
        B, Sq, D = x.shape
        H, Dh = 32, 128
        q = (lambda x, *d: x.permute(*d))((x @ wq).reshape(B, Sq, H, Dh), 0, 2, 1, 3)
        scores = torch.einsum("bhqd,bhkd->bhqk", q, k_cache) * (Dh ** -0.5)
        p = _softmax(scores, axis=-1)
        o = torch.einsum("bhqk,bhkd->bhqd", p, v_cache)
        return (lambda x, *d: x.permute(*d))(o, 0, 2, 1, 3).reshape(B, Sq, H * Dh) @ wo

    def _B_ref(x, k_cache, v_cache, wq, wo):
        B, Sq, D = x.shape
        Hq, Dh = 32, 128
        Hkv = k_cache.shape[1]
        rep = Hq // Hkv
        q = (lambda x, *d: x.permute(*d))((x @ wq).reshape(B, Sq, Hq, Dh), 0, 2, 1, 3)
        k = (lambda x, n, axis: torch.repeat_interleave(x, n, dim=axis))(k_cache, rep, axis=1)
        v = (lambda x, n, axis: torch.repeat_interleave(x, n, dim=axis))(v_cache, rep, axis=1)
        scores = torch.einsum("bhqd,bhkd->bhqk", q, k) * (Dh ** -0.5)
        p = _softmax(scores, axis=-1)
        o = torch.einsum("bhqk,bhkd->bhqd", p, v)
        return (lambda x, *d: x.permute(*d))(o, 0, 2, 1, 3).reshape(B, Sq, Hq * Dh) @ wo

    a = _A_ref(A_x, A_k_cache, A_v_cache, A_wq, A_wo)
    b = _B_ref(B_x, B_k_cache, B_v_cache, B_wq, B_wo)
    return torch.concatenate([a, b], axis=-1)
```

```asm
; @launch grid=(256,1,1) block=(256,1,1) lds=163840
.amdgcn_target "amdgcn-amd-amdhsa--gfx950"
.text
.globl concat_heads__mha_block_cached__gqa_block_cached__near_ridge_kernel
.p2align 8
.type concat_heads__mha_block_cached__gqa_block_cached__near_ridge_kernel,@function
concat_heads__mha_block_cached__gqa_block_cached__near_ridge_kernel:
    s_cmp_ge_u32 s2, 256
    s_cbranch_scc1 K1_END
    s_getpc_b64 s[70:71]
    v_lshlrev_b32 v236, 7, v0
    global_load_dword v237, v236, s[70:71]
    v_add_u32 v236, 0x8000, v236
    global_load_dword v237, v236, s[70:71]
    s_and_b32 s3, s2, 7
    s_lshr_b32 s5, s3, 2
    s_mul_i32 s4, s5, 40
    s_add_u32 s58, s0, s4
    s_addc_u32 s59, s1, 0
    s_load_dwordx8 s[60:67], s[58:59], 0
    s_load_dwordx2 s[54:55], s[0:1], 96
    s_load_dwordx2 s[76:77], s[58:59], 32
    s_load_dwordx2 s[78:79], s[0:1], 80
    s_load_dwordx2 s[100:101], s[0:1], 88
    v_lshrrev_b32 v4, 6, v0
    v_and_b32 v1, 63, v0
    s_lshr_b32 s57, s2, 3
    v_readfirstlane_b32 s32, v4
    v_and_b32 v2, 15, v1
    v_lshrrev_b32 v3, 4, v1
    s_and_b32 s68, s3, 3
    s_lshr_b32 s7, s57, 2
    s_and_b32 s4, s57, 3
    s_lshl_b32 s6, s68, 3
    s_lshl_b32 s4, s4, 1
    s_add_u32 s6, s6, s4
    s_lshr_b32 s33, s32, 1
    s_and_b32 s34, s32, 1
    s_and_b32 s35, s32, 1
    s_mov_b32 s38, 0
    s_mov_b32 s36, 0
    s_mov_b32 s37, 0
    s_cmp_lt_u32 s32, 2
    s_cbranch_scc0 K1_SB
    v_lshrrev_b32 v4, 5, v1
    v_mul_u32_u24 v4, 3, v4
    v_and_b32 v5, 3, v1
    v_xor_b32 v4, v4, v5
    v_lshlrev_b32 v4, 4, v4
    v_lshrrev_b32 v5, 2, v1
    s_mul_i32 s3, s35, 80
    v_add_u32 v5, s3, v5
    v_mul_u32_u24 v5, 1152, v5
    v_add_u32 v217, v5, v4
    v_add_u32 v218, 17408, v217
    v_add_u32 v219, 34816, v217
    v_add_u32 v220, 52224, v217
    v_add_u32 v221, 73728, v217
    s_lshl_b32 s3, s35, 8
    v_lshlrev_b32 v4, 13, v3
    v_add_u32 v4, s3, v4
    v_lshlrev_b32 v5, 1, v3
    v_xor_b32 v5, v5, v2
    v_xor_b32 v6, 8, v5
    v_lshl_add_u32 v5, v5, 4, v4
    v_lshl_add_u32 v6, v6, 4, v4
    v_add_u32 v222, 0, v5
    v_add_u32 v223, 31744, v5
    v_add_u32 v224, 63488, v6
    v_add_u32 v225, 95232, v6
    v_add_u32 v226, 131072, v5
    v_add_u32 v227, 162816, v5
    v_add_u32 v228, 194560, v6
    v_add_u32 v229, 226304, v6
    s_and_b32 s3, s57, 3
    s_lshl_b32 s3, s3, 1
    s_add_u32 s3, s3, s7
    s_mul_i32 s3, s3, 4
    s_lshr_b32 s3, s3, 2
    s_cmp_ge_u32 s3, 18
    s_cselect_b32 s4, 18, 0
    s_sub_u32 s51, s3, s4
    s_lshl_b32 s36, s51, 6
    s_lshl_b32 s37, s51, 18
    s_mul_i32 s39, s35, 5120
    s_add_u32 s39, s39, 81920
    s_lshl_b32 s40, s35, 13
    s_add_u32 s40, s40, 112640
    s_mul_i32 s4, s7, 184320
    s_lshl_b32 s3, s6, 8
    s_sub_u32 s56, 4718592, s3
    s_mov_b32 s10, 184320
    s_mov_b32 s11, 0x20000
    s_mov_b32 s14, s56
    s_mov_b32 s15, 0x20000
    s_waitcnt lgkmcnt(0)
    s_add_u32 s8, s60, s4
    s_addc_u32 s9, s61, 0
    s_add_u32 s12, s66, s3
    s_addc_u32 s13, s67, 0
    s_add_u32 m0, s39, 0
    s_nop 0
    buffer_load_dwordx4 v217, s[8:11], s36 offen offset:0 lds
    buffer_load_dwordx4 v218, s[8:11], s36 offen offset:1024 lds
    buffer_load_dwordx4 v219, s[8:11], s36 offen offset:2048 lds
    buffer_load_dwordx4 v220, s[8:11], s36 offen offset:3072 lds
    s_add_u32 m0, s39, 4096
    s_nop 0
    buffer_load_dwordx4 v221, s[8:11], s36 offen lds
    s_add_u32 m0, s40, 0
    s_nop 0
    buffer_load_dwordx4 v222, s[12:15], s37 offen offset:0 lds
    buffer_load_dwordx4 v223, s[12:15], s37 offen offset:1024 lds
    buffer_load_dwordx4 v224, s[12:15], s37 offen offset:2048 lds
    buffer_load_dwordx4 v225, s[12:15], s37 offen offset:3072 lds
    s_add_u32 m0, s40, 4096
    s_nop 0
    buffer_load_dwordx4 v226, s[12:15], s37 offen offset:0 lds
    buffer_load_dwordx4 v227, s[12:15], s37 offen offset:1024 lds
    buffer_load_dwordx4 v228, s[12:15], s37 offen offset:2048 lds
    buffer_load_dwordx4 v229, s[12:15], s37 offen offset:3072 lds
    s_add_u32 s38, s38, 1
    s_add_u32 s51, s51, 1
    s_cmp_eq_u32 s51, 18
    s_cselect_b32 s51, 0, s51
    s_lshl_b32 s36, s51, 6
    s_lshl_b32 s37, s51, 18
    s_cmp_lt_u32 s38, 18
    s_cselect_b32 s10, 184320, 0
    s_cselect_b32 s14, s56, 0
    s_add_u32 m0, s39, 10240
    s_nop 0
    buffer_load_dwordx4 v217, s[8:11], s36 offen offset:0 lds
    buffer_load_dwordx4 v218, s[8:11], s36 offen offset:1024 lds
    buffer_load_dwordx4 v219, s[8:11], s36 offen offset:2048 lds
    buffer_load_dwordx4 v220, s[8:11], s36 offen offset:3072 lds
    s_add_u32 m0, s39, 14336
    s_nop 0
    buffer_load_dwordx4 v221, s[8:11], s36 offen lds
    s_add_u32 m0, s40, 16384
    s_nop 0
    buffer_load_dwordx4 v222, s[12:15], s37 offen offset:0 lds
    buffer_load_dwordx4 v223, s[12:15], s37 offen offset:1024 lds
    buffer_load_dwordx4 v224, s[12:15], s37 offen offset:2048 lds
    buffer_load_dwordx4 v225, s[12:15], s37 offen offset:3072 lds
    s_add_u32 m0, s40, 20480
    s_nop 0
    buffer_load_dwordx4 v226, s[12:15], s37 offen offset:0 lds
    buffer_load_dwordx4 v227, s[12:15], s37 offen offset:1024 lds
    buffer_load_dwordx4 v228, s[12:15], s37 offen offset:2048 lds
    buffer_load_dwordx4 v229, s[12:15], s37 offen offset:3072 lds
    s_add_u32 s38, s38, 1
    s_add_u32 s51, s51, 1
    s_cmp_eq_u32 s51, 18
    s_cselect_b32 s51, 0, s51
    s_lshl_b32 s36, s51, 6
    s_lshl_b32 s37, s51, 18
    s_cmp_lt_u32 s38, 18
    s_cselect_b32 s10, 184320, 0
    s_cselect_b32 s14, s56, 0
    s_add_u32 m0, s39, 20480
    s_nop 0
    buffer_load_dwordx4 v217, s[8:11], s36 offen offset:0 lds
    buffer_load_dwordx4 v218, s[8:11], s36 offen offset:1024 lds
    buffer_load_dwordx4 v219, s[8:11], s36 offen offset:2048 lds
    buffer_load_dwordx4 v220, s[8:11], s36 offen offset:3072 lds
    s_add_u32 m0, s39, 24576
    s_nop 0
    buffer_load_dwordx4 v221, s[8:11], s36 offen lds
    s_add_u32 m0, s40, 32768
    s_nop 0
    buffer_load_dwordx4 v222, s[12:15], s37 offen offset:0 lds
    buffer_load_dwordx4 v223, s[12:15], s37 offen offset:1024 lds
    buffer_load_dwordx4 v224, s[12:15], s37 offen offset:2048 lds
    buffer_load_dwordx4 v225, s[12:15], s37 offen offset:3072 lds
    s_add_u32 m0, s40, 36864
    s_nop 0
    buffer_load_dwordx4 v226, s[12:15], s37 offen offset:0 lds
    buffer_load_dwordx4 v227, s[12:15], s37 offen offset:1024 lds
    buffer_load_dwordx4 v228, s[12:15], s37 offen offset:2048 lds
    buffer_load_dwordx4 v229, s[12:15], s37 offen offset:3072 lds
    s_add_u32 s38, s38, 1
    s_add_u32 s51, s51, 1
    s_cmp_eq_u32 s51, 18
    s_cselect_b32 s51, 0, s51
    s_lshl_b32 s36, s51, 6
    s_lshl_b32 s37, s51, 18
    s_cmp_lt_u32 s38, 18
    s_cselect_b32 s10, 184320, 0
    s_cselect_b32 s14, s56, 0
    s_mov_b32 s72, s76
    s_mov_b32 s73, s77
    s_mov_b32 s74, 0
    s_mov_b32 s75, 0x20000
    v_mov_b32 v236, 0
    v_mov_b32 v13, 0
    s_branch K1_SC
K1_SB:
    s_mul_i32 s3, s57, 40
    v_add_u32 v4, s3, v1
    v_mul_u32_u24 v4, 1152, v4
    s_lshl_b32 s3, s57, 13
    s_lshl_b32 s4, s68, 11
    s_add_u32 s3, s3, s4
    v_lshlrev_b32 v5, 7, v1
    v_add_u32 v5, s3, v5
    s_cmp_eq_u32 s32, 2
    s_cselect_b64 vcc, -1, 0
    s_cselect_b32 s3, 40, 16
    v_cndmask_b32 v236, v5, v4, vcc
    v_mov_b32 v6, 0x7ff00000
    v_cmp_gt_u32 vcc, s3, v1
    s_nop 1
    v_cndmask_b32 v236, v6, v236, vcc
    s_lshl_b32 s4, s7, 5
    s_add_u32 s4, s4, s6
    s_add_u32 s4, s4, s35
    s_lshl_b32 s4, s4, 17
    v_mov_b32 v7, 0
    s_waitcnt lgkmcnt(0)
    s_cmp_eq_u32 s32, 2
    s_cselect_b32 s8, s60, s66
    s_cselect_b32 s9, s61, s67
    s_mov_b32 s10, 4718592
    s_cselect_b32 s10, 1474560, s10
    s_mov_b32 s11, 0x20000
    s_mov_b32 s12, s66
    s_mov_b32 s13, s67
    s_mov_b32 s14, 0
    s_mov_b32 s15, 0x20000
    s_mov_b32 s56, 0
    s_mov_b32 s51, 0
    s_mov_b32 s39, 0
    s_mov_b32 s40, 0
    v_mov_b32 v217, 0
    v_mov_b32 v218, 0
    v_mov_b32 v219, 0
    v_mov_b32 v220, 0
    v_mov_b32 v221, 0
    v_mov_b32 v222, 0
    v_mov_b32 v223, 0
    v_mov_b32 v224, 0
    v_mov_b32 v225, 0
    v_mov_b32 v226, 0
    v_mov_b32 v227, 0
    v_mov_b32 v228, 0
    v_mov_b32 v229, 0
    s_mov_b32 s36, 64
    s_mov_b32 s38, 1
    v_mov_b32 v8, s60
    v_mov_b32 v9, s61
    s_add_u32 s72, s62, s4
    s_addc_u32 s73, s63, 0
    v_writelane_b32 v8, s72, 1
    v_writelane_b32 v9, s73, 1
    s_add_u32 s72, s64, s4
    s_addc_u32 s73, s65, 0
    v_writelane_b32 v8, s72, 2
    v_writelane_b32 v9, s73, 2
    s_add_u32 s72, s66, 0x200000
    s_addc_u32 s73, s67, 0
    v_writelane_b32 v8, s72, 3
    v_writelane_b32 v9, s73, 3
    s_add_u32 s72, s66, 0x400000
    s_addc_u32 s73, s67, 0
    v_writelane_b32 v8, s72, 4
    v_writelane_b32 v9, s73, 4
    s_add_u32 s72, s76, 0x0
    s_addc_u32 s73, s77, 0
    v_writelane_b32 v8, s72, 5
    v_writelane_b32 v9, s73, 5
    s_add_u32 s72, s76, 0x200000
    s_addc_u32 s73, s77, 0
    v_writelane_b32 v8, s72, 6
    v_writelane_b32 v9, s73, 6
    s_add_u32 s72, s76, 0x400000
    s_addc_u32 s73, s77, 0
    v_writelane_b32 v8, s72, 7
    v_writelane_b32 v9, s73, 7
    s_lshl_b32 s3, s5, 3
    s_add_u32 s3, s3, s7
    s_lshl_b32 s3, s3, 5
    s_add_u32 s3, s3, s6
    s_mul_i32 s3, s3, 40960
    s_nop 3
    global_load_dword v237, v[8:9], off
    s_mul_i32 s3, s68, 1179648
    s_add_u32 s72, s76, s3
    s_addc_u32 s73, s77, 0
    s_mov_b32 s74, 1179648
    s_mov_b32 s75, 0x20000
    s_mul_i32 s3, s57, 288
    s_cmp_eq_u32 s32, 3
    s_cselect_b32 s3, s3, 0xffffff
    v_add_u32 v13, s3, v1
    v_lshlrev_b32 v13, 7, v13
K1_SC:
    s_mov_b32 s48, 0x3e0293ee
    s_mov_b32 s49, 0x3e0293ee
    s_mov_b32 s50, 0x46800000
    v_lshrrev_b32 v4, 3, v2
    v_mul_u32_u24 v4, 3, v4
    v_xor_b32 v4, v4, v3
    v_lshlrev_b32 v4, 4, v4
    v_lshl_add_u32 v4, v2, 6, v4
    s_mul_i32 s3, s34, 5120
    s_add_u32 s3, s3, 81920
    v_add_u32 v208, s3, v4
    v_lshrrev_b32 v4, 2, v2
    v_and_b32 v5, 1, v3
    v_lshl_or_b32 v6, v5, 2, v4
    v_lshlrev_b32 v6, 1, v6
    v_lshl_add_u32 v5, v3, 3, v4
    v_lshlrev_b32 v5, 8, v5
    v_and_b32 v7, 3, v2
    v_lshrrev_b32 v8, 1, v7
    v_and_b32 v7, 1, v7
    v_lshl_add_u32 v5, v7, 3, v5
    s_lshl_b32 s3, s33, 13
    s_add_u32 s3, s3, 112640
    v_add_u32 v5, s3, v5
    v_xor_b32 v8, v8, v6
    v_lshl_add_u32 v209, v8, 4, v5
    v_xor_b32 v210, 32, v209
    v_xor_b32 v211, 64, v209
    v_xor_b32 v212, 96, v209
    v_xor_b32 v213, 128, v209
    v_xor_b32 v214, 160, v209
    v_xor_b32 v215, 192, v209
    v_xor_b32 v216, 224, v209
    v_mov_b32 v176, 0
    v_mov_b32 v177, 0
    v_mov_b32 v178, 0
    v_mov_b32 v179, 0
    s_nop 1
    v_mfma_f32_32x32x16_bf16 v[16:31], v[176:179], v[176:179], 0
    v_mfma_f32_32x32x16_bf16 v[32:47], v[176:179], v[176:179], 0
    v_mfma_f32_32x32x16_bf16 v[48:63], v[176:179], v[176:179], 0
    v_mfma_f32_32x32x16_bf16 v[64:79], v[176:179], v[176:179], 0
    v_mfma_f32_32x32x16_bf16 v[80:95], v[176:179], v[176:179], 0
    v_mfma_f32_32x32x16_bf16 v[96:111], v[176:179], v[176:179], 0
    v_mfma_f32_32x32x16_bf16 v[112:127], v[176:179], v[176:179], 0
    v_mfma_f32_32x32x16_bf16 v[128:143], v[176:179], v[176:179], 0
    v_mfma_f32_32x32x16_bf16 v[144:159], v[176:179], v[176:179], 0
    v_mfma_f32_32x32x16_bf16 v[160:175], v[176:179], v[176:179], 0
    s_lshl_b32 s4, s7, 5
    s_add_u32 s4, s4, s6
    s_add_u32 s4, s4, s35
    s_lshl_b32 s4, s4, 17
    s_add_u32 s16, s62, s4
    s_addc_u32 s17, s63, 0
    s_mov_b32 s18, 131072
    s_mov_b32 s19, 0x20000
    s_add_u32 s20, s64, s4
    s_addc_u32 s21, s65, 0
    s_mov_b32 s22, 131072
    s_mov_b32 s23, 0x20000
    s_memrealtime s[64:65]
    s_cmp_lt_u32 s32, 2
    s_cselect_b32 s24, s16, s20
    s_cselect_b32 s25, s17, s21
    s_mov_b32 s26, 131072
    s_mov_b32 s27, 0x20000
    s_cselect_b32 s42, 0, 65536
    s_lshl_b32 s3, s35, 13
    s_add_u32 s42, s42, s3
    s_lshl_b32 s4, s5, 3
    s_add_u32 s4, s4, s7
    s_lshl_b32 s4, s4, 5
    s_add_u32 s4, s4, s6
    s_add_u32 s4, s4, s33
    s_mul_i32 s4, s4, 40960
    s_mul_i32 s3, s34, 20480
    s_add_u32 s4, s4, s3
    s_add_u32 s28, s54, s4
    s_addc_u32 s29, s55, 0
    s_mov_b32 s30, 20480
    s_mov_b32 s31, 0x20000
    v_lshlrev_b32 v4, 8, v3
    v_add_u32 v5, 0, v3
    v_xor_b32 v5, v5, v2
    v_lshl_add_u32 v230, v5, 4, v4
    v_add_u32 v5, 4, v3
    v_xor_b32 v5, v5, v2
    v_lshl_add_u32 v231, v5, 4, v4
    v_add_u32 v5, 8, v3
    v_xor_b32 v5, v5, v2
    v_lshl_add_u32 v232, v5, 4, v4
    v_add_u32 v5, 12, v3
    v_xor_b32 v5, v5, v2
    v_lshl_add_u32 v233, v5, 4, v4
    v_add_u32 v5, 0, v3
    v_lshlrev_b32 v5, 1, v5
    v_xor_b32 v5, v5, v2
    v_lshl_add_u32 v234, v5, 4, v4
    v_add_u32 v5, 4, v3
    v_lshlrev_b32 v5, 1, v5
    v_xor_b32 v5, v5, v2
    v_lshl_add_u32 v235, v5, 4, v4
    s_cmp_lt_u32 s32, 2
    s_cselect_b64 vcc, -1, 0
    v_cndmask_b32 v252, v234, v230, vcc
    v_cndmask_b32 v253, v235, v231, vcc
    v_cndmask_b32 v254, v234, v232, vcc
    v_cndmask_b32 v255, v235, v233, vcc
    s_lshl_b32 s3, s33, 13
    v_lshlrev_b32 v4, 8, v2
    v_add_u32 v4, s3, v4
    v_xor_b32 v5, v3, v2
    v_lshl_add_u32 v240, v5, 4, v4
    v_xor_b32 v241, 64, v240
    v_xor_b32 v242, 128, v240
    v_xor_b32 v243, 192, v240
    v_lshrrev_b32 v4, 2, v2
    v_lshl_add_u32 v5, v3, 2, v4
    v_and_b32 v6, 7, v5
    v_lshlrev_b32 v6, 1, v6
    v_and_b32 v7, 3, v2
    v_lshrrev_b32 v8, 1, v7
    v_and_b32 v7, 1, v7
    v_lshlrev_b32 v7, 3, v7
    v_lshlrev_b32 v5, 8, v5
    v_add_u32 v5, v5, v7
    s_add_u32 s4, s3, 65536
    v_add_u32 v5, s4, v5
    v_xor_b32 v8, v8, v6
    v_lshl_add_u32 v244, v8, 4, v5
    v_xor_b32 v245, 32, v244
    v_xor_b32 v246, 64, v244
    v_xor_b32 v247, 96, v244
    v_xor_b32 v248, 128, v244
    v_xor_b32 v249, 160, v244
    v_xor_b32 v250, 192, v244
    v_xor_b32 v251, 224, v244
    s_cmp_lt_u32 s32, 2
    s_cbranch_scc0 K1_PB
    s_waitcnt vmcnt(26)
    s_barrier
    ds_read_b128 a[0:3], v208 offset:0
    ds_read_b128 a[4:7], v208 offset:1024
    ds_read_b128 a[8:11], v208 offset:2048
    ds_read_b128 a[12:15], v208 offset:3072
    ds_read_b128 a[16:19], v208 offset:4096
    ds_read_b64_tr_b16 a[40:41], v209 offset:0
    ds_read_b64_tr_b16 a[42:43], v209 offset:1024
    ds_read_b64_tr_b16 a[44:45], v210 offset:0
    ds_read_b64_tr_b16 a[46:47], v210 offset:1024
    ds_read_b64_tr_b16 a[48:49], v211 offset:0
    ds_read_b64_tr_b16 a[50:51], v211 offset:1024
    ds_read_b64_tr_b16 a[52:53], v212 offset:0
    ds_read_b64_tr_b16 a[54:55], v212 offset:1024
    ds_read_b64_tr_b16 a[56:57], v213 offset:0
    ds_read_b64_tr_b16 a[58:59], v213 offset:1024
    ds_read_b64_tr_b16 a[60:61], v214 offset:0
    ds_read_b64_tr_b16 a[62:63], v214 offset:1024
    ds_read_b64_tr_b16 a[64:65], v215 offset:0
    ds_read_b64_tr_b16 a[66:67], v215 offset:1024
    ds_read_b64_tr_b16 a[68:69], v216 offset:0
    ds_read_b64_tr_b16 a[70:71], v216 offset:1024
    s_mov_b32 s41, 0
K1_QL0:
    s_waitcnt vmcnt(13) lgkmcnt(0)
    s_barrier
    s_add_u32 m0, s39, 0
    ds_read_b128 a[20:23], v208 offset:10240
    v_mfma_f32_16x16x32_bf16 v[16:19], a[40:43], a[0:3], v[16:19]
    v_mfma_f32_16x16x32_bf16 v[20:23], a[44:47], a[0:3], v[20:23]
    s_nop 0
    ds_read_b128 a[24:27], v208 offset:11264
    v_mfma_f32_16x16x32_bf16 v[24:27], a[48:51], a[0:3], v[24:27]
    buffer_load_dwordx4 v217, s[8:11], s36 offen offset:0 lds
    ds_read_b128 a[28:31], v208 offset:12288
    v_mfma_f32_16x16x32_bf16 v[28:31], a[52:55], a[0:3], v[28:31]
    buffer_load_dwordx4 v218, s[8:11], s36 offen offset:1024 lds
    v_mfma_f32_16x16x32_bf16 v[32:35], a[56:59], a[0:3], v[32:35]
    ds_read_b128 a[32:35], v208 offset:13312
    v_mfma_f32_16x16x32_bf16 v[36:39], a[60:63], a[0:3], v[36:39]
    buffer_load_dwordx4 v219, s[8:11], s36 offen offset:2048 lds
    ds_read_b128 a[36:39], v208 offset:14336
    v_mfma_f32_16x16x32_bf16 v[40:43], a[64:67], a[0:3], v[40:43]
    buffer_load_dwordx4 v220, s[8:11], s36 offen offset:3072 lds
    v_mfma_f32_16x16x32_bf16 v[44:47], a[68:71], a[0:3], v[44:47]
    ds_read_b64_tr_b16 a[72:73], v209 offset:16384
    s_add_u32 m0, s39, 4096
    v_mfma_f32_16x16x32_bf16 v[48:51], a[40:43], a[4:7], v[48:51]
    ds_read_b64_tr_b16 a[74:75], v209 offset:17408
    v_mfma_f32_16x16x32_bf16 v[52:55], a[44:47], a[4:7], v[52:55]
    s_nop 0
    v_mfma_f32_16x16x32_bf16 v[56:59], a[48:51], a[4:7], v[56:59]
    buffer_load_dwordx4 v221, s[8:11], s36 offen lds
    ds_read_b64_tr_b16 a[76:77], v210 offset:16384
    v_mfma_f32_16x16x32_bf16 v[60:63], a[52:55], a[4:7], v[60:63]
    s_add_u32 m0, s40, 0
    ds_read_b64_tr_b16 a[78:79], v210 offset:17408
    v_mfma_f32_16x16x32_bf16 v[64:67], a[56:59], a[4:7], v[64:67]
    v_mfma_f32_16x16x32_bf16 v[68:71], a[60:63], a[4:7], v[68:71]
    s_nop 0
    ds_read_b64_tr_b16 a[80:81], v211 offset:16384
    v_mfma_f32_16x16x32_bf16 v[72:75], a[64:67], a[4:7], v[72:75]
    buffer_load_dwordx4 v222, s[12:15], s37 offen offset:0 lds
    v_mfma_f32_16x16x32_bf16 v[76:79], a[68:71], a[4:7], v[76:79]
    ds_read_b64_tr_b16 a[82:83], v211 offset:17408
    buffer_load_dwordx4 v223, s[12:15], s37 offen offset:1024 lds
    v_mfma_f32_16x16x32_bf16 v[80:83], a[40:43], a[8:11], v[80:83]
    ds_read_b64_tr_b16 a[84:85], v212 offset:16384
    v_mfma_f32_16x16x32_bf16 v[84:87], a[44:47], a[8:11], v[84:87]
    buffer_load_dwordx4 v224, s[12:15], s37 offen offset:2048 lds
    v_mfma_f32_16x16x32_bf16 v[88:91], a[48:51], a[8:11], v[88:91]
    ds_read_b64_tr_b16 a[86:87], v212 offset:17408
    buffer_load_dwordx4 v225, s[12:15], s37 offen offset:3072 lds
    v_mfma_f32_16x16x32_bf16 v[92:95], a[52:55], a[8:11], v[92:95]
    ds_read_b64_tr_b16 a[88:89], v213 offset:16384
    s_add_u32 m0, s40, 4096
    v_mfma_f32_16x16x32_bf16 v[96:99], a[56:59], a[8:11], v[96:99]
    v_mfma_f32_16x16x32_bf16 v[100:103], a[60:63], a[8:11], v[100:103]
    s_nop 0
    ds_read_b64_tr_b16 a[90:91], v213 offset:17408
    v_mfma_f32_16x16x32_bf16 v[104:107], a[64:67], a[8:11], v[104:107]
    buffer_load_dwordx4 v226, s[12:15], s37 offen offset:0 lds
    ds_read_b64_tr_b16 a[92:93], v214 offset:16384
    v_mfma_f32_16x16x32_bf16 v[108:111], a[68:71], a[8:11], v[108:111]
    buffer_load_dwordx4 v227, s[12:15], s37 offen offset:1024 lds
    v_mfma_f32_16x16x32_bf16 v[112:115], a[40:43], a[12:15], v[112:115]
    ds_read_b64_tr_b16 a[94:95], v214 offset:17408
    v_mfma_f32_16x16x32_bf16 v[116:119], a[44:47], a[12:15], v[116:119]
    buffer_load_dwordx4 v228, s[12:15], s37 offen offset:2048 lds
    ds_read_b64_tr_b16 a[96:97], v215 offset:16384
    v_mfma_f32_16x16x32_bf16 v[120:123], a[48:51], a[12:15], v[120:123]
    buffer_load_dwordx4 v229, s[12:15], s37 offen offset:3072 lds
    v_mfma_f32_16x16x32_bf16 v[124:127], a[52:55], a[12:15], v[124:127]
    ds_read_b64_tr_b16 a[98:99], v215 offset:17408
    s_add_u32 s38, s38, 1
    v_mfma_f32_16x16x32_bf16 v[128:131], a[56:59], a[12:15], v[128:131]
    ds_read_b64_tr_b16 a[100:101], v216 offset:16384
    v_mfma_f32_16x16x32_bf16 v[132:135], a[60:63], a[12:15], v[132:135]
    s_add_u32 s51, s51, 1
    v_mfma_f32_16x16x32_bf16 v[136:139], a[64:67], a[12:15], v[136:139]
    ds_read_b64_tr_b16 a[102:103], v216 offset:17408
    s_cmp_eq_u32 s51, 18
    v_mfma_f32_16x16x32_bf16 v[140:143], a[68:71], a[12:15], v[140:143]
    s_cselect_b32 s51, 0, s51
    v_mfma_f32_16x16x32_bf16 v[144:147], a[40:43], a[16:19], v[144:147]
    v_mfma_f32_16x16x32_bf16 v[148:151], a[44:47], a[16:19], v[148:151]
    s_lshl_b32 s36, s51, 6
    v_mfma_f32_16x16x32_bf16 v[152:155], a[48:51], a[16:19], v[152:155]
    s_lshl_b32 s37, s51, 18
    v_mfma_f32_16x16x32_bf16 v[156:159], a[52:55], a[16:19], v[156:159]
    s_cmp_lt_u32 s38, 18
    v_mfma_f32_16x16x32_bf16 v[160:163], a[56:59], a[16:19], v[160:163]
    v_mfma_f32_16x16x32_bf16 v[164:167], a[60:63], a[16:19], v[164:167]
    s_cselect_b32 s10, 184320, 0
    v_mfma_f32_16x16x32_bf16 v[168:171], a[64:67], a[16:19], v[168:171]
    s_cselect_b32 s14, s56, 0
    v_mfma_f32_16x16x32_bf16 v[172:175], a[68:71], a[16:19], v[172:175]
    s_waitcnt vmcnt(13) lgkmcnt(0)
    s_barrier
    s_add_u32 m0, s39, 10240
    ds_read_b128 a[0:3], v208 offset:20480
    v_mfma_f32_16x16x32_bf16 v[16:19], a[72:75], a[20:23], v[16:19]
    v_mfma_f32_16x16x32_bf16 v[20:23], a[76:79], a[20:23], v[20:23]
    s_nop 0
    ds_read_b128 a[4:7], v208 offset:21504
    v_mfma_f32_16x16x32_bf16 v[24:27], a[80:83], a[20:23], v[24:27]
    buffer_load_dwordx4 v217, s[8:11], s36 offen offset:0 lds
    ds_read_b128 a[8:11], v208 offset:22528
    v_mfma_f32_16x16x32_bf16 v[28:31], a[84:87], a[20:23], v[28:31]
    buffer_load_dwordx4 v218, s[8:11], s36 offen offset:1024 lds
    v_mfma_f32_16x16x32_bf16 v[32:35], a[88:91], a[20:23], v[32:35]
    ds_read_b128 a[12:15], v208 offset:23552
    v_mfma_f32_16x16x32_bf16 v[36:39], a[92:95], a[20:23], v[36:39]
    buffer_load_dwordx4 v219, s[8:11], s36 offen offset:2048 lds
    ds_read_b128 a[16:19], v208 offset:24576
    v_mfma_f32_16x16x32_bf16 v[40:43], a[96:99], a[20:23], v[40:43]
    buffer_load_dwordx4 v220, s[8:11], s36 offen offset:3072 lds
    v_mfma_f32_16x16x32_bf16 v[44:47], a[100:103], a[20:23], v[44:47]
    ds_read_b64_tr_b16 a[40:41], v209 offset:32768
    s_add_u32 m0, s39, 14336
    v_mfma_f32_16x16x32_bf16 v[48:51], a[72:75], a[24:27], v[48:51]
    ds_read_b64_tr_b16 a[42:43], v209 offset:33792
    v_mfma_f32_16x16x32_bf16 v[52:55], a[76:79], a[24:27], v[52:55]
    s_nop 0
    v_mfma_f32_16x16x32_bf16 v[56:59], a[80:83], a[24:27], v[56:59]
    buffer_load_dwordx4 v221, s[8:11], s36 offen lds
    ds_read_b64_tr_b16 a[44:45], v210 offset:32768
    v_mfma_f32_16x16x32_bf16 v[60:63], a[84:87], a[24:27], v[60:63]
    s_add_u32 m0, s40, 16384
    ds_read_b64_tr_b16 a[46:47], v210 offset:33792
    v_mfma_f32_16x16x32_bf16 v[64:67], a[88:91], a[24:27], v[64:67]
    v_mfma_f32_16x16x32_bf16 v[68:71], a[92:95], a[24:27], v[68:71]
    s_nop 0
    ds_read_b64_tr_b16 a[48:49], v211 offset:32768
    v_mfma_f32_16x16x32_bf16 v[72:75], a[96:99], a[24:27], v[72:75]
    buffer_load_dwordx4 v222, s[12:15], s37 offen offset:0 lds
    v_mfma_f32_16x16x32_bf16 v[76:79], a[100:103], a[24:27], v[76:79]
    ds_read_b64_tr_b16 a[50:51], v211 offset:33792
    buffer_load_dwordx4 v223, s[12:15], s37 offen offset:1024 lds
    v_mfma_f32_16x16x32_bf16 v[80:83], a[72:75], a[28:31], v[80:83]
    ds_read_b64_tr_b16 a[52:53], v212 offset:32768
    v_mfma_f32_16x16x32_bf16 v[84:87], a[76:79], a[28:31], v[84:87]
    buffer_load_dwordx4 v224, s[12:15], s37 offen offset:2048 lds
    v_mfma_f32_16x16x32_bf16 v[88:91], a[80:83], a[28:31], v[88:91]
    ds_read_b64_tr_b16 a[54:55], v212 offset:33792
    buffer_load_dwordx4 v225, s[12:15], s37 offen offset:3072 lds
    v_mfma_f32_16x16x32_bf16 v[92:95], a[84:87], a[28:31], v[92:95]
    ds_read_b64_tr_b16 a[56:57], v213 offset:32768
    s_add_u32 m0, s40, 20480
    v_mfma_f32_16x16x32_bf16 v[96:99], a[88:91], a[28:31], v[96:99]
    v_mfma_f32_16x16x32_bf16 v[100:103], a[92:95], a[28:31], v[100:103]
    s_nop 0
    ds_read_b64_tr_b16 a[58:59], v213 offset:33792
    v_mfma_f32_16x16x32_bf16 v[104:107], a[96:99], a[28:31], v[104:107]
    buffer_load_dwordx4 v226, s[12:15], s37 offen offset:0 lds
    ds_read_b64_tr_b16 a[60:61], v214 offset:32768
    v_mfma_f32_16x16x32_bf16 v[108:111], a[100:103], a[28:31], v[108:111]
    buffer_load_dwordx4 v227, s[12:15], s37 offen offset:1024 lds
    v_mfma_f32_16x16x32_bf16 v[112:115], a[72:75], a[32:35], v[112:115]
    ds_read_b64_tr_b16 a[62:63], v214 offset:33792
    v_mfma_f32_16x16x32_bf16 v[116:119], a[76:79], a[32:35], v[116:119]
    buffer_load_dwordx4 v228, s[12:15], s37 offen offset:2048 lds
    ds_read_b64_tr_b16 a[64:65], v215 offset:32768
    v_mfma_f32_16x16x32_bf16 v[120:123], a[80:83], a[32:35], v[120:123]
    buffer_load_dwordx4 v229, s[12:15], s37 offen offset:3072 lds
    v_mfma_f32_16x16x32_bf16 v[124:127], a[84:87], a[32:35], v[124:127]
    ds_read_b64_tr_b16 a[66:67], v215 offset:33792
    s_add_u32 s38, s38, 1
    v_mfma_f32_16x16x32_bf16 v[128:131], a[88:91], a[32:35], v[128:131]
    ds_read_b64_tr_b16 a[68:69], v216 offset:32768
    v_mfma_f32_16x16x32_bf16 v[132:135], a[92:95], a[32:35], v[132:135]
    s_add_u32 s51, s51, 1
    v_mfma_f32_16x16x32_bf16 v[136:139], a[96:99], a[32:35], v[136:139]
    ds_read_b64_tr_b16 a[70:71], v216 offset:33792
    s_cmp_eq_u32 s51, 18
    v_mfma_f32_16x16x32_bf16 v[140:143], a[100:103], a[32:35], v[140:143]
    s_cselect_b32 s51, 0, s51
    v_mfma_f32_16x16x32_bf16 v[144:147], a[72:75], a[36:39], v[144:147]
    v_mfma_f32_16x16x32_bf16 v[148:151], a[76:79], a[36:39], v[148:151]
    s_lshl_b32 s36, s51, 6
    v_mfma_f32_16x16x32_bf16 v[152:155], a[80:83], a[36:39], v[152:155]
    s_lshl_b32 s37, s51, 18
    v_mfma_f32_16x16x32_bf16 v[156:159], a[84:87], a[36:39], v[156:159]
    s_cmp_lt_u32 s38, 18
    v_mfma_f32_16x16x32_bf16 v[160:163], a[88:91], a[36:39], v[160:163]
    v_mfma_f32_16x16x32_bf16 v[164:167], a[92:95], a[36:39], v[164:167]
    s_cselect_b32 s10, 184320, 0
    v_mfma_f32_16x16x32_bf16 v[168:171], a[96:99], a[36:39], v[168:171]
    s_cselect_b32 s14, s56, 0
    v_mfma_f32_16x16x32_bf16 v[172:175], a[100:103], a[36:39], v[172:175]
    s_waitcnt vmcnt(13) lgkmcnt(0)
    s_barrier
    s_add_u32 m0, s39, 20480
    ds_read_b128 a[20:23], v208 offset:0
    v_mfma_f32_16x16x32_bf16 v[16:19], a[40:43], a[0:3], v[16:19]
    v_mfma_f32_16x16x32_bf16 v[20:23], a[44:47], a[0:3], v[20:23]
    s_nop 0
    ds_read_b128 a[24:27], v208 offset:1024
    v_mfma_f32_16x16x32_bf16 v[24:27], a[48:51], a[0:3], v[24:27]
    buffer_load_dwordx4 v217, s[8:11], s36 offen offset:0 lds
    ds_read_b128 a[28:31], v208 offset:2048
    v_mfma_f32_16x16x32_bf16 v[28:31], a[52:55], a[0:3], v[28:31]
    buffer_load_dwordx4 v218, s[8:11], s36 offen offset:1024 lds
    v_mfma_f32_16x16x32_bf16 v[32:35], a[56:59], a[0:3], v[32:35]
    ds_read_b128 a[32:35], v208 offset:3072
    v_mfma_f32_16x16x32_bf16 v[36:39], a[60:63], a[0:3], v[36:39]
    buffer_load_dwordx4 v219, s[8:11], s36 offen offset:2048 lds
    ds_read_b128 a[36:39], v208 offset:4096
    v_mfma_f32_16x16x32_bf16 v[40:43], a[64:67], a[0:3], v[40:43]
    buffer_load_dwordx4 v220, s[8:11], s36 offen offset:3072 lds
    v_mfma_f32_16x16x32_bf16 v[44:47], a[68:71], a[0:3], v[44:47]
    ds_read_b64_tr_b16 a[72:73], v209 offset:0
    s_add_u32 m0, s39, 24576
    v_mfma_f32_16x16x32_bf16 v[48:51], a[40:43], a[4:7], v[48:51]
    ds_read_b64_tr_b16 a[74:75], v209 offset:1024
    v_mfma_f32_16x16x32_bf16 v[52:55], a[44:47], a[4:7], v[52:55]
    s_nop 0
    v_mfma_f32_16x16x32_bf16 v[56:59], a[48:51], a[4:7], v[56:59]
    buffer_load_dwordx4 v221, s[8:11], s36 offen lds
    ds_read_b64_tr_b16 a[76:77], v210 offset:0
    v_mfma_f32_16x16x32_bf16 v[60:63], a[52:55], a[4:7], v[60:63]
    s_add_u32 m0, s40, 32768
    ds_read_b64_tr_b16 a[78:79], v210 offset:1024
    v_mfma_f32_16x16x32_bf16 v[64:67], a[56:59], a[4:7], v[64:67]
    v_mfma_f32_16x16x32_bf16 v[68:71], a[60:63], a[4:7], v[68:71]
    s_nop 0
    ds_read_b64_tr_b16 a[80:81], v211 offset:0
    v_mfma_f32_16x16x32_bf16 v[72:75], a[64:67], a[4:7], v[72:75]
    buffer_load_dwordx4 v222, s[12:15], s37 offen offset:0 lds
    v_mfma_f32_16x16x32_bf16 v[76:79], a[68:71], a[4:7], v[76:79]
    ds_read_b64_tr_b16 a[82:83], v211 offset:1024
    buffer_load_dwordx4 v223, s[12:15], s37 offen offset:1024 lds
    v_mfma_f32_16x16x32_bf16 v[80:83], a[40:43], a[8:11], v[80:83]
    ds_read_b64_tr_b16 a[84:85], v212 offset:0
    v_mfma_f32_16x16x32_bf16 v[84:87], a[44:47], a[8:11], v[84:87]
    buffer_load_dwordx4 v224, s[12:15], s37 offen offset:2048 lds
    v_mfma_f32_16x16x32_bf16 v[88:91], a[48:51], a[8:11], v[88:91]
    ds_read_b64_tr_b16 a[86:87], v212 offset:1024
    buffer_load_dwordx4 v225, s[12:15], s37 offen offset:3072 lds
    v_mfma_f32_16x16x32_bf16 v[92:95], a[52:55], a[8:11], v[92:95]
    ds_read_b64_tr_b16 a[88:89], v213 offset:0
    s_add_u32 m0, s40, 36864
    v_mfma_f32_16x16x32_bf16 v[96:99], a[56:59], a[8:11], v[96:99]
    v_mfma_f32_16x16x32_bf16 v[100:103], a[60:63], a[8:11], v[100:103]
    s_nop 0
    ds_read_b64_tr_b16 a[90:91], v213 offset:1024
    v_mfma_f32_16x16x32_bf16 v[104:107], a[64:67], a[8:11], v[104:107]
    buffer_load_dwordx4 v226, s[12:15], s37 offen offset:0 lds
    ds_read_b64_tr_b16 a[92:93], v214 offset:0
    v_mfma_f32_16x16x32_bf16 v[108:111], a[68:71], a[8:11], v[108:111]
    buffer_load_dwordx4 v227, s[12:15], s37 offen offset:1024 lds
    v_mfma_f32_16x16x32_bf16 v[112:115], a[40:43], a[12:15], v[112:115]
    ds_read_b64_tr_b16 a[94:95], v214 offset:1024
    v_mfma_f32_16x16x32_bf16 v[116:119], a[44:47], a[12:15], v[116:119]
    buffer_load_dwordx4 v228, s[12:15], s37 offen offset:2048 lds
    ds_read_b64_tr_b16 a[96:97], v215 offset:0
    v_mfma_f32_16x16x32_bf16 v[120:123], a[48:51], a[12:15], v[120:123]
    buffer_load_dwordx4 v229, s[12:15], s37 offen offset:3072 lds
    v_mfma_f32_16x16x32_bf16 v[124:127], a[52:55], a[12:15], v[124:127]
    ds_read_b64_tr_b16 a[98:99], v215 offset:1024
    s_add_u32 s38, s38, 1
    v_mfma_f32_16x16x32_bf16 v[128:131], a[56:59], a[12:15], v[128:131]
    ds_read_b64_tr_b16 a[100:101], v216 offset:0
    v_mfma_f32_16x16x32_bf16 v[132:135], a[60:63], a[12:15], v[132:135]
    s_add_u32 s51, s51, 1
    v_mfma_f32_16x16x32_bf16 v[136:139], a[64:67], a[12:15], v[136:139]
    ds_read_b64_tr_b16 a[102:103], v216 offset:1024
    s_cmp_eq_u32 s51, 18
    v_mfma_f32_16x16x32_bf16 v[140:143], a[68:71], a[12:15], v[140:143]
    s_cselect_b32 s51, 0, s51
    v_mfma_f32_16x16x32_bf16 v[144:147], a[40:43], a[16:19], v[144:147]
    v_mfma_f32_16x16x32_bf16 v[148:151], a[44:47], a[16:19], v[148:151]
    s_lshl_b32 s36, s51, 6
    v_mfma_f32_16x16x32_bf16 v[152:155], a[48:51], a[16:19], v[152:155]
    s_lshl_b32 s37, s51, 18
    v_mfma_f32_16x16x32_bf16 v[156:159], a[52:55], a[16:19], v[156:159]
    s_cmp_lt_u32 s38, 18
    v_mfma_f32_16x16x32_bf16 v[160:163], a[56:59], a[16:19], v[160:163]
    v_mfma_f32_16x16x32_bf16 v[164:167], a[60:63], a[16:19], v[164:167]
    s_cselect_b32 s10, 184320, 0
    v_mfma_f32_16x16x32_bf16 v[168:171], a[64:67], a[16:19], v[168:171]
    s_cselect_b32 s14, s56, 0
    v_mfma_f32_16x16x32_bf16 v[172:175], a[68:71], a[16:19], v[172:175]
    s_waitcnt vmcnt(13) lgkmcnt(0)
    s_barrier
    s_add_u32 m0, s39, 0
    ds_read_b128 a[0:3], v208 offset:10240
    v_mfma_f32_16x16x32_bf16 v[16:19], a[72:75], a[20:23], v[16:19]
    v_mfma_f32_16x16x32_bf16 v[20:23], a[76:79], a[20:23], v[20:23]
    s_nop 0
    ds_read_b128 a[4:7], v208 offset:11264
    v_mfma_f32_16x16x32_bf16 v[24:27], a[80:83], a[20:23], v[24:27]
    buffer_load_dwordx4 v217, s[8:11], s36 offen offset:0 lds
    ds_read_b128 a[8:11], v208 offset:12288
    v_mfma_f32_16x16x32_bf16 v[28:31], a[84:87], a[20:23], v[28:31]
    buffer_load_dwordx4 v218, s[8:11], s36 offen offset:1024 lds
    v_mfma_f32_16x16x32_bf16 v[32:35], a[88:91], a[20:23], v[32:35]
    ds_read_b128 a[12:15], v208 offset:13312
    v_mfma_f32_16x16x32_bf16 v[36:39], a[92:95], a[20:23], v[36:39]
    buffer_load_dwordx4 v219, s[8:11], s36 offen offset:2048 lds
    ds_read_b128 a[16:19], v208 offset:14336
    v_mfma_f32_16x16x32_bf16 v[40:43], a[96:99], a[20:23], v[40:43]
    buffer_load_dwordx4 v220, s[8:11], s36 offen offset:3072 lds
    v_mfma_f32_16x16x32_bf16 v[44:47], a[100:103], a[20:23], v[44:47]
    ds_read_b64_tr_b16 a[40:41], v209 offset:16384
    s_add_u32 m0, s39, 4096
    v_mfma_f32_16x16x32_bf16 v[48:51], a[72:75], a[24:27], v[48:51]
    ds_read_b64_tr_b16 a[42:43], v209 offset:17408
    v_mfma_f32_16x16x32_bf16 v[52:55], a[76:79], a[24:27], v[52:55]
    s_nop 0
    v_mfma_f32_16x16x32_bf16 v[56:59], a[80:83], a[24:27], v[56:59]
    buffer_load_dwordx4 v221, s[8:11], s36 offen lds
    ds_read_b64_tr_b16 a[44:45], v210 offset:16384
    v_mfma_f32_16x16x32_bf16 v[60:63], a[84:87], a[24:27], v[60:63]
    s_add_u32 m0, s40, 0
    ds_read_b64_tr_b16 a[46:47], v210 offset:17408
    v_mfma_f32_16x16x32_bf16 v[64:67], a[88:91], a[24:27], v[64:67]
    v_mfma_f32_16x16x32_bf16 v[68:71], a[92:95], a[24:27], v[68:71]
    s_nop 0
    ds_read_b64_tr_b16 a[48:49], v211 offset:16384
    v_mfma_f32_16x16x32_bf16 v[72:75], a[96:99], a[24:27], v[72:75]
    buffer_load_dwordx4 v222, s[12:15], s37 offen offset:0 lds
    v_mfma_f32_16x16x32_bf16 v[76:79], a[100:103], a[24:27], v[76:79]
    ds_read_b64_tr_b16 a[50:51], v211 offset:17408
    buffer_load_dwordx4 v223, s[12:15], s37 offen offset:1024 lds
    v_mfma_f32_16x16x32_bf16 v[80:83], a[72:75], a[28:31], v[80:83]
    ds_read_b64_tr_b16 a[52:53], v212 offset:16384
    v_mfma_f32_16x16x32_bf16 v[84:87], a[76:79], a[28:31], v[84:87]
    buffer_load_dwordx4 v224, s[12:15], s37 offen offset:2048 lds
    v_mfma_f32_16x16x32_bf16 v[88:91], a[80:83], a[28:31], v[88:91]
    ds_read_b64_tr_b16 a[54:55], v212 offset:17408
    buffer_load_dwordx4 v225, s[12:15], s37 offen offset:3072 lds
    v_mfma_f32_16x16x32_bf16 v[92:95], a[84:87], a[28:31], v[92:95]
    ds_read_b64_tr_b16 a[56:57], v213 offset:16384
    s_add_u32 m0, s40, 4096
    v_mfma_f32_16x16x32_bf16 v[96:99], a[88:91], a[28:31], v[96:99]
    v_mfma_f32_16x16x32_bf16 v[100:103], a[92:95], a[28:31], v[100:103]
    s_nop 0
    ds_read_b64_tr_b16 a[58:59], v213 offset:17408
    v_mfma_f32_16x16x32_bf16 v[104:107], a[96:99], a[28:31], v[104:107]
    buffer_load_dwordx4 v226, s[12:15], s37 offen offset:0 lds
    ds_read_b64_tr_b16 a[60:61], v214 offset:16384
    v_mfma_f32_16x16x32_bf16 v[108:111], a[100:103], a[28:31], v[108:111]
    buffer_load_dwordx4 v227, s[12:15], s37 offen offset:1024 lds
    v_mfma_f32_16x16x32_bf16 v[112:115], a[72:75], a[32:35], v[112:115]
    ds_read_b64_tr_b16 a[62:63], v214 offset:17408
    v_mfma_f32_16x16x32_bf16 v[116:119], a[76:79], a[32:35], v[116:119]
    buffer_load_dwordx4 v228, s[12:15], s37 offen offset:2048 lds
    ds_read_b64_tr_b16 a[64:65], v215 offset:16384
    v_mfma_f32_16x16x32_bf16 v[120:123], a[80:83], a[32:35], v[120:123]
    buffer_load_dwordx4 v229, s[12:15], s37 offen offset:3072 lds
    v_mfma_f32_16x16x32_bf16 v[124:127], a[84:87], a[32:35], v[124:127]
    ds_read_b64_tr_b16 a[66:67], v215 offset:17408
    s_add_u32 s38, s38, 1
    v_mfma_f32_16x16x32_bf16 v[128:131], a[88:91], a[32:35], v[128:131]
    ds_read_b64_tr_b16 a[68:69], v216 offset:16384
    v_mfma_f32_16x16x32_bf16 v[132:135], a[92:95], a[32:35], v[132:135]
    s_add_u32 s51, s51, 1
    v_mfma_f32_16x16x32_bf16 v[136:139], a[96:99], a[32:35], v[136:139]
    ds_read_b64_tr_b16 a[70:71], v216 offset:17408
    s_cmp_eq_u32 s51, 18
    v_mfma_f32_16x16x32_bf16 v[140:143], a[100:103], a[32:35], v[140:143]
    s_cselect_b32 s51, 0, s51
    v_mfma_f32_16x16x32_bf16 v[144:147], a[72:75], a[36:39], v[144:147]
    v_mfma_f32_16x16x32_bf16 v[148:151], a[76:79], a[36:39], v[148:151]
    s_lshl_b32 s36, s51, 6
    v_mfma_f32_16x16x32_bf16 v[152:155], a[80:83], a[36:39], v[152:155]
    s_lshl_b32 s37, s51, 18
    v_mfma_f32_16x16x32_bf16 v[156:159], a[84:87], a[36:39], v[156:159]
    s_cmp_lt_u32 s38, 18
    v_mfma_f32_16x16x32_bf16 v[160:163], a[88:91], a[36:39], v[160:163]
    v_mfma_f32_16x16x32_bf16 v[164:167], a[92:95], a[36:39], v[164:167]
    s_cselect_b32 s10, 184320, 0
    v_mfma_f32_16x16x32_bf16 v[168:171], a[96:99], a[36:39], v[168:171]
    s_cselect_b32 s14, s56, 0
    v_mfma_f32_16x16x32_bf16 v[172:175], a[100:103], a[36:39], v[172:175]
    s_waitcnt vmcnt(13) lgkmcnt(0)
    s_barrier
    s_add_u32 m0, s39, 10240
    ds_read_b128 a[20:23], v208 offset:20480
    v_mfma_f32_16x16x32_bf16 v[16:19], a[40:43], a[0:3], v[16:19]
    v_mfma_f32_16x16x32_bf16 v[20:23], a[44:47], a[0:3], v[20:23]
    s_nop 0
    ds_read_b128 a[24:27], v208 offset:21504
    v_mfma_f32_16x16x32_bf16 v[24:27], a[48:51], a[0:3], v[24:27]
    buffer_load_dwordx4 v217, s[8:11], s36 offen offset:0 lds
    ds_read_b128 a[28:31], v208 offset:22528
    v_mfma_f32_16x16x32_bf16 v[28:31], a[52:55], a[0:3], v[28:31]
    buffer_load_dwordx4 v218, s[8:11], s36 offen offset:1024 lds
    v_mfma_f32_16x16x32_bf16 v[32:35], a[56:59], a[0:3], v[32:35]
    ds_read_b128 a[32:35], v208 offset:23552
    v_mfma_f32_16x16x32_bf16 v[36:39], a[60:63], a[0:3], v[36:39]
    buffer_load_dwordx4 v219, s[8:11], s36 offen offset:2048 lds
    ds_read_b128 a[36:39], v208 offset:24576
    v_mfma_f32_16x16x32_bf16 v[40:43], a[64:67], a[0:3], v[40:43]
    buffer_load_dwordx4 v220, s[8:11], s36 offen offset:3072 lds
    v_mfma_f32_16x16x32_bf16 v[44:47], a[68:71], a[0:3], v[44:47]
    ds_read_b64_tr_b16 a[72:73], v209 offset:32768
    s_add_u32 m0, s39, 14336
    v_mfma_f32_16x16x32_bf16 v[48:51], a[40:43], a[4:7], v[48:51]
    ds_read_b64_tr_b16 a[74:75], v209 offset:33792
    v_mfma_f32_16x16x32_bf16 v[52:55], a[44:47], a[4:7], v[52:55]
    s_nop 0
    v_mfma_f32_16x16x32_bf16 v[56:59], a[48:51], a[4:7], v[56:59]
    buffer_load_dwordx4 v221, s[8:11], s36 offen lds
    ds_read_b64_tr_b16 a[76:77], v210 offset:32768
    v_mfma_f32_16x16x32_bf16 v[60:63], a[52:55], a[4:7], v[60:63]
    s_add_u32 m0, s40, 16384
    ds_read_b64_tr_b16 a[78:79], v210 offset:33792
    v_mfma_f32_16x16x32_bf16 v[64:67], a[56:59], a[4:7], v[64:67]
    v_mfma_f32_16x16x32_bf16 v[68:71], a[60:63], a[4:7], v[68:71]
    s_nop 0
    ds_read_b64_tr_b16 a[80:81], v211 offset:32768
    v_mfma_f32_16x16x32_bf16 v[72:75], a[64:67], a[4:7], v[72:75]
    buffer_load_dwordx4 v222, s[12:15], s37 offen offset:0 lds
    v_mfma_f32_16x16x32_bf16 v[76:79], a[68:71], a[4:7], v[76:79]
    ds_read_b64_tr_b16 a[82:83], v211 offset:33792
    buffer_load_dwordx4 v223, s[12:15], s37 offen offset:1024 lds
    v_mfma_f32_16x16x32_bf16 v[80:83], a[40:43], a[8:11], v[80:83]
    ds_read_b64_tr_b16 a[84:85], v212 offset:32768
    v_mfma_f32_16x16x32_bf16 v[84:87], a[44:47], a[8:11], v[84:87]
    buffer_load_dwordx4 v224, s[12:15], s37 offen offset:2048 lds
    v_mfma_f32_16x16x32_bf16 v[88:91], a[48:51], a[8:11], v[88:91]
    ds_read_b64_tr_b16 a[86:87], v212 offset:33792
    buffer_load_dwordx4 v225, s[12:15], s37 offen offset:3072 lds
    v_mfma_f32_16x16x32_bf16 v[92:95], a[52:55], a[8:11], v[92:95]
    ds_read_b64_tr_b16 a[88:89], v213 offset:32768
    s_add_u32 m0, s40, 20480
    v_mfma_f32_16x16x32_bf16 v[96:99], a[56:59], a[8:11], v[96:99]
    v_mfma_f32_16x16x32_bf16 v[100:103], a[60:63], a[8:11], v[100:103]
    s_nop 0
    ds_read_b64_tr_b16 a[90:91], v213 offset:33792
    v_mfma_f32_16x16x32_bf16 v[104:107], a[64:67], a[8:11], v[104:107]
    buffer_load_dwordx4 v226, s[12:15], s37 offen offset:0 lds
    ds_read_b64_tr_b16 a[92:93], v214 offset:32768
    v_mfma_f32_16x16x32_bf16 v[108:111], a[68:71], a[8:11], v[108:111]
    buffer_load_dwordx4 v227, s[12:15], s37 offen offset:1024 lds
    v_mfma_f32_16x16x32_bf16 v[112:115], a[40:43], a[12:15], v[112:115]
    ds_read_b64_tr_b16 a[94:95], v214 offset:33792
    v_mfma_f32_16x16x32_bf16 v[116:119], a[44:47], a[12:15], v[116:119]
    buffer_load_dwordx4 v228, s[12:15], s37 offen offset:2048 lds
    ds_read_b64_tr_b16 a[96:97], v215 offset:32768
    v_mfma_f32_16x16x32_bf16 v[120:123], a[48:51], a[12:15], v[120:123]
    buffer_load_dwordx4 v229, s[12:15], s37 offen offset:3072 lds
    v_mfma_f32_16x16x32_bf16 v[124:127], a[52:55], a[12:15], v[124:127]
    ds_read_b64_tr_b16 a[98:99], v215 offset:33792
    s_add_u32 s38, s38, 1
    v_mfma_f32_16x16x32_bf16 v[128:131], a[56:59], a[12:15], v[128:131]
    ds_read_b64_tr_b16 a[100:101], v216 offset:32768
    v_mfma_f32_16x16x32_bf16 v[132:135], a[60:63], a[12:15], v[132:135]
    s_add_u32 s51, s51, 1
    v_mfma_f32_16x16x32_bf16 v[136:139], a[64:67], a[12:15], v[136:139]
    ds_read_b64_tr_b16 a[102:103], v216 offset:33792
    s_cmp_eq_u32 s51, 18
    v_mfma_f32_16x16x32_bf16 v[140:143], a[68:71], a[12:15], v[140:143]
    s_cselect_b32 s51, 0, s51
    v_mfma_f32_16x16x32_bf16 v[144:147], a[40:43], a[16:19], v[144:147]
    v_mfma_f32_16x16x32_bf16 v[148:151], a[44:47], a[16:19], v[148:151]
    s_lshl_b32 s36, s51, 6
    v_mfma_f32_16x16x32_bf16 v[152:155], a[48:51], a[16:19], v[152:155]
    s_lshl_b32 s37, s51, 18
    v_mfma_f32_16x16x32_bf16 v[156:159], a[52:55], a[16:19], v[156:159]
    s_cmp_lt_u32 s38, 18
    v_mfma_f32_16x16x32_bf16 v[160:163], a[56:59], a[16:19], v[160:163]
    v_mfma_f32_16x16x32_bf16 v[164:167], a[60:63], a[16:19], v[164:167]
    s_cselect_b32 s10, 184320, 0
    v_mfma_f32_16x16x32_bf16 v[168:171], a[64:67], a[16:19], v[168:171]
    s_cselect_b32 s14, s56, 0
    v_mfma_f32_16x16x32_bf16 v[172:175], a[68:71], a[16:19], v[172:175]
    s_waitcnt vmcnt(13) lgkmcnt(0)
    s_barrier
    s_add_u32 m0, s39, 20480
    ds_read_b128 a[0:3], v208 offset:0
    v_mfma_f32_16x16x32_bf16 v[16:19], a[72:75], a[20:23], v[16:19]
    v_mfma_f32_16x16x32_bf16 v[20:23], a[76:79], a[20:23], v[20:23]
    s_nop 0
    ds_read_b128 a[4:7], v208 offset:1024
    v_mfma_f32_16x16x32_bf16 v[24:27], a[80:83], a[20:23], v[24:27]
    buffer_load_dwordx4 v217, s[8:11], s36 offen offset:0 lds
    ds_read_b128 a[8:11], v208 offset:2048
    v_mfma_f32_16x16x32_bf16 v[28:31], a[84:87], a[20:23], v[28:31]
    buffer_load_dwordx4 v218, s[8:11], s36 offen offset:1024 lds
    v_mfma_f32_16x16x32_bf16 v[32:35], a[88:91], a[20:23], v[32:35]
    ds_read_b128 a[12:15], v208 offset:3072
    v_mfma_f32_16x16x32_bf16 v[36:39], a[92:95], a[20:23], v[36:39]
    buffer_load_dwordx4 v219, s[8:11], s36 offen offset:2048 lds
    ds_read_b128 a[16:19], v208 offset:4096
    v_mfma_f32_16x16x32_bf16 v[40:43], a[96:99], a[20:23], v[40:43]
    buffer_load_dwordx4 v220, s[8:11], s36 offen offset:3072 lds
    v_mfma_f32_16x16x32_bf16 v[44:47], a[100:103], a[20:23], v[44:47]
    ds_read_b64_tr_b16 a[40:41], v209 offset:0
    s_add_u32 m0, s39, 24576
    v_mfma_f32_16x16x32_bf16 v[48:51], a[72:75], a[24:27], v[48:51]
    ds_read_b64_tr_b16 a[42:43], v209 offset:1024
    v_mfma_f32_16x16x32_bf16 v[52:55], a[76:79], a[24:27], v[52:55]
    s_nop 0
    v_mfma_f32_16x16x32_bf16 v[56:59], a[80:83], a[24:27], v[56:59]
    buffer_load_dwordx4 v221, s[8:11], s36 offen lds
    ds_read_b64_tr_b16 a[44:45], v210 offset:0
    v_mfma_f32_16x16x32_bf16 v[60:63], a[84:87], a[24:27], v[60:63]
    s_add_u32 m0, s40, 32768
    ds_read_b64_tr_b16 a[46:47], v210 offset:1024
    v_mfma_f32_16x16x32_bf16 v[64:67], a[88:91], a[24:27], v[64:67]
    v_mfma_f32_16x16x32_bf16 v[68:71], a[92:95], a[24:27], v[68:71]
    s_nop 0
    ds_read_b64_tr_b16 a[48:49], v211 offset:0
    v_mfma_f32_16x16x32_bf16 v[72:75], a[96:99], a[24:27], v[72:75]
    buffer_load_dwordx4 v222, s[12:15], s37 offen offset:0 lds
    v_mfma_f32_16x16x32_bf16 v[76:79], a[100:103], a[24:27], v[76:79]
    ds_read_b64_tr_b16 a[50:51], v211 offset:1024
    buffer_load_dwordx4 v223, s[12:15], s37 offen offset:1024 lds
    v_mfma_f32_16x16x32_bf16 v[80:83], a[72:75], a[28:31], v[80:83]
    ds_read_b64_tr_b16 a[52:53], v212 offset:0
    v_mfma_f32_16x16x32_bf16 v[84:87], a[76:79], a[28:31], v[84:87]
    buffer_load_dwordx4 v224, s[12:15], s37 offen offset:2048 lds
    v_mfma_f32_16x16x32_bf16 v[88:91], a[80:83], a[28:31], v[88:91]
    ds_read_b64_tr_b16 a[54:55], v212 offset:1024
    buffer_load_dwordx4 v225, s[12:15], s37 offen offset:3072 lds
    v_mfma_f32_16x16x32_bf16 v[92:95], a[84:87], a[28:31], v[92:95]
    ds_read_b64_tr_b16 a[56:57], v213 offset:0
    s_add_u32 m0, s40, 36864
    v_mfma_f32_16x16x32_bf16 v[96:99], a[88:91], a[28:31], v[96:99]
    v_mfma_f32_16x16x32_bf16 v[100:103], a[92:95], a[28:31], v[100:103]
    s_nop 0
    ds_read_b64_tr_b16 a[58:59], v213 offset:1024
    v_mfma_f32_16x16x32_bf16 v[104:107], a[96:99], a[28:31], v[104:107]
    buffer_load_dwordx4 v226, s[12:15], s37 offen offset:0 lds
    ds_read_b64_tr_b16 a[60:61], v214 offset:0
    v_mfma_f32_16x16x32_bf16 v[108:111], a[100:103], a[28:31], v[108:111]
    buffer_load_dwordx4 v227, s[12:15], s37 offen offset:1024 lds
    v_mfma_f32_16x16x32_bf16 v[112:115], a[72:75], a[32:35], v[112:115]
    ds_read_b64_tr_b16 a[62:63], v214 offset:1024
    v_mfma_f32_16x16x32_bf16 v[116:119], a[76:79], a[32:35], v[116:119]
    buffer_load_dwordx4 v228, s[12:15], s37 offen offset:2048 lds
    ds_read_b64_tr_b16 a[64:65], v215 offset:0
    v_mfma_f32_16x16x32_bf16 v[120:123], a[80:83], a[32:35], v[120:123]
    buffer_load_dwordx4 v229, s[12:15], s37 offen offset:3072 lds
    v_mfma_f32_16x16x32_bf16 v[124:127], a[84:87], a[32:35], v[124:127]
    ds_read_b64_tr_b16 a[66:67], v215 offset:1024
    s_add_u32 s38, s38, 1
    v_mfma_f32_16x16x32_bf16 v[128:131], a[88:91], a[32:35], v[128:131]
    ds_read_b64_tr_b16 a[68:69], v216 offset:0
    v_mfma_f32_16x16x32_bf16 v[132:135], a[92:95], a[32:35], v[132:135]
    s_add_u32 s51, s51, 1
    v_mfma_f32_16x16x32_bf16 v[136:139], a[96:99], a[32:35], v[136:139]
    ds_read_b64_tr_b16 a[70:71], v216 offset:1024
    s_cmp_eq_u32 s51, 18
    v_mfma_f32_16x16x32_bf16 v[140:143], a[100:103], a[32:35], v[140:143]
    s_cselect_b32 s51, 0, s51
    v_mfma_f32_16x16x32_bf16 v[144:147], a[72:75], a[36:39], v[144:147]
    v_mfma_f32_16x16x32_bf16 v[148:151], a[76:79], a[36:39], v[148:151]
    s_lshl_b32 s36, s51, 6
    v_mfma_f32_16x16x32_bf16 v[152:155], a[80:83], a[36:39], v[152:155]
    s_lshl_b32 s37, s51, 18
    v_mfma_f32_16x16x32_bf16 v[156:159], a[84:87], a[36:39], v[156:159]
    s_cmp_lt_u32 s38, 18
    v_mfma_f32_16x16x32_bf16 v[160:163], a[88:91], a[36:39], v[160:163]
    v_mfma_f32_16x16x32_bf16 v[164:167], a[92:95], a[36:39], v[164:167]
    s_cselect_b32 s10, 184320, 0
    v_mfma_f32_16x16x32_bf16 v[168:171], a[96:99], a[36:39], v[168:171]
    s_cselect_b32 s14, s56, 0
    v_mfma_f32_16x16x32_bf16 v[172:175], a[100:103], a[36:39], v[172:175]
    s_add_u32 s41, s41, 1
    s_cmp_lt_u32 s41, 3
    s_cbranch_scc1 K1_QL0
    s_branch K1_QEPI
K1_PB:
    s_barrier
    ds_read_b128 a[0:3], v208 offset:0
    ds_read_b128 a[4:7], v208 offset:1024
    ds_read_b128 a[8:11], v208 offset:2048
    ds_read_b128 a[12:15], v208 offset:3072
    ds_read_b128 a[16:19], v208 offset:4096
    ds_read_b64_tr_b16 a[40:41], v209 offset:0
    ds_read_b64_tr_b16 a[42:43], v209 offset:1024
    ds_read_b64_tr_b16 a[44:45], v210 offset:0
    ds_read_b64_tr_b16 a[46:47], v210 offset:1024
    ds_read_b64_tr_b16 a[48:49], v211 offset:0
    ds_read_b64_tr_b16 a[50:51], v211 offset:1024
    ds_read_b64_tr_b16 a[52:53], v212 offset:0
    ds_read_b64_tr_b16 a[54:55], v212 offset:1024
    ds_read_b64_tr_b16 a[56:57], v213 offset:0
    ds_read_b64_tr_b16 a[58:59], v213 offset:1024
    ds_read_b64_tr_b16 a[60:61], v214 offset:0
    ds_read_b64_tr_b16 a[62:63], v214 offset:1024
    ds_read_b64_tr_b16 a[64:65], v215 offset:0
    ds_read_b64_tr_b16 a[66:67], v215 offset:1024
    ds_read_b64_tr_b16 a[68:69], v216 offset:0
    ds_read_b64_tr_b16 a[70:71], v216 offset:1024
    s_mov_b32 s41, 0
K1_QL1:
    s_waitcnt lgkmcnt(0)
    s_barrier
    ds_read_b128 a[20:23], v208 offset:10240
    v_mfma_f32_16x16x32_bf16 v[16:19], a[40:43], a[0:3], v[16:19]
    v_mfma_f32_16x16x32_bf16 v[20:23], a[44:47], a[0:3], v[20:23]
    ds_read_b128 a[24:27], v208 offset:11264
    v_mfma_f32_16x16x32_bf16 v[24:27], a[48:51], a[0:3], v[24:27]
    ds_read_b128 a[28:31], v208 offset:12288
    v_mfma_f32_16x16x32_bf16 v[28:31], a[52:55], a[0:3], v[28:31]
    v_mfma_f32_16x16x32_bf16 v[32:35], a[56:59], a[0:3], v[32:35]
    ds_read_b128 a[32:35], v208 offset:13312
    v_mfma_f32_16x16x32_bf16 v[36:39], a[60:63], a[0:3], v[36:39]
    ds_read_b128 a[36:39], v208 offset:14336
    v_mfma_f32_16x16x32_bf16 v[40:43], a[64:67], a[0:3], v[40:43]
    v_mfma_f32_16x16x32_bf16 v[44:47], a[68:71], a[0:3], v[44:47]
    ds_read_b64_tr_b16 a[72:73], v209 offset:16384
    v_mfma_f32_16x16x32_bf16 v[48:51], a[40:43], a[4:7], v[48:51]
    ds_read_b64_tr_b16 a[74:75], v209 offset:17408
    v_mfma_f32_16x16x32_bf16 v[52:55], a[44:47], a[4:7], v[52:55]
    v_mfma_f32_16x16x32_bf16 v[56:59], a[48:51], a[4:7], v[56:59]
    ds_read_b64_tr_b16 a[76:77], v210 offset:16384
    v_mfma_f32_16x16x32_bf16 v[60:63], a[52:55], a[4:7], v[60:63]
    ds_read_b64_tr_b16 a[78:79], v210 offset:17408
    v_mfma_f32_16x16x32_bf16 v[64:67], a[56:59], a[4:7], v[64:67]
    v_mfma_f32_16x16x32_bf16 v[68:71], a[60:63], a[4:7], v[68:71]
    ds_read_b64_tr_b16 a[80:81], v211 offset:16384
    v_mfma_f32_16x16x32_bf16 v[72:75], a[64:67], a[4:7], v[72:75]
    v_mfma_f32_16x16x32_bf16 v[76:79], a[68:71], a[4:7], v[76:79]
    ds_read_b64_tr_b16 a[82:83], v211 offset:17408
    v_mfma_f32_16x16x32_bf16 v[80:83], a[40:43], a[8:11], v[80:83]
    ds_read_b64_tr_b16 a[84:85], v212 offset:16384
    v_mfma_f32_16x16x32_bf16 v[84:87], a[44:47], a[8:11], v[84:87]
    v_mfma_f32_16x16x32_bf16 v[88:91], a[48:51], a[8:11], v[88:91]
    ds_read_b64_tr_b16 a[86:87], v212 offset:17408
    v_mfma_f32_16x16x32_bf16 v[92:95], a[52:55], a[8:11], v[92:95]
    ds_read_b64_tr_b16 a[88:89], v213 offset:16384
    v_mfma_f32_16x16x32_bf16 v[96:99], a[56:59], a[8:11], v[96:99]
    v_mfma_f32_16x16x32_bf16 v[100:103], a[60:63], a[8:11], v[100:103]
    ds_read_b64_tr_b16 a[90:91], v213 offset:17408
    v_mfma_f32_16x16x32_bf16 v[104:107], a[64:67], a[8:11], v[104:107]
    ds_read_b64_tr_b16 a[92:93], v214 offset:16384
    v_mfma_f32_16x16x32_bf16 v[108:111], a[68:71], a[8:11], v[108:111]
    v_mfma_f32_16x16x32_bf16 v[112:115], a[40:43], a[12:15], v[112:115]
    ds_read_b64_tr_b16 a[94:95], v214 offset:17408
    v_mfma_f32_16x16x32_bf16 v[116:119], a[44:47], a[12:15], v[116:119]
    ds_read_b64_tr_b16 a[96:97], v215 offset:16384
    v_mfma_f32_16x16x32_bf16 v[120:123], a[48:51], a[12:15], v[120:123]
    v_mfma_f32_16x16x32_bf16 v[124:127], a[52:55], a[12:15], v[124:127]
    ds_read_b64_tr_b16 a[98:99], v215 offset:17408
    v_mfma_f32_16x16x32_bf16 v[128:131], a[56:59], a[12:15], v[128:131]
    ds_read_b64_tr_b16 a[100:101], v216 offset:16384
    v_mfma_f32_16x16x32_bf16 v[132:135], a[60:63], a[12:15], v[132:135]
    v_mfma_f32_16x16x32_bf16 v[136:139], a[64:67], a[12:15], v[136:139]
    ds_read_b64_tr_b16 a[102:103], v216 offset:17408
    v_mfma_f32_16x16x32_bf16 v[140:143], a[68:71], a[12:15], v[140:143]
    v_mfma_f32_16x16x32_bf16 v[144:147], a[40:43], a[16:19], v[144:147]
    v_mfma_f32_16x16x32_bf16 v[148:151], a[44:47], a[16:19], v[148:151]
    v_mfma_f32_16x16x32_bf16 v[152:155], a[48:51], a[16:19], v[152:155]
    v_mfma_f32_16x16x32_bf16 v[156:159], a[52:55], a[16:19], v[156:159]
    v_mfma_f32_16x16x32_bf16 v[160:163], a[56:59], a[16:19], v[160:163]
    v_mfma_f32_16x16x32_bf16 v[164:167], a[60:63], a[16:19], v[164:167]
    v_mfma_f32_16x16x32_bf16 v[168:171], a[64:67], a[16:19], v[168:171]
    v_mfma_f32_16x16x32_bf16 v[172:175], a[68:71], a[16:19], v[172:175]
    s_waitcnt lgkmcnt(0)
    s_barrier
    ds_read_b128 a[0:3], v208 offset:20480
    v_mfma_f32_16x16x32_bf16 v[16:19], a[72:75], a[20:23], v[16:19]
    v_mfma_f32_16x16x32_bf16 v[20:23], a[76:79], a[20:23], v[20:23]
    ds_read_b128 a[4:7], v208 offset:21504
    v_mfma_f32_16x16x32_bf16 v[24:27], a[80:83], a[20:23], v[24:27]
    ds_read_b128 a[8:11], v208 offset:22528
    v_mfma_f32_16x16x32_bf16 v[28:31], a[84:87], a[20:23], v[28:31]
    v_mfma_f32_16x16x32_bf16 v[32:35], a[88:91], a[20:23], v[32:35]
    ds_read_b128 a[12:15], v208 offset:23552
    v_mfma_f32_16x16x32_bf16 v[36:39], a[92:95], a[20:23], v[36:39]
    ds_read_b128 a[16:19], v208 offset:24576
    v_mfma_f32_16x16x32_bf16 v[40:43], a[96:99], a[20:23], v[40:43]
    v_mfma_f32_16x16x32_bf16 v[44:47], a[100:103], a[20:23], v[44:47]
    ds_read_b64_tr_b16 a[40:41], v209 offset:32768
    v_mfma_f32_16x16x32_bf16 v[48:51], a[72:75], a[24:27], v[48:51]
    ds_read_b64_tr_b16 a[42:43], v209 offset:33792
    v_mfma_f32_16x16x32_bf16 v[52:55], a[76:79], a[24:27], v[52:55]
    v_mfma_f32_16x16x32_bf16 v[56:59], a[80:83], a[24:27], v[56:59]
    ds_read_b64_tr_b16 a[44:45], v210 offset:32768
    v_mfma_f32_16x16x32_bf16 v[60:63], a[84:87], a[24:27], v[60:63]
    ds_read_b64_tr_b16 a[46:47], v210 offset:33792
    v_mfma_f32_16x16x32_bf16 v[64:67], a[88:91], a[24:27], v[64:67]
    v_mfma_f32_16x16x32_bf16 v[68:71], a[92:95], a[24:27], v[68:71]
    ds_read_b64_tr_b16 a[48:49], v211 offset:32768
    v_mfma_f32_16x16x32_bf16 v[72:75], a[96:99], a[24:27], v[72:75]
    v_mfma_f32_16x16x32_bf16 v[76:79], a[100:103], a[24:27], v[76:79]
    ds_read_b64_tr_b16 a[50:51], v211 offset:33792
    v_mfma_f32_16x16x32_bf16 v[80:83], a[72:75], a[28:31], v[80:83]
    ds_read_b64_tr_b16 a[52:53], v212 offset:32768
    v_mfma_f32_16x16x32_bf16 v[84:87], a[76:79], a[28:31], v[84:87]
    v_mfma_f32_16x16x32_bf16 v[88:91], a[80:83], a[28:31], v[88:91]
    ds_read_b64_tr_b16 a[54:55], v212 offset:33792
    v_mfma_f32_16x16x32_bf16 v[92:95], a[84:87], a[28:31], v[92:95]
    ds_read_b64_tr_b16 a[56:57], v213 offset:32768
    v_mfma_f32_16x16x32_bf16 v[96:99], a[88:91], a[28:31], v[96:99]
    v_mfma_f32_16x16x32_bf16 v[100:103], a[92:95], a[28:31], v[100:103]
    ds_read_b64_tr_b16 a[58:59], v213 offset:33792
    v_mfma_f32_16x16x32_bf16 v[104:107], a[96:99], a[28:31], v[104:107]
    ds_read_b64_tr_b16 a[60:61], v214 offset:32768
    v_mfma_f32_16x16x32_bf16 v[108:111], a[100:103], a[28:31], v[108:111]
    v_mfma_f32_16x16x32_bf16 v[112:115], a[72:75], a[32:35], v[112:115]
    ds_read_b64_tr_b16 a[62:63], v214 offset:33792
    v_mfma_f32_16x16x32_bf16 v[116:119], a[76:79], a[32:35], v[116:119]
    ds_read_b64_tr_b16 a[64:65], v215 offset:32768
    v_mfma_f32_16x16x32_bf16 v[120:123], a[80:83], a[32:35], v[120:123]
    v_mfma_f32_16x16x32_bf16 v[124:127], a[84:87], a[32:35], v[124:127]
    ds_read_b64_tr_b16 a[66:67], v215 offset:33792
    v_mfma_f32_16x16x32_bf16 v[128:131], a[88:91], a[32:35], v[128:131]
    ds_read_b64_tr_b16 a[68:69], v216 offset:32768
    v_mfma_f32_16x16x32_bf16 v[132:135], a[92:95], a[32:35], v[132:135]
    v_mfma_f32_16x16x32_bf16 v[136:139], a[96:99], a[32:35], v[136:139]
    ds_read_b64_tr_b16 a[70:71], v216 offset:33792
    v_mfma_f32_16x16x32_bf16 v[140:143], a[100:103], a[32:35], v[140:143]
    v_mfma_f32_16x16x32_bf16 v[144:147], a[72:75], a[36:39], v[144:147]
    v_mfma_f32_16x16x32_bf16 v[148:151], a[76:79], a[36:39], v[148:151]
    v_mfma_f32_16x16x32_bf16 v[152:155], a[80:83], a[36:39], v[152:155]
    v_mfma_f32_16x16x32_bf16 v[156:159], a[84:87], a[36:39], v[156:159]
    v_mfma_f32_16x16x32_bf16 v[160:163], a[88:91], a[36:39], v[160:163]
    v_mfma_f32_16x16x32_bf16 v[164:167], a[92:95], a[36:39], v[164:167]
    v_mfma_f32_16x16x32_bf16 v[168:171], a[96:99], a[36:39], v[168:171]
    v_mfma_f32_16x16x32_bf16 v[172:175], a[100:103], a[36:39], v[172:175]
    s_waitcnt lgkmcnt(0)
    s_barrier
    ds_read_b128 a[20:23], v208 offset:0
    v_mfma_f32_16x16x32_bf16 v[16:19], a[40:43], a[0:3], v[16:19]
    v_mfma_f32_16x16x32_bf16 v[20:23], a[44:47], a[0:3], v[20:23]
    ds_read_b128 a[24:27], v208 offset:1024
    v_mfma_f32_16x16x32_bf16 v[24:27], a[48:51], a[0:3], v[24:27]
    ds_read_b128 a[28:31], v208 offset:2048
    v_mfma_f32_16x16x32_bf16 v[28:31], a[52:55], a[0:3], v[28:31]
    v_mfma_f32_16x16x32_bf16 v[32:35], a[56:59], a[0:3], v[32:35]
    ds_read_b128 a[32:35], v208 offset:3072
    v_mfma_f32_16x16x32_bf16 v[36:39], a[60:63], a[0:3], v[36:39]
    ds_read_b128 a[36:39], v208 offset:4096
    v_mfma_f32_16x16x32_bf16 v[40:43], a[64:67], a[0:3], v[40:43]
    v_mfma_f32_16x16x32_bf16 v[44:47], a[68:71], a[0:3], v[44:47]
    ds_read_b64_tr_b16 a[72:73], v209 offset:0
    v_mfma_f32_16x16x32_bf16 v[48:51], a[40:43], a[4:7], v[48:51]
    ds_read_b64_tr_b16 a[74:75], v209 offset:1024
    v_mfma_f32_16x16x32_bf16 v[52:55], a[44:47], a[4:7], v[52:55]
    v_mfma_f32_16x16x32_bf16 v[56:59], a[48:51], a[4:7], v[56:59]
    ds_read_b64_tr_b16 a[76:77], v210 offset:0
    v_mfma_f32_16x16x32_bf16 v[60:63], a[52:55], a[4:7], v[60:63]
    ds_read_b64_tr_b16 a[78:79], v210 offset:1024
    v_mfma_f32_16x16x32_bf16 v[64:67], a[56:59], a[4:7], v[64:67]
    v_mfma_f32_16x16x32_bf16 v[68:71], a[60:63], a[4:7], v[68:71]
    ds_read_b64_tr_b16 a[80:81], v211 offset:0
    v_mfma_f32_16x16x32_bf16 v[72:75], a[64:67], a[4:7], v[72:75]
    v_mfma_f32_16x16x32_bf16 v[76:79], a[68:71], a[4:7], v[76:79]
    ds_read_b64_tr_b16 a[82:83], v211 offset:1024
    v_mfma_f32_16x16x32_bf16 v[80:83], a[40:43], a[8:11], v[80:83]
    ds_read_b64_tr_b16 a[84:85], v212 offset:0
    v_mfma_f32_16x16x32_bf16 v[84:87], a[44:47], a[8:11], v[84:87]
    v_mfma_f32_16x16x32_bf16 v[88:91], a[48:51], a[8:11], v[88:91]
    ds_read_b64_tr_b16 a[86:87], v212 offset:1024
    v_mfma_f32_16x16x32_bf16 v[92:95], a[52:55], a[8:11], v[92:95]
    ds_read_b64_tr_b16 a[88:89], v213 offset:0
    v_mfma_f32_16x16x32_bf16 v[96:99], a[56:59], a[8:11], v[96:99]
    v_mfma_f32_16x16x32_bf16 v[100:103], a[60:63], a[8:11], v[100:103]
    ds_read_b64_tr_b16 a[90:91], v213 offset:1024
    v_mfma_f32_16x16x32_bf16 v[104:107], a[64:67], a[8:11], v[104:107]
    ds_read_b64_tr_b16 a[92:93], v214 offset:0
    v_mfma_f32_16x16x32_bf16 v[108:111], a[68:71], a[8:11], v[108:111]
    v_mfma_f32_16x16x32_bf16 v[112:115], a[40:43], a[12:15], v[112:115]
    ds_read_b64_tr_b16 a[94:95], v214 offset:1024
    v_mfma_f32_16x16x32_bf16 v[116:119], a[44:47], a[12:15], v[116:119]
    ds_read_b64_tr_b16 a[96:97], v215 offset:0
    v_mfma_f32_16x16x32_bf16 v[120:123], a[48:51], a[12:15], v[120:123]
    v_mfma_f32_16x16x32_bf16 v[124:127], a[52:55], a[12:15], v[124:127]
    ds_read_b64_tr_b16 a[98:99], v215 offset:1024
    v_mfma_f32_16x16x32_bf16 v[128:131], a[56:59], a[12:15], v[128:131]
    ds_read_b64_tr_b16 a[100:101], v216 offset:0
    v_mfma_f32_16x16x32_bf16 v[132:135], a[60:63], a[12:15], v[132:135]
    v_mfma_f32_16x16x32_bf16 v[136:139], a[64:67], a[12:15], v[136:139]
    ds_read_b64_tr_b16 a[102:103], v216 offset:1024
    v_mfma_f32_16x16x32_bf16 v[140:143], a[68:71], a[12:15], v[140:143]
    v_mfma_f32_16x16x32_bf16 v[144:147], a[40:43], a[16:19], v[144:147]
    v_mfma_f32_16x16x32_bf16 v[148:151], a[44:47], a[16:19], v[148:151]
    v_mfma_f32_16x16x32_bf16 v[152:155], a[48:51], a[16:19], v[152:155]
    v_mfma_f32_16x16x32_bf16 v[156:159], a[52:55], a[16:19], v[156:159]
    v_mfma_f32_16x16x32_bf16 v[160:163], a[56:59], a[16:19], v[160:163]
    v_mfma_f32_16x16x32_bf16 v[164:167], a[60:63], a[16:19], v[164:167]
    v_mfma_f32_16x16x32_bf16 v[168:171], a[64:67], a[16:19], v[168:171]
    v_mfma_f32_16x16x32_bf16 v[172:175], a[68:71], a[16:19], v[172:175]
    s_cmp_eq_u32 s41, 2
    s_cbranch_scc0 K1_TR2_2
    s_lshl_b32 s3, s35, 13
    s_add_u32 m0, s3, 0
    s_mov_b32 s4, 0
    buffer_load_dwordx4 v230, s[16:19], s4 offen offset:0 nt lds
    buffer_load_dwordx4 v231, s[16:19], s4 offen offset:1024 nt lds
    buffer_load_dwordx4 v232, s[16:19], s4 offen offset:2048 nt lds
    buffer_load_dwordx4 v233, s[16:19], s4 offen offset:3072 nt lds
    s_lshl_b32 s3, s35, 13
    s_add_u32 m0, s3, 4096
    s_mov_b32 s4, 4096
    buffer_load_dwordx4 v230, s[16:19], s4 offen offset:0 nt lds
    buffer_load_dwordx4 v231, s[16:19], s4 offen offset:1024 nt lds
    buffer_load_dwordx4 v232, s[16:19], s4 offen offset:2048 nt lds
    buffer_load_dwordx4 v233, s[16:19], s4 offen offset:3072 nt lds
K1_TR2_2:
    s_waitcnt lgkmcnt(0)
    s_barrier
    ds_read_b128 a[0:3], v208 offset:10240
    v_mfma_f32_16x16x32_bf16 v[16:19], a[72:75], a[20:23], v[16:19]
    v_mfma_f32_16x16x32_bf16 v[20:23], a[76:79], a[20:23], v[20:23]
    ds_read_b128 a[4:7], v208 offset:11264
    v_mfma_f32_16x16x32_bf16 v[24:27], a[80:83], a[20:23], v[24:27]
    ds_read_b128 a[8:11], v208 offset:12288
    v_mfma_f32_16x16x32_bf16 v[28:31], a[84:87], a[20:23], v[28:31]
    v_mfma_f32_16x16x32_bf16 v[32:35], a[88:91], a[20:23], v[32:35]
    ds_read_b128 a[12:15], v208 offset:13312
    v_mfma_f32_16x16x32_bf16 v[36:39], a[92:95], a[20:23], v[36:39]
    ds_read_b128 a[16:19], v208 offset:14336
    v_mfma_f32_16x16x32_bf16 v[40:43], a[96:99], a[20:23], v[40:43]
    v_mfma_f32_16x16x32_bf16 v[44:47], a[100:103], a[20:23], v[44:47]
    ds_read_b64_tr_b16 a[40:41], v209 offset:16384
    v_mfma_f32_16x16x32_bf16 v[48:51], a[72:75], a[24:27], v[48:51]
    ds_read_b64_tr_b16 a[42:43], v209 offset:17408
    v_mfma_f32_16x16x32_bf16 v[52:55], a[76:79], a[24:27], v[52:55]
    v_mfma_f32_16x16x32_bf16 v[56:59], a[80:83], a[24:27], v[56:59]
    ds_read_b64_tr_b16 a[44:45], v210 offset:16384
    v_mfma_f32_16x16x32_bf16 v[60:63], a[84:87], a[24:27], v[60:63]
    ds_read_b64_tr_b16 a[46:47], v210 offset:17408
    v_mfma_f32_16x16x32_bf16 v[64:67], a[88:91], a[24:27], v[64:67]
    v_mfma_f32_16x16x32_bf16 v[68:71], a[92:95], a[24:27], v[68:71]
    ds_read_b64_tr_b16 a[48:49], v211 offset:16384
    v_mfma_f32_16x16x32_bf16 v[72:75], a[96:99], a[24:27], v[72:75]
    v_mfma_f32_16x16x32_bf16 v[76:79], a[100:103], a[24:27], v[76:79]
    ds_read_b64_tr_b16 a[50:51], v211 offset:17408
    v_mfma_f32_16x16x32_bf16 v[80:83], a[72:75], a[28:31], v[80:83]
    ds_read_b64_tr_b16 a[52:53], v212 offset:16384
    v_mfma_f32_16x16x32_bf16 v[84:87], a[76:79], a[28:31], v[84:87]
    v_mfma_f32_16x16x32_bf16 v[88:91], a[80:83], a[28:31], v[88:91]
    ds_read_b64_tr_b16 a[54:55], v212 offset:17408
    v_mfma_f32_16x16x32_bf16 v[92:95], a[84:87], a[28:31], v[92:95]
    ds_read_b64_tr_b16 a[56:57], v213 offset:16384
    v_mfma_f32_16x16x32_bf16 v[96:99], a[88:91], a[28:31], v[96:99]
    v_mfma_f32_16x16x32_bf16 v[100:103], a[92:95], a[28:31], v[100:103]
    ds_read_b64_tr_b16 a[58:59], v213 offset:17408
    v_mfma_f32_16x16x32_bf16 v[104:107], a[96:99], a[28:31], v[104:107]
    ds_read_b64_tr_b16 a[60:61], v214 offset:16384
    v_mfma_f32_16x16x32_bf16 v[108:111], a[100:103], a[28:31], v[108:111]
    v_mfma_f32_16x16x32_bf16 v[112:115], a[72:75], a[32:35], v[112:115]
    ds_read_b64_tr_b16 a[62:63], v214 offset:17408
    v_mfma_f32_16x16x32_bf16 v[116:119], a[76:79], a[32:35], v[116:119]
    ds_read_b64_tr_b16 a[64:65], v215 offset:16384
    v_mfma_f32_16x16x32_bf16 v[120:123], a[80:83], a[32:35], v[120:123]
    v_mfma_f32_16x16x32_bf16 v[124:127], a[84:87], a[32:35], v[124:127]
    ds_read_b64_tr_b16 a[66:67], v215 offset:17408
    v_mfma_f32_16x16x32_bf16 v[128:131], a[88:91], a[32:35], v[128:131]
    ds_read_b64_tr_b16 a[68:69], v216 offset:16384
    v_mfma_f32_16x16x32_bf16 v[132:135], a[92:95], a[32:35], v[132:135]
    v_mfma_f32_16x16x32_bf16 v[136:139], a[96:99], a[32:35], v[136:139]
    ds_read_b64_tr_b16 a[70:71], v216 offset:17408
    v_mfma_f32_16x16x32_bf16 v[140:143], a[100:103], a[32:35], v[140:143]
    v_mfma_f32_16x16x32_bf16 v[144:147], a[72:75], a[36:39], v[144:147]
    v_mfma_f32_16x16x32_bf16 v[148:151], a[76:79], a[36:39], v[148:151]
    v_mfma_f32_16x16x32_bf16 v[152:155], a[80:83], a[36:39], v[152:155]
    v_mfma_f32_16x16x32_bf16 v[156:159], a[84:87], a[36:39], v[156:159]
    v_mfma_f32_16x16x32_bf16 v[160:163], a[88:91], a[36:39], v[160:163]
    v_mfma_f32_16x16x32_bf16 v[164:167], a[92:95], a[36:39], v[164:167]
    v_mfma_f32_16x16x32_bf16 v[168:171], a[96:99], a[36:39], v[168:171]
    v_mfma_f32_16x16x32_bf16 v[172:175], a[100:103], a[36:39], v[172:175]
    s_cmp_eq_u32 s41, 0
    s_cbranch_scc0 K1_WQ
    s_cmp_eq_u32 s32, 3
    s_cbranch_scc0 K1_NB
    s_or_b32 s64, s64, 1
    v_mov_b32 v4, s64
    v_mov_b32 v5, 0
    v_mov_b32 v6, 0
    v_cmp_eq_u32 vcc, 0, v1
    s_and_saveexec_b64 s[46:47], vcc
    global_atomic_cmpswap v10, v6, v[4:5], s[100:101] sc0 sc1
    s_mov_b64 exec, s[46:47]
K1_NB:
    v_add_u32 v9, 0, v13
    buffer_load_dword v8, v9, s[72:75], 0 offen
    v_add_u32 v9, 8192, v13
    buffer_load_dword v8, v9, s[72:75], 0 offen
    v_add_u32 v9, 16384, v13
    buffer_load_dword v8, v9, s[72:75], 0 offen
    v_add_u32 v9, 24576, v13
    buffer_load_dword v8, v9, s[72:75], 0 offen
    v_add_u32 v9, 32768, v13
    buffer_load_dword v8, v9, s[72:75], 0 offen
K1_WQ:
    s_cmp_eq_u32 s41, 2
    s_cbranch_scc0 K1_TR2_3
    s_lshl_b32 s3, s35, 13
    s_add_u32 m0, s3, 16384
    s_mov_b32 s4, 8192
    buffer_load_dwordx4 v230, s[16:19], s4 offen offset:0 nt lds
    buffer_load_dwordx4 v231, s[16:19], s4 offen offset:1024 nt lds
    buffer_load_dwordx4 v232, s[16:19], s4 offen offset:2048 nt lds
    buffer_load_dwordx4 v233, s[16:19], s4 offen offset:3072 nt lds
    s_lshl_b32 s3, s35, 13
    s_add_u32 m0, s3, 20480
    s_mov_b32 s4, 12288
    buffer_load_dwordx4 v230, s[16:19], s4 offen offset:0 nt lds
    buffer_load_dwordx4 v231, s[16:19], s4 offen offset:1024 nt lds
    buffer_load_dwordx4 v232, s[16:19], s4 offen offset:2048 nt lds
    buffer_load_dwordx4 v233, s[16:19], s4 offen offset:3072 nt lds
K1_TR2_3:
    s_waitcnt lgkmcnt(0)
    s_barrier
    ds_read_b128 a[20:23], v208 offset:20480
    v_mfma_f32_16x16x32_bf16 v[16:19], a[40:43], a[0:3], v[16:19]
    v_mfma_f32_16x16x32_bf16 v[20:23], a[44:47], a[0:3], v[20:23]
    ds_read_b128 a[24:27], v208 offset:21504
    v_mfma_f32_16x16x32_bf16 v[24:27], a[48:51], a[0:3], v[24:27]
    ds_read_b128 a[28:31], v208 offset:22528
    v_mfma_f32_16x16x32_bf16 v[28:31], a[52:55], a[0:3], v[28:31]
    v_mfma_f32_16x16x32_bf16 v[32:35], a[56:59], a[0:3], v[32:35]
    ds_read_b128 a[32:35], v208 offset:23552
    v_mfma_f32_16x16x32_bf16 v[36:39], a[60:63], a[0:3], v[36:39]
    ds_read_b128 a[36:39], v208 offset:24576
    v_mfma_f32_16x16x32_bf16 v[40:43], a[64:67], a[0:3], v[40:43]
    v_mfma_f32_16x16x32_bf16 v[44:47], a[68:71], a[0:3], v[44:47]
    ds_read_b64_tr_b16 a[72:73], v209 offset:32768
    v_mfma_f32_16x16x32_bf16 v[48:51], a[40:43], a[4:7], v[48:51]
    ds_read_b64_tr_b16 a[74:75], v209 offset:33792
    v_mfma_f32_16x16x32_bf16 v[52:55], a[44:47], a[4:7], v[52:55]
    v_mfma_f32_16x16x32_bf16 v[56:59], a[48:51], a[4:7], v[56:59]
    ds_read_b64_tr_b16 a[76:77], v210 offset:32768
    v_mfma_f32_16x16x32_bf16 v[60:63], a[52:55], a[4:7], v[60:63]
    ds_read_b64_tr_b16 a[78:79], v210 offset:33792
    v_mfma_f32_16x16x32_bf16 v[64:67], a[56:59], a[4:7], v[64:67]
    v_mfma_f32_16x16x32_bf16 v[68:71], a[60:63], a[4:7], v[68:71]
    ds_read_b64_tr_b16 a[80:81], v211 offset:32768
    v_mfma_f32_16x16x32_bf16 v[72:75], a[64:67], a[4:7], v[72:75]
    v_mfma_f32_16x16x32_bf16 v[76:79], a[68:71], a[4:7], v[76:79]
    ds_read_b64_tr_b16 a[82:83], v211 offset:33792
    v_mfma_f32_16x16x32_bf16 v[80:83], a[40:43], a[8:11], v[80:83]
    ds_read_b64_tr_b16 a[84:85], v212 offset:32768
    v_mfma_f32_16x16x32_bf16 v[84:87], a[44:47], a[8:11], v[84:87]
    v_mfma_f32_16x16x32_bf16 v[88:91], a[48:51], a[8:11], v[88:91]
    ds_read_b64_tr_b16 a[86:87], v212 offset:33792
    v_mfma_f32_16x16x32_bf16 v[92:95], a[52:55], a[8:11], v[92:95]
    ds_read_b64_tr_b16 a[88:89], v213 offset:32768
    v_mfma_f32_16x16x32_bf16 v[96:99], a[56:59], a[8:11], v[96:99]
    v_mfma_f32_16x16x32_bf16 v[100:103], a[60:63], a[8:11], v[100:103]
    ds_read_b64_tr_b16 a[90:91], v213 offset:33792
    v_mfma_f32_16x16x32_bf16 v[104:107], a[64:67], a[8:11], v[104:107]
    ds_read_b64_tr_b16 a[92:93], v214 offset:32768
    v_mfma_f32_16x16x32_bf16 v[108:111], a[68:71], a[8:11], v[108:111]
    v_mfma_f32_16x16x32_bf16 v[112:115], a[40:43], a[12:15], v[112:115]
    ds_read_b64_tr_b16 a[94:95], v214 offset:33792
    v_mfma_f32_16x16x32_bf16 v[116:119], a[44:47], a[12:15], v[116:119]
    ds_read_b64_tr_b16 a[96:97], v215 offset:32768
    v_mfma_f32_16x16x32_bf16 v[120:123], a[48:51], a[12:15], v[120:123]
    v_mfma_f32_16x16x32_bf16 v[124:127], a[52:55], a[12:15], v[124:127]
    ds_read_b64_tr_b16 a[98:99], v215 offset:33792
    v_mfma_f32_16x16x32_bf16 v[128:131], a[56:59], a[12:15], v[128:131]
    ds_read_b64_tr_b16 a[100:101], v216 offset:32768
    v_mfma_f32_16x16x32_bf16 v[132:135], a[60:63], a[12:15], v[132:135]
    v_mfma_f32_16x16x32_bf16 v[136:139], a[64:67], a[12:15], v[136:139]
    ds_read_b64_tr_b16 a[102:103], v216 offset:33792
    v_mfma_f32_16x16x32_bf16 v[140:143], a[68:71], a[12:15], v[140:143]
    v_mfma_f32_16x16x32_bf16 v[144:147], a[40:43], a[16:19], v[144:147]
    v_mfma_f32_16x16x32_bf16 v[148:151], a[44:47], a[16:19], v[148:151]
    v_mfma_f32_16x16x32_bf16 v[152:155], a[48:51], a[16:19], v[152:155]
    v_mfma_f32_16x16x32_bf16 v[156:159], a[52:55], a[16:19], v[156:159]
    v_mfma_f32_16x16x32_bf16 v[160:163], a[56:59], a[16:19], v[160:163]
    v_mfma_f32_16x16x32_bf16 v[164:167], a[60:63], a[16:19], v[164:167]
    v_mfma_f32_16x16x32_bf16 v[168:171], a[64:67], a[16:19], v[168:171]
    v_mfma_f32_16x16x32_bf16 v[172:175], a[68:71], a[16:19], v[172:175]
    s_cmp_eq_u32 s41, 2
    s_cbranch_scc0 K1_TR2_4
    s_lshl_b32 s3, s35, 13
    s_add_u32 m0, s3, 32768
    s_mov_b32 s4, 16384
    buffer_load_dwordx4 v230, s[16:19], s4 offen offset:0 nt lds
    buffer_load_dwordx4 v231, s[16:19], s4 offen offset:1024 nt lds
    buffer_load_dwordx4 v232, s[16:19], s4 offen offset:2048 nt lds
    buffer_load_dwordx4 v233, s[16:19], s4 offen offset:3072 nt lds
    s_lshl_b32 s3, s35, 13
    s_add_u32 m0, s3, 36864
    s_mov_b32 s4, 20480
    buffer_load_dwordx4 v230, s[16:19], s4 offen offset:0 nt lds
    buffer_load_dwordx4 v231, s[16:19], s4 offen offset:1024 nt lds
    buffer_load_dwordx4 v232, s[16:19], s4 offen offset:2048 nt lds
    buffer_load_dwordx4 v233, s[16:19], s4 offen offset:3072 nt lds
K1_TR2_4:
    s_waitcnt lgkmcnt(0)
    s_barrier
    ds_read_b128 a[0:3], v208 offset:0
    v_mfma_f32_16x16x32_bf16 v[16:19], a[72:75], a[20:23], v[16:19]
    v_mfma_f32_16x16x32_bf16 v[20:23], a[76:79], a[20:23], v[20:23]
    ds_read_b128 a[4:7], v208 offset:1024
    v_mfma_f32_16x16x32_bf16 v[24:27], a[80:83], a[20:23], v[24:27]
    ds_read_b128 a[8:11], v208 offset:2048
    v_mfma_f32_16x16x32_bf16 v[28:31], a[84:87], a[20:23], v[28:31]
    v_mfma_f32_16x16x32_bf16 v[32:35], a[88:91], a[20:23], v[32:35]
    ds_read_b128 a[12:15], v208 offset:3072
    v_mfma_f32_16x16x32_bf16 v[36:39], a[92:95], a[20:23], v[36:39]
    ds_read_b128 a[16:19], v208 offset:4096
    v_mfma_f32_16x16x32_bf16 v[40:43], a[96:99], a[20:23], v[40:43]
    v_mfma_f32_16x16x32_bf16 v[44:47], a[100:103], a[20:23], v[44:47]
    ds_read_b64_tr_b16 a[40:41], v209 offset:0
    v_mfma_f32_16x16x32_bf16 v[48:51], a[72:75], a[24:27], v[48:51]
    ds_read_b64_tr_b16 a[42:43], v209 offset:1024
    v_mfma_f32_16x16x32_bf16 v[52:55], a[76:79], a[24:27], v[52:55]
    v_mfma_f32_16x16x32_bf16 v[56:59], a[80:83], a[24:27], v[56:59]
    ds_read_b64_tr_b16 a[44:45], v210 offset:0
    v_mfma_f32_16x16x32_bf16 v[60:63], a[84:87], a[24:27], v[60:63]
    ds_read_b64_tr_b16 a[46:47], v210 offset:1024
    v_mfma_f32_16x16x32_bf16 v[64:67], a[88:91], a[24:27], v[64:67]
    v_mfma_f32_16x16x32_bf16 v[68:71], a[92:95], a[24:27], v[68:71]
    ds_read_b64_tr_b16 a[48:49], v211 offset:0
    v_mfma_f32_16x16x32_bf16 v[72:75], a[96:99], a[24:27], v[72:75]
    v_mfma_f32_16x16x32_bf16 v[76:79], a[100:103], a[24:27], v[76:79]
    ds_read_b64_tr_b16 a[50:51], v211 offset:1024
    v_mfma_f32_16x16x32_bf16 v[80:83], a[72:75], a[28:31], v[80:83]
    ds_read_b64_tr_b16 a[52:53], v212 offset:0
    v_mfma_f32_16x16x32_bf16 v[84:87], a[76:79], a[28:31], v[84:87]
    v_mfma_f32_16x16x32_bf16 v[88:91], a[80:83], a[28:31], v[88:91]
    ds_read_b64_tr_b16 a[54:55], v212 offset:1024
    v_mfma_f32_16x16x32_bf16 v[92:95], a[84:87], a[28:31], v[92:95]
    ds_read_b64_tr_b16 a[56:57], v213 offset:0
    v_mfma_f32_16x16x32_bf16 v[96:99], a[88:91], a[28:31], v[96:99]
    v_mfma_f32_16x16x32_bf16 v[100:103], a[92:95], a[28:31], v[100:103]
    ds_read_b64_tr_b16 a[58:59], v213 offset:1024
    v_mfma_f32_16x16x32_bf16 v[104:107], a[96:99], a[28:31], v[104:107]
    ds_read_b64_tr_b16 a[60:61], v214 offset:0
    v_mfma_f32_16x16x32_bf16 v[108:111], a[100:103], a[28:31], v[108:111]
    v_mfma_f32_16x16x32_bf16 v[112:115], a[72:75], a[32:35], v[112:115]
    ds_read_b64_tr_b16 a[62:63], v214 offset:1024
    v_mfma_f32_16x16x32_bf16 v[116:119], a[76:79], a[32:35], v[116:119]
    ds_read_b64_tr_b16 a[64:65], v215 offset:0
    v_mfma_f32_16x16x32_bf16 v[120:123], a[80:83], a[32:35], v[120:123]
    v_mfma_f32_16x16x32_bf16 v[124:127], a[84:87], a[32:35], v[124:127]
    ds_read_b64_tr_b16 a[66:67], v215 offset:1024
    v_mfma_f32_16x16x32_bf16 v[128:131], a[88:91], a[32:35], v[128:131]
    ds_read_b64_tr_b16 a[68:69], v216 offset:0
    v_mfma_f32_16x16x32_bf16 v[132:135], a[92:95], a[32:35], v[132:135]
    v_mfma_f32_16x16x32_bf16 v[136:139], a[96:99], a[32:35], v[136:139]
    ds_read_b64_tr_b16 a[70:71], v216 offset:1024
    v_mfma_f32_16x16x32_bf16 v[140:143], a[100:103], a[32:35], v[140:143]
    v_mfma_f32_16x16x32_bf16 v[144:147], a[72:75], a[36:39], v[144:147]
    v_mfma_f32_16x16x32_bf16 v[148:151], a[76:79], a[36:39], v[148:151]
    v_mfma_f32_16x16x32_bf16 v[152:155], a[80:83], a[36:39], v[152:155]
    v_mfma_f32_16x16x32_bf16 v[156:159], a[84:87], a[36:39], v[156:159]
    v_mfma_f32_16x16x32_bf16 v[160:163], a[88:91], a[36:39], v[160:163]
    v_mfma_f32_16x16x32_bf16 v[164:167], a[92:95], a[36:39], v[164:167]
    v_mfma_f32_16x16x32_bf16 v[168:171], a[96:99], a[36:39], v[168:171]
    v_mfma_f32_16x16x32_bf16 v[172:175], a[100:103], a[36:39], v[172:175]
    s_cmp_eq_u32 s41, 2
    s_cbranch_scc0 K1_TR2_5
    s_lshl_b32 s3, s35, 13
    s_add_u32 m0, s3, 49152
    s_mov_b32 s4, 24576
    buffer_load_dwordx4 v230, s[16:19], s4 offen offset:0 nt lds
    buffer_load_dwordx4 v231, s[16:19], s4 offen offset:1024 nt lds
    buffer_load_dwordx4 v232, s[16:19], s4 offen offset:2048 nt lds
    buffer_load_dwordx4 v233, s[16:19], s4 offen offset:3072 nt lds
    s_lshl_b32 s3, s35, 13
    s_add_u32 m0, s3, 53248
    s_mov_b32 s4, 28672
    buffer_load_dwordx4 v230, s[16:19], s4 offen offset:0 nt lds
    buffer_load_dwordx4 v231, s[16:19], s4 offen offset:1024 nt lds
    buffer_load_dwordx4 v232, s[16:19], s4 offen offset:2048 nt lds
    buffer_load_dwordx4 v233, s[16:19], s4 offen offset:3072 nt lds
K1_TR2_5:
    s_add_u32 s41, s41, 1
    s_cmp_lt_u32 s41, 3
    s_cbranch_scc1 K1_QL1
K1_QEPI:
    s_cmp_lt_u32 s32, 2
    s_cbranch_scc1 K1_NOPF
    s_lshl_b32 s3, s35, 13
    s_add_u32 m0, s3, 65536
    s_mov_b32 s4, 0
    buffer_load_dwordx4 v234, s[20:23], s4 offen offset:0 nt lds
    buffer_load_dwordx4 v235, s[20:23], s4 offen offset:1024 nt lds
    buffer_load_dwordx4 v234, s[20:23], s4 offen offset:2048 nt lds
    buffer_load_dwordx4 v235, s[20:23], s4 offen offset:3072 nt lds
    s_lshl_b32 s3, s35, 13
    s_add_u32 m0, s3, 69632
    s_mov_b32 s4, 4096
    buffer_load_dwordx4 v234, s[20:23], s4 offen offset:0 nt lds
    buffer_load_dwordx4 v235, s[20:23], s4 offen offset:1024 nt lds
    buffer_load_dwordx4 v234, s[20:23], s4 offen offset:2048 nt lds
    buffer_load_dwordx4 v235, s[20:23], s4 offen offset:3072 nt lds
K1_NOPF:
    s_waitcnt vmcnt(24) lgkmcnt(0)
    s_add_u32 s58, s54, 62914560
    s_addc_u32 s59, s55, 0
    s_barrier
    ds_read_b128 v[176:179], v240 offset:0
    ds_read_b128 v[180:183], v241 offset:0
    ds_read_b128 v[184:187], v242 offset:0
    ds_read_b128 v[188:191], v243 offset:0
    ds_read_b128 v[192:195], v240 offset:4096
    ds_read_b128 v[196:199], v241 offset:4096
    ds_read_b128 v[200:203], v242 offset:4096
    ds_read_b128 v[204:207], v243 offset:4096
    s_nop 4
    v_pk_mul_f32 v[16:17], v[16:17], s[48:49]
    v_pk_mul_f32 v[24:25], v[24:25], s[48:49]
    v_pk_mul_f32 v[32:33], v[32:33], s[48:49]
    v_pk_mul_f32 v[40:41], v[40:41], s[48:49]
    v_pk_mul_f32 v[18:19], v[18:19], s[48:49]
    v_pk_mul_f32 v[26:27], v[26:27], s[48:49]
    v_pk_mul_f32 v[34:35], v[34:35], s[48:49]
    v_pk_mul_f32 v[42:43], v[42:43], s[48:49]
    v_pk_mul_f32 v[20:21], v[20:21], s[48:49]
    v_pk_mul_f32 v[28:29], v[28:29], s[48:49]
    v_pk_mul_f32 v[36:37], v[36:37], s[48:49]
    v_pk_mul_f32 v[44:45], v[44:45], s[48:49]
    v_pk_mul_f32 v[22:23], v[22:23], s[48:49]
    v_pk_mul_f32 v[30:31], v[30:31], s[48:49]
    v_pk_mul_f32 v[38:39], v[38:39], s[48:49]
    v_pk_mul_f32 v[46:47], v[46:47], s[48:49]
    v_cvt_pk_bf16_f32 v16, v16, v17
    v_cvt_pk_bf16_f32 v24, v24, v25
    v_cvt_pk_bf16_f32 v32, v32, v33
    v_cvt_pk_bf16_f32 v40, v40, v41
    v_cvt_pk_bf16_f32 v17, v18, v19
    v_cvt_pk_bf16_f32 v25, v26, v27
    v_cvt_pk_bf16_f32 v33, v34, v35
    v_cvt_pk_bf16_f32 v41, v42, v43
    v_cvt_pk_bf16_f32 v20, v20, v21
    v_cvt_pk_bf16_f32 v28, v28, v29
    v_cvt_pk_bf16_f32 v36, v36, v37
    v_cvt_pk_bf16_f32 v44, v44, v45
    v_cvt_pk_bf16_f32 v21, v22, v23
    v_cvt_pk_bf16_f32 v29, v30, v31
    v_cvt_pk_bf16_f32 v37, v38, v39
    v_cvt_pk_bf16_f32 v45, v46, v47
    v_permlane32_swap_b32 v16, v20
    v_permlane32_swap_b32 v24, v28
    v_permlane32_swap_b32 v32, v36
    v_permlane32_swap_b32 v40, v44
    v_permlane32_swap_b32 v17, v21
    v_permlane32_swap_b32 v25, v29
    v_permlane32_swap_b32 v33, v37
    v_permlane32_swap_b32 v41, v45
    v_permlane16_swap_b32 v16, v20
    v_permlane16_swap_b32 v24, v28
    v_permlane16_swap_b32 v32, v36
    v_permlane16_swap_b32 v40, v44
    v_permlane16_swap_b32 v17, v21
    v_permlane16_swap_b32 v25, v29
    v_permlane16_swap_b32 v33, v37
    v_permlane16_swap_b32 v41, v45
    v_accvgpr_write_b32 a160, v16
    v_accvgpr_write_b32 a180, v24
    v_accvgpr_write_b32 a200, v32
    v_accvgpr_write_b32 a220, v40
    v_accvgpr_write_b32 a161, v17
    v_accvgpr_write_b32 a181, v25
    v_accvgpr_write_b32 a201, v33
    v_accvgpr_write_b32 a221, v41
    v_accvgpr_write_b32 a162, v20
    v_accvgpr_write_b32 a182, v28
    v_accvgpr_write_b32 a202, v36
    v_accvgpr_write_b32 a222, v44
    v_accvgpr_write_b32 a163, v21
    v_accvgpr_write_b32 a183, v29
    v_accvgpr_write_b32 a203, v37
    v_accvgpr_write_b32 a223, v45
    s_waitcnt lgkmcnt(0)
    v_pk_mul_f32 v[48:49], v[48:49], s[48:49]
    s_nop 1
    v_pk_mul_f32 v[56:57], v[56:57], s[48:49]
    v_pk_mul_f32 v[64:65], v[64:65], s[48:49]
    v_pk_mul_f32 v[72:73], v[72:73], s[48:49]
    v_pk_mul_f32 v[50:51], v[50:51], s[48:49]
    v_pk_mul_f32 v[58:59], v[58:59], s[48:49]
    v_pk_mul_f32 v[66:67], v[66:67], s[48:49]
    v_pk_mul_f32 v[74:75], v[74:75], s[48:49]
    v_pk_mul_f32 v[52:53], v[52:53], s[48:49]
    v_mfma_f32_16x16x32_bf16 v[16:19], v[176:179], a[160:163], 0
    v_pk_mul_f32 v[60:61], v[60:61], s[48:49]
    v_pk_mul_f32 v[68:69], v[68:69], s[48:49]
    v_pk_mul_f32 v[76:77], v[76:77], s[48:49]
    v_pk_mul_f32 v[54:55], v[54:55], s[48:49]
    v_pk_mul_f32 v[62:63], v[62:63], s[48:49]
    v_pk_mul_f32 v[70:71], v[70:71], s[48:49]
    v_pk_mul_f32 v[78:79], v[78:79], s[48:49]
    v_cvt_pk_bf16_f32 v48, v48, v49
    v_mfma_f32_16x16x32_bf16 v[16:19], v[180:183], a[180:183], v[16:19]
    v_cvt_pk_bf16_f32 v56, v56, v57
    v_cvt_pk_bf16_f32 v64, v64, v65
    v_cvt_pk_bf16_f32 v72, v72, v73
    v_cvt_pk_bf16_f32 v49, v50, v51
    v_cvt_pk_bf16_f32 v57, v58, v59
    v_cvt_pk_bf16_f32 v65, v66, v67
    v_cvt_pk_bf16_f32 v73, v74, v75
    v_mfma_f32_16x16x32_bf16 v[16:19], v[184:187], a[200:203], v[16:19]
    v_cvt_pk_bf16_f32 v52, v52, v53
    v_cvt_pk_bf16_f32 v60, v60, v61
    v_cvt_pk_bf16_f32 v68, v68, v69
    v_cvt_pk_bf16_f32 v76, v76, v77
    v_cvt_pk_bf16_f32 v53, v54, v55
    v_cvt_pk_bf16_f32 v61, v62, v63
    v_cvt_pk_bf16_f32 v69, v70, v71
    v_cvt_pk_bf16_f32 v77, v78, v79
    v_mfma_f32_16x16x32_bf16 v[16:19], v[188:191], a[220:223], v[16:19]
    v_permlane32_swap_b32 v48, v52
    v_permlane32_swap_b32 v56, v60
    v_permlane32_swap_b32 v64, v68
    v_permlane32_swap_b32 v72, v76
    v_permlane32_swap_b32 v49, v53
    v_permlane32_swap_b32 v57, v61
    v_permlane32_swap_b32 v65, v69
    v_permlane32_swap_b32 v73, v77
    v_mfma_f32_16x16x32_bf16 v[20:23], v[192:195], a[160:163], 0
    v_permlane16_swap_b32 v48, v52
    v_permlane16_swap_b32 v56, v60
    v_permlane16_swap_b32 v64, v68
    v_permlane16_swap_b32 v72, v76
    v_permlane16_swap_b32 v49, v53
    v_permlane16_swap_b32 v57, v61
    v_permlane16_swap_b32 v65, v69
    v_permlane16_swap_b32 v73, v77
    v_mfma_f32_16x16x32_bf16 v[20:23], v[196:199], a[180:183], v[20:23]
    v_accvgpr_write_b32 a164, v48
    v_accvgpr_write_b32 a184, v56
    v_accvgpr_write_b32 a204, v64
    v_accvgpr_write_b32 a224, v72
    v_accvgpr_write_b32 a165, v49
    v_accvgpr_write_b32 a185, v57
    v_accvgpr_write_b32 a205, v65
    v_accvgpr_write_b32 a225, v73
    v_mfma_f32_16x16x32_bf16 v[20:23], v[200:203], a[200:203], v[20:23]
    v_accvgpr_write_b32 a166, v52
    v_accvgpr_write_b32 a186, v60
    v_accvgpr_write_b32 a206, v68
    v_accvgpr_write_b32 a226, v76
    v_accvgpr_write_b32 a167, v53
    v_accvgpr_write_b32 a187, v61
    v_accvgpr_write_b32 a207, v69
    v_accvgpr_write_b32 a227, v77
    v_mfma_f32_16x16x32_bf16 v[20:23], v[204:207], a[220:223], v[20:23]
    v_pk_mul_f32 v[80:81], v[80:81], s[48:49]
    s_nop 1
    v_pk_mul_f32 v[88:89], v[88:89], s[48:49]
    v_pk_mul_f32 v[96:97], v[96:97], s[48:49]
    v_pk_mul_f32 v[104:105], v[104:105], s[48:49]
    v_pk_mul_f32 v[82:83], v[82:83], s[48:49]
    v_pk_mul_f32 v[90:91], v[90:91], s[48:49]
    v_pk_mul_f32 v[98:99], v[98:99], s[48:49]
    v_pk_mul_f32 v[106:107], v[106:107], s[48:49]
    v_pk_mul_f32 v[84:85], v[84:85], s[48:49]
    v_mfma_f32_16x16x32_bf16 v[24:27], v[176:179], a[164:167], 0
    v_pk_mul_f32 v[92:93], v[92:93], s[48:49]
    v_pk_mul_f32 v[100:101], v[100:101], s[48:49]
    v_pk_mul_f32 v[108:109], v[108:109], s[48:49]
    v_pk_mul_f32 v[86:87], v[86:87], s[48:49]
    v_pk_mul_f32 v[94:95], v[94:95], s[48:49]
    v_pk_mul_f32 v[102:103], v[102:103], s[48:49]
    v_pk_mul_f32 v[110:111], v[110:111], s[48:49]
    v_cvt_pk_bf16_f32 v80, v80, v81
    v_mfma_f32_16x16x32_bf16 v[24:27], v[180:183], a[184:187], v[24:27]
    v_cvt_pk_bf16_f32 v88, v88, v89
    v_cvt_pk_bf16_f32 v96, v96, v97
    v_cvt_pk_bf16_f32 v104, v104, v105
    v_cvt_pk_bf16_f32 v81, v82, v83
    v_cvt_pk_bf16_f32 v89, v90, v91
    v_cvt_pk_bf16_f32 v97, v98, v99
    v_cvt_pk_bf16_f32 v105, v106, v107
    v_mfma_f32_16x16x32_bf16 v[24:27], v[184:187], a[204:207], v[24:27]
    v_cvt_pk_bf16_f32 v84, v84, v85
    v_cvt_pk_bf16_f32 v92, v92, v93
    v_cvt_pk_bf16_f32 v100, v100, v101
    v_cvt_pk_bf16_f32 v108, v108, v109
    v_cvt_pk_bf16_f32 v85, v86, v87
    v_cvt_pk_bf16_f32 v93, v94, v95
    v_cvt_pk_bf16_f32 v101, v102, v103
    v_cvt_pk_bf16_f32 v109, v110, v111
    v_mfma_f32_16x16x32_bf16 v[24:27], v[188:191], a[224:227], v[24:27]
    v_permlane32_swap_b32 v80, v84
    v_permlane32_swap_b32 v88, v92
    v_permlane32_swap_b32 v96, v100
    v_permlane32_swap_b32 v104, v108
    v_permlane32_swap_b32 v81, v85
    v_permlane32_swap_b32 v89, v93
    v_permlane32_swap_b32 v97, v101
    v_permlane32_swap_b32 v105, v109
    v_mfma_f32_16x16x32_bf16 v[28:31], v[192:195], a[164:167], 0
    v_permlane16_swap_b32 v80, v84
    v_permlane16_swap_b32 v88, v92
    v_permlane16_swap_b32 v96, v100
    v_permlane16_swap_b32 v104, v108
    v_permlane16_swap_b32 v81, v85
    v_permlane16_swap_b32 v89, v93
    v_permlane16_swap_b32 v97, v101
    v_permlane16_swap_b32 v105, v109
    v_mfma_f32_16x16x32_bf16 v[28:31], v[196:199], a[184:187], v[28:31]
    v_accvgpr_write_b32 a168, v80
    v_accvgpr_write_b32 a188, v88
    v_accvgpr_write_b32 a208, v96
    v_accvgpr_write_b32 a228, v104
    v_accvgpr_write_b32 a169, v81
    v_accvgpr_write_b32 a189, v89
    v_accvgpr_write_b32 a209, v97
    v_accvgpr_write_b32 a229, v105
    v_mfma_f32_16x16x32_bf16 v[28:31], v[200:203], a[204:207], v[28:31]
    v_accvgpr_write_b32 a170, v84
    v_accvgpr_write_b32 a190, v92
    v_accvgpr_write_b32 a210, v100
    v_accvgpr_write_b32 a230, v108
    v_accvgpr_write_b32 a171, v85
    v_accvgpr_write_b32 a191, v93
    v_accvgpr_write_b32 a211, v101
    v_accvgpr_write_b32 a231, v109
    v_mfma_f32_16x16x32_bf16 v[28:31], v[204:207], a[224:227], v[28:31]
    v_pk_mul_f32 v[112:113], v[112:113], s[48:49]
    s_nop 1
    v_pk_mul_f32 v[120:121], v[120:121], s[48:49]
    v_pk_mul_f32 v[128:129], v[128:129], s[48:49]
    v_pk_mul_f32 v[136:137], v[136:137], s[48:49]
    v_pk_mul_f32 v[114:115], v[114:115], s[48:49]
    v_pk_mul_f32 v[122:123], v[122:123], s[48:49]
    v_pk_mul_f32 v[130:131], v[130:131], s[48:49]
    v_pk_mul_f32 v[138:139], v[138:139], s[48:49]
    v_pk_mul_f32 v[116:117], v[116:117], s[48:49]
    v_mfma_f32_16x16x32_bf16 v[32:35], v[176:179], a[168:171], 0
    v_pk_mul_f32 v[124:125], v[124:125], s[48:49]
    v_pk_mul_f32 v[132:133], v[132:133], s[48:49]
    v_pk_mul_f32 v[140:141], v[140:141], s[48:49]
    v_pk_mul_f32 v[118:119], v[118:119], s[48:49]
    v_pk_mul_f32 v[126:127], v[126:127], s[48:49]
    v_pk_mul_f32 v[134:135], v[134:135], s[48:49]
    v_pk_mul_f32 v[142:143], v[142:143], s[48:49]
    v_cvt_pk_bf16_f32 v112, v112, v113
    v_mfma_f32_16x16x32_bf16 v[32:35], v[180:183], a[188:191], v[32:35]
    v_cvt_pk_bf16_f32 v120, v120, v121
    v_cvt_pk_bf16_f32 v128, v128, v129
    v_cvt_pk_bf16_f32 v136, v136, v137
    v_cvt_pk_bf16_f32 v113, v114, v115
    v_cvt_pk_bf16_f32 v121, v122, v123
    v_cvt_pk_bf16_f32 v129, v130, v131
    v_cvt_pk_bf16_f32 v137, v138, v139
    v_mfma_f32_16x16x32_bf16 v[32:35], v[184:187], a[208:211], v[32:35]
    v_cvt_pk_bf16_f32 v116, v116, v117
    v_cvt_pk_bf16_f32 v124, v124, v125
    v_cvt_pk_bf16_f32 v132, v132, v133
    v_cvt_pk_bf16_f32 v140, v140, v141
    v_cvt_pk_bf16_f32 v117, v118, v119
    v_cvt_pk_bf16_f32 v125, v126, v127
    v_cvt_pk_bf16_f32 v133, v134, v135
    v_cvt_pk_bf16_f32 v141, v142, v143
    v_mfma_f32_16x16x32_bf16 v[32:35], v[188:191], a[228:231], v[32:35]
    v_permlane32_swap_b32 v112, v116
    v_permlane32_swap_b32 v120, v124
    v_permlane32_swap_b32 v128, v132
    v_permlane32_swap_b32 v136, v140
    v_permlane32_swap_b32 v113, v117
    v_permlane32_swap_b32 v121, v125
    v_permlane32_swap_b32 v129, v133
    v_permlane32_swap_b32 v137, v141
    v_mfma_f32_16x16x32_bf16 v[36:39], v[192:195], a[168:171], 0
    v_permlane16_swap_b32 v112, v116
    v_permlane16_swap_b32 v120, v124
    v_permlane16_swap_b32 v128, v132
    v_permlane16_swap_b32 v136, v140
    v_permlane16_swap_b32 v113, v117
    v_permlane16_swap_b32 v121, v125
    v_permlane16_swap_b32 v129, v133
    v_permlane16_swap_b32 v137, v141
    v_mfma_f32_16x16x32_bf16 v[36:39], v[196:199], a[188:191], v[36:39]
    v_accvgpr_write_b32 a172, v112
    v_accvgpr_write_b32 a192, v120
    v_accvgpr_write_b32 a212, v128
    v_accvgpr_write_b32 a232, v136
    v_accvgpr_write_b32 a173, v113
    v_accvgpr_write_b32 a193, v121
    v_accvgpr_write_b32 a213, v129
    v_accvgpr_write_b32 a233, v137
    v_mfma_f32_16x16x32_bf16 v[36:39], v[200:203], a[208:211], v[36:39]
    v_accvgpr_write_b32 a174, v116
    v_accvgpr_write_b32 a194, v124
    v_accvgpr_write_b32 a214, v132
    v_accvgpr_write_b32 a234, v140
    v_accvgpr_write_b32 a175, v117
    v_accvgpr_write_b32 a195, v125
    v_accvgpr_write_b32 a215, v133
    v_accvgpr_write_b32 a235, v141
    v_mfma_f32_16x16x32_bf16 v[36:39], v[204:207], a[228:231], v[36:39]
    v_pk_mul_f32 v[144:145], v[144:145], s[48:49]
    s_nop 1
    v_pk_mul_f32 v[152:153], v[152:153], s[48:49]
    v_pk_mul_f32 v[160:161], v[160:161], s[48:49]
    v_pk_mul_f32 v[168:169], v[168:169], s[48:49]
    v_pk_mul_f32 v[146:147], v[146:147], s[48:49]
    v_pk_mul_f32 v[154:155], v[154:155], s[48:49]
    v_pk_mul_f32 v[162:163], v[162:163], s[48:49]
    v_pk_mul_f32 v[170:171], v[170:171], s[48:49]
    v_pk_mul_f32 v[148:149], v[148:149], s[48:49]
    v_mfma_f32_16x16x32_bf16 v[40:43], v[176:179], a[172:175], 0
    v_pk_mul_f32 v[156:157], v[156:157], s[48:49]
    v_pk_mul_f32 v[164:165], v[164:165], s[48:49]
    v_pk_mul_f32 v[172:173], v[172:173], s[48:49]
    v_pk_mul_f32 v[150:151], v[150:151], s[48:49]
    v_pk_mul_f32 v[158:159], v[158:159], s[48:49]
    v_pk_mul_f32 v[166:167], v[166:167], s[48:49]
    v_pk_mul_f32 v[174:175], v[174:175], s[48:49]
    v_cvt_pk_bf16_f32 v144, v144, v145
    v_mfma_f32_16x16x32_bf16 v[40:43], v[180:183], a[192:195], v[40:43]
    v_cvt_pk_bf16_f32 v152, v152, v153
    v_cvt_pk_bf16_f32 v160, v160, v161
    v_cvt_pk_bf16_f32 v168, v168, v169
    v_cvt_pk_bf16_f32 v145, v146, v147
    v_cvt_pk_bf16_f32 v153, v154, v155
    v_cvt_pk_bf16_f32 v161, v162, v163
    v_cvt_pk_bf16_f32 v169, v170, v171
    v_mfma_f32_16x16x32_bf16 v[40:43], v[184:187], a[212:215], v[40:43]
    v_cvt_pk_bf16_f32 v148, v148, v149
    v_cvt_pk_bf16_f32 v156, v156, v157
    v_cvt_pk_bf16_f32 v164, v164, v165
    v_cvt_pk_bf16_f32 v172, v172, v173
    v_cvt_pk_bf16_f32 v149, v150, v151
    v_cvt_pk_bf16_f32 v157, v158, v159
    v_cvt_pk_bf16_f32 v165, v166, v167
    v_cvt_pk_bf16_f32 v173, v174, v175
    v_mfma_f32_16x16x32_bf16 v[40:43], v[188:191], a[232:235], v[40:43]
    v_permlane32_swap_b32 v144, v148
    v_permlane32_swap_b32 v152, v156
    v_permlane32_swap_b32 v160, v164
    v_permlane32_swap_b32 v168, v172
    v_permlane32_swap_b32 v145, v149
    v_permlane32_swap_b32 v153, v157
    v_permlane32_swap_b32 v161, v165
    v_permlane32_swap_b32 v169, v173
    v_mfma_f32_16x16x32_bf16 v[44:47], v[192:195], a[172:175], 0
    v_permlane16_swap_b32 v144, v148
    v_permlane16_swap_b32 v152, v156
    v_permlane16_swap_b32 v160, v164
    v_permlane16_swap_b32 v168, v172
    v_permlane16_swap_b32 v145, v149
    v_permlane16_swap_b32 v153, v157
    v_permlane16_swap_b32 v161, v165
    v_permlane16_swap_b32 v169, v173
    v_mfma_f32_16x16x32_bf16 v[44:47], v[196:199], a[192:195], v[44:47]
    v_accvgpr_write_b32 a176, v144
    v_accvgpr_write_b32 a196, v152
    v_accvgpr_write_b32 a216, v160
    v_accvgpr_write_b32 a236, v168
    v_accvgpr_write_b32 a177, v145
    v_accvgpr_write_b32 a197, v153
    v_accvgpr_write_b32 a217, v161
    v_accvgpr_write_b32 a237, v169
    v_mfma_f32_16x16x32_bf16 v[44:47], v[200:203], a[212:215], v[44:47]
    v_accvgpr_write_b32 a178, v148
    v_accvgpr_write_b32 a198, v156
    v_accvgpr_write_b32 a218, v164
    v_accvgpr_write_b32 a238, v172
    v_accvgpr_write_b32 a179, v149
    v_accvgpr_write_b32 a199, v157
    v_accvgpr_write_b32 a219, v165
    v_accvgpr_write_b32 a239, v173
    v_mfma_f32_16x16x32_bf16 v[44:47], v[204:207], a[232:235], v[44:47]
    s_nop 1
    v_max3_f32 v166, v16, v17, v18
    v_max3_f32 v169, v24, v25, v26
    v_max3_f32 v172, v32, v33, v34
    v_max3_f32 v166, v166, v19, v20
    v_max3_f32 v169, v169, v27, v28
    v_max3_f32 v172, v172, v35, v36
    v_mfma_f32_16x16x32_bf16 v[48:51], v[176:179], a[176:179], 0
    v_max3_f32 v166, v166, v21, v22
    v_max3_f32 v169, v169, v29, v30
    v_max3_f32 v172, v172, v37, v38
    v_max_f32 v166, v166, v23
    v_max_f32 v169, v169, v31
    v_max_f32 v172, v172, v39
    v_mov_b32 v167, v166
    v_mov_b32 v170, v169
    v_mov_b32 v173, v172
    v_mov_b32 v168, v166
    v_mfma_f32_16x16x32_bf16 v[48:51], v[180:183], a[196:199], v[48:51]
    v_mov_b32 v171, v169
    v_mov_b32 v174, v172
    v_permlane32_swap_b32 v167, v168
    v_permlane32_swap_b32 v170, v171
    v_permlane32_swap_b32 v173, v174
    v_max_f32 v166, v167, v168
    v_max_f32 v169, v170, v171
    v_max_f32 v172, v173, v174
    v_mov_b32 v167, v166
    v_mfma_f32_16x16x32_bf16 v[48:51], v[184:187], a[216:219], v[48:51]
    v_mov_b32 v170, v169
    v_mov_b32 v173, v172
    v_mov_b32 v168, v166
    v_mov_b32 v171, v169
    v_mov_b32 v174, v172
    v_permlane16_swap_b32 v167, v168
    v_permlane16_swap_b32 v170, v171
    v_permlane16_swap_b32 v173, v174
    v_max_f32 v166, v167, v168
    v_mfma_f32_16x16x32_bf16 v[48:51], v[188:191], a[236:239], v[48:51]
    v_max_f32 v169, v170, v171
    v_max_f32 v172, v173, v174
    v_sub_f32 v16, v16, v166
    v_sub_f32 v24, v24, v169
    v_sub_f32 v32, v32, v172
    v_sub_f32 v17, v17, v166
    v_sub_f32 v25, v25, v169
    v_sub_f32 v33, v33, v172
    v_sub_f32 v18, v18, v166
    v_sub_f32 v26, v26, v169
    v_mfma_f32_16x16x32_bf16 v[52:55], v[192:195], a[176:179], 0
    v_sub_f32 v34, v34, v172
    v_sub_f32 v19, v19, v166
    v_sub_f32 v27, v27, v169
    v_sub_f32 v35, v35, v172
    v_sub_f32 v20, v20, v166
    v_sub_f32 v28, v28, v169
    v_sub_f32 v36, v36, v172
    v_sub_f32 v21, v21, v166
    v_sub_f32 v29, v29, v169
    v_mfma_f32_16x16x32_bf16 v[52:55], v[196:199], a[196:199], v[52:55]
    v_sub_f32 v37, v37, v172
    v_sub_f32 v22, v22, v166
    v_sub_f32 v30, v30, v169
    v_sub_f32 v38, v38, v172
    v_sub_f32 v23, v23, v166
    v_sub_f32 v31, v31, v169
    v_sub_f32 v39, v39, v172
    v_sub_f32 v136, 0, v166
    v_sub_f32 v140, 0, v169
    v_sub_f32 v144, 0, v172
    v_mfma_f32_16x16x32_bf16 v[52:55], v[200:203], a[216:219], v[52:55]
    v_sub_f32 v137, 0, v166
    v_sub_f32 v141, 0, v169
    v_sub_f32 v145, 0, v172
    v_sub_f32 v138, 0, v166
    v_sub_f32 v142, 0, v169
    v_sub_f32 v146, 0, v172
    v_sub_f32 v139, 0, v166
    v_sub_f32 v143, 0, v169
    v_sub_f32 v147, 0, v172
    v_mfma_f32_16x16x32_bf16 v[52:55], v[204:207], a[236:239], v[52:55]
    ds_read_b128 v[176:179], v240 offset:16384
    ds_read_b128 v[180:183], v241 offset:16384
    ds_read_b128 v[184:187], v242 offset:16384
    ds_read_b128 v[188:191], v243 offset:16384
    ds_read_b128 v[192:195], v240 offset:20480
    ds_read_b128 v[196:199], v241 offset:20480
    ds_read_b128 v[200:203], v242 offset:20480
    ds_read_b128 v[204:207], v243 offset:20480
    s_nop 3
    v_max3_f32 v166, v40, v41, v42
    v_max3_f32 v169, v48, v49, v50
    s_nop 0
    v_max3_f32 v166, v166, v43, v44
    v_max3_f32 v169, v169, v51, v52
    s_nop 0
    v_max3_f32 v166, v166, v45, v46
    v_max3_f32 v169, v169, v53, v54
    s_nop 0
    v_max_f32 v166, v166, v47
    v_max_f32 v169, v169, v55
    s_nop 0
    v_mov_b32 v167, v166
    v_mov_b32 v170, v169
    s_nop 0
    v_mov_b32 v168, v166
    v_mov_b32 v171, v169
    s_nop 0
    v_permlane32_swap_b32 v167, v168
    v_permlane32_swap_b32 v170, v171
    s_nop 0
    v_max_f32 v166, v167, v168
    v_max_f32 v169, v170, v171
    s_nop 0
    v_mov_b32 v167, v166
    v_mov_b32 v170, v169
    s_nop 0
    v_mov_b32 v168, v166
    v_mov_b32 v171, v169
    s_nop 0
    v_permlane16_swap_b32 v167, v168
    v_permlane16_swap_b32 v170, v171
    s_nop 0
    v_max_f32 v166, v167, v168
    v_max_f32 v169, v170, v171
    s_nop 0
    v_sub_f32 v40, v40, v166
    v_sub_f32 v48, v48, v169
    s_nop 0
    v_sub_f32 v41, v41, v166
    v_sub_f32 v49, v49, v169
    s_nop 0
    v_sub_f32 v42, v42, v166
    v_sub_f32 v50, v50, v169
    s_nop 0
    v_sub_f32 v43, v43, v166
    v_sub_f32 v51, v51, v169
    s_nop 0
    v_sub_f32 v44, v44, v166
    v_sub_f32 v52, v52, v169
    s_nop 0
    v_sub_f32 v45, v45, v166
    v_sub_f32 v53, v53, v169
    s_nop 0
    v_sub_f32 v46, v46, v166
    v_sub_f32 v54, v54, v169
    s_nop 0
    v_sub_f32 v47, v47, v166
    v_sub_f32 v55, v55, v169
    s_nop 0
    v_sub_f32 v148, 0, v166
    v_sub_f32 v152, 0, v169
    s_nop 0
    v_sub_f32 v149, 0, v166
    v_sub_f32 v153, 0, v169
    s_nop 0
    v_sub_f32 v150, 0, v166
    v_sub_f32 v154, 0, v169
    s_nop 0
    v_sub_f32 v151, 0, v166
    v_sub_f32 v155, 0, v169
    s_nop 0
    s_nop 0
    s_nop 0
    s_nop 0
    s_nop 0
    s_nop 0
    s_nop 0
    s_nop 0
    s_nop 0
    s_nop 0
    s_nop 0
    s_nop 0
    s_nop 0
    s_nop 0
    s_nop 0
    s_nop 0
    s_nop 0
    v_mov_b32 v161, 0
    v_mov_b32 v162, 0
    v_mov_b32 v163, 0
    v_mov_b32 v164, 0
    v_mov_b32 v165, 0
    s_waitcnt vmcnt(0) lgkmcnt(0)
    s_barrier
    s_cmp_lt_u32 s32, 2
    s_cselect_b32 s43, 4, 1
    s_and_b32 s45, s43, 3
    s_lshl_b32 s45, s45, 14
    s_add_u32 s45, s45, s42
    s_cmp_lt_u32 s43, 16
    s_cselect_b32 s45, s45, 0x24000
    s_lshl_b32 s44, s43, 13
    s_mov_b32 m0, s45
    s_add_u32 s46, s44, 4096
    buffer_load_dwordx4 v252, s[24:27], s44 offen offset:0 nt lds
    buffer_load_dwordx4 v253, s[24:27], s44 offen offset:1024 nt lds
    buffer_load_dwordx4 v254, s[24:27], s44 offen offset:2048 nt lds
    buffer_load_dwordx4 v255, s[24:27], s44 offen offset:3072 nt lds
    s_add_u32 m0, s45, 4096
    s_add_u32 s43, s43, 1
    buffer_load_dwordx4 v252, s[24:27], s46 offen offset:0 nt lds
    buffer_load_dwordx4 v253, s[24:27], s46 offen offset:1024 nt lds
    buffer_load_dwordx4 v254, s[24:27], s46 offen offset:2048 nt lds
    buffer_load_dwordx4 v255, s[24:27], s46 offen offset:3072 nt lds
    v_exp_f32 v166, v16
    v_exp_f32 v167, v17
    v_mfma_f32_16x16x32_bf16 v[56:59], v[176:179], a[160:163], v[136:139]
    v_exp_f32 v168, v18
    v_add_f32 v156, v166, v167
    v_exp_f32 v169, v19
    v_mfma_f32_16x16x32_bf16 v[56:59], v[180:183], a[180:183], v[56:59]
    v_cvt_pk_bf16_f32 v96, v166, v167
    v_add_f32 v156, v156, v168
    v_mfma_f32_16x16x32_bf16 v[56:59], v[184:187], a[200:203], v[56:59]
    v_exp_f32 v170, v20
    v_add_f32 v156, v156, v169
    v_cvt_pk_bf16_f32 v97, v168, v169
    v_mfma_f32_16x16x32_bf16 v[56:59], v[188:191], a[220:223], v[56:59]
    v_exp_f32 v171, v21
    v_add_f32 v156, v156, v170
    v_mfma_f32_16x16x32_bf16 v[60:63], v[192:195], a[160:163], v[136:139]
    v_exp_f32 v172, v22
    v_add_f32 v156, v156, v171
    v_cvt_pk_bf16_f32 v98, v170, v171
    v_mfma_f32_16x16x32_bf16 v[60:63], v[196:199], a[180:183], v[60:63]
    v_exp_f32 v173, v23
    v_add_f32 v156, v156, v172
    v_mfma_f32_16x16x32_bf16 v[60:63], v[200:203], a[200:203], v[60:63]
    v_nop
    v_add_f32 v156, v156, v173
    v_cvt_pk_bf16_f32 v99, v172, v173
    v_mfma_f32_16x16x32_bf16 v[60:63], v[204:207], a[220:223], v[60:63]
    v_exp_f32 v166, v24
    v_exp_f32 v167, v25
    v_mfma_f32_16x16x32_bf16 v[64:67], v[176:179], a[164:167], v[140:143]
    v_exp_f32 v168, v26
    v_add_f32 v157, v166, v167
    v_exp_f32 v169, v27
    v_mfma_f32_16x16x32_bf16 v[64:67], v[180:183], a[184:187], v[64:67]
    v_cvt_pk_bf16_f32 v100, v166, v167
    v_add_f32 v157, v157, v168
    v_mfma_f32_16x16x32_bf16 v[64:67], v[184:187], a[204:207], v[64:67]
    v_exp_f32 v170, v28
    v_add_f32 v157, v157, v169
    v_cvt_pk_bf16_f32 v101, v168, v169
    v_mfma_f32_16x16x32_bf16 v[64:67], v[188:191], a[224:227], v[64:67]
    v_exp_f32 v171, v29
    v_add_f32 v157, v157, v170
    v_mfma_f32_16x16x32_bf16 v[68:71], v[192:195], a[164:167], v[140:143]
    v_exp_f32 v172, v30
    v_add_f32 v157, v157, v171
    v_cvt_pk_bf16_f32 v102, v170, v171
    v_mfma_f32_16x16x32_bf16 v[68:71], v[196:199], a[184:187], v[68:71]
    v_exp_f32 v173, v31
    v_add_f32 v157, v157, v172
    v_mfma_f32_16x16x32_bf16 v[68:71], v[200:203], a[204:207], v[68:71]
    v_nop
    v_add_f32 v157, v157, v173
    v_cvt_pk_bf16_f32 v103, v172, v173
    v_mfma_f32_16x16x32_bf16 v[68:71], v[204:207], a[224:227], v[68:71]
    v_exp_f32 v166, v32
    v_exp_f32 v167, v33
    v_mfma_f32_16x16x32_bf16 v[72:75], v[176:179], a[168:171], v[144:147]
    v_exp_f32 v168, v34
    v_add_f32 v158, v166, v167
    v_exp_f32 v169, v35
    v_mfma_f32_16x16x32_bf16 v[72:75], v[180:183], a[188:191], v[72:75]
    v_cvt_pk_bf16_f32 v104, v166, v167
    v_add_f32 v158, v158, v168
    v_mfma_f32_16x16x32_bf16 v[72:75], v[184:187], a[208:211], v[72:75]
    v_exp_f32 v170, v36
    v_add_f32 v158, v158, v169
    v_cvt_pk_bf16_f32 v105, v168, v169
    v_mfma_f32_16x16x32_bf16 v[72:75], v[188:191], a[228:231], v[72:75]
    v_exp_f32 v171, v37
    s_and_b32 s45, s43, 3
    v_add_f32 v158, v158, v170
    v_mfma_f32_16x16x32_bf16 v[76:79], v[192:195], a[168:171], v[144:147]
    v_exp_f32 v172, v38
    v_add_f32 v158, v158, v171
    s_lshl_b32 s45, s45, 14
    v_cvt_pk_bf16_f32 v106, v170, v171
    v_mfma_f32_16x16x32_bf16 v[76:79], v[196:199], a[188:191], v[76:79]
    v_exp_f32 v173, v39
    v_add_f32 v158, v158, v172
    s_add_u32 s45, s45, s42
    v_mfma_f32_16x16x32_bf16 v[76:79], v[200:203], a[208:211], v[76:79]
    v_nop
    v_add_f32 v158, v158, v173
    s_cmp_lt_u32 s43, 16
    v_cvt_pk_bf16_f32 v107, v172, v173
    v_mfma_f32_16x16x32_bf16 v[76:79], v[204:207], a[228:231], v[76:79]
    v_exp_f32 v166, v40
    v_exp_f32 v167, v41
    s_cselect_b32 s45, s45, 0x24000
    v_mfma_f32_16x16x32_bf16 v[80:83], v[176:179], a[172:175], v[148:151]
    v_exp_f32 v168, v42
    v_add_f32 v159, v166, v167
    v_exp_f32 v169, v43
    s_lshl_b32 s44, s43, 13
    v_mfma_f32_16x16x32_bf16 v[80:83], v[180:183], a[192:195], v[80:83]
    v_cvt_pk_bf16_f32 v108, v166, v167
    v_add_f32 v159, v159, v168
    s_mov_b32 m0, s45
    v_mfma_f32_16x16x32_bf16 v[80:83], v[184:187], a[212:215], v[80:83]
    v_exp_f32 v170, v44
    v_add_f32 v159, v159, v169
    v_cvt_pk_bf16_f32 v109, v168, v169
    v_mfma_f32_16x16x32_bf16 v[80:83], v[188:191], a[232:235], v[80:83]
    s_add_u32 s46, s44, 4096
    v_exp_f32 v171, v45
    v_add_f32 v159, v159, v170
    v_mfma_f32_16x16x32_bf16 v[84:87], v[192:195], a[172:175], v[148:151]
    v_exp_f32 v172, v46
    buffer_load_dwordx4 v252, s[24:27], s44 offen offset:0 nt lds
    v_add_f32 v159, v159, v171
    v_cvt_pk_bf16_f32 v110, v170, v171
    v_mfma_f32_16x16x32_bf16 v[84:87], v[196:199], a[192:195], v[84:87]
    buffer_load_dwordx4 v253, s[24:27], s44 offen offset:1024 nt lds
    v_exp_f32 v173, v47
    v_add_f32 v159, v159, v172
    v_mfma_f32_16x16x32_bf16 v[84:87], v[200:203], a[212:215], v[84:87]
    v_nop
    buffer_load_dwordx4 v254, s[24:27], s44 offen offset:2048 nt lds
    v_add_f32 v159, v159, v173
    v_cvt_pk_bf16_f32 v111, v172, v173
    v_mfma_f32_16x16x32_bf16 v[84:87], v[204:207], a[232:235], v[84:87]
    v_exp_f32 v166, v48
    buffer_load_dwordx4 v255, s[24:27], s44 offen offset:3072 nt lds
    v_exp_f32 v167, v49
    v_mfma_f32_16x16x32_bf16 v[88:91], v[176:179], a[176:179], v[152:155]
    v_exp_f32 v168, v50
    s_add_u32 m0, s45, 4096
    v_add_f32 v160, v166, v167
    v_exp_f32 v169, v51
    v_mfma_f32_16x16x32_bf16 v[88:91], v[180:183], a[196:199], v[88:91]
    v_cvt_pk_bf16_f32 v112, v166, v167
    s_add_u32 s43, s43, 1
    v_add_f32 v160, v160, v168
    v_mfma_f32_16x16x32_bf16 v[88:91], v[184:187], a[216:219], v[88:91]
    v_exp_f32 v170, v52
    v_add_f32 v160, v160, v169
    buffer_load_dwordx4 v252, s[24:27], s46 offen offset:0 nt lds
    v_cvt_pk_bf16_f32 v113, v168, v169
    v_mfma_f32_16x16x32_bf16 v[88:91], v[188:191], a[236:239], v[88:91]
    v_exp_f32 v171, v53
    buffer_load_dwordx4 v253, s[24:27], s46 offen offset:1024 nt lds
    v_add_f32 v160, v160, v170
    v_mfma_f32_16x16x32_bf16 v[92:95], v[192:195], a[176:179], v[152:155]
    v_exp_f32 v172, v54
    v_add_f32 v160, v160, v171
    buffer_load_dwordx4 v254, s[24:27], s46 offen offset:2048 nt lds
    v_cvt_pk_bf16_f32 v114, v170, v171
    v_mfma_f32_16x16x32_bf16 v[92:95], v[196:199], a[196:199], v[92:95]
    v_exp_f32 v173, v55
    v_add_f32 v160, v160, v172
    buffer_load_dwordx4 v255, s[24:27], s46 offen offset:3072 nt lds
    v_mfma_f32_16x16x32_bf16 v[92:95], v[200:203], a[216:219], v[92:95]
    v_nop
    v_add_f32 v160, v160, v173
    v_cvt_pk_bf16_f32 v115, v172, v173
    v_mfma_f32_16x16x32_bf16 v[92:95], v[204:207], a[236:239], v[92:95]
    ds_read_b128 v[176:179], v240 offset:32768
    ds_read_b128 v[180:183], v241 offset:32768
    ds_read_b128 v[184:187], v242 offset:32768
    ds_read_b128 v[188:191], v243 offset:32768
    ds_read_b128 v[192:195], v240 offset:36864
    ds_read_b128 v[196:199], v241 offset:36864
    ds_read_b128 v[200:203], v242 offset:36864
    ds_read_b128 v[204:207], v243 offset:36864
    v_max3_f32 v174, v156, v157, v158
    v_max3_f32 v174, v174, v159, v160
    v_cmp_nge_f32 vcc, s50, v174
    s_cbranch_vccz K1_OK_1
    s_call_b64 s[52:53], K1_FB0
K1_OK_1:
    v_add_f32 v161, v161, v156
    v_add_f32 v162, v162, v157
    v_add_f32 v163, v163, v158
    v_add_f32 v164, v164, v159
    v_add_f32 v165, v165, v160
    s_waitcnt vmcnt(16) lgkmcnt(0)
    s_barrier
    v_exp_f32 v166, v56
    ds_read_b64_tr_b16 v[208:209], v244 offset:0
    v_mfma_f32_16x16x32_bf16 v[16:19], v[176:179], a[160:163], v[136:139]
    v_exp_f32 v167, v57
    v_mfma_f32_16x16x32_bf16 v[16:19], v[180:183], a[180:183], v[16:19]
    v_exp_f32 v168, v58
    ds_read_b64_tr_b16 v[210:211], v244 offset:4096
    v_add_f32 v156, v166, v167
    v_mfma_f32_16x16x32_bf16 v[16:19], v[184:187], a[200:203], v[16:19]
    v_exp_f32 v169, v59
    ds_read_b64_tr_b16 v[212:213], v245 offset:0
    v_mfma_f32_16x16x32_bf16 v[16:19], v[188:191], a[220:223], v[16:19]
    v_cvt_pk_bf16_f32 v116, v166, v167
    v_mfma_f32_16x16x32_bf16 v[20:23], v[192:195], a[160:163], v[136:139]
    v_add_f32 v156, v156, v168
    ds_read_b64_tr_b16 v[214:215], v245 offset:4096
    v_mfma_f32_16x16x32_bf16 v[20:23], v[196:199], a[180:183], v[20:23]
    v_exp_f32 v170, v60
    ds_read_b64_tr_b16 v[216:217], v246 offset:0
    v_add_f32 v156, v156, v169
    v_mfma_f32_16x16x32_bf16 v[20:23], v[200:203], a[200:203], v[20:23]
    v_cvt_pk_bf16_f32 v117, v168, v169
    v_mfma_f32_16x16x32_bf16 v[20:23], v[204:207], a[220:223], v[20:23]
    ds_read_b64_tr_b16 v[218:219], v246 offset:4096
    v_exp_f32 v171, v61
    v_mfma_f32_16x16x32_bf16 v[24:27], v[176:179], a[164:167], v[140:143]
    v_add_f32 v156, v156, v170
    ds_read_b64_tr_b16 v[220:221], v247 offset:0
    v_mfma_f32_16x16x32_bf16 v[24:27], v[180:183], a[184:187], v[24:27]
    v_exp_f32 v172, v62
    v_add_f32 v156, v156, v171
    v_mfma_f32_16x16x32_bf16 v[24:27], v[184:187], a[204:207], v[24:27]
    ds_read_b64_tr_b16 v[222:223], v247 offset:4096
    v_cvt_pk_bf16_f32 v118, v170, v171
    v_mfma_f32_16x16x32_bf16 v[24:27], v[188:191], a[224:227], v[24:27]
    v_exp_f32 v173, v63
    ds_read_b64_tr_b16 v[224:225], v248 offset:0
    v_mfma_f32_16x16x32_bf16 v[28:31], v[192:195], a[164:167], v[140:143]
    v_add_f32 v156, v156, v172
    v_mfma_f32_16x16x32_bf16 v[28:31], v[196:199], a[184:187], v[28:31]
    v_nop
    ds_read_b64_tr_b16 v[226:227], v248 offset:4096
    v_add_f32 v156, v156, v173
    v_mfma_f32_16x16x32_bf16 v[28:31], v[200:203], a[204:207], v[28:31]
    v_cvt_pk_bf16_f32 v119, v172, v173
    ds_read_b64_tr_b16 v[228:229], v249 offset:0
    v_mfma_f32_16x16x32_bf16 v[28:31], v[204:207], a[224:227], v[28:31]
    v_exp_f32 v166, v64
    v_mfma_f32_16x16x32_bf16 v[32:35], v[176:179], a[168:171], v[144:147]
    v_exp_f32 v167, v65
    ds_read_b64_tr_b16 v[230:231], v249 offset:4096
    v_mfma_f32_16x16x32_bf16 v[32:35], v[180:183], a[188:191], v[32:35]
    v_exp_f32 v168, v66
    ds_read_b64_tr_b16 v[232:233], v250 offset:0
    v_mfma_f32_16x16x32_bf16 v[32:35], v[184:187], a[208:211], v[32:35]
    v_add_f32 v157, v166, v167
    v_exp_f32 v169, v67
    v_mfma_f32_16x16x32_bf16 v[32:35], v[188:191], a[228:231], v[32:35]
    ds_read_b64_tr_b16 v[234:235], v250 offset:4096
    v_cvt_pk_bf16_f32 v120, v166, v167
    v_mfma_f32_16x16x32_bf16 v[36:39], v[192:195], a[168:171], v[144:147]
    v_add_f32 v157, v157, v168
    v_mfma_f32_16x16x32_bf16 v[36:39], v[196:199], a[188:191], v[36:39]
    ds_read_b64_tr_b16 v[236:237], v251 offset:0
    v_exp_f32 v170, v68
    v_mfma_f32_16x16x32_bf16 v[36:39], v[200:203], a[208:211], v[36:39]
    v_add_f32 v157, v157, v169
    ds_read_b64_tr_b16 v[238:239], v251 offset:4096
    v_cvt_pk_bf16_f32 v121, v168, v169
    v_mfma_f32_16x16x32_bf16 v[36:39], v[204:207], a[228:231], v[36:39]
    v_exp_f32 v171, v69
    v_mfma_f32_16x16x32_bf16 v[40:43], v[176:179], a[172:175], v[148:151]
    v_add_f32 v157, v157, v170
    v_mfma_f32_16x16x32_bf16 v[40:43], v[180:183], a[192:195], v[40:43]
    v_exp_f32 v172, v70
    v_mfma_f32_16x16x32_bf16 v[40:43], v[184:187], a[212:215], v[40:43]
    v_add_f32 v157, v157, v171
    v_cvt_pk_bf16_f32 v122, v170, v171
    v_mfma_f32_16x16x32_bf16 v[40:43], v[188:191], a[232:235], v[40:43]
    v_exp_f32 v173, v71
    v_mfma_f32_16x16x32_bf16 v[44:47], v[192:195], a[172:175], v[148:151]
    v_add_f32 v157, v157, v172
    v_mfma_f32_16x16x32_bf16 v[44:47], v[196:199], a[192:195], v[44:47]
    v_nop
    v_mfma_f32_16x16x32_bf16 v[44:47], v[200:203], a[212:215], v[44:47]
    v_add_f32 v157, v157, v173
    v_cvt_pk_bf16_f32 v123, v172, v173
    v_mfma_f32_16x16x32_bf16 v[44:47], v[204:207], a[232:235], v[44:47]
    v_exp_f32 v166, v72
    v_mfma_f32_16x16x32_bf16 v[48:51], v[176:179], a[176:179], v[152:155]
    v_exp_f32 v167, v73
    v_mfma_f32_16x16x32_bf16 v[48:51], v[180:183], a[196:199], v[48:51]
    v_exp_f32 v168, v74
    v_mfma_f32_16x16x32_bf16 v[48:51], v[184:187], a[216:219], v[48:51]
    v_add_f32 v158, v166, v167
    v_mfma_f32_16x16x32_bf16 v[48:51], v[188:191], a[236:239], v[48:51]
    v_exp_f32 v169, v75
    v_cvt_pk_bf16_f32 v124, v166, v167
    v_mfma_f32_16x16x32_bf16 v[52:55], v[192:195], a[176:179], v[152:155]
    v_add_f32 v158, v158, v168
    v_mfma_f32_16x16x32_bf16 v[52:55], v[196:199], a[196:199], v[52:55]
    v_exp_f32 v170, v76
    v_mfma_f32_16x16x32_bf16 v[52:55], v[200:203], a[216:219], v[52:55]
    v_add_f32 v158, v158, v169
    v_mfma_f32_16x16x32_bf16 v[52:55], v[204:207], a[236:239], v[52:55]
    v_cvt_pk_bf16_f32 v125, v168, v169
    v_exp_f32 v171, v77
    s_waitcnt lgkmcnt(0)
    s_and_b32 s45, s43, 3
    v_add_f32 v158, v158, v170
    v_mfma_f32_16x16x32_bf16 a[0:3], v[208:211], v[96:99], 0
    v_exp_f32 v172, v78
    v_mfma_f32_16x16x32_bf16 a[20:23], v[212:215], v[96:99], 0
    v_add_f32 v158, v158, v171
    s_lshl_b32 s45, s45, 14
    v_mfma_f32_16x16x32_bf16 a[40:43], v[216:219], v[96:99], 0
    v_cvt_pk_bf16_f32 v126, v170, v171
    ds_read_b128 v[176:179], v240 offset:49152
    v_exp_f32 v173, v79
    v_mfma_f32_16x16x32_bf16 a[60:63], v[220:223], v[96:99], 0
    v_add_f32 v158, v158, v172
    s_add_u32 s45, s45, s42
    v_mfma_f32_16x16x32_bf16 a[80:83], v[224:227], v[96:99], 0
    v_nop
    v_mfma_f32_16x16x32_bf16 a[100:103], v[228:231], v[96:99], 0
    v_add_f32 v158, v158, v173
    v_mfma_f32_16x16x32_bf16 a[120:123], v[232:235], v[96:99], 0
    s_cmp_lt_u32 s43, 16
    v_cvt_pk_bf16_f32 v127, v172, v173
    ds_read_b128 v[180:183], v241 offset:49152
    v_mfma_f32_16x16x32_bf16 a[140:143], v[236:239], v[96:99], 0
    v_exp_f32 v166, v80
    v_exp_f32 v167, v81
    v_mfma_f32_16x16x32_bf16 a[4:7], v[208:211], v[100:103], 0
    s_cselect_b32 s45, s45, 0x24000
    v_exp_f32 v168, v82
    v_mfma_f32_16x16x32_bf16 a[24:27], v[212:215], v[100:103], 0
    v_add_f32 v159, v166, v167
    v_mfma_f32_16x16x32_bf16 a[44:47], v[216:219], v[100:103], 0
    v_exp_f32 v169, v83
    s_lshl_b32 s44, s43, 13
    ds_read_b128 v[184:187], v242 offset:49152
    v_mfma_f32_16x16x32_bf16 a[64:67], v[220:223], v[100:103], 0
    v_cvt_pk_bf16_f32 v128, v166, v167
    v_add_f32 v159, v159, v168
    v_mfma_f32_16x16x32_bf16 a[84:87], v[224:227], v[100:103], 0
    s_mov_b32 m0, s45
    v_exp_f32 v170, v84
    v_mfma_f32_16x16x32_bf16 a[104:107], v[228:231], v[100:103], 0
    v_add_f32 v159, v159, v169
    v_mfma_f32_16x16x32_bf16 a[124:127], v[232:235], v[100:103], 0
    v_cvt_pk_bf16_f32 v129, v168, v169
    s_add_u32 s46, s44, 4096
    v_mfma_f32_16x16x32_bf16 a[144:147], v[236:239], v[100:103], 0
    v_exp_f32 v171, v85
    ds_read_b128 v[188:191], v243 offset:49152
    v_add_f32 v159, v159, v170
    v_mfma_f32_16x16x32_bf16 a[8:11], v[208:211], v[104:107], 0
    v_exp_f32 v172, v86
    buffer_load_dwordx4 v252, s[24:27], s44 offen offset:0 nt lds
    v_mfma_f32_16x16x32_bf16 a[28:31], v[212:215], v[104:107], 0
    v_add_f32 v159, v159, v171
    v_mfma_f32_16x16x32_bf16 a[48:51], v[216:219], v[104:107], 0
    v_cvt_pk_bf16_f32 v130, v170, v171
    v_mfma_f32_16x16x32_bf16 a[68:71], v[220:223], v[104:107], 0
    buffer_load_dwordx4 v253, s[24:27], s44 offen offset:1024 nt lds
    v_exp_f32 v173, v87
    ds_read_b128 v[192:195], v240 offset:53248
    v_add_f32 v159, v159, v172
    v_mfma_f32_16x16x32_bf16 a[88:91], v[224:227], v[104:107], 0
    v_nop
    v_mfma_f32_16x16x32_bf16 a[108:111], v[228:231], v[104:107], 0
    buffer_load_dwordx4 v254, s[24:27], s44 offen offset:2048 nt lds
    v_add_f32 v159, v159, v173
    v_mfma_f32_16x16x32_bf16 a[128:131], v[232:235], v[104:107], 0
    v_cvt_pk_bf16_f32 v131, v172, v173
    v_mfma_f32_16x16x32_bf16 a[148:151], v[236:239], v[104:107], 0
    v_exp_f32 v166, v88
    buffer_load_dwordx4 v255, s[24:27], s44 offen offset:3072 nt lds
    v_mfma_f32_16x16x32_bf16 a[12:15], v[208:211], v[108:111], 0
    v_exp_f32 v167, v89
    ds_read_b128 v[196:199], v241 offset:53248
    v_exp_f32 v168, v90
    v_mfma_f32_16x16x32_bf16 a[32:35], v[212:215], v[108:111], 0
    s_add_u32 m0, s45, 4096
    v_add_f32 v160, v166, v167
    v_mfma_f32_16x16x32_bf16 a[52:55], v[216:219], v[108:111], 0
    v_exp_f32 v169, v91
    v_mfma_f32_16x16x32_bf16 a[72:75], v[220:223], v[108:111], 0
    v_cvt_pk_bf16_f32 v132, v166, v167
    s_add_u32 s43, s43, 1
    v_mfma_f32_16x16x32_bf16 a[92:95], v[224:227], v[108:111], 0
    v_add_f32 v160, v160, v168
    ds_read_b128 v[200:203], v242 offset:53248
    v_exp_f32 v170, v92
    v_mfma_f32_16x16x32_bf16 a[112:115], v[228:231], v[108:111], 0
    v_add_f32 v160, v160, v169
    buffer_load_dwordx4 v252, s[24:27], s46 offen offset:0 nt lds
    v_mfma_f32_16x16x32_bf16 a[132:135], v[232:235], v[108:111], 0
    v_cvt_pk_bf16_f32 v133, v168, v169
    v_mfma_f32_16x16x32_bf16 a[152:155], v[236:239], v[108:111], 0
    v_exp_f32 v171, v93
    buffer_load_dwordx4 v253, s[24:27], s46 offen offset:1024 nt lds
    v_mfma_f32_16x16x32_bf16 a[16:19], v[208:211], v[112:115], 0
    v_add_f32 v160, v160, v170
    ds_read_b128 v[204:207], v243 offset:53248
    v_exp_f32 v172, v94
    v_mfma_f32_16x16x32_bf16 a[36:39], v[212:215], v[112:115], 0
    v_add_f32 v160, v160, v171
    v_mfma_f32_16x16x32_bf16 a[56:59], v[216:219], v[112:115], 0
    buffer_load_dwordx4 v254, s[24:27], s46 offen offset:2048 nt lds
    v_cvt_pk_bf16_f32 v134, v170, v171
    v_mfma_f32_16x16x32_bf16 a[76:79], v[220:223], v[112:115], 0
    v_exp_f32 v173, v95
    v_mfma_f32_16x16x32_bf16 a[96:99], v[224:227], v[112:115], 0
    v_add_f32 v160, v160, v172
    buffer_load_dwordx4 v255, s[24:27], s46 offen offset:3072 nt lds
    v_nop
    v_mfma_f32_16x16x32_bf16 a[116:119], v[228:231], v[112:115], 0
    v_add_f32 v160, v160, v173
    v_mfma_f32_16x16x32_bf16 a[136:139], v[232:235], v[112:115], 0
    v_cvt_pk_bf16_f32 v135, v172, v173
    v_mfma_f32_16x16x32_bf16 a[156:159], v[236:239], v[112:115], 0
    v_max3_f32 v174, v156, v157, v158
    v_max3_f32 v174, v174, v159, v160
    v_cmp_nge_f32 vcc, s50, v174
    s_cbranch_vccz K1_OK_2
    s_call_b64 s[52:53], K1_FB1
K1_OK_2:
    v_add_f32 v161, v161, v156
    v_add_f32 v162, v162, v157
    v_add_f32 v163, v163, v158
    v_add_f32 v164, v164, v159
    v_add_f32 v165, v165, v160
    s_mov_b32 s41, 0
K1_AL:
    s_waitcnt vmcnt(16) lgkmcnt(0)
    s_barrier
    s_cmp_eq_u32 s41, 0
    s_cbranch_scc0 K1_XF_3
    s_cmp_eq_u32 s32, 3
    s_cbranch_scc0 K1_XF_3
    v_readfirstlane_b32 s3, v10
    s_nop 3
    s_cmp_eq_u32 s3, 0
    s_cselect_b32 s66, s64, s3
    s_getreg_b32 s3, hwreg(HW_REG_XCC_ID)
    s_and_b32 s3, s3, 7
    s_add_u32 s3, s3, 1
    s_add_u32 s3, s3, s66
    s_lshl_b32 s4, s5, 2
    s_add_u32 s4, s4, s68
    s_lshl_b32 s4, s4, 3
    s_add_u32 s4, s4, s7
    s_lshl_b32 s4, s4, 7
    s_and_b32 s47, s57, 3
    s_lshl_b32 s47, s47, 2
    s_add_u32 s4, s4, s47
    s_add_u32 s4, s4, 16
    v_mov_b32 v4, s4
    v_mov_b32 v5, s3
    v_cmp_eq_u32 vcc, 0, v1
    s_and_saveexec_b64 s[46:47], vcc
    global_store_dword v4, v5, s[58:59] sc0 sc1
    s_mov_b64 exec, s[46:47]
K1_XF_3:
    v_exp_f32 v166, v16
    ds_read_b64_tr_b16 v[208:209], v244 offset:16384
    v_mfma_f32_16x16x32_bf16 v[56:59], v[176:179], a[160:163], v[136:139]
    v_exp_f32 v167, v17
    v_mfma_f32_16x16x32_bf16 v[56:59], v[180:183], a[180:183], v[56:59]
    v_exp_f32 v168, v18
    ds_read_b64_tr_b16 v[210:211], v244 offset:20480
    v_add_f32 v156, v166, v167
    v_mfma_f32_16x16x32_bf16 v[56:59], v[184:187], a[200:203], v[56:59]
    v_exp_f32 v169, v19
    ds_read_b64_tr_b16 v[212:213], v245 offset:16384
    v_mfma_f32_16x16x32_bf16 v[56:59], v[188:191], a[220:223], v[56:59]
    v_cvt_pk_bf16_f32 v96, v166, v167
    v_mfma_f32_16x16x32_bf16 v[60:63], v[192:195], a[160:163], v[136:139]
    v_add_f32 v156, v156, v168
    ds_read_b64_tr_b16 v[214:215], v245 offset:20480
    v_mfma_f32_16x16x32_bf16 v[60:63], v[196:199], a[180:183], v[60:63]
    v_exp_f32 v170, v20
    ds_read_b64_tr_b16 v[216:217], v246 offset:16384
    v_add_f32 v156, v156, v169
    v_mfma_f32_16x16x32_bf16 v[60:63], v[200:203], a[200:203], v[60:63]
    v_cvt_pk_bf16_f32 v97, v168, v169
    v_mfma_f32_16x16x32_bf16 v[60:63], v[204:207], a[220:223], v[60:63]
    ds_read_b64_tr_b16 v[218:219], v246 offset:20480
    v_exp_f32 v171, v21
    v_mfma_f32_16x16x32_bf16 v[64:67], v[176:179], a[164:167], v[140:143]
    v_add_f32 v156, v156, v170
    ds_read_b64_tr_b16 v[220:221], v247 offset:16384
    v_mfma_f32_16x16x32_bf16 v[64:67], v[180:183], a[184:187], v[64:67]
    v_exp_f32 v172, v22
    v_add_f32 v156, v156, v171
    v_mfma_f32_16x16x32_bf16 v[64:67], v[184:187], a[204:207], v[64:67]
    ds_read_b64_tr_b16 v[222:223], v247 offset:20480
    v_cvt_pk_bf16_f32 v98, v170, v171
    v_mfma_f32_16x16x32_bf16 v[64:67], v[188:191], a[224:227], v[64:67]
    v_exp_f32 v173, v23
    ds_read_b64_tr_b16 v[224:225], v248 offset:16384
    v_mfma_f32_16x16x32_bf16 v[68:71], v[192:195], a[164:167], v[140:143]
    v_add_f32 v156, v156, v172
    v_mfma_f32_16x16x32_bf16 v[68:71], v[196:199], a[184:187], v[68:71]
    v_nop
    ds_read_b64_tr_b16 v[226:227], v248 offset:20480
    v_add_f32 v156, v156, v173
    v_mfma_f32_16x16x32_bf16 v[68:71], v[200:203], a[204:207], v[68:71]
    v_cvt_pk_bf16_f32 v99, v172, v173
    ds_read_b64_tr_b16 v[228:229], v249 offset:16384
    v_mfma_f32_16x16x32_bf16 v[68:71], v[204:207], a[224:227], v[68:71]
    v_exp_f32 v166, v24
    v_mfma_f32_16x16x32_bf16 v[72:75], v[176:179], a[168:171], v[144:147]
    v_exp_f32 v167, v25
    ds_read_b64_tr_b16 v[230:231], v249 offset:20480
    v_mfma_f32_16x16x32_bf16 v[72:75], v[180:183], a[188:191], v[72:75]
    v_exp_f32 v168, v26
    ds_read_b64_tr_b16 v[232:233], v250 offset:16384
    v_mfma_f32_16x16x32_bf16 v[72:75], v[184:187], a[208:211], v[72:75]
    v_add_f32 v157, v166, v167
    v_exp_f32 v169, v27
    v_mfma_f32_16x16x32_bf16 v[72:75], v[188:191], a[228:231], v[72:75]
    ds_read_b64_tr_b16 v[234:235], v250 offset:20480
    v_cvt_pk_bf16_f32 v100, v166, v167
    v_mfma_f32_16x16x32_bf16 v[76:79], v[192:195], a[168:171], v[144:147]
    v_add_f32 v157, v157, v168
    v_mfma_f32_16x16x32_bf16 v[76:79], v[196:199], a[188:191], v[76:79]
    ds_read_b64_tr_b16 v[236:237], v251 offset:16384
    v_exp_f32 v170, v28
    v_mfma_f32_16x16x32_bf16 v[76:79], v[200:203], a[208:211], v[76:79]
    v_add_f32 v157, v157, v169
    ds_read_b64_tr_b16 v[238:239], v251 offset:20480
    v_cvt_pk_bf16_f32 v101, v168, v169
    v_mfma_f32_16x16x32_bf16 v[76:79], v[204:207], a[228:231], v[76:79]
    v_exp_f32 v171, v29
    v_mfma_f32_16x16x32_bf16 v[80:83], v[176:179], a[172:175], v[148:151]
    v_add_f32 v157, v157, v170
    v_mfma_f32_16x16x32_bf16 v[80:83], v[180:183], a[192:195], v[80:83]
    v_exp_f32 v172, v30
    v_mfma_f32_16x16x32_bf16 v[80:83], v[184:187], a[212:215], v[80:83]
    v_add_f32 v157, v157, v171
    v_cvt_pk_bf16_f32 v102, v170, v171
    v_mfma_f32_16x16x32_bf16 v[80:83], v[188:191], a[232:235], v[80:83]
    v_exp_f32 v173, v31
    v_mfma_f32_16x16x32_bf16 v[84:87], v[192:195], a[172:175], v[148:151]
    v_add_f32 v157, v157, v172
    v_mfma_f32_16x16x32_bf16 v[84:87], v[196:199], a[192:195], v[84:87]
    v_nop
    v_mfma_f32_16x16x32_bf16 v[84:87], v[200:203], a[212:215], v[84:87]
    v_add_f32 v157, v157, v173
    v_cvt_pk_bf16_f32 v103, v172, v173
    v_mfma_f32_16x16x32_bf16 v[84:87], v[204:207], a[232:235], v[84:87]
    v_exp_f32 v166, v32
    v_mfma_f32_16x16x32_bf16 v[88:91], v[176:179], a[176:179], v[152:155]
    v_exp_f32 v167, v33
    v_mfma_f32_16x16x32_bf16 v[88:91], v[180:183], a[196:199], v[88:91]
    v_exp_f32 v168, v34
    v_mfma_f32_16x16x32_bf16 v[88:91], v[184:187], a[216:219], v[88:91]
    v_add_f32 v158, v166, v167
    v_mfma_f32_16x16x32_bf16 v[88:91], v[188:191], a[236:239], v[88:91]
    v_exp_f32 v169, v35
    v_cvt_pk_bf16_f32 v104, v166, v167
    v_mfma_f32_16x16x32_bf16 v[92:95], v[192:195], a[176:179], v[152:155]
    v_add_f32 v158, v158, v168
    v_mfma_f32_16x16x32_bf16 v[92:95], v[196:199], a[196:199], v[92:95]
    v_exp_f32 v170, v36
    v_mfma_f32_16x16x32_bf16 v[92:95], v[200:203], a[216:219], v[92:95]
    v_add_f32 v158, v158, v169
    v_mfma_f32_16x16x32_bf16 v[92:95], v[204:207], a[236:239], v[92:95]
    v_cvt_pk_bf16_f32 v105, v168, v169
    v_exp_f32 v171, v37
    s_waitcnt lgkmcnt(0)
    s_and_b32 s45, s43, 3
    v_add_f32 v158, v158, v170
    v_mfma_f32_16x16x32_bf16 a[0:3], v[208:211], v[116:119], a[0:3]
    v_exp_f32 v172, v38
    v_mfma_f32_16x16x32_bf16 a[20:23], v[212:215], v[116:119], a[20:23]
    v_add_f32 v158, v158, v171
    s_lshl_b32 s45, s45, 14
    v_mfma_f32_16x16x32_bf16 a[40:43], v[216:219], v[116:119], a[40:43]
    v_cvt_pk_bf16_f32 v106, v170, v171
    ds_read_b128 v[176:179], v240 offset:0
    v_exp_f32 v173, v39
    v_mfma_f32_16x16x32_bf16 a[60:63], v[220:223], v[116:119], a[60:63]
    v_add_f32 v158, v158, v172
    s_add_u32 s45, s45, s42
    v_mfma_f32_16x16x32_bf16 a[80:83], v[224:227], v[116:119], a[80:83]
    v_nop
    v_mfma_f32_16x16x32_bf16 a[100:103], v[228:231], v[116:119], a[100:103]
    v_add_f32 v158, v158, v173
    v_mfma_f32_16x16x32_bf16 a[120:123], v[232:235], v[116:119], a[120:123]
    s_cmp_lt_u32 s43, 16
    v_cvt_pk_bf16_f32 v107, v172, v173
    ds_read_b128 v[180:183], v241 offset:0
    v_mfma_f32_16x16x32_bf16 a[140:143], v[236:239], v[116:119], a[140:143]
    v_exp_f32 v166, v40
    v_exp_f32 v167, v41
    v_mfma_f32_16x16x32_bf16 a[4:7], v[208:211], v[120:123], a[4:7]
    s_cselect_b32 s45, s45, 0x24000
    v_exp_f32 v168, v42
    v_mfma_f32_16x16x32_bf16 a[24:27], v[212:215], v[120:123], a[24:27]
    v_add_f32 v159, v166, v167
    v_mfma_f32_16x16x32_bf16 a[44:47], v[216:219], v[120:123], a[44:47]
    v_exp_f32 v169, v43
    s_lshl_b32 s44, s43, 13
    ds_read_b128 v[184:187], v242 offset:0
    v_mfma_f32_16x16x32_bf16 a[64:67], v[220:223], v[120:123], a[64:67]
    v_cvt_pk_bf16_f32 v108, v166, v167
    v_add_f32 v159, v159, v168
    v_mfma_f32_16x16x32_bf16 a[84:87], v[224:227], v[120:123], a[84:87]
    s_mov_b32 m0, s45
    v_exp_f32 v170, v44
    v_mfma_f32_16x16x32_bf16 a[104:107], v[228:231], v[120:123], a[104:107]
    v_add_f32 v159, v159, v169
    v_mfma_f32_16x16x32_bf16 a[124:127], v[232:235], v[120:123], a[124:127]
    v_cvt_pk_bf16_f32 v109, v168, v169
    s_add_u32 s46, s44, 4096
    v_mfma_f32_16x16x32_bf16 a[144:147], v[236:239], v[120:123], a[144:147]
    v_exp_f32 v171, v45
    ds_read_b128 v[188:191], v243 offset:0
    v_add_f32 v159, v159, v170
    v_mfma_f32_16x16x32_bf16 a[8:11], v[208:211], v[124:127], a[8:11]
    v_exp_f32 v172, v46
    buffer_load_dwordx4 v252, s[24:27], s44 offen offset:0 nt lds
    v_mfma_f32_16x16x32_bf16 a[28:31], v[212:215], v[124:127], a[28:31]
    v_add_f32 v159, v159, v171
    v_mfma_f32_16x16x32_bf16 a[48:51], v[216:219], v[124:127], a[48:51]
    v_cvt_pk_bf16_f32 v110, v170, v171
    v_mfma_f32_16x16x32_bf16 a[68:71], v[220:223], v[124:127], a[68:71]
    buffer_load_dwordx4 v253, s[24:27], s44 offen offset:1024 nt lds
    v_exp_f32 v173, v47
    ds_read_b128 v[192:195], v240 offset:4096
    v_add_f32 v159, v159, v172
    v_mfma_f32_16x16x32_bf16 a[88:91], v[224:227], v[124:127], a[88:91]
    v_nop
    v_mfma_f32_16x16x32_bf16 a[108:111], v[228:231], v[124:127], a[108:111]
    buffer_load_dwordx4 v254, s[24:27], s44 offen offset:2048 nt lds
    v_add_f32 v159, v159, v173
    v_mfma_f32_16x16x32_bf16 a[128:131], v[232:235], v[124:127], a[128:131]
    v_cvt_pk_bf16_f32 v111, v172, v173
    v_mfma_f32_16x16x32_bf16 a[148:151], v[236:239], v[124:127], a[148:151]
    v_exp_f32 v166, v48
    buffer_load_dwordx4 v255, s[24:27], s44 offen offset:3072 nt lds
    v_mfma_f32_16x16x32_bf16 a[12:15], v[208:211], v[128:131], a[12:15]
    v_exp_f32 v167, v49
    ds_read_b128 v[196:199], v241 offset:4096
    v_exp_f32 v168, v50
    v_mfma_f32_16x16x32_bf16 a[32:35], v[212:215], v[128:131], a[32:35]
    s_add_u32 m0, s45, 4096
    v_add_f32 v160, v166, v167
    v_mfma_f32_16x16x32_bf16 a[52:55], v[216:219], v[128:131], a[52:55]
    v_exp_f32 v169, v51
    v_mfma_f32_16x16x32_bf16 a[72:75], v[220:223], v[128:131], a[72:75]
    v_cvt_pk_bf16_f32 v112, v166, v167
    s_add_u32 s43, s43, 1
    v_mfma_f32_16x16x32_bf16 a[92:95], v[224:227], v[128:131], a[92:95]
    v_add_f32 v160, v160, v168
    ds_read_b128 v[200:203], v242 offset:4096
    v_exp_f32 v170, v52
    v_mfma_f32_16x16x32_bf16 a[112:115], v[228:231], v[128:131], a[112:115]
    v_add_f32 v160, v160, v169
    buffer_load_dwordx4 v252, s[24:27], s46 offen offset:0 nt lds
    v_mfma_f32_16x16x32_bf16 a[132:135], v[232:235], v[128:131], a[132:135]
    v_cvt_pk_bf16_f32 v113, v168, v169
    v_mfma_f32_16x16x32_bf16 a[152:155], v[236:239], v[128:131], a[152:155]
    v_exp_f32 v171, v53
    buffer_load_dwordx4 v253, s[24:27], s46 offen offset:1024 nt lds
    v_mfma_f32_16x16x32_bf16 a[16:19], v[208:211], v[132:135], a[16:19]
    v_add_f32 v160, v160, v170
    ds_read_b128 v[204:207], v243 offset:4096
    v_exp_f32 v172, v54
    v_mfma_f32_16x16x32_bf16 a[36:39], v[212:215], v[132:135], a[36:39]
    v_add_f32 v160, v160, v171
    v_mfma_f32_16x16x32_bf16 a[56:59], v[216:219], v[132:135], a[56:59]
    buffer_load_dwordx4 v254, s[24:27], s46 offen offset:2048 nt lds
    v_cvt_pk_bf16_f32 v114, v170, v171
    v_mfma_f32_16x16x32_bf16 a[76:79], v[220:223], v[132:135], a[76:79]
    v_exp_f32 v173, v55
    v_mfma_f32_16x16x32_bf16 a[96:99], v[224:227], v[132:135], a[96:99]
    v_add_f32 v160, v160, v172
    buffer_load_dwordx4 v255, s[24:27], s46 offen offset:3072 nt lds
    v_nop
    v_mfma_f32_16x16x32_bf16 a[116:119], v[228:231], v[132:135], a[116:119]
    v_add_f32 v160, v160, v173
    v_mfma_f32_16x16x32_bf16 a[136:139], v[232:235], v[132:135], a[136:139]
    v_cvt_pk_bf16_f32 v115, v172, v173
    v_mfma_f32_16x16x32_bf16 a[156:159], v[236:239], v[132:135], a[156:159]
    v_max3_f32 v174, v156, v157, v158
    v_max3_f32 v174, v174, v159, v160
    v_cmp_nge_f32 vcc, s50, v174
    s_cbranch_vccz K1_OK_4
    s_call_b64 s[52:53], K1_FB0
K1_OK_4:
    v_add_f32 v161, v161, v156
    v_add_f32 v162, v162, v157
    v_add_f32 v163, v163, v158
    v_add_f32 v164, v164, v159
    v_add_f32 v165, v165, v160
    s_waitcnt vmcnt(16) lgkmcnt(0)
    s_barrier
    v_exp_f32 v166, v56
    ds_read_b64_tr_b16 v[208:209], v244 offset:32768
    v_mfma_f32_16x16x32_bf16 v[16:19], v[176:179], a[160:163], v[136:139]
    v_exp_f32 v167, v57
    v_mfma_f32_16x16x32_bf16 v[16:19], v[180:183], a[180:183], v[16:19]
    v_exp_f32 v168, v58
    ds_read_b64_tr_b16 v[210:211], v244 offset:36864
    v_add_f32 v156, v166, v167
    v_mfma_f32_16x16x32_bf16 v[16:19], v[184:187], a[200:203], v[16:19]
    v_exp_f32 v169, v59
    ds_read_b64_tr_b16 v[212:213], v245 offset:32768
    v_mfma_f32_16x16x32_bf16 v[16:19], v[188:191], a[220:223], v[16:19]
    v_cvt_pk_bf16_f32 v116, v166, v167
    v_mfma_f32_16x16x32_bf16 v[20:23], v[192:195], a[160:163], v[136:139]
    v_add_f32 v156, v156, v168
    ds_read_b64_tr_b16 v[214:215], v245 offset:36864
    v_mfma_f32_16x16x32_bf16 v[20:23], v[196:199], a[180:183], v[20:23]
    v_exp_f32 v170, v60
    ds_read_b64_tr_b16 v[216:217], v246 offset:32768
    v_add_f32 v156, v156, v169
    v_mfma_f32_16x16x32_bf16 v[20:23], v[200:203], a[200:203], v[20:23]
    v_cvt_pk_bf16_f32 v117, v168, v169
    v_mfma_f32_16x16x32_bf16 v[20:23], v[204:207], a[220:223], v[20:23]
    ds_read_b64_tr_b16 v[218:219], v246 offset:36864
    v_exp_f32 v171, v61
    v_mfma_f32_16x16x32_bf16 v[24:27], v[176:179], a[164:167], v[140:143]
    v_add_f32 v156, v156, v170
    ds_read_b64_tr_b16 v[220:221], v247 offset:32768
    v_mfma_f32_16x16x32_bf16 v[24:27], v[180:183], a[184:187], v[24:27]
    v_exp_f32 v172, v62
    v_add_f32 v156, v156, v171
    v_mfma_f32_16x16x32_bf16 v[24:27], v[184:187], a[204:207], v[24:27]
    ds_read_b64_tr_b16 v[222:223], v247 offset:36864
    v_cvt_pk_bf16_f32 v118, v170, v171
    v_mfma_f32_16x16x32_bf16 v[24:27], v[188:191], a[224:227], v[24:27]
    v_exp_f32 v173, v63
    ds_read_b64_tr_b16 v[224:225], v248 offset:32768
    v_mfma_f32_16x16x32_bf16 v[28:31], v[192:195], a[164:167], v[140:143]
    v_add_f32 v156, v156, v172
    v_mfma_f32_16x16x32_bf16 v[28:31], v[196:199], a[184:187], v[28:31]
    v_nop
    ds_read_b64_tr_b16 v[226:227], v248 offset:36864
    v_add_f32 v156, v156, v173
    v_mfma_f32_16x16x32_bf16 v[28:31], v[200:203], a[204:207], v[28:31]
    v_cvt_pk_bf16_f32 v119, v172, v173
    ds_read_b64_tr_b16 v[228:229], v249 offset:32768
    v_mfma_f32_16x16x32_bf16 v[28:31], v[204:207], a[224:227], v[28:31]
    v_exp_f32 v166, v64
    v_mfma_f32_16x16x32_bf16 v[32:35], v[176:179], a[168:171], v[144:147]
    v_exp_f32 v167, v65
    ds_read_b64_tr_b16 v[230:231], v249 offset:36864
    v_mfma_f32_16x16x32_bf16 v[32:35], v[180:183], a[188:191], v[32:35]
    v_exp_f32 v168, v66
    ds_read_b64_tr_b16 v[232:233], v250 offset:32768
    v_mfma_f32_16x16x32_bf16 v[32:35], v[184:187], a[208:211], v[32:35]
    v_add_f32 v157, v166, v167
    v_exp_f32 v169, v67
    v_mfma_f32_16x16x32_bf16 v[32:35], v[188:191], a[228:231], v[32:35]
    ds_read_b64_tr_b16 v[234:235], v250 offset:36864
    v_cvt_pk_bf16_f32 v120, v166, v167
    v_mfma_f32_16x16x32_bf16 v[36:39], v[192:195], a[168:171], v[144:147]
    v_add_f32 v157, v157, v168
    v_mfma_f32_16x16x32_bf16 v[36:39], v[196:199], a[188:191], v[36:39]
    ds_read_b64_tr_b16 v[236:237], v251 offset:32768
    v_exp_f32 v170, v68
    v_mfma_f32_16x16x32_bf16 v[36:39], v[200:203], a[208:211], v[36:39]
    v_add_f32 v157, v157, v169
    ds_read_b64_tr_b16 v[238:239], v251 offset:36864
    v_cvt_pk_bf16_f32 v121, v168, v169
    v_mfma_f32_16x16x32_bf16 v[36:39], v[204:207], a[228:231], v[36:39]
    v_exp_f32 v171, v69
    v_mfma_f32_16x16x32_bf16 v[40:43], v[176:179], a[172:175], v[148:151]
    v_add_f32 v157, v157, v170
    v_mfma_f32_16x16x32_bf16 v[40:43], v[180:183], a[192:195], v[40:43]
    v_exp_f32 v172, v70
    v_mfma_f32_16x16x32_bf16 v[40:43], v[184:187], a[212:215], v[40:43]
    v_add_f32 v157, v157, v171
    v_cvt_pk_bf16_f32 v122, v170, v171
    v_mfma_f32_16x16x32_bf16 v[40:43], v[188:191], a[232:235], v[40:43]
    v_exp_f32 v173, v71
    v_mfma_f32_16x16x32_bf16 v[44:47], v[192:195], a[172:175], v[148:151]
    v_add_f32 v157, v157, v172
    v_mfma_f32_16x16x32_bf16 v[44:47], v[196:199], a[192:195], v[44:47]
    v_nop
    v_mfma_f32_16x16x32_bf16 v[44:47], v[200:203], a[212:215], v[44:47]
    v_add_f32 v157, v157, v173
    v_cvt_pk_bf16_f32 v123, v172, v173
    v_mfma_f32_16x16x32_bf16 v[44:47], v[204:207], a[232:235], v[44:47]
    v_exp_f32 v166, v72
    v_mfma_f32_16x16x32_bf16 v[48:51], v[176:179], a[176:179], v[152:155]
    v_exp_f32 v167, v73
    v_mfma_f32_16x16x32_bf16 v[48:51], v[180:183], a[196:199], v[48:51]
    v_exp_f32 v168, v74
    v_mfma_f32_16x16x32_bf16 v[48:51], v[184:187], a[216:219], v[48:51]
    v_add_f32 v158, v166, v167
    v_mfma_f32_16x16x32_bf16 v[48:51], v[188:191], a[236:239], v[48:51]
    v_exp_f32 v169, v75
    v_cvt_pk_bf16_f32 v124, v166, v167
    v_mfma_f32_16x16x32_bf16 v[52:55], v[192:195], a[176:179], v[152:155]
    v_add_f32 v158, v158, v168
    v_mfma_f32_16x16x32_bf16 v[52:55], v[196:199], a[196:199], v[52:55]
    v_exp_f32 v170, v76
    v_mfma_f32_16x16x32_bf16 v[52:55], v[200:203], a[216:219], v[52:55]
    v_add_f32 v158, v158, v169
    v_mfma_f32_16x16x32_bf16 v[52:55], v[204:207], a[236:239], v[52:55]
    v_cvt_pk_bf16_f32 v125, v168, v169
    v_exp_f32 v171, v77
    s_waitcnt lgkmcnt(0)
    s_and_b32 s45, s43, 3
    v_add_f32 v158, v158, v170
    v_mfma_f32_16x16x32_bf16 a[0:3], v[208:211], v[96:99], a[0:3]
    v_exp_f32 v172, v78
    v_mfma_f32_16x16x32_bf16 a[20:23], v[212:215], v[96:99], a[20:23]
    v_add_f32 v158, v158, v171
    s_lshl_b32 s45, s45, 14
    v_mfma_f32_16x16x32_bf16 a[40:43], v[216:219], v[96:99], a[40:43]
    v_cvt_pk_bf16_f32 v126, v170, v171
    ds_read_b128 v[176:179], v240 offset:16384
    v_exp_f32 v173, v79
    v_mfma_f32_16x16x32_bf16 a[60:63], v[220:223], v[96:99], a[60:63]
    v_add_f32 v158, v158, v172
    s_add_u32 s45, s45, s42
    v_mfma_f32_16x16x32_bf16 a[80:83], v[224:227], v[96:99], a[80:83]
    v_nop
    v_mfma_f32_16x16x32_bf16 a[100:103], v[228:231], v[96:99], a[100:103]
    v_add_f32 v158, v158, v173
    v_mfma_f32_16x16x32_bf16 a[120:123], v[232:235], v[96:99], a[120:123]
    s_cmp_lt_u32 s43, 16
    v_cvt_pk_bf16_f32 v127, v172, v173
    ds_read_b128 v[180:183], v241 offset:16384
    v_mfma_f32_16x16x32_bf16 a[140:143], v[236:239], v[96:99], a[140:143]
    v_exp_f32 v166, v80
    v_exp_f32 v167, v81
    v_mfma_f32_16x16x32_bf16 a[4:7], v[208:211], v[100:103], a[4:7]
    s_cselect_b32 s45, s45, 0x24000
    v_exp_f32 v168, v82
    v_mfma_f32_16x16x32_bf16 a[24:27], v[212:215], v[100:103], a[24:27]
    v_add_f32 v159, v166, v167
    v_mfma_f32_16x16x32_bf16 a[44:47], v[216:219], v[100:103], a[44:47]
    v_exp_f32 v169, v83
    s_lshl_b32 s44, s43, 13
    ds_read_b128 v[184:187], v242 offset:16384
    v_mfma_f32_16x16x32_bf16 a[64:67], v[220:223], v[100:103], a[64:67]
    v_cvt_pk_bf16_f32 v128, v166, v167
    v_add_f32 v159, v159, v168
    v_mfma_f32_16x16x32_bf16 a[84:87], v[224:227], v[100:103], a[84:87]
    s_mov_b32 m0, s45
    v_exp_f32 v170, v84
    v_mfma_f32_16x16x32_bf16 a[104:107], v[228:231], v[100:103], a[104:107]
    v_add_f32 v159, v159, v169
    v_mfma_f32_16x16x32_bf16 a[124:127], v[232:235], v[100:103], a[124:127]
    v_cvt_pk_bf16_f32 v129, v168, v169
    s_add_u32 s46, s44, 4096
    v_mfma_f32_16x16x32_bf16 a[144:147], v[236:239], v[100:103], a[144:147]
    v_exp_f32 v171, v85
    ds_read_b128 v[188:191], v243 offset:16384
    v_add_f32 v159, v159, v170
    v_mfma_f32_16x16x32_bf16 a[8:11], v[208:211], v[104:107], a[8:11]
    v_exp_f32 v172, v86
    buffer_load_dwordx4 v252, s[24:27], s44 offen offset:0 nt lds
    v_mfma_f32_16x16x32_bf16 a[28:31], v[212:215], v[104:107], a[28:31]
    v_add_f32 v159, v159, v171
    v_mfma_f32_16x16x32_bf16 a[48:51], v[216:219], v[104:107], a[48:51]
    v_cvt_pk_bf16_f32 v130, v170, v171
    v_mfma_f32_16x16x32_bf16 a[68:71], v[220:223], v[104:107], a[68:71]
    buffer_load_dwordx4 v253, s[24:27], s44 offen offset:1024 nt lds
    v_exp_f32 v173, v87
    ds_read_b128 v[192:195], v240 offset:20480
    v_add_f32 v159, v159, v172
    v_mfma_f32_16x16x32_bf16 a[88:91], v[224:227], v[104:107], a[88:91]
    v_nop
    v_mfma_f32_16x16x32_bf16 a[108:111], v[228:231], v[104:107], a[108:111]
    buffer_load_dwordx4 v254, s[24:27], s44 offen offset:2048 nt lds
    v_add_f32 v159, v159, v173
    v_mfma_f32_16x16x32_bf16 a[128:131], v[232:235], v[104:107], a[128:131]
    v_cvt_pk_bf16_f32 v131, v172, v173
    v_mfma_f32_16x16x32_bf16 a[148:151], v[236:239], v[104:107], a[148:151]
    v_exp_f32 v166, v88
    buffer_load_dwordx4 v255, s[24:27], s44 offen offset:3072 nt lds
    v_mfma_f32_16x16x32_bf16 a[12:15], v[208:211], v[108:111], a[12:15]
    v_exp_f32 v167, v89
    ds_read_b128 v[196:199], v241 offset:20480
    v_exp_f32 v168, v90
    v_mfma_f32_16x16x32_bf16 a[32:35], v[212:215], v[108:111], a[32:35]
    s_add_u32 m0, s45, 4096
    v_add_f32 v160, v166, v167
    v_mfma_f32_16x16x32_bf16 a[52:55], v[216:219], v[108:111], a[52:55]
    v_exp_f32 v169, v91
    v_mfma_f32_16x16x32_bf16 a[72:75], v[220:223], v[108:111], a[72:75]
    v_cvt_pk_bf16_f32 v132, v166, v167
    s_add_u32 s43, s43, 1
    v_mfma_f32_16x16x32_bf16 a[92:95], v[224:227], v[108:111], a[92:95]
    v_add_f32 v160, v160, v168
    ds_read_b128 v[200:203], v242 offset:20480
    v_exp_f32 v170, v92
    v_mfma_f32_16x16x32_bf16 a[112:115], v[228:231], v[108:111], a[112:115]
    v_add_f32 v160, v160, v169
    buffer_load_dwordx4 v252, s[24:27], s46 offen offset:0 nt lds
    v_mfma_f32_16x16x32_bf16 a[132:135], v[232:235], v[108:111], a[132:135]
    v_cvt_pk_bf16_f32 v133, v168, v169
    v_mfma_f32_16x16x32_bf16 a[152:155], v[236:239], v[108:111], a[152:155]
    v_exp_f32 v171, v93
    buffer_load_dwordx4 v253, s[24:27], s46 offen offset:1024 nt lds
    v_mfma_f32_16x16x32_bf16 a[16:19], v[208:211], v[112:115], a[16:19]
    v_add_f32 v160, v160, v170
    ds_read_b128 v[204:207], v243 offset:20480
    v_exp_f32 v172, v94
    v_mfma_f32_16x16x32_bf16 a[36:39], v[212:215], v[112:115], a[36:39]
    v_add_f32 v160, v160, v171
    v_mfma_f32_16x16x32_bf16 a[56:59], v[216:219], v[112:115], a[56:59]
    buffer_load_dwordx4 v254, s[24:27], s46 offen offset:2048 nt lds
    v_cvt_pk_bf16_f32 v134, v170, v171
    v_mfma_f32_16x16x32_bf16 a[76:79], v[220:223], v[112:115], a[76:79]
    v_exp_f32 v173, v95
    v_mfma_f32_16x16x32_bf16 a[96:99], v[224:227], v[112:115], a[96:99]
    v_add_f32 v160, v160, v172
    buffer_load_dwordx4 v255, s[24:27], s46 offen offset:3072 nt lds
    v_nop
    v_mfma_f32_16x16x32_bf16 a[116:119], v[228:231], v[112:115], a[116:119]
    v_add_f32 v160, v160, v173
    v_mfma_f32_16x16x32_bf16 a[136:139], v[232:235], v[112:115], a[136:139]
    v_cvt_pk_bf16_f32 v135, v172, v173
    v_mfma_f32_16x16x32_bf16 a[156:159], v[236:239], v[112:115], a[156:159]
    v_max3_f32 v174, v156, v157, v158
    v_max3_f32 v174, v174, v159, v160
    v_cmp_nge_f32 vcc, s50, v174
    s_cbranch_vccz K1_OK_5
    s_call_b64 s[52:53], K1_FB1
K1_OK_5:
    v_add_f32 v161, v161, v156
    v_add_f32 v162, v162, v157
    v_add_f32 v163, v163, v158
    v_add_f32 v164, v164, v159
    v_add_f32 v165, v165, v160
    s_waitcnt vmcnt(16) lgkmcnt(0)
    s_barrier
    v_exp_f32 v166, v16
    ds_read_b64_tr_b16 v[208:209], v244 offset:49152
    v_mfma_f32_16x16x32_bf16 v[56:59], v[176:179], a[160:163], v[136:139]
    v_exp_f32 v167, v17
    v_mfma_f32_16x16x32_bf16 v[56:59], v[180:183], a[180:183], v[56:59]
    v_exp_f32 v168, v18
    ds_read_b64_tr_b16 v[210:211], v244 offset:53248
    v_add_f32 v156, v166, v167
    v_mfma_f32_16x16x32_bf16 v[56:59], v[184:187], a[200:203], v[56:59]
    v_exp_f32 v169, v19
    ds_read_b64_tr_b16 v[212:213], v245 offset:49152
    v_mfma_f32_16x16x32_bf16 v[56:59], v[188:191], a[220:223], v[56:59]
    v_cvt_pk_bf16_f32 v96, v166, v167
    v_mfma_f32_16x16x32_bf16 v[60:63], v[192:195], a[160:163], v[136:139]
    v_add_f32 v156, v156, v168
    ds_read_b64_tr_b16 v[214:215], v245 offset:53248
    v_mfma_f32_16x16x32_bf16 v[60:63], v[196:199], a[180:183], v[60:63]
    v_exp_f32 v170, v20
    ds_read_b64_tr_b16 v[216:217], v246 offset:49152
    v_add_f32 v156, v156, v169
    v_mfma_f32_16x16x32_bf16 v[60:63], v[200:203], a[200:203], v[60:63]
    v_cvt_pk_bf16_f32 v97, v168, v169
    v_mfma_f32_16x16x32_bf16 v[60:63], v[204:207], a[220:223], v[60:63]
    ds_read_b64_tr_b16 v[218:219], v246 offset:53248
    v_exp_f32 v171, v21
    v_mfma_f32_16x16x32_bf16 v[64:67], v[176:179], a[164:167], v[140:143]
    v_add_f32 v156, v156, v170
    ds_read_b64_tr_b16 v[220:221], v247 offset:49152
    v_mfma_f32_16x16x32_bf16 v[64:67], v[180:183], a[184:187], v[64:67]
    v_exp_f32 v172, v22
    v_add_f32 v156, v156, v171
    v_mfma_f32_16x16x32_bf16 v[64:67], v[184:187], a[204:207], v[64:67]
    ds_read_b64_tr_b16 v[222:223], v247 offset:53248
    v_cvt_pk_bf16_f32 v98, v170, v171
    v_mfma_f32_16x16x32_bf16 v[64:67], v[188:191], a[224:227], v[64:67]
    v_exp_f32 v173, v23
    ds_read_b64_tr_b16 v[224:225], v248 offset:49152
    v_mfma_f32_16x16x32_bf16 v[68:71], v[192:195], a[164:167], v[140:143]
    v_add_f32 v156, v156, v172
    v_mfma_f32_16x16x32_bf16 v[68:71], v[196:199], a[184:187], v[68:71]
    v_nop
    ds_read_b64_tr_b16 v[226:227], v248 offset:53248
    v_add_f32 v156, v156, v173
    v_mfma_f32_16x16x32_bf16 v[68:71], v[200:203], a[204:207], v[68:71]
    v_cvt_pk_bf16_f32 v99, v172, v173
    ds_read_b64_tr_b16 v[228:229], v249 offset:49152
    v_mfma_f32_16x16x32_bf16 v[68:71], v[204:207], a[224:227], v[68:71]
    v_exp_f32 v166, v24
    v_mfma_f32_16x16x32_bf16 v[72:75], v[176:179], a[168:171], v[144:147]
    v_exp_f32 v167, v25
    ds_read_b64_tr_b16 v[230:231], v249 offset:53248
    v_mfma_f32_16x16x32_bf16 v[72:75], v[180:183], a[188:191], v[72:75]
    v_exp_f32 v168, v26
    ds_read_b64_tr_b16 v[232:233], v250 offset:49152
    v_mfma_f32_16x16x32_bf16 v[72:75], v[184:187], a[208:211], v[72:75]
    v_add_f32 v157, v166, v167
    v_exp_f32 v169, v27
    v_mfma_f32_16x16x32_bf16 v[72:75], v[188:191], a[228:231], v[72:75]
    ds_read_b64_tr_b16 v[234:235], v250 offset:53248
    v_cvt_pk_bf16_f32 v100, v166, v167
    v_mfma_f32_16x16x32_bf16 v[76:79], v[192:195], a[168:171], v[144:147]
    v_add_f32 v157, v157, v168
    v_mfma_f32_16x16x32_bf16 v[76:79], v[196:199], a[188:191], v[76:79]
    ds_read_b64_tr_b16 v[236:237], v251 offset:49152
    v_exp_f32 v170, v28
    v_mfma_f32_16x16x32_bf16 v[76:79], v[200:203], a[208:211], v[76:79]
    v_add_f32 v157, v157, v169
    ds_read_b64_tr_b16 v[238:239], v251 offset:53248
    v_cvt_pk_bf16_f32 v101, v168, v169
    v_mfma_f32_16x16x32_bf16 v[76:79], v[204:207], a[228:231], v[76:79]
    v_exp_f32 v171, v29
    v_mfma_f32_16x16x32_bf16 v[80:83], v[176:179], a[172:175], v[148:151]
    v_add_f32 v157, v157, v170
    v_mfma_f32_16x16x32_bf16 v[80:83], v[180:183], a[192:195], v[80:83]
    v_exp_f32 v172, v30
    v_mfma_f32_16x16x32_bf16 v[80:83], v[184:187], a[212:215], v[80:83]
    v_add_f32 v157, v157, v171
    v_cvt_pk_bf16_f32 v102, v170, v171
    v_mfma_f32_16x16x32_bf16 v[80:83], v[188:191], a[232:235], v[80:83]
    v_exp_f32 v173, v31
    v_mfma_f32_16x16x32_bf16 v[84:87], v[192:195], a[172:175], v[148:151]
    v_add_f32 v157, v157, v172
    v_mfma_f32_16x16x32_bf16 v[84:87], v[196:199], a[192:195], v[84:87]
    v_nop
    v_mfma_f32_16x16x32_bf16 v[84:87], v[200:203], a[212:215], v[84:87]
    v_add_f32 v157, v157, v173
    v_cvt_pk_bf16_f32 v103, v172, v173
    v_mfma_f32_16x16x32_bf16 v[84:87], v[204:207], a[232:235], v[84:87]
    v_exp_f32 v166, v32
    v_mfma_f32_16x16x32_bf16 v[88:91], v[176:179], a[176:179], v[152:155]
    v_exp_f32 v167, v33
    v_mfma_f32_16x16x32_bf16 v[88:91], v[180:183], a[196:199], v[88:91]
    v_exp_f32 v168, v34
    v_mfma_f32_16x16x32_bf16 v[88:91], v[184:187], a[216:219], v[88:91]
    v_add_f32 v158, v166, v167
    v_mfma_f32_16x16x32_bf16 v[88:91], v[188:191], a[236:239], v[88:91]
    v_exp_f32 v169, v35
    v_cvt_pk_bf16_f32 v104, v166, v167
    v_mfma_f32_16x16x32_bf16 v[92:95], v[192:195], a[176:179], v[152:155]
    v_add_f32 v158, v158, v168
    v_mfma_f32_16x16x32_bf16 v[92:95], v[196:199], a[196:199], v[92:95]
    v_exp_f32 v170, v36
    v_mfma_f32_16x16x32_bf16 v[92:95], v[200:203], a[216:219], v[92:95]
    v_add_f32 v158, v158, v169
    v_mfma_f32_16x16x32_bf16 v[92:95], v[204:207], a[236:239], v[92:95]
    v_cvt_pk_bf16_f32 v105, v168, v169
    v_exp_f32 v171, v37
    s_waitcnt lgkmcnt(0)
    s_and_b32 s45, s43, 3
    v_add_f32 v158, v158, v170
    v_mfma_f32_16x16x32_bf16 a[0:3], v[208:211], v[116:119], a[0:3]
    v_exp_f32 v172, v38
    v_mfma_f32_16x16x32_bf16 a[20:23], v[212:215], v[116:119], a[20:23]
    v_add_f32 v158, v158, v171
    s_lshl_b32 s45, s45, 14
    v_mfma_f32_16x16x32_bf16 a[40:43], v[216:219], v[116:119], a[40:43]
    v_cvt_pk_bf16_f32 v106, v170, v171
    ds_read_b128 v[176:179], v240 offset:32768
    v_exp_f32 v173, v39
    v_mfma_f32_16x16x32_bf16 a[60:63], v[220:223], v[116:119], a[60:63]
    v_add_f32 v158, v158, v172
    s_add_u32 s45, s45, s42
    v_mfma_f32_16x16x32_bf16 a[80:83], v[224:227], v[116:119], a[80:83]
    v_nop
    v_mfma_f32_16x16x32_bf16 a[100:103], v[228:231], v[116:119], a[100:103]
    v_add_f32 v158, v158, v173
    v_mfma_f32_16x16x32_bf16 a[120:123], v[232:235], v[116:119], a[120:123]
    s_cmp_lt_u32 s43, 16
    v_cvt_pk_bf16_f32 v107, v172, v173
    ds_read_b128 v[180:183], v241 offset:32768
    v_mfma_f32_16x16x32_bf16 a[140:143], v[236:239], v[116:119], a[140:143]
    v_exp_f32 v166, v40
    v_exp_f32 v167, v41
    v_mfma_f32_16x16x32_bf16 a[4:7], v[208:211], v[120:123], a[4:7]
    s_cselect_b32 s45, s45, 0x24000
    v_exp_f32 v168, v42
    v_mfma_f32_16x16x32_bf16 a[24:27], v[212:215], v[120:123], a[24:27]
    v_add_f32 v159, v166, v167
    v_mfma_f32_16x16x32_bf16 a[44:47], v[216:219], v[120:123], a[44:47]
    v_exp_f32 v169, v43
    s_lshl_b32 s44, s43, 13
    ds_read_b128 v[184:187], v242 offset:32768
    v_mfma_f32_16x16x32_bf16 a[64:67], v[220:223], v[120:123], a[64:67]
    v_cvt_pk_bf16_f32 v108, v166, v167
    v_add_f32 v159, v159, v168
    v_mfma_f32_16x16x32_bf16 a[84:87], v[224:227], v[120:123], a[84:87]
    s_mov_b32 m0, s45
    v_exp_f32 v170, v44
    v_mfma_f32_16x16x32_bf16 a[104:107], v[228:231], v[120:123], a[104:107]
    v_add_f32 v159, v159, v169
    v_mfma_f32_16x16x32_bf16 a[124:127], v[232:235], v[120:123], a[124:127]
    v_cvt_pk_bf16_f32 v109, v168, v169
    s_add_u32 s46, s44, 4096
    v_mfma_f32_16x16x32_bf16 a[144:147], v[236:239], v[120:123], a[144:147]
    v_exp_f32 v171, v45
    ds_read_b128 v[188:191], v243 offset:32768
    v_add_f32 v159, v159, v170
    v_mfma_f32_16x16x32_bf16 a[8:11], v[208:211], v[124:127], a[8:11]
    v_exp_f32 v172, v46
    buffer_load_dwordx4 v252, s[24:27], s44 offen offset:0 nt lds
    v_mfma_f32_16x16x32_bf16 a[28:31], v[212:215], v[124:127], a[28:31]
    v_add_f32 v159, v159, v171
    v_mfma_f32_16x16x32_bf16 a[48:51], v[216:219], v[124:127], a[48:51]
    v_cvt_pk_bf16_f32 v110, v170, v171
    v_mfma_f32_16x16x32_bf16 a[68:71], v[220:223], v[124:127], a[68:71]
    buffer_load_dwordx4 v253, s[24:27], s44 offen offset:1024 nt lds
    v_exp_f32 v173, v47
    ds_read_b128 v[192:195], v240 offset:36864
    v_add_f32 v159, v159, v172
    v_mfma_f32_16x16x32_bf16 a[88:91], v[224:227], v[124:127], a[88:91]
    v_nop
    v_mfma_f32_16x16x32_bf16 a[108:111], v[228:231], v[124:127], a[108:111]
    buffer_load_dwordx4 v254, s[24:27], s44 offen offset:2048 nt lds
    v_add_f32 v159, v159, v173
    v_mfma_f32_16x16x32_bf16 a[128:131], v[232:235], v[124:127], a[128:131]
    v_cvt_pk_bf16_f32 v111, v172, v173
    v_mfma_f32_16x16x32_bf16 a[148:151], v[236:239], v[124:127], a[148:151]
    v_exp_f32 v166, v48
    buffer_load_dwordx4 v255, s[24:27], s44 offen offset:3072 nt lds
    v_mfma_f32_16x16x32_bf16 a[12:15], v[208:211], v[128:131], a[12:15]
    v_exp_f32 v167, v49
    ds_read_b128 v[196:199], v241 offset:36864
    v_exp_f32 v168, v50
    v_mfma_f32_16x16x32_bf16 a[32:35], v[212:215], v[128:131], a[32:35]
    s_add_u32 m0, s45, 4096
    v_add_f32 v160, v166, v167
    v_mfma_f32_16x16x32_bf16 a[52:55], v[216:219], v[128:131], a[52:55]
    v_exp_f32 v169, v51
    v_mfma_f32_16x16x32_bf16 a[72:75], v[220:223], v[128:131], a[72:75]
    v_cvt_pk_bf16_f32 v112, v166, v167
    s_add_u32 s43, s43, 1
    v_mfma_f32_16x16x32_bf16 a[92:95], v[224:227], v[128:131], a[92:95]
    v_add_f32 v160, v160, v168
    ds_read_b128 v[200:203], v242 offset:36864
    v_exp_f32 v170, v52
    v_mfma_f32_16x16x32_bf16 a[112:115], v[228:231], v[128:131], a[112:115]
    v_add_f32 v160, v160, v169
    buffer_load_dwordx4 v252, s[24:27], s46 offen offset:0 nt lds
    v_mfma_f32_16x16x32_bf16 a[132:135], v[232:235], v[128:131], a[132:135]
    v_cvt_pk_bf16_f32 v113, v168, v169
    v_mfma_f32_16x16x32_bf16 a[152:155], v[236:239], v[128:131], a[152:155]
    v_exp_f32 v171, v53
    buffer_load_dwordx4 v253, s[24:27], s46 offen offset:1024 nt lds
    v_mfma_f32_16x16x32_bf16 a[16:19], v[208:211], v[132:135], a[16:19]
    v_add_f32 v160, v160, v170
    ds_read_b128 v[204:207], v243 offset:36864
    v_exp_f32 v172, v54
    v_mfma_f32_16x16x32_bf16 a[36:39], v[212:215], v[132:135], a[36:39]
    v_add_f32 v160, v160, v171
    v_mfma_f32_16x16x32_bf16 a[56:59], v[216:219], v[132:135], a[56:59]
    buffer_load_dwordx4 v254, s[24:27], s46 offen offset:2048 nt lds
    v_cvt_pk_bf16_f32 v114, v170, v171
    v_mfma_f32_16x16x32_bf16 a[76:79], v[220:223], v[132:135], a[76:79]
    v_exp_f32 v173, v55
    v_mfma_f32_16x16x32_bf16 a[96:99], v[224:227], v[132:135], a[96:99]
    v_add_f32 v160, v160, v172
    buffer_load_dwordx4 v255, s[24:27], s46 offen offset:3072 nt lds
    v_nop
    v_mfma_f32_16x16x32_bf16 a[116:119], v[228:231], v[132:135], a[116:119]
    v_add_f32 v160, v160, v173
    v_mfma_f32_16x16x32_bf16 a[136:139], v[232:235], v[132:135], a[136:139]
    v_cvt_pk_bf16_f32 v115, v172, v173
    v_mfma_f32_16x16x32_bf16 a[156:159], v[236:239], v[132:135], a[156:159]
    v_max3_f32 v174, v156, v157, v158
    v_max3_f32 v174, v174, v159, v160
    v_cmp_nge_f32 vcc, s50, v174
    s_cbranch_vccz K1_OK_6
    s_call_b64 s[52:53], K1_FB0
K1_OK_6:
    v_add_f32 v161, v161, v156
    v_add_f32 v162, v162, v157
    v_add_f32 v163, v163, v158
    v_add_f32 v164, v164, v159
    v_add_f32 v165, v165, v160
    s_waitcnt vmcnt(16) lgkmcnt(0)
    s_barrier
    v_exp_f32 v166, v56
    ds_read_b64_tr_b16 v[208:209], v244 offset:0
    v_mfma_f32_16x16x32_bf16 v[16:19], v[176:179], a[160:163], v[136:139]
    v_exp_f32 v167, v57
    v_mfma_f32_16x16x32_bf16 v[16:19], v[180:183], a[180:183], v[16:19]
    v_exp_f32 v168, v58
    ds_read_b64_tr_b16 v[210:211], v244 offset:4096
    v_add_f32 v156, v166, v167
    v_mfma_f32_16x16x32_bf16 v[16:19], v[184:187], a[200:203], v[16:19]
    v_exp_f32 v169, v59
    ds_read_b64_tr_b16 v[212:213], v245 offset:0
    v_mfma_f32_16x16x32_bf16 v[16:19], v[188:191], a[220:223], v[16:19]
    v_cvt_pk_bf16_f32 v116, v166, v167
    v_mfma_f32_16x16x32_bf16 v[20:23], v[192:195], a[160:163], v[136:139]
    v_add_f32 v156, v156, v168
    ds_read_b64_tr_b16 v[214:215], v245 offset:4096
    v_mfma_f32_16x16x32_bf16 v[20:23], v[196:199], a[180:183], v[20:23]
    v_exp_f32 v170, v60
    ds_read_b64_tr_b16 v[216:217], v246 offset:0
    v_add_f32 v156, v156, v169
    v_mfma_f32_16x16x32_bf16 v[20:23], v[200:203], a[200:203], v[20:23]
    v_cvt_pk_bf16_f32 v117, v168, v169
    v_mfma_f32_16x16x32_bf16 v[20:23], v[204:207], a[220:223], v[20:23]
    ds_read_b64_tr_b16 v[218:219], v246 offset:4096
    v_exp_f32 v171, v61
    v_mfma_f32_16x16x32_bf16 v[24:27], v[176:179], a[164:167], v[140:143]
    v_add_f32 v156, v156, v170
    ds_read_b64_tr_b16 v[220:221], v247 offset:0
    v_mfma_f32_16x16x32_bf16 v[24:27], v[180:183], a[184:187], v[24:27]
    v_exp_f32 v172, v62
    v_add_f32 v156, v156, v171
    v_mfma_f32_16x16x32_bf16 v[24:27], v[184:187], a[204:207], v[24:27]
    ds_read_b64_tr_b16 v[222:223], v247 offset:4096
    v_cvt_pk_bf16_f32 v118, v170, v171
    v_mfma_f32_16x16x32_bf16 v[24:27], v[188:191], a[224:227], v[24:27]
    v_exp_f32 v173, v63
    ds_read_b64_tr_b16 v[224:225], v248 offset:0
    v_mfma_f32_16x16x32_bf16 v[28:31], v[192:195], a[164:167], v[140:143]
    v_add_f32 v156, v156, v172
    v_mfma_f32_16x16x32_bf16 v[28:31], v[196:199], a[184:187], v[28:31]
    v_nop
    ds_read_b64_tr_b16 v[226:227], v248 offset:4096
    v_add_f32 v156, v156, v173
    v_mfma_f32_16x16x32_bf16 v[28:31], v[200:203], a[204:207], v[28:31]
    v_cvt_pk_bf16_f32 v119, v172, v173
    ds_read_b64_tr_b16 v[228:229], v249 offset:0
    v_mfma_f32_16x16x32_bf16 v[28:31], v[204:207], a[224:227], v[28:31]
    v_exp_f32 v166, v64
    v_mfma_f32_16x16x32_bf16 v[32:35], v[176:179], a[168:171], v[144:147]
    v_exp_f32 v167, v65
    ds_read_b64_tr_b16 v[230:231], v249 offset:4096
    v_mfma_f32_16x16x32_bf16 v[32:35], v[180:183], a[188:191], v[32:35]
    v_exp_f32 v168, v66
    ds_read_b64_tr_b16 v[232:233], v250 offset:0
    v_mfma_f32_16x16x32_bf16 v[32:35], v[184:187], a[208:211], v[32:35]
    v_add_f32 v157, v166, v167
    v_exp_f32 v169, v67
    v_mfma_f32_16x16x32_bf16 v[32:35], v[188:191], a[228:231], v[32:35]
    ds_read_b64_tr_b16 v[234:235], v250 offset:4096
    v_cvt_pk_bf16_f32 v120, v166, v167
    v_mfma_f32_16x16x32_bf16 v[36:39], v[192:195], a[168:171], v[144:147]
    v_add_f32 v157, v157, v168
    v_mfma_f32_16x16x32_bf16 v[36:39], v[196:199], a[188:191], v[36:39]
    ds_read_b64_tr_b16 v[236:237], v251 offset:0
    v_exp_f32 v170, v68
    v_mfma_f32_16x16x32_bf16 v[36:39], v[200:203], a[208:211], v[36:39]
    v_add_f32 v157, v157, v169
    ds_read_b64_tr_b16 v[238:239], v251 offset:4096
    v_cvt_pk_bf16_f32 v121, v168, v169
    v_mfma_f32_16x16x32_bf16 v[36:39], v[204:207], a[228:231], v[36:39]
    v_exp_f32 v171, v69
    v_mfma_f32_16x16x32_bf16 v[40:43], v[176:179], a[172:175], v[148:151]
    v_add_f32 v157, v157, v170
    v_mfma_f32_16x16x32_bf16 v[40:43], v[180:183], a[192:195], v[40:43]
    v_exp_f32 v172, v70
    v_mfma_f32_16x16x32_bf16 v[40:43], v[184:187], a[212:215], v[40:43]
    v_add_f32 v157, v157, v171
    v_cvt_pk_bf16_f32 v122, v170, v171
    v_mfma_f32_16x16x32_bf16 v[40:43], v[188:191], a[232:235], v[40:43]
    v_exp_f32 v173, v71
    v_mfma_f32_16x16x32_bf16 v[44:47], v[192:195], a[172:175], v[148:151]
    v_add_f32 v157, v157, v172
    v_mfma_f32_16x16x32_bf16 v[44:47], v[196:199], a[192:195], v[44:47]
    v_nop
    v_mfma_f32_16x16x32_bf16 v[44:47], v[200:203], a[212:215], v[44:47]
    v_add_f32 v157, v157, v173
    v_cvt_pk_bf16_f32 v123, v172, v173
    v_mfma_f32_16x16x32_bf16 v[44:47], v[204:207], a[232:235], v[44:47]
    v_exp_f32 v166, v72
    v_mfma_f32_16x16x32_bf16 v[48:51], v[176:179], a[176:179], v[152:155]
    v_exp_f32 v167, v73
    v_mfma_f32_16x16x32_bf16 v[48:51], v[180:183], a[196:199], v[48:51]
    v_exp_f32 v168, v74
    v_mfma_f32_16x16x32_bf16 v[48:51], v[184:187], a[216:219], v[48:51]
    v_add_f32 v158, v166, v167
    v_mfma_f32_16x16x32_bf16 v[48:51], v[188:191], a[236:239], v[48:51]
    v_exp_f32 v169, v75
    v_cvt_pk_bf16_f32 v124, v166, v167
    v_mfma_f32_16x16x32_bf16 v[52:55], v[192:195], a[176:179], v[152:155]
    v_add_f32 v158, v158, v168
    v_mfma_f32_16x16x32_bf16 v[52:55], v[196:199], a[196:199], v[52:55]
    v_exp_f32 v170, v76
    v_mfma_f32_16x16x32_bf16 v[52:55], v[200:203], a[216:219], v[52:55]
    v_add_f32 v158, v158, v169
    v_mfma_f32_16x16x32_bf16 v[52:55], v[204:207], a[236:239], v[52:55]
    v_cvt_pk_bf16_f32 v125, v168, v169
    v_exp_f32 v171, v77
    s_waitcnt lgkmcnt(0)
    s_and_b32 s45, s43, 3
    v_add_f32 v158, v158, v170
    v_mfma_f32_16x16x32_bf16 a[0:3], v[208:211], v[96:99], a[0:3]
    v_exp_f32 v172, v78
    v_mfma_f32_16x16x32_bf16 a[20:23], v[212:215], v[96:99], a[20:23]
    v_add_f32 v158, v158, v171
    s_lshl_b32 s45, s45, 14
    v_mfma_f32_16x16x32_bf16 a[40:43], v[216:219], v[96:99], a[40:43]
    v_cvt_pk_bf16_f32 v126, v170, v171
    ds_read_b128 v[176:179], v240 offset:49152
    v_exp_f32 v173, v79
    v_mfma_f32_16x16x32_bf16 a[60:63], v[220:223], v[96:99], a[60:63]
    v_add_f32 v158, v158, v172
    s_add_u32 s45, s45, s42
    v_mfma_f32_16x16x32_bf16 a[80:83], v[224:227], v[96:99], a[80:83]
    v_nop
    v_mfma_f32_16x16x32_bf16 a[100:103], v[228:231], v[96:99], a[100:103]
    v_add_f32 v158, v158, v173
    v_mfma_f32_16x16x32_bf16 a[120:123], v[232:235], v[96:99], a[120:123]
    s_cmp_lt_u32 s43, 16
    v_cvt_pk_bf16_f32 v127, v172, v173
    ds_read_b128 v[180:183], v241 offset:49152
    v_mfma_f32_16x16x32_bf16 a[140:143], v[236:239], v[96:99], a[140:143]
    v_exp_f32 v166, v80
    v_exp_f32 v167, v81
    v_mfma_f32_16x16x32_bf16 a[4:7], v[208:211], v[100:103], a[4:7]
    s_cselect_b32 s45, s45, 0x24000
    v_exp_f32 v168, v82
    v_mfma_f32_16x16x32_bf16 a[24:27], v[212:215], v[100:103], a[24:27]
    v_add_f32 v159, v166, v167
    v_mfma_f32_16x16x32_bf16 a[44:47], v[216:219], v[100:103], a[44:47]
    v_exp_f32 v169, v83
    s_lshl_b32 s44, s43, 13
    ds_read_b128 v[184:187], v242 offset:49152
    v_mfma_f32_16x16x32_bf16 a[64:67], v[220:223], v[100:103], a[64:67]
    v_cvt_pk_bf16_f32 v128, v166, v167
    v_add_f32 v159, v159, v168
    v_mfma_f32_16x16x32_bf16 a[84:87], v[224:227], v[100:103], a[84:87]
    s_mov_b32 m0, s45
    v_exp_f32 v170, v84
    v_mfma_f32_16x16x32_bf16 a[104:107], v[228:231], v[100:103], a[104:107]
    v_add_f32 v159, v159, v169
    v_mfma_f32_16x16x32_bf16 a[124:127], v[232:235], v[100:103], a[124:127]
    v_cvt_pk_bf16_f32 v129, v168, v169
    s_add_u32 s46, s44, 4096
    v_mfma_f32_16x16x32_bf16 a[144:147], v[236:239], v[100:103], a[144:147]
    v_exp_f32 v171, v85
    ds_read_b128 v[188:191], v243 offset:49152
    v_add_f32 v159, v159, v170
    v_mfma_f32_16x16x32_bf16 a[8:11], v[208:211], v[104:107], a[8:11]
    v_exp_f32 v172, v86
    buffer_load_dwordx4 v252, s[24:27], s44 offen offset:0 nt lds
    v_mfma_f32_16x16x32_bf16 a[28:31], v[212:215], v[104:107], a[28:31]
    v_add_f32 v159, v159, v171
    v_mfma_f32_16x16x32_bf16 a[48:51], v[216:219], v[104:107], a[48:51]
    v_cvt_pk_bf16_f32 v130, v170, v171
    v_mfma_f32_16x16x32_bf16 a[68:71], v[220:223], v[104:107], a[68:71]
    buffer_load_dwordx4 v253, s[24:27], s44 offen offset:1024 nt lds
    v_exp_f32 v173, v87
    ds_read_b128 v[192:195], v240 offset:53248
    v_add_f32 v159, v159, v172
    v_mfma_f32_16x16x32_bf16 a[88:91], v[224:227], v[104:107], a[88:91]
    v_nop
    v_mfma_f32_16x16x32_bf16 a[108:111], v[228:231], v[104:107], a[108:111]
    buffer_load_dwordx4 v254, s[24:27], s44 offen offset:2048 nt lds
    v_add_f32 v159, v159, v173
    v_mfma_f32_16x16x32_bf16 a[128:131], v[232:235], v[104:107], a[128:131]
    v_cvt_pk_bf16_f32 v131, v172, v173
    v_mfma_f32_16x16x32_bf16 a[148:151], v[236:239], v[104:107], a[148:151]
    v_exp_f32 v166, v88
    buffer_load_dwordx4 v255, s[24:27], s44 offen offset:3072 nt lds
    v_mfma_f32_16x16x32_bf16 a[12:15], v[208:211], v[108:111], a[12:15]
    v_exp_f32 v167, v89
    ds_read_b128 v[196:199], v241 offset:53248
    v_exp_f32 v168, v90
    v_mfma_f32_16x16x32_bf16 a[32:35], v[212:215], v[108:111], a[32:35]
    s_add_u32 m0, s45, 4096
    v_add_f32 v160, v166, v167
    v_mfma_f32_16x16x32_bf16 a[52:55], v[216:219], v[108:111], a[52:55]
    v_exp_f32 v169, v91
    v_mfma_f32_16x16x32_bf16 a[72:75], v[220:223], v[108:111], a[72:75]
    v_cvt_pk_bf16_f32 v132, v166, v167
    s_add_u32 s43, s43, 1
    v_mfma_f32_16x16x32_bf16 a[92:95], v[224:227], v[108:111], a[92:95]
    v_add_f32 v160, v160, v168
    ds_read_b128 v[200:203], v242 offset:53248
    v_exp_f32 v170, v92
    v_mfma_f32_16x16x32_bf16 a[112:115], v[228:231], v[108:111], a[112:115]
    v_add_f32 v160, v160, v169
    buffer_load_dwordx4 v252, s[24:27], s46 offen offset:0 nt lds
    v_mfma_f32_16x16x32_bf16 a[132:135], v[232:235], v[108:111], a[132:135]
    v_cvt_pk_bf16_f32 v133, v168, v169
    v_mfma_f32_16x16x32_bf16 a[152:155], v[236:239], v[108:111], a[152:155]
    v_exp_f32 v171, v93
    buffer_load_dwordx4 v253, s[24:27], s46 offen offset:1024 nt lds
    v_mfma_f32_16x16x32_bf16 a[16:19], v[208:211], v[112:115], a[16:19]
    v_add_f32 v160, v160, v170
    ds_read_b128 v[204:207], v243 offset:53248
    v_exp_f32 v172, v94
    v_mfma_f32_16x16x32_bf16 a[36:39], v[212:215], v[112:115], a[36:39]
    v_add_f32 v160, v160, v171
    v_mfma_f32_16x16x32_bf16 a[56:59], v[216:219], v[112:115], a[56:59]
    buffer_load_dwordx4 v254, s[24:27], s46 offen offset:2048 nt lds
    v_cvt_pk_bf16_f32 v134, v170, v171
    v_mfma_f32_16x16x32_bf16 a[76:79], v[220:223], v[112:115], a[76:79]
    v_exp_f32 v173, v95
    v_mfma_f32_16x16x32_bf16 a[96:99], v[224:227], v[112:115], a[96:99]
    v_add_f32 v160, v160, v172
    buffer_load_dwordx4 v255, s[24:27], s46 offen offset:3072 nt lds
    v_nop
    v_mfma_f32_16x16x32_bf16 a[116:119], v[228:231], v[112:115], a[116:119]
    v_add_f32 v160, v160, v173
    v_mfma_f32_16x16x32_bf16 a[136:139], v[232:235], v[112:115], a[136:139]
    v_cvt_pk_bf16_f32 v135, v172, v173
    v_mfma_f32_16x16x32_bf16 a[156:159], v[236:239], v[112:115], a[156:159]
    v_max3_f32 v174, v156, v157, v158
    v_max3_f32 v174, v174, v159, v160
    v_cmp_nge_f32 vcc, s50, v174
    s_cbranch_vccz K1_OK_7
    s_call_b64 s[52:53], K1_FB1
K1_OK_7:
    v_add_f32 v161, v161, v156
    v_add_f32 v162, v162, v157
    v_add_f32 v163, v163, v158
    v_add_f32 v164, v164, v159
    v_add_f32 v165, v165, v160
    s_add_u32 s41, s41, 1
    s_cmp_lt_u32 s41, 3
    s_cbranch_scc1 K1_AL
    s_waitcnt vmcnt(16) lgkmcnt(0)
    s_barrier
    s_and_b32 s3, s57, 3
    s_mul_i32 s4, s68, 1179648
    s_mul_i32 s38, s3, 288
    s_add_u32 s4, s4, s38
    s_and_b32 s3, s3, 1
    s_lshl_b32 s3, s3, 5
    s_sub_u32 s4, s4, s3
    s_add_u32 s8, s76, s4
    s_addc_u32 s9, s77, 0
    s_sub_u32 s39, 4718592, s4
    s_mov_b32 s10, s39
    s_mov_b32 s11, 0x20000
    s_mul_i32 s3, s32, 5
    s_lshl_b32 s36, s3, 10
    s_add_u32 s36, s36, 0
    s_mov_b32 s4, 0xccccccd
    s_add_u32 s38, s3, 0
    s_lshl_b32 s38, s38, 6
    v_add_u32 v4, s38, v1
    v_mul_hi_u32 v5, v4, s4
    v_mul_u32_u24 v6, 20, v5
    v_sub_u32 v6, v4, v6
    v_bfe_u32 v7, v5, 2, 1
    v_lshlrev_b32 v7, 1, v7
    v_xor_b32 v6, v6, v7
    v_mul_u32_u24 v5, 1152, v5
    v_lshl_add_u32 v5, v6, 4, v5
    v_subrev_u32 v240, 0, v5
    s_add_u32 s38, s3, 1
    s_lshl_b32 s38, s38, 6
    v_add_u32 v4, s38, v1
    v_mul_hi_u32 v5, v4, s4
    v_mul_u32_u24 v6, 20, v5
    v_sub_u32 v6, v4, v6
    v_bfe_u32 v7, v5, 2, 1
    v_lshlrev_b32 v7, 1, v7
    v_xor_b32 v6, v6, v7
    v_mul_u32_u24 v5, 1152, v5
    v_lshl_add_u32 v5, v6, 4, v5
    v_subrev_u32 v241, 1024, v5
    s_add_u32 s38, s3, 2
    s_lshl_b32 s38, s38, 6
    v_add_u32 v4, s38, v1
    v_mul_hi_u32 v5, v4, s4
    v_mul_u32_u24 v6, 20, v5
    v_sub_u32 v6, v4, v6
    v_bfe_u32 v7, v5, 2, 1
    v_lshlrev_b32 v7, 1, v7
    v_xor_b32 v6, v6, v7
    v_mul_u32_u24 v5, 1152, v5
    v_lshl_add_u32 v5, v6, 4, v5
    v_subrev_u32 v242, 2048, v5
    s_add_u32 s38, s3, 3
    s_lshl_b32 s38, s38, 6
    v_add_u32 v4, s38, v1
    v_mul_hi_u32 v5, v4, s4
    v_mul_u32_u24 v6, 20, v5
    v_sub_u32 v6, v4, v6
    v_bfe_u32 v7, v5, 2, 1
    v_lshlrev_b32 v7, 1, v7
    v_xor_b32 v6, v6, v7
    v_mul_u32_u24 v5, 1152, v5
    v_lshl_add_u32 v5, v6, 4, v5
    v_subrev_u32 v243, 3072, v5
    s_add_u32 s38, s3, 4
    s_lshl_b32 s38, s38, 6
    v_add_u32 v4, s38, v1
    v_mul_hi_u32 v5, v4, s4
    v_mul_u32_u24 v6, 20, v5
    v_sub_u32 v6, v4, v6
    v_bfe_u32 v7, v5, 2, 1
    v_lshlrev_b32 v7, 1, v7
    v_xor_b32 v6, v6, v7
    v_mul_u32_u24 v5, 1152, v5
    v_lshl_add_u32 v5, v6, 4, v5
    v_subrev_u32 v253, 0, v5
    s_and_b32 s3, s57, 3
    s_mul_i32 s38, s3, 294912
    s_add_u32 m0, s36, 61440
    s_nop 0
    buffer_load_dwordx4 v240, s[8:11], s38 offen offset:0 lds
    buffer_load_dwordx4 v241, s[8:11], s38 offen offset:1024 lds
    buffer_load_dwordx4 v242, s[8:11], s38 offen offset:2048 lds
    buffer_load_dwordx4 v243, s[8:11], s38 offen offset:3072 lds
    s_add_u32 m0, s36, 65536
    s_nop 0
    buffer_load_dwordx4 v253, s[8:11], s38 offen offset:0 lds
    s_and_b32 s3, s57, 3
    s_lshl_b32 s3, s3, 1
    s_add_u32 s3, s3, 0
    s_mul_i32 s38, s3, 147456
    s_add_u32 s38, s38, 73728
    s_add_u32 m0, s36, 0
    s_nop 0
    buffer_load_dwordx4 v240, s[8:11], s38 offen offset:0 lds
    buffer_load_dwordx4 v241, s[8:11], s38 offen offset:1024 lds
    buffer_load_dwordx4 v242, s[8:11], s38 offen offset:2048 lds
    buffer_load_dwordx4 v243, s[8:11], s38 offen offset:3072 lds
    s_add_u32 m0, s36, 4096
    s_nop 0
    buffer_load_dwordx4 v253, s[8:11], s38 offen offset:0 lds
    v_exp_f32 v166, v16
    ds_read_b64_tr_b16 v[208:209], v244 offset:16384
    v_mfma_f32_16x16x32_bf16 v[56:59], v[176:179], a[160:163], v[136:139]
    v_exp_f32 v167, v17
    v_mfma_f32_16x16x32_bf16 v[56:59], v[180:183], a[180:183], v[56:59]
    v_exp_f32 v168, v18
    ds_read_b64_tr_b16 v[210:211], v244 offset:20480
    v_add_f32 v156, v166, v167
    v_mfma_f32_16x16x32_bf16 v[56:59], v[184:187], a[200:203], v[56:59]
    v_exp_f32 v169, v19
    ds_read_b64_tr_b16 v[212:213], v245 offset:16384
    v_mfma_f32_16x16x32_bf16 v[56:59], v[188:191], a[220:223], v[56:59]
    v_cvt_pk_bf16_f32 v96, v166, v167
    v_mfma_f32_16x16x32_bf16 v[60:63], v[192:195], a[160:163], v[136:139]
    v_add_f32 v156, v156, v168
    ds_read_b64_tr_b16 v[214:215], v245 offset:20480
    v_mfma_f32_16x16x32_bf16 v[60:63], v[196:199], a[180:183], v[60:63]
    v_exp_f32 v170, v20
    ds_read_b64_tr_b16 v[216:217], v246 offset:16384
    v_add_f32 v156, v156, v169
    v_mfma_f32_16x16x32_bf16 v[60:63], v[200:203], a[200:203], v[60:63]
    v_cvt_pk_bf16_f32 v97, v168, v169
    v_mfma_f32_16x16x32_bf16 v[60:63], v[204:207], a[220:223], v[60:63]
    ds_read_b64_tr_b16 v[218:219], v246 offset:20480
    v_exp_f32 v171, v21
    v_mfma_f32_16x16x32_bf16 v[64:67], v[176:179], a[164:167], v[140:143]
    v_add_f32 v156, v156, v170
    ds_read_b64_tr_b16 v[220:221], v247 offset:16384
    v_mfma_f32_16x16x32_bf16 v[64:67], v[180:183], a[184:187], v[64:67]
    v_exp_f32 v172, v22
    v_add_f32 v156, v156, v171
    v_mfma_f32_16x16x32_bf16 v[64:67], v[184:187], a[204:207], v[64:67]
    ds_read_b64_tr_b16 v[222:223], v247 offset:20480
    v_cvt_pk_bf16_f32 v98, v170, v171
    v_mfma_f32_16x16x32_bf16 v[64:67], v[188:191], a[224:227], v[64:67]
    v_exp_f32 v173, v23
    ds_read_b64_tr_b16 v[224:225], v248 offset:16384
    v_mfma_f32_16x16x32_bf16 v[68:71], v[192:195], a[164:167], v[140:143]
    v_add_f32 v156, v156, v172
    v_mfma_f32_16x16x32_bf16 v[68:71], v[196:199], a[184:187], v[68:71]
    v_nop
    ds_read_b64_tr_b16 v[226:227], v248 offset:20480
    v_add_f32 v156, v156, v173
    v_mfma_f32_16x16x32_bf16 v[68:71], v[200:203], a[204:207], v[68:71]
    v_cvt_pk_bf16_f32 v99, v172, v173
    ds_read_b64_tr_b16 v[228:229], v249 offset:16384
    v_mfma_f32_16x16x32_bf16 v[68:71], v[204:207], a[224:227], v[68:71]
    v_exp_f32 v166, v24
    v_mfma_f32_16x16x32_bf16 v[72:75], v[176:179], a[168:171], v[144:147]
    v_exp_f32 v167, v25
    ds_read_b64_tr_b16 v[230:231], v249 offset:20480
    v_mfma_f32_16x16x32_bf16 v[72:75], v[180:183], a[188:191], v[72:75]
    v_exp_f32 v168, v26
    ds_read_b64_tr_b16 v[232:233], v250 offset:16384
    v_mfma_f32_16x16x32_bf16 v[72:75], v[184:187], a[208:211], v[72:75]
    v_add_f32 v157, v166, v167
    v_exp_f32 v169, v27
    v_mfma_f32_16x16x32_bf16 v[72:75], v[188:191], a[228:231], v[72:75]
    ds_read_b64_tr_b16 v[234:235], v250 offset:20480
    v_cvt_pk_bf16_f32 v100, v166, v167
    v_mfma_f32_16x16x32_bf16 v[76:79], v[192:195], a[168:171], v[144:147]
    v_add_f32 v157, v157, v168
    v_mfma_f32_16x16x32_bf16 v[76:79], v[196:199], a[188:191], v[76:79]
    ds_read_b64_tr_b16 v[236:237], v251 offset:16384
    v_exp_f32 v170, v28
    v_mfma_f32_16x16x32_bf16 v[76:79], v[200:203], a[208:211], v[76:79]
    v_add_f32 v157, v157, v169
    ds_read_b64_tr_b16 v[238:239], v251 offset:20480
    v_cvt_pk_bf16_f32 v101, v168, v169
    v_mfma_f32_16x16x32_bf16 v[76:79], v[204:207], a[228:231], v[76:79]
    v_exp_f32 v171, v29
    v_mfma_f32_16x16x32_bf16 v[80:83], v[176:179], a[172:175], v[148:151]
    v_add_f32 v157, v157, v170
    v_mfma_f32_16x16x32_bf16 v[80:83], v[180:183], a[192:195], v[80:83]
    v_exp_f32 v172, v30
    v_mfma_f32_16x16x32_bf16 v[80:83], v[184:187], a[212:215], v[80:83]
    v_add_f32 v157, v157, v171
    v_cvt_pk_bf16_f32 v102, v170, v171
    v_mfma_f32_16x16x32_bf16 v[80:83], v[188:191], a[232:235], v[80:83]
    v_exp_f32 v173, v31
    v_mfma_f32_16x16x32_bf16 v[84:87], v[192:195], a[172:175], v[148:151]
    v_add_f32 v157, v157, v172
    v_mfma_f32_16x16x32_bf16 v[84:87], v[196:199], a[192:195], v[84:87]
    v_nop
    v_mfma_f32_16x16x32_bf16 v[84:87], v[200:203], a[212:215], v[84:87]
    v_add_f32 v157, v157, v173
    v_cvt_pk_bf16_f32 v103, v172, v173
    v_mfma_f32_16x16x32_bf16 v[84:87], v[204:207], a[232:235], v[84:87]
    v_exp_f32 v166, v32
    v_mfma_f32_16x16x32_bf16 v[88:91], v[176:179], a[176:179], v[152:155]
    v_exp_f32 v167, v33
    v_mfma_f32_16x16x32_bf16 v[88:91], v[180:183], a[196:199], v[88:91]
    v_exp_f32 v168, v34
    v_mfma_f32_16x16x32_bf16 v[88:91], v[184:187], a[216:219], v[88:91]
    v_add_f32 v158, v166, v167
    v_mfma_f32_16x16x32_bf16 v[88:91], v[188:191], a[236:239], v[88:91]
    v_exp_f32 v169, v35
    v_cvt_pk_bf16_f32 v104, v166, v167
    v_mfma_f32_16x16x32_bf16 v[92:95], v[192:195], a[176:179], v[152:155]
    v_add_f32 v158, v158, v168
    v_mfma_f32_16x16x32_bf16 v[92:95], v[196:199], a[196:199], v[92:95]
    v_exp_f32 v170, v36
    v_mfma_f32_16x16x32_bf16 v[92:95], v[200:203], a[216:219], v[92:95]
    v_add_f32 v158, v158, v169
    v_mfma_f32_16x16x32_bf16 v[92:95], v[204:207], a[236:239], v[92:95]
    v_cvt_pk_bf16_f32 v105, v168, v169
    v_exp_f32 v171, v37
    s_waitcnt lgkmcnt(0)
    v_add_f32 v158, v158, v170
    v_mfma_f32_16x16x32_bf16 a[0:3], v[208:211], v[116:119], a[0:3]
    v_exp_f32 v172, v38
    v_mfma_f32_16x16x32_bf16 a[20:23], v[212:215], v[116:119], a[20:23]
    v_add_f32 v158, v158, v171
    v_mfma_f32_16x16x32_bf16 a[40:43], v[216:219], v[116:119], a[40:43]
    v_cvt_pk_bf16_f32 v106, v170, v171
    v_exp_f32 v173, v39
    v_mfma_f32_16x16x32_bf16 a[60:63], v[220:223], v[116:119], a[60:63]
    v_add_f32 v158, v158, v172
    v_mfma_f32_16x16x32_bf16 a[80:83], v[224:227], v[116:119], a[80:83]
    v_nop
    v_mfma_f32_16x16x32_bf16 a[100:103], v[228:231], v[116:119], a[100:103]
    v_add_f32 v158, v158, v173
    v_mfma_f32_16x16x32_bf16 a[120:123], v[232:235], v[116:119], a[120:123]
    v_cvt_pk_bf16_f32 v107, v172, v173
    v_mfma_f32_16x16x32_bf16 a[140:143], v[236:239], v[116:119], a[140:143]
    v_exp_f32 v166, v40
    v_exp_f32 v167, v41
    v_mfma_f32_16x16x32_bf16 a[4:7], v[208:211], v[120:123], a[4:7]
    v_exp_f32 v168, v42
    v_mfma_f32_16x16x32_bf16 a[24:27], v[212:215], v[120:123], a[24:27]
    v_add_f32 v159, v166, v167
    v_mfma_f32_16x16x32_bf16 a[44:47], v[216:219], v[120:123], a[44:47]
    v_exp_f32 v169, v43
    v_mfma_f32_16x16x32_bf16 a[64:67], v[220:223], v[120:123], a[64:67]
    v_cvt_pk_bf16_f32 v108, v166, v167
    v_add_f32 v159, v159, v168
    v_mfma_f32_16x16x32_bf16 a[84:87], v[224:227], v[120:123], a[84:87]
    v_exp_f32 v170, v44
    v_mfma_f32_16x16x32_bf16 a[104:107], v[228:231], v[120:123], a[104:107]
    v_add_f32 v159, v159, v169
    v_mfma_f32_16x16x32_bf16 a[124:127], v[232:235], v[120:123], a[124:127]
    v_cvt_pk_bf16_f32 v109, v168, v169
    v_mfma_f32_16x16x32_bf16 a[144:147], v[236:239], v[120:123], a[144:147]
    v_exp_f32 v171, v45
    v_add_f32 v159, v159, v170
    v_mfma_f32_16x16x32_bf16 a[8:11], v[208:211], v[124:127], a[8:11]
    v_exp_f32 v172, v46
    v_mfma_f32_16x16x32_bf16 a[28:31], v[212:215], v[124:127], a[28:31]
    v_add_f32 v159, v159, v171
    v_mfma_f32_16x16x32_bf16 a[48:51], v[216:219], v[124:127], a[48:51]
    v_cvt_pk_bf16_f32 v110, v170, v171
    v_mfma_f32_16x16x32_bf16 a[68:71], v[220:223], v[124:127], a[68:71]
    v_exp_f32 v173, v47
    v_add_f32 v159, v159, v172
    v_mfma_f32_16x16x32_bf16 a[88:91], v[224:227], v[124:127], a[88:91]
    v_nop
    v_mfma_f32_16x16x32_bf16 a[108:111], v[228:231], v[124:127], a[108:111]
    v_add_f32 v159, v159, v173
    v_mfma_f32_16x16x32_bf16 a[128:131], v[232:235], v[124:127], a[128:131]
    v_cvt_pk_bf16_f32 v111, v172, v173
    v_mfma_f32_16x16x32_bf16 a[148:151], v[236:239], v[124:127], a[148:151]
    v_exp_f32 v166, v48
    v_mfma_f32_16x16x32_bf16 a[12:15], v[208:211], v[128:131], a[12:15]
    v_exp_f32 v167, v49
    v_exp_f32 v168, v50
    v_mfma_f32_16x16x32_bf16 a[32:35], v[212:215], v[128:131], a[32:35]
    v_add_f32 v160, v166, v167
    v_mfma_f32_16x16x32_bf16 a[52:55], v[216:219], v[128:131], a[52:55]
    v_exp_f32 v169, v51
    v_mfma_f32_16x16x32_bf16 a[72:75], v[220:223], v[128:131], a[72:75]
    v_cvt_pk_bf16_f32 v112, v166, v167
    v_mfma_f32_16x16x32_bf16 a[92:95], v[224:227], v[128:131], a[92:95]
    v_add_f32 v160, v160, v168
    v_exp_f32 v170, v52
    v_mfma_f32_16x16x32_bf16 a[112:115], v[228:231], v[128:131], a[112:115]
    v_add_f32 v160, v160, v169
    v_mfma_f32_16x16x32_bf16 a[132:135], v[232:235], v[128:131], a[132:135]
    v_cvt_pk_bf16_f32 v113, v168, v169
    v_mfma_f32_16x16x32_bf16 a[152:155], v[236:239], v[128:131], a[152:155]
    v_exp_f32 v171, v53
    v_mfma_f32_16x16x32_bf16 a[16:19], v[208:211], v[132:135], a[16:19]
    v_add_f32 v160, v160, v170
    v_exp_f32 v172, v54
    v_mfma_f32_16x16x32_bf16 a[36:39], v[212:215], v[132:135], a[36:39]
    v_add_f32 v160, v160, v171
    v_mfma_f32_16x16x32_bf16 a[56:59], v[216:219], v[132:135], a[56:59]
    v_cvt_pk_bf16_f32 v114, v170, v171
    v_mfma_f32_16x16x32_bf16 a[76:79], v[220:223], v[132:135], a[76:79]
    v_exp_f32 v173, v55
    v_mfma_f32_16x16x32_bf16 a[96:99], v[224:227], v[132:135], a[96:99]
    v_add_f32 v160, v160, v172
    v_nop
    v_mfma_f32_16x16x32_bf16 a[116:119], v[228:231], v[132:135], a[116:119]
    v_add_f32 v160, v160, v173
    v_mfma_f32_16x16x32_bf16 a[136:139], v[232:235], v[132:135], a[136:139]
    v_cvt_pk_bf16_f32 v115, v172, v173
    v_mfma_f32_16x16x32_bf16 a[156:159], v[236:239], v[132:135], a[156:159]
    v_max3_f32 v174, v156, v157, v158
    v_max3_f32 v174, v174, v159, v160
    v_cmp_nge_f32 vcc, s50, v174
    s_cbranch_vccz K1_OK_8
    s_call_b64 s[52:53], K1_FB0
K1_OK_8:
    v_add_f32 v161, v161, v156
    v_add_f32 v162, v162, v157
    v_add_f32 v163, v163, v158
    v_add_f32 v164, v164, v159
    v_add_f32 v165, v165, v160
    s_waitcnt vmcnt(18) lgkmcnt(0)
    s_barrier
    s_lshl_b32 s3, s5, 2
    s_add_u32 s3, s3, s68
    s_lshl_b32 s3, s3, 3
    s_add_u32 s3, s3, s7
    s_lshl_b32 s3, s3, 7
    v_mov_b32 v4, s3
    global_load_dwordx4 v[176:179], v4, s[58:59] offset:16 sc0 sc1
    s_and_b32 s3, s57, 3
    s_lshl_b32 s3, s3, 1
    s_add_u32 s3, s3, 1
    s_mul_i32 s38, s3, 147456
    s_add_u32 m0, s36, 20480
    s_nop 0
    buffer_load_dwordx4 v240, s[8:11], s38 offen offset:0 lds
    buffer_load_dwordx4 v241, s[8:11], s38 offen offset:1024 lds
    buffer_load_dwordx4 v242, s[8:11], s38 offen offset:2048 lds
    buffer_load_dwordx4 v243, s[8:11], s38 offen offset:3072 lds
    s_add_u32 m0, s36, 24576
    s_nop 0
    buffer_load_dwordx4 v253, s[8:11], s38 offen offset:0 lds
    s_and_b32 s3, s57, 3
    s_lshl_b32 s3, s3, 1
    s_add_u32 s3, s3, 1
    s_mul_i32 s38, s3, 147456
    s_add_u32 s38, s38, 73728
    s_add_u32 m0, s36, 40960
    s_nop 0
    buffer_load_dwordx4 v240, s[8:11], s38 offen offset:0 lds
    buffer_load_dwordx4 v241, s[8:11], s38 offen offset:1024 lds
    buffer_load_dwordx4 v242, s[8:11], s38 offen offset:2048 lds
    buffer_load_dwordx4 v243, s[8:11], s38 offen offset:3072 lds
    s_add_u32 m0, s36, 45056
    s_nop 0
    buffer_load_dwordx4 v253, s[8:11], s38 offen offset:0 lds
    s_lshl_b32 s4, s5, 3
    s_add_u32 s4, s4, s7
    s_lshl_b32 s4, s4, 5
    s_lshl_b32 s38, s68, 3
    s_add_u32 s4, s4, s38
    s_mul_i32 s4, s4, 40960
    s_add_u32 s12, s54, s4
    s_addc_u32 s13, s55, 0
    s_mov_b32 s14, 327680
    s_mov_b32 s15, 0x20000
    s_mul_i32 s3, s32, 5
    s_lshl_b32 s37, s3, 10
    s_add_u32 s37, s37, 81920
    s_mul_i32 s3, s32, 5
    s_add_u32 s4, s3, 0
    s_lshl_b32 s4, s4, 3
    v_lshrrev_b32 v4, 3, v1
    v_add_u32 v4, s4, v4
    v_bfe_u32 v5, v4, 1, 3
    v_and_b32 v6, 7, v1
    v_xor_b32 v5, v5, v6
    v_lshrrev_b32 v6, 4, v4
    v_lshlrev_b32 v6, 12, v6
    v_and_b32 v7, 15, v4
    v_lshl_add_u32 v6, v7, 6, v6
    v_lshrrev_b32 v7, 2, v5
    v_lshl_add_u32 v6, v7, 10, v6
    v_and_b32 v7, 3, v5
    v_lshl_add_u32 v181, v7, 4, v6
    s_add_u32 s4, s3, 1
    s_lshl_b32 s4, s4, 3
    v_lshrrev_b32 v4, 3, v1
    v_add_u32 v4, s4, v4
    v_bfe_u32 v5, v4, 1, 3
    v_and_b32 v6, 7, v1
    v_xor_b32 v5, v5, v6
    v_lshrrev_b32 v6, 4, v4
    v_lshlrev_b32 v6, 12, v6
    v_and_b32 v7, 15, v4
    v_lshl_add_u32 v6, v7, 6, v6
    v_lshrrev_b32 v7, 2, v5
    v_lshl_add_u32 v6, v7, 10, v6
    v_and_b32 v7, 3, v5
    v_lshl_add_u32 v182, v7, 4, v6
    s_add_u32 s4, s3, 2
    s_lshl_b32 s4, s4, 3
    v_lshrrev_b32 v4, 3, v1
    v_add_u32 v4, s4, v4
    v_bfe_u32 v5, v4, 1, 3
    v_and_b32 v6, 7, v1
    v_xor_b32 v5, v5, v6
    v_lshrrev_b32 v6, 4, v4
    v_lshlrev_b32 v6, 12, v6
    v_and_b32 v7, 15, v4
    v_lshl_add_u32 v6, v7, 6, v6
    v_lshrrev_b32 v7, 2, v5
    v_lshl_add_u32 v6, v7, 10, v6
    v_and_b32 v7, 3, v5
    v_lshl_add_u32 v183, v7, 4, v6
    s_add_u32 s4, s3, 3
    s_lshl_b32 s4, s4, 3
    v_lshrrev_b32 v4, 3, v1
    v_add_u32 v4, s4, v4
    v_bfe_u32 v5, v4, 1, 3
    v_and_b32 v6, 7, v1
    v_xor_b32 v5, v5, v6
    v_lshrrev_b32 v6, 4, v4
    v_lshlrev_b32 v6, 12, v6
    v_and_b32 v7, 15, v4
    v_lshl_add_u32 v6, v7, 6, v6
    v_lshrrev_b32 v7, 2, v5
    v_lshl_add_u32 v6, v7, 10, v6
    v_and_b32 v7, 3, v5
    v_lshl_add_u32 v184, v7, 4, v6
    s_add_u32 s4, s3, 4
    s_lshl_b32 s4, s4, 3
    v_lshrrev_b32 v4, 3, v1
    v_add_u32 v4, s4, v4
    v_bfe_u32 v5, v4, 1, 3
    v_and_b32 v6, 7, v1
    v_xor_b32 v5, v5, v6
    v_lshrrev_b32 v6, 4, v4
    v_lshlrev_b32 v6, 12, v6
    v_and_b32 v7, 15, v4
    v_lshl_add_u32 v6, v7, 6, v6
    v_lshrrev_b32 v7, 2, v5
    v_lshl_add_u32 v6, v7, 10, v6
    v_and_b32 v7, 3, v5
    v_lshl_add_u32 v185, v7, 4, v6
    v_lshrrev_b32 v4, 1, v2
    v_lshlrev_b32 v5, 7, v2
    s_mul_i32 s3, s34, 10240
    v_add_u32 v5, s3, v5
    v_add_u32 v6, 0, v3
    v_xor_b32 v6, v6, v4
    v_lshl_add_u32 v190, v6, 4, v5
    v_add_u32 v6, 4, v3
    v_xor_b32 v6, v6, v4
    v_lshl_add_u32 v191, v6, 4, v5
    s_lshl_b32 s3, s33, 1
    s_add_u32 s3, s3, 3
    s_and_b32 s3, s3, 3
    s_mul_i32 s3, s3, 20480
    s_add_u32 s3, s3, 81920
    v_add_u32 v186, s3, v190
    s_lshl_b32 s3, s33, 1
    s_add_u32 s3, s3, 3
    s_and_b32 s3, s3, 3
    s_mul_i32 s3, s3, 20480
    s_add_u32 s3, s3, 81920
    v_add_u32 v187, s3, v191
    s_lshl_b32 s3, s33, 1
    s_add_u32 s3, s3, 4
    s_and_b32 s3, s3, 3
    s_mul_i32 s3, s3, 20480
    s_add_u32 s3, s3, 81920
    v_add_u32 v188, s3, v190
    s_lshl_b32 s3, s33, 1
    s_add_u32 s3, s3, 4
    s_and_b32 s3, s3, 3
    s_mul_i32 s3, s3, 20480
    s_add_u32 s3, s3, 81920
    v_add_u32 v189, s3, v191
    v_add_u32 v190, 143360, v190
    v_add_u32 v191, 143360, v191
    v_lshrrev_b32 v4, 2, v2
    v_lshl_add_u32 v4, v3, 2, v4
    v_mul_u32_u24 v4, 320, v4
    v_and_b32 v5, 3, v2
    v_lshl_add_u32 v4, v5, 3, v4
    s_and_b32 s3, s57, 1
    s_mul_i32 s4, s33, 5
    s_add_u32 s3, s3, s4
    s_lshl_b32 s4, s3, 5
    s_add_u32 s4, s4, 61440
    v_add_u32 v4, s4, v4
    v_and_b32 v5, 1, v3
    v_lshlrev_b32 v5, 5, v5
    s_and_b32 s3, s3, 1
    v_add_u32 v6, v4, v5
    v_sub_u32 v7, v4, v5
    s_cmp_eq_u32 s3, 0
    s_cselect_b64 vcc, -1, 0
    v_cndmask_b32 v192, v7, v6, vcc
    v_cndmask_b32 v193, v6, v7, vcc
    s_mul_i32 s3, s34, 80
    v_add_u32 v4, s3, v2
    v_mul_u32_u24 v4, 2304, v4
    v_lshl_add_u32 v4, v3, 3, v4
    s_mul_i32 s3, s33, 160
    v_add_u32 v254, s3, v4
    ds_read_b64_tr_b16 v[208:209], v244 offset:32768
    ds_read_b64_tr_b16 v[210:211], v244 offset:36864
    ds_read_b64_tr_b16 v[212:213], v245 offset:32768
    ds_read_b64_tr_b16 v[214:215], v245 offset:36864
    ds_read_b64_tr_b16 v[216:217], v246 offset:32768
    ds_read_b64_tr_b16 v[218:219], v246 offset:36864
    ds_read_b64_tr_b16 v[220:221], v247 offset:32768
    ds_read_b64_tr_b16 v[222:223], v247 offset:36864
    ds_read_b64_tr_b16 v[224:225], v248 offset:32768
    ds_read_b64_tr_b16 v[226:227], v248 offset:36864
    ds_read_b64_tr_b16 v[228:229], v249 offset:32768
    ds_read_b64_tr_b16 v[230:231], v249 offset:36864
    ds_read_b64_tr_b16 v[232:233], v250 offset:32768
    ds_read_b64_tr_b16 v[234:235], v250 offset:36864
    ds_read_b64_tr_b16 v[236:237], v251 offset:32768
    ds_read_b64_tr_b16 v[238:239], v251 offset:36864
    v_exp_f32 v166, v56
    v_exp_f32 v167, v57
    s_waitcnt lgkmcnt(0)
    v_exp_f32 v168, v58
    v_add_f32 v156, v166, v167
    v_exp_f32 v169, v59
    v_mfma_f32_16x16x32_bf16 a[0:3], v[208:211], v[96:99], a[0:3]
    v_cvt_pk_bf16_f32 v116, v166, v167
    v_add_f32 v156, v156, v168
    v_mfma_f32_16x16x32_bf16 a[20:23], v[212:215], v[96:99], a[20:23]
    v_exp_f32 v170, v60
    v_add_f32 v156, v156, v169
    v_cvt_pk_bf16_f32 v117, v168, v169
    v_mfma_f32_16x16x32_bf16 a[40:43], v[216:219], v[96:99], a[40:43]
    v_exp_f32 v171, v61
    v_add_f32 v156, v156, v170
    v_mfma_f32_16x16x32_bf16 a[60:63], v[220:223], v[96:99], a[60:63]
    v_exp_f32 v172, v62
    v_add_f32 v156, v156, v171
    v_cvt_pk_bf16_f32 v118, v170, v171
    v_mfma_f32_16x16x32_bf16 a[80:83], v[224:227], v[96:99], a[80:83]
    v_exp_f32 v173, v63
    v_add_f32 v156, v156, v172
    v_mfma_f32_16x16x32_bf16 a[100:103], v[228:231], v[96:99], a[100:103]
    v_nop
    v_add_f32 v156, v156, v173
    v_cvt_pk_bf16_f32 v119, v172, v173
    v_mfma_f32_16x16x32_bf16 a[120:123], v[232:235], v[96:99], a[120:123]
    v_exp_f32 v166, v64
    v_exp_f32 v167, v65
    v_mfma_f32_16x16x32_bf16 a[140:143], v[236:239], v[96:99], a[140:143]
    v_exp_f32 v168, v66
    v_add_f32 v157, v166, v167
    v_mfma_f32_16x16x32_bf16 a[4:7], v[208:211], v[100:103], a[4:7]
    v_exp_f32 v169, v67
    v_cvt_pk_bf16_f32 v120, v166, v167
    v_add_f32 v157, v157, v168
    v_mfma_f32_16x16x32_bf16 a[24:27], v[212:215], v[100:103], a[24:27]
    v_exp_f32 v170, v68
    v_add_f32 v157, v157, v169
    v_mfma_f32_16x16x32_bf16 a[44:47], v[216:219], v[100:103], a[44:47]
    v_cvt_pk_bf16_f32 v121, v168, v169
    v_exp_f32 v171, v69
    v_add_f32 v157, v157, v170
    v_mfma_f32_16x16x32_bf16 a[64:67], v[220:223], v[100:103], a[64:67]
    v_exp_f32 v172, v70
    v_add_f32 v157, v157, v171
    v_mfma_f32_16x16x32_bf16 a[84:87], v[224:227], v[100:103], a[84:87]
    v_cvt_pk_bf16_f32 v122, v170, v171
    v_exp_f32 v173, v71
    v_add_f32 v157, v157, v172
    v_mfma_f32_16x16x32_bf16 a[104:107], v[228:231], v[100:103], a[104:107]
    v_nop
    v_add_f32 v157, v157, v173
    v_mfma_f32_16x16x32_bf16 a[124:127], v[232:235], v[100:103], a[124:127]
    v_cvt_pk_bf16_f32 v123, v172, v173
    v_exp_f32 v166, v72
    v_mfma_f32_16x16x32_bf16 a[144:147], v[236:239], v[100:103], a[144:147]
    v_exp_f32 v167, v73
    v_exp_f32 v168, v74
    v_add_f32 v158, v166, v167
    v_mfma_f32_16x16x32_bf16 a[8:11], v[208:211], v[104:107], a[8:11]
    v_exp_f32 v169, v75
    v_cvt_pk_bf16_f32 v124, v166, v167
    v_mfma_f32_16x16x32_bf16 a[28:31], v[212:215], v[104:107], a[28:31]
    v_add_f32 v158, v158, v168
    v_exp_f32 v170, v76
    v_add_f32 v158, v158, v169
    v_mfma_f32_16x16x32_bf16 a[48:51], v[216:219], v[104:107], a[48:51]
    v_cvt_pk_bf16_f32 v125, v168, v169
    v_exp_f32 v171, v77
    v_mfma_f32_16x16x32_bf16 a[68:71], v[220:223], v[104:107], a[68:71]
    v_add_f32 v158, v158, v170
    v_exp_f32 v172, v78
    v_add_f32 v158, v158, v171
    v_mfma_f32_16x16x32_bf16 a[88:91], v[224:227], v[104:107], a[88:91]
    v_cvt_pk_bf16_f32 v126, v170, v171
    v_exp_f32 v173, v79
    v_mfma_f32_16x16x32_bf16 a[108:111], v[228:231], v[104:107], a[108:111]
    v_add_f32 v158, v158, v172
    v_nop
    v_add_f32 v158, v158, v173
    v_mfma_f32_16x16x32_bf16 a[128:131], v[232:235], v[104:107], a[128:131]
    v_cvt_pk_bf16_f32 v127, v172, v173
    v_exp_f32 v166, v80
    v_mfma_f32_16x16x32_bf16 a[148:151], v[236:239], v[104:107], a[148:151]
    v_exp_f32 v167, v81
    v_exp_f32 v168, v82
    v_mfma_f32_16x16x32_bf16 a[12:15], v[208:211], v[108:111], a[12:15]
    v_add_f32 v159, v166, v167
    v_exp_f32 v169, v83
    v_cvt_pk_bf16_f32 v128, v166, v167
    v_mfma_f32_16x16x32_bf16 a[32:35], v[212:215], v[108:111], a[32:35]
    v_add_f32 v159, v159, v168
    v_exp_f32 v170, v84
    v_mfma_f32_16x16x32_bf16 a[52:55], v[216:219], v[108:111], a[52:55]
    v_add_f32 v159, v159, v169
    v_cvt_pk_bf16_f32 v129, v168, v169
    v_exp_f32 v171, v85
    v_mfma_f32_16x16x32_bf16 a[72:75], v[220:223], v[108:111], a[72:75]
    v_add_f32 v159, v159, v170
    v_exp_f32 v172, v86
    v_mfma_f32_16x16x32_bf16 a[92:95], v[224:227], v[108:111], a[92:95]
    v_add_f32 v159, v159, v171
    v_cvt_pk_bf16_f32 v130, v170, v171
    v_exp_f32 v173, v87
    v_mfma_f32_16x16x32_bf16 a[112:115], v[228:231], v[108:111], a[112:115]
    v_add_f32 v159, v159, v172
    v_nop
    v_mfma_f32_16x16x32_bf16 a[132:135], v[232:235], v[108:111], a[132:135]
    v_add_f32 v159, v159, v173
    v_cvt_pk_bf16_f32 v131, v172, v173
    v_mfma_f32_16x16x32_bf16 a[152:155], v[236:239], v[108:111], a[152:155]
    v_exp_f32 v166, v88
    v_exp_f32 v167, v89
    v_exp_f32 v168, v90
    v_mfma_f32_16x16x32_bf16 a[16:19], v[208:211], v[112:115], a[16:19]
    v_add_f32 v160, v166, v167
    v_exp_f32 v169, v91
    v_mfma_f32_16x16x32_bf16 a[36:39], v[212:215], v[112:115], a[36:39]
    v_cvt_pk_bf16_f32 v132, v166, v167
    v_add_f32 v160, v160, v168
    v_exp_f32 v170, v92
    v_mfma_f32_16x16x32_bf16 a[56:59], v[216:219], v[112:115], a[56:59]
    v_add_f32 v160, v160, v169
    v_cvt_pk_bf16_f32 v133, v168, v169
    v_mfma_f32_16x16x32_bf16 a[76:79], v[220:223], v[112:115], a[76:79]
    v_exp_f32 v171, v93
    v_add_f32 v160, v160, v170
    v_exp_f32 v172, v94
    v_mfma_f32_16x16x32_bf16 a[96:99], v[224:227], v[112:115], a[96:99]
    v_add_f32 v160, v160, v171
    v_cvt_pk_bf16_f32 v134, v170, v171
    v_mfma_f32_16x16x32_bf16 a[116:119], v[228:231], v[112:115], a[116:119]
    v_exp_f32 v173, v95
    v_add_f32 v160, v160, v172
    v_nop
    v_mfma_f32_16x16x32_bf16 a[136:139], v[232:235], v[112:115], a[136:139]
    v_add_f32 v160, v160, v173
    v_cvt_pk_bf16_f32 v135, v172, v173
    v_mfma_f32_16x16x32_bf16 a[156:159], v[236:239], v[112:115], a[156:159]
    v_max3_f32 v174, v156, v157, v158
    v_max3_f32 v174, v174, v159, v160
    v_cmp_nge_f32 vcc, s50, v174
    s_cbranch_vccz K1_OK_9
    s_call_b64 s[52:53], K1_FB3
K1_OK_9:
    v_add_f32 v161, v161, v156
    v_add_f32 v162, v162, v157
    v_add_f32 v163, v163, v158
    v_add_f32 v164, v164, v159
    v_add_f32 v165, v165, v160
    s_waitcnt vmcnt(0) lgkmcnt(0)
    s_barrier
    ds_read_b64_tr_b16 v[208:209], v244 offset:49152
    ds_read_b64_tr_b16 v[210:211], v244 offset:53248
    ds_read_b64_tr_b16 v[212:213], v245 offset:49152
    ds_read_b64_tr_b16 v[214:215], v245 offset:53248
    ds_read_b64_tr_b16 v[216:217], v246 offset:49152
    ds_read_b64_tr_b16 v[218:219], v246 offset:53248
    ds_read_b64_tr_b16 v[220:221], v247 offset:49152
    ds_read_b64_tr_b16 v[222:223], v247 offset:53248
    ds_read_b64_tr_b16 v[224:225], v248 offset:49152
    ds_read_b64_tr_b16 v[226:227], v248 offset:53248
    ds_read_b64_tr_b16 v[228:229], v249 offset:49152
    ds_read_b64_tr_b16 v[230:231], v249 offset:53248
    ds_read_b64_tr_b16 v[232:233], v250 offset:49152
    ds_read_b64_tr_b16 v[234:235], v250 offset:53248
    ds_read_b64_tr_b16 v[236:237], v251 offset:49152
    ds_read_b64_tr_b16 v[238:239], v251 offset:53248
    v_mov_b32 v166, v161
    v_mov_b32 v168, v162
    v_mov_b32 v170, v163
    v_mov_b32 v172, v164
    v_mov_b32 v174, v165
    v_mov_b32 v167, v161
    v_mov_b32 v169, v162
    v_mov_b32 v171, v163
    v_mov_b32 v173, v164
    v_mov_b32 v175, v165
    s_nop 1
    s_nop 1
    s_nop 1
    s_nop 1
    s_nop 1
    v_permlane32_swap_b32 v166, v167
    v_permlane32_swap_b32 v168, v169
    v_permlane32_swap_b32 v170, v171
    v_permlane32_swap_b32 v172, v173
    v_permlane32_swap_b32 v174, v175
    s_nop 1
    s_nop 1
    s_nop 1
    s_nop 1
    s_nop 1
    v_add_f32 v161, v166, v167
    v_add_f32 v162, v168, v169
    v_add_f32 v163, v170, v171
    v_add_f32 v164, v172, v173
    v_add_f32 v165, v174, v175
    v_mov_b32 v166, v161
    v_mov_b32 v168, v162
    v_mov_b32 v170, v163
    v_mov_b32 v172, v164
    v_mov_b32 v174, v165
    v_mov_b32 v167, v161
    v_mov_b32 v169, v162
    v_mov_b32 v171, v163
    v_mov_b32 v173, v164
    v_mov_b32 v175, v165
    s_nop 1
    s_nop 1
    s_nop 1
    s_nop 1
    s_nop 1
    v_permlane16_swap_b32 v166, v167
    v_permlane16_swap_b32 v168, v169
    v_permlane16_swap_b32 v170, v171
    v_permlane16_swap_b32 v172, v173
    v_permlane16_swap_b32 v174, v175
    s_nop 1
    s_nop 1
    s_nop 1
    s_nop 1
    s_nop 1
    v_add_f32 v161, v166, v167
    v_add_f32 v162, v168, v169
    v_add_f32 v163, v170, v171
    v_add_f32 v164, v172, v173
    v_add_f32 v165, v174, v175
    v_rcp_f32 v96, v161
    v_rcp_f32 v98, v162
    v_rcp_f32 v100, v163
    v_rcp_f32 v102, v164
    v_rcp_f32 v104, v165
    v_lshlrev_b32 v4, 6, v2
    v_lshl_add_u32 v4, v3, 4, v4
    s_waitcnt lgkmcnt(0)
    s_barrier
    s_mov_b32 s69, 0
    s_mov_b32 s70, 4096
    s_mov_b32 s71, 8192
    s_mov_b32 s72, 12288
    s_mov_b32 s73, 16384
    v_mfma_f32_16x16x32_bf16 a[0:3], v[208:211], v[116:119], a[0:3]
    v_mfma_f32_16x16x32_bf16 a[20:23], v[212:215], v[116:119], a[20:23]
    v_mfma_f32_16x16x32_bf16 a[40:43], v[216:219], v[116:119], a[40:43]
    v_mfma_f32_16x16x32_bf16 a[60:63], v[220:223], v[116:119], a[60:63]
    v_mfma_f32_16x16x32_bf16 a[80:83], v[224:227], v[116:119], a[80:83]
    v_mfma_f32_16x16x32_bf16 a[100:103], v[228:231], v[116:119], a[100:103]
    v_mfma_f32_16x16x32_bf16 a[120:123], v[232:235], v[116:119], a[120:123]
    v_mfma_f32_16x16x32_bf16 a[140:143], v[236:239], v[116:119], a[140:143]
    v_mfma_f32_16x16x32_bf16 a[4:7], v[208:211], v[120:123], a[4:7]
    v_mfma_f32_16x16x32_bf16 a[24:27], v[212:215], v[120:123], a[24:27]
    v_mfma_f32_16x16x32_bf16 a[44:47], v[216:219], v[120:123], a[44:47]
    v_mfma_f32_16x16x32_bf16 a[64:67], v[220:223], v[120:123], a[64:67]
    v_accvgpr_read_b32 v16, a0
    v_accvgpr_read_b32 v24, a40
    v_accvgpr_read_b32 v32, a80
    v_accvgpr_read_b32 v40, a120
    v_accvgpr_read_b32 v20, a20
    v_accvgpr_read_b32 v28, a60
    v_accvgpr_read_b32 v36, a100
    v_accvgpr_read_b32 v44, a140
    v_accvgpr_read_b32 v17, a1
    v_accvgpr_read_b32 v25, a41
    v_accvgpr_read_b32 v33, a81
    v_accvgpr_read_b32 v41, a121
    v_accvgpr_read_b32 v21, a21
    v_accvgpr_read_b32 v29, a61
    v_accvgpr_read_b32 v37, a101
    v_accvgpr_read_b32 v45, a141
    v_accvgpr_read_b32 v18, a2
    v_accvgpr_read_b32 v26, a42
    v_mfma_f32_16x16x32_bf16 a[84:87], v[224:227], v[120:123], a[84:87]
    v_accvgpr_read_b32 v34, a82
    v_accvgpr_read_b32 v42, a122
    v_accvgpr_read_b32 v22, a22
    v_accvgpr_read_b32 v30, a62
    v_accvgpr_read_b32 v38, a102
    v_accvgpr_read_b32 v46, a142
    v_accvgpr_read_b32 v19, a3
    v_accvgpr_read_b32 v27, a43
    v_accvgpr_read_b32 v35, a83
    v_accvgpr_read_b32 v43, a123
    v_accvgpr_read_b32 v23, a23
    v_accvgpr_read_b32 v31, a63
    v_accvgpr_read_b32 v39, a103
    v_accvgpr_read_b32 v47, a143
    v_pk_mul_f32 v[16:17], v[16:17], v[96:97] op_sel_hi:[1,0]
    v_pk_mul_f32 v[24:25], v[24:25], v[96:97] op_sel_hi:[1,0]
    v_pk_mul_f32 v[32:33], v[32:33], v[96:97] op_sel_hi:[1,0]
    v_pk_mul_f32 v[40:41], v[40:41], v[96:97] op_sel_hi:[1,0]
    v_mfma_f32_16x16x32_bf16 a[104:107], v[228:231], v[120:123], a[104:107]
    v_pk_mul_f32 v[18:19], v[18:19], v[96:97] op_sel_hi:[1,0]
    v_pk_mul_f32 v[26:27], v[26:27], v[96:97] op_sel_hi:[1,0]
    v_pk_mul_f32 v[34:35], v[34:35], v[96:97] op_sel_hi:[1,0]
    v_pk_mul_f32 v[42:43], v[42:43], v[96:97] op_sel_hi:[1,0]
    v_pk_mul_f32 v[20:21], v[20:21], v[96:97] op_sel_hi:[1,0]
    v_pk_mul_f32 v[28:29], v[28:29], v[96:97] op_sel_hi:[1,0]
    v_pk_mul_f32 v[36:37], v[36:37], v[96:97] op_sel_hi:[1,0]
    v_pk_mul_f32 v[44:45], v[44:45], v[96:97] op_sel_hi:[1,0]
    v_pk_mul_f32 v[22:23], v[22:23], v[96:97] op_sel_hi:[1,0]
    v_pk_mul_f32 v[30:31], v[30:31], v[96:97] op_sel_hi:[1,0]
    v_pk_mul_f32 v[38:39], v[38:39], v[96:97] op_sel_hi:[1,0]
    v_pk_mul_f32 v[46:47], v[46:47], v[96:97] op_sel_hi:[1,0]
    v_cvt_pk_bf16_f32 v16, v16, v17
    v_cvt_pk_bf16_f32 v24, v24, v25
    v_cvt_pk_bf16_f32 v32, v32, v33
    v_cvt_pk_bf16_f32 v40, v40, v41
    v_cvt_pk_bf16_f32 v17, v18, v19
    v_cvt_pk_bf16_f32 v25, v26, v27
    v_mfma_f32_16x16x32_bf16 a[124:127], v[232:235], v[120:123], a[124:127]
    v_cvt_pk_bf16_f32 v33, v34, v35
    v_cvt_pk_bf16_f32 v41, v42, v43
    v_cvt_pk_bf16_f32 v18, v20, v21
    v_cvt_pk_bf16_f32 v26, v28, v29
    v_cvt_pk_bf16_f32 v34, v36, v37
    v_cvt_pk_bf16_f32 v42, v44, v45
    v_cvt_pk_bf16_f32 v19, v22, v23
    v_cvt_pk_bf16_f32 v27, v30, v31
    v_cvt_pk_bf16_f32 v35, v38, v39
    v_cvt_pk_bf16_f32 v43, v46, v47
    buffer_store_dwordx4 v[16:19], v4, s[28:31], s69 offen offset:0 sc0 sc1
    buffer_store_dwordx4 v[24:27], v4, s[28:31], s69 offen offset:1024 sc0 sc1
    buffer_store_dwordx4 v[32:35], v4, s[28:31], s69 offen offset:2048 sc0 sc1
    buffer_store_dwordx4 v[40:43], v4, s[28:31], s69 offen offset:3072 sc0 sc1
    ds_write_b128 v186, v[16:19] offset:0
    ds_write_b128 v187, v[24:27] offset:0
    ds_write_b128 v188, v[32:35] offset:0
    ds_write_b128 v189, v[40:43] offset:0
    v_mfma_f32_16x16x32_bf16 a[144:147], v[236:239], v[120:123], a[144:147]
    v_mfma_f32_16x16x32_bf16 a[8:11], v[208:211], v[124:127], a[8:11]
    v_mfma_f32_16x16x32_bf16 a[28:31], v[212:215], v[124:127], a[28:31]
    v_mfma_f32_16x16x32_bf16 a[48:51], v[216:219], v[124:127], a[48:51]
    v_mfma_f32_16x16x32_bf16 a[68:71], v[220:223], v[124:127], a[68:71]
    v_accvgpr_read_b32 v48, a4
    v_accvgpr_read_b32 v56, a44
    v_accvgpr_read_b32 v64, a84
    v_accvgpr_read_b32 v72, a124
    v_accvgpr_read_b32 v52, a24
    v_accvgpr_read_b32 v60, a64
    v_accvgpr_read_b32 v68, a104
    v_accvgpr_read_b32 v76, a144
    v_accvgpr_read_b32 v49, a5
    v_accvgpr_read_b32 v57, a45
    v_accvgpr_read_b32 v65, a85
    v_accvgpr_read_b32 v73, a125
    v_accvgpr_read_b32 v53, a25
    v_accvgpr_read_b32 v61, a65
    v_accvgpr_read_b32 v69, a105
    v_accvgpr_read_b32 v77, a145
    v_accvgpr_read_b32 v50, a6
    v_accvgpr_read_b32 v58, a46
    v_mfma_f32_16x16x32_bf16 a[88:91], v[224:227], v[124:127], a[88:91]
    v_accvgpr_read_b32 v66, a86
    v_accvgpr_read_b32 v74, a126
    v_accvgpr_read_b32 v54, a26
    v_accvgpr_read_b32 v62, a66
    v_accvgpr_read_b32 v70, a106
    v_accvgpr_read_b32 v78, a146
    v_accvgpr_read_b32 v51, a7
    v_accvgpr_read_b32 v59, a47
    v_accvgpr_read_b32 v67, a87
    v_accvgpr_read_b32 v75, a127
    v_accvgpr_read_b32 v55, a27
    v_accvgpr_read_b32 v63, a67
    v_accvgpr_read_b32 v71, a107
    v_accvgpr_read_b32 v79, a147
    v_pk_mul_f32 v[48:49], v[48:49], v[98:99] op_sel_hi:[1,0]
    v_pk_mul_f32 v[56:57], v[56:57], v[98:99] op_sel_hi:[1,0]
    v_pk_mul_f32 v[64:65], v[64:65], v[98:99] op_sel_hi:[1,0]
    v_pk_mul_f32 v[72:73], v[72:73], v[98:99] op_sel_hi:[1,0]
    v_mfma_f32_16x16x32_bf16 a[108:111], v[228:231], v[124:127], a[108:111]
    v_pk_mul_f32 v[50:51], v[50:51], v[98:99] op_sel_hi:[1,0]
    v_pk_mul_f32 v[58:59], v[58:59], v[98:99] op_sel_hi:[1,0]
    v_pk_mul_f32 v[66:67], v[66:67], v[98:99] op_sel_hi:[1,0]
    v_pk_mul_f32 v[74:75], v[74:75], v[98:99] op_sel_hi:[1,0]
    v_pk_mul_f32 v[52:53], v[52:53], v[98:99] op_sel_hi:[1,0]
    v_pk_mul_f32 v[60:61], v[60:61], v[98:99] op_sel_hi:[1,0]
    v_pk_mul_f32 v[68:69], v[68:69], v[98:99] op_sel_hi:[1,0]
    v_pk_mul_f32 v[76:77], v[76:77], v[98:99] op_sel_hi:[1,0]
    v_pk_mul_f32 v[54:55], v[54:55], v[98:99] op_sel_hi:[1,0]
    v_pk_mul_f32 v[62:63], v[62:63], v[98:99] op_sel_hi:[1,0]
    v_pk_mul_f32 v[70:71], v[70:71], v[98:99] op_sel_hi:[1,0]
    v_pk_mul_f32 v[78:79], v[78:79], v[98:99] op_sel_hi:[1,0]
    v_cvt_pk_bf16_f32 v48, v48, v49
    v_cvt_pk_bf16_f32 v56, v56, v57
    v_cvt_pk_bf16_f32 v64, v64, v65
    v_cvt_pk_bf16_f32 v72, v72, v73
    v_cvt_pk_bf16_f32 v49, v50, v51
    v_cvt_pk_bf16_f32 v57, v58, v59
    v_mfma_f32_16x16x32_bf16 a[128:131], v[232:235], v[124:127], a[128:131]
    v_cvt_pk_bf16_f32 v65, v66, v67
    v_cvt_pk_bf16_f32 v73, v74, v75
    v_cvt_pk_bf16_f32 v50, v52, v53
    v_cvt_pk_bf16_f32 v58, v60, v61
    v_cvt_pk_bf16_f32 v66, v68, v69
    v_cvt_pk_bf16_f32 v74, v76, v77
    v_cvt_pk_bf16_f32 v51, v54, v55
    v_cvt_pk_bf16_f32 v59, v62, v63
    v_cvt_pk_bf16_f32 v67, v70, v71
    v_cvt_pk_bf16_f32 v75, v78, v79
    buffer_store_dwordx4 v[48:51], v4, s[28:31], s70 offen offset:0 sc0 sc1
    buffer_store_dwordx4 v[56:59], v4, s[28:31], s70 offen offset:1024 sc0 sc1
    buffer_store_dwordx4 v[64:67], v4, s[28:31], s70 offen offset:2048 sc0 sc1
    buffer_store_dwordx4 v[72:75], v4, s[28:31], s70 offen offset:3072 sc0 sc1
    ds_write_b128 v186, v[48:51] offset:2048
    ds_write_b128 v187, v[56:59] offset:2048
    ds_write_b128 v188, v[64:67] offset:2048
    ds_write_b128 v189, v[72:75] offset:2048
    v_mfma_f32_16x16x32_bf16 a[148:151], v[236:239], v[124:127], a[148:151]
    v_mfma_f32_16x16x32_bf16 a[12:15], v[208:211], v[128:131], a[12:15]
    v_mfma_f32_16x16x32_bf16 a[32:35], v[212:215], v[128:131], a[32:35]
    v_mfma_f32_16x16x32_bf16 a[52:55], v[216:219], v[128:131], a[52:55]
    v_mfma_f32_16x16x32_bf16 a[72:75], v[220:223], v[128:131], a[72:75]
    v_accvgpr_read_b32 v16, a8
    v_accvgpr_read_b32 v24, a48
    v_accvgpr_read_b32 v32, a88
    v_accvgpr_read_b32 v40, a128
    v_accvgpr_read_b32 v20, a28
    v_accvgpr_read_b32 v28, a68
    v_accvgpr_read_b32 v36, a108
    v_accvgpr_read_b32 v44, a148
    v_accvgpr_read_b32 v17, a9
    v_accvgpr_read_b32 v25, a49
    v_accvgpr_read_b32 v33, a89
    v_accvgpr_read_b32 v41, a129
    v_accvgpr_read_b32 v21, a29
    v_accvgpr_read_b32 v29, a69
    v_accvgpr_read_b32 v37, a109
    v_accvgpr_read_b32 v45, a149
    v_accvgpr_read_b32 v18, a10
    v_accvgpr_read_b32 v26, a50
    v_mfma_f32_16x16x32_bf16 a[92:95], v[224:227], v[128:131], a[92:95]
    v_accvgpr_read_b32 v34, a90
    v_accvgpr_read_b32 v42, a130
    v_accvgpr_read_b32 v22, a30
    v_accvgpr_read_b32 v30, a70
    v_accvgpr_read_b32 v38, a110
    v_accvgpr_read_b32 v46, a150
    v_accvgpr_read_b32 v19, a11
    v_accvgpr_read_b32 v27, a51
    v_accvgpr_read_b32 v35, a91
    v_accvgpr_read_b32 v43, a131
    v_accvgpr_read_b32 v23, a31
    v_accvgpr_read_b32 v31, a71
    v_accvgpr_read_b32 v39, a111
    v_accvgpr_read_b32 v47, a151
    v_pk_mul_f32 v[16:17], v[16:17], v[100:101] op_sel_hi:[1,0]
    v_pk_mul_f32 v[24:25], v[24:25], v[100:101] op_sel_hi:[1,0]
    v_pk_mul_f32 v[32:33], v[32:33], v[100:101] op_sel_hi:[1,0]
    v_pk_mul_f32 v[40:41], v[40:41], v[100:101] op_sel_hi:[1,0]
    v_mfma_f32_16x16x32_bf16 a[112:115], v[228:231], v[128:131], a[112:115]
    v_pk_mul_f32 v[18:19], v[18:19], v[100:101] op_sel_hi:[1,0]
    v_pk_mul_f32 v[26:27], v[26:27], v[100:101] op_sel_hi:[1,0]
    v_pk_mul_f32 v[34:35], v[34:35], v[100:101] op_sel_hi:[1,0]
    v_pk_mul_f32 v[42:43], v[42:43], v[100:101] op_sel_hi:[1,0]
    v_pk_mul_f32 v[20:21], v[20:21], v[100:101] op_sel_hi:[1,0]
    v_pk_mul_f32 v[28:29], v[28:29], v[100:101] op_sel_hi:[1,0]
    v_pk_mul_f32 v[36:37], v[36:37], v[100:101] op_sel_hi:[1,0]
    v_pk_mul_f32 v[44:45], v[44:45], v[100:101] op_sel_hi:[1,0]
    v_pk_mul_f32 v[22:23], v[22:23], v[100:101] op_sel_hi:[1,0]
    v_pk_mul_f32 v[30:31], v[30:31], v[100:101] op_sel_hi:[1,0]
    v_pk_mul_f32 v[38:39], v[38:39], v[100:101] op_sel_hi:[1,0]
    v_pk_mul_f32 v[46:47], v[46:47], v[100:101] op_sel_hi:[1,0]
    v_cvt_pk_bf16_f32 v16, v16, v17
    v_cvt_pk_bf16_f32 v24, v24, v25
    v_cvt_pk_bf16_f32 v32, v32, v33
    v_cvt_pk_bf16_f32 v40, v40, v41
    v_cvt_pk_bf16_f32 v17, v18, v19
    v_cvt_pk_bf16_f32 v25, v26, v27
    v_mfma_f32_16x16x32_bf16 a[132:135], v[232:235], v[128:131], a[132:135]
    v_cvt_pk_bf16_f32 v33, v34, v35
    v_cvt_pk_bf16_f32 v41, v42, v43
    v_cvt_pk_bf16_f32 v18, v20, v21
    v_cvt_pk_bf16_f32 v26, v28, v29
    v_cvt_pk_bf16_f32 v34, v36, v37
    v_cvt_pk_bf16_f32 v42, v44, v45
    v_cvt_pk_bf16_f32 v19, v22, v23
    v_cvt_pk_bf16_f32 v27, v30, v31
    v_cvt_pk_bf16_f32 v35, v38, v39
    v_cvt_pk_bf16_f32 v43, v46, v47
    buffer_store_dwordx4 v[16:19], v4, s[28:31], s71 offen offset:0 sc0 sc1
    buffer_store_dwordx4 v[24:27], v4, s[28:31], s71 offen offset:1024 sc0 sc1
    buffer_store_dwordx4 v[32:35], v4, s[28:31], s71 offen offset:2048 sc0 sc1
    buffer_store_dwordx4 v[40:43], v4, s[28:31], s71 offen offset:3072 sc0 sc1
    ds_write_b128 v186, v[16:19] offset:4096
    ds_write_b128 v187, v[24:27] offset:4096
    ds_write_b128 v188, v[32:35] offset:4096
    ds_write_b128 v189, v[40:43] offset:4096
    v_mfma_f32_16x16x32_bf16 a[152:155], v[236:239], v[128:131], a[152:155]
    v_mfma_f32_16x16x32_bf16 a[16:19], v[208:211], v[132:135], a[16:19]
    v_mfma_f32_16x16x32_bf16 a[36:39], v[212:215], v[132:135], a[36:39]
    v_mfma_f32_16x16x32_bf16 a[56:59], v[216:219], v[132:135], a[56:59]
    v_mfma_f32_16x16x32_bf16 a[76:79], v[220:223], v[132:135], a[76:79]
    v_accvgpr_read_b32 v48, a12
    v_accvgpr_read_b32 v56, a52
    v_accvgpr_read_b32 v64, a92
    v_accvgpr_read_b32 v72, a132
    v_accvgpr_read_b32 v52, a32
    v_accvgpr_read_b32 v60, a72
    v_accvgpr_read_b32 v68, a112
    v_accvgpr_read_b32 v76, a152
    v_accvgpr_read_b32 v49, a13
    v_accvgpr_read_b32 v57, a53
    v_accvgpr_read_b32 v65, a93
    v_accvgpr_read_b32 v73, a133
    v_accvgpr_read_b32 v53, a33
    v_accvgpr_read_b32 v61, a73
    v_accvgpr_read_b32 v69, a113
    v_accvgpr_read_b32 v77, a153
    v_accvgpr_read_b32 v50, a14
    v_accvgpr_read_b32 v58, a54
    v_mfma_f32_16x16x32_bf16 a[96:99], v[224:227], v[132:135], a[96:99]
    v_accvgpr_read_b32 v66, a94
    v_accvgpr_read_b32 v74, a134
    v_accvgpr_read_b32 v54, a34
    v_accvgpr_read_b32 v62, a74
    v_accvgpr_read_b32 v70, a114
    v_accvgpr_read_b32 v78, a154
    v_accvgpr_read_b32 v51, a15
    v_accvgpr_read_b32 v59, a55
    v_accvgpr_read_b32 v67, a95
    v_accvgpr_read_b32 v75, a135
    v_accvgpr_read_b32 v55, a35
    v_accvgpr_read_b32 v63, a75
    v_accvgpr_read_b32 v71, a115
    v_accvgpr_read_b32 v79, a155
    v_pk_mul_f32 v[48:49], v[48:49], v[102:103] op_sel_hi:[1,0]
    v_pk_mul_f32 v[56:57], v[56:57], v[102:103] op_sel_hi:[1,0]
    v_pk_mul_f32 v[64:65], v[64:65], v[102:103] op_sel_hi:[1,0]
    v_pk_mul_f32 v[72:73], v[72:73], v[102:103] op_sel_hi:[1,0]
    v_mfma_f32_16x16x32_bf16 a[116:119], v[228:231], v[132:135], a[116:119]
    v_pk_mul_f32 v[50:51], v[50:51], v[102:103] op_sel_hi:[1,0]
    v_pk_mul_f32 v[58:59], v[58:59], v[102:103] op_sel_hi:[1,0]
    v_pk_mul_f32 v[66:67], v[66:67], v[102:103] op_sel_hi:[1,0]
    v_pk_mul_f32 v[74:75], v[74:75], v[102:103] op_sel_hi:[1,0]
    v_pk_mul_f32 v[52:53], v[52:53], v[102:103] op_sel_hi:[1,0]
    v_pk_mul_f32 v[60:61], v[60:61], v[102:103] op_sel_hi:[1,0]
    v_pk_mul_f32 v[68:69], v[68:69], v[102:103] op_sel_hi:[1,0]
    v_pk_mul_f32 v[76:77], v[76:77], v[102:103] op_sel_hi:[1,0]
    v_pk_mul_f32 v[54:55], v[54:55], v[102:103] op_sel_hi:[1,0]
    v_pk_mul_f32 v[62:63], v[62:63], v[102:103] op_sel_hi:[1,0]
    v_pk_mul_f32 v[70:71], v[70:71], v[102:103] op_sel_hi:[1,0]
    v_pk_mul_f32 v[78:79], v[78:79], v[102:103] op_sel_hi:[1,0]
    v_cvt_pk_bf16_f32 v48, v48, v49
    v_cvt_pk_bf16_f32 v56, v56, v57
    v_cvt_pk_bf16_f32 v64, v64, v65
    v_cvt_pk_bf16_f32 v72, v72, v73
    v_cvt_pk_bf16_f32 v49, v50, v51
    v_cvt_pk_bf16_f32 v57, v58, v59
    v_mfma_f32_16x16x32_bf16 a[136:139], v[232:235], v[132:135], a[136:139]
    v_cvt_pk_bf16_f32 v65, v66, v67
    v_cvt_pk_bf16_f32 v73, v74, v75
    v_cvt_pk_bf16_f32 v50, v52, v53
    v_cvt_pk_bf16_f32 v58, v60, v61
    v_cvt_pk_bf16_f32 v66, v68, v69
    v_cvt_pk_bf16_f32 v74, v76, v77
    v_cvt_pk_bf16_f32 v51, v54, v55
    v_cvt_pk_bf16_f32 v59, v62, v63
    v_cvt_pk_bf16_f32 v67, v70, v71
    v_cvt_pk_bf16_f32 v75, v78, v79
    buffer_store_dwordx4 v[48:51], v4, s[28:31], s72 offen offset:0 sc0 sc1
    buffer_store_dwordx4 v[56:59], v4, s[28:31], s72 offen offset:1024 sc0 sc1
    buffer_store_dwordx4 v[64:67], v4, s[28:31], s72 offen offset:2048 sc0 sc1
    buffer_store_dwordx4 v[72:75], v4, s[28:31], s72 offen offset:3072 sc0 sc1
    ds_write_b128 v186, v[48:51] offset:6144
    ds_write_b128 v187, v[56:59] offset:6144
    ds_write_b128 v188, v[64:67] offset:6144
    ds_write_b128 v189, v[72:75] offset:6144
    v_mfma_f32_16x16x32_bf16 a[156:159], v[236:239], v[132:135], a[156:159]
    s_nop 7
    s_nop 3
    v_accvgpr_read_b32 v16, a16
    v_accvgpr_read_b32 v24, a56
    v_accvgpr_read_b32 v32, a96
    v_accvgpr_read_b32 v40, a136
    v_accvgpr_read_b32 v20, a36
    v_accvgpr_read_b32 v28, a76
    v_accvgpr_read_b32 v36, a116
    v_accvgpr_read_b32 v44, a156
    v_accvgpr_read_b32 v17, a17
    v_accvgpr_read_b32 v25, a57
    v_accvgpr_read_b32 v33, a97
    v_accvgpr_read_b32 v41, a137
    v_accvgpr_read_b32 v21, a37
    v_accvgpr_read_b32 v29, a77
    v_accvgpr_read_b32 v37, a117
    v_accvgpr_read_b32 v45, a157
    v_accvgpr_read_b32 v18, a18
    v_accvgpr_read_b32 v26, a58
    v_accvgpr_read_b32 v34, a98
    v_accvgpr_read_b32 v42, a138
    v_accvgpr_read_b32 v22, a38
    v_accvgpr_read_b32 v30, a78
    v_accvgpr_read_b32 v38, a118
    v_accvgpr_read_b32 v46, a158
    v_accvgpr_read_b32 v19, a19
    v_accvgpr_read_b32 v27, a59
    v_accvgpr_read_b32 v35, a99
    v_accvgpr_read_b32 v43, a139
    v_accvgpr_read_b32 v23, a39
    v_accvgpr_read_b32 v31, a79
    v_accvgpr_read_b32 v39, a119
    v_accvgpr_read_b32 v47, a159
    v_pk_mul_f32 v[16:17], v[16:17], v[104:105] op_sel_hi:[1,0]
    v_pk_mul_f32 v[24:25], v[24:25], v[104:105] op_sel_hi:[1,0]
    v_pk_mul_f32 v[32:33], v[32:33], v[104:105] op_sel_hi:[1,0]
    v_pk_mul_f32 v[40:41], v[40:41], v[104:105] op_sel_hi:[1,0]
    v_pk_mul_f32 v[18:19], v[18:19], v[104:105] op_sel_hi:[1,0]
    v_pk_mul_f32 v[26:27], v[26:27], v[104:105] op_sel_hi:[1,0]
    v_pk_mul_f32 v[34:35], v[34:35], v[104:105] op_sel_hi:[1,0]
    v_pk_mul_f32 v[42:43], v[42:43], v[104:105] op_sel_hi:[1,0]
    v_pk_mul_f32 v[20:21], v[20:21], v[104:105] op_sel_hi:[1,0]
    v_pk_mul_f32 v[28:29], v[28:29], v[104:105] op_sel_hi:[1,0]
    v_pk_mul_f32 v[36:37], v[36:37], v[104:105] op_sel_hi:[1,0]
    v_pk_mul_f32 v[44:45], v[44:45], v[104:105] op_sel_hi:[1,0]
    v_pk_mul_f32 v[22:23], v[22:23], v[104:105] op_sel_hi:[1,0]
    v_pk_mul_f32 v[30:31], v[30:31], v[104:105] op_sel_hi:[1,0]
    v_pk_mul_f32 v[38:39], v[38:39], v[104:105] op_sel_hi:[1,0]
    v_pk_mul_f32 v[46:47], v[46:47], v[104:105] op_sel_hi:[1,0]
    v_cvt_pk_bf16_f32 v16, v16, v17
    v_cvt_pk_bf16_f32 v24, v24, v25
    v_cvt_pk_bf16_f32 v32, v32, v33
    v_cvt_pk_bf16_f32 v40, v40, v41
    v_cvt_pk_bf16_f32 v17, v18, v19
    v_cvt_pk_bf16_f32 v25, v26, v27
    v_cvt_pk_bf16_f32 v33, v34, v35
    v_cvt_pk_bf16_f32 v41, v42, v43
    v_cvt_pk_bf16_f32 v18, v20, v21
    v_cvt_pk_bf16_f32 v26, v28, v29
    v_cvt_pk_bf16_f32 v34, v36, v37
    v_cvt_pk_bf16_f32 v42, v44, v45
    v_cvt_pk_bf16_f32 v19, v22, v23
    v_cvt_pk_bf16_f32 v27, v30, v31
    v_cvt_pk_bf16_f32 v35, v38, v39
    v_cvt_pk_bf16_f32 v43, v46, v47
    buffer_store_dwordx4 v[16:19], v4, s[28:31], s73 offen offset:0 sc0 sc1
    buffer_store_dwordx4 v[24:27], v4, s[28:31], s73 offen offset:1024 sc0 sc1
    buffer_store_dwordx4 v[32:35], v4, s[28:31], s73 offen offset:2048 sc0 sc1
    buffer_store_dwordx4 v[40:43], v4, s[28:31], s73 offen offset:3072 sc0 sc1
    ds_write_b128 v186, v[16:19] offset:8192
    ds_write_b128 v187, v[24:27] offset:8192
    ds_write_b128 v188, v[32:35] offset:8192
    ds_write_b128 v189, v[40:43] offset:8192
    s_lshl_b32 s3, s5, 2
    s_add_u32 s3, s3, s68
    s_lshl_b32 s3, s3, 3
    s_add_u32 s47, s3, s7
    s_lshl_b32 s3, s5, 3
    s_add_u32 s3, s3, s7
    s_lshl_b32 s3, s3, 2
    s_and_b32 s4, s57, 3
    s_add_u32 s46, s3, s4
    s_mul_i32 s4, s46, 205056
    s_add_u32 s4, s4, 33554432
    s_add_u32 s16, s54, s4
    s_addc_u32 s17, s55, 0
    s_mov_b32 s18, 204800
    s_mov_b32 s19, 0x20000
    s_mul_i32 s4, s7, 368640
    s_mul_i32 s3, s5, 1152
    s_add_u32 s4, s4, s3
    s_and_b32 s3, s57, 3
    s_mul_i32 s3, s3, 288
    s_add_u32 s4, s4, s3
    s_add_u32 s20, s78, s4
    s_addc_u32 s21, s79, 0
    s_mov_b32 s22, 366624
    s_mov_b32 s23, 0x20000
    s_mov_b32 s41, 4
    s_mov_b32 s60, 4
    s_and_b32 s3, s57, 3
    s_lshl_b32 s42, s3, 1
    s_lshl_b32 s63, 1, s3
    s_waitcnt vmcnt(20) lgkmcnt(0)
    s_barrier
    s_cmp_lt_u32 s32, 2
    s_cbranch_scc0 KF_V1
    ds_read_b128 v[116:119], v190 offset:0
    ds_read_b128 v[120:123], v190 offset:2048
    ds_read_b128 v[124:127], v190 offset:4096
    ds_read_b128 v[128:131], v190 offset:6144
    ds_read_b128 v[132:135], v190 offset:8192
    ds_read_b64_tr_b16 v[196:197], v192 offset:0
    ds_read_b64_tr_b16 v[198:199], v192 offset:5120
    ds_read_b64_tr_b16 v[200:201], v193 offset:32
    ds_read_b64_tr_b16 v[202:203], v193 offset:5152
    ds_read_b64_tr_b16 v[204:205], v192 offset:64
    ds_read_b64_tr_b16 v[206:207], v192 offset:5184
    ds_read_b64_tr_b16 v[208:209], v193 offset:96
    ds_read_b64_tr_b16 v[210:211], v193 offset:5216
    ds_read_b64_tr_b16 v[212:213], v192 offset:128
    ds_read_b64_tr_b16 v[214:215], v192 offset:5248
    s_waitcnt lgkmcnt(0)
    ds_read_b128 v[136:139], v191 offset:0
    v_mfma_f32_16x16x32_bf16 v[16:19], v[196:199], v[116:119], 0
    ds_read_b128 v[140:143], v191 offset:2048
    v_mfma_f32_16x16x32_bf16 v[20:23], v[196:199], v[120:123], 0
    ds_read_b128 v[144:147], v191 offset:4096
    v_mfma_f32_16x16x32_bf16 v[24:27], v[196:199], v[124:127], 0
    v_mfma_f32_16x16x32_bf16 v[28:31], v[196:199], v[128:131], 0
    ds_read_b128 v[148:151], v191 offset:6144
    v_mfma_f32_16x16x32_bf16 v[32:35], v[196:199], v[132:135], 0
    ds_read_b128 v[152:155], v191 offset:8192
    v_mfma_f32_16x16x32_bf16 v[36:39], v[200:203], v[116:119], 0
    ds_read_b64_tr_b16 v[216:217], v192 offset:10240
    v_mfma_f32_16x16x32_bf16 v[40:43], v[200:203], v[120:123], 0
    ds_read_b64_tr_b16 v[218:219], v192 offset:15360
    v_mfma_f32_16x16x32_bf16 v[44:47], v[200:203], v[124:127], 0
    ds_read_b64_tr_b16 v[220:221], v193 offset:10272
    v_mfma_f32_16x16x32_bf16 v[48:51], v[200:203], v[128:131], 0
    ds_read_b64_tr_b16 v[222:223], v193 offset:15392
    v_mfma_f32_16x16x32_bf16 v[52:55], v[200:203], v[132:135], 0
    v_mfma_f32_16x16x32_bf16 v[56:59], v[204:207], v[116:119], 0
    ds_read_b64_tr_b16 v[224:225], v192 offset:10304
    v_mfma_f32_16x16x32_bf16 v[60:63], v[204:207], v[120:123], 0
    ds_read_b64_tr_b16 v[226:227], v192 offset:15424
    v_mfma_f32_16x16x32_bf16 v[64:67], v[204:207], v[124:127], 0
    ds_read_b64_tr_b16 v[228:229], v193 offset:10336
    v_mfma_f32_16x16x32_bf16 v[68:71], v[204:207], v[128:131], 0
    ds_read_b64_tr_b16 v[230:231], v193 offset:15456
    v_mfma_f32_16x16x32_bf16 v[72:75], v[204:207], v[132:135], 0
    ds_read_b64_tr_b16 v[232:233], v192 offset:10368
    v_mfma_f32_16x16x32_bf16 v[76:79], v[208:211], v[116:119], 0
    ds_read_b64_tr_b16 v[234:235], v192 offset:15488
    v_mfma_f32_16x16x32_bf16 v[80:83], v[208:211], v[120:123], 0
    v_mfma_f32_16x16x32_bf16 v[84:87], v[208:211], v[124:127], 0
    v_mfma_f32_16x16x32_bf16 v[88:91], v[208:211], v[128:131], 0
    v_mfma_f32_16x16x32_bf16 v[92:95], v[208:211], v[132:135], 0
    v_mfma_f32_16x16x32_bf16 v[96:99], v[212:215], v[116:119], 0
    v_mfma_f32_16x16x32_bf16 v[100:103], v[212:215], v[120:123], 0
    v_mfma_f32_16x16x32_bf16 v[104:107], v[212:215], v[124:127], 0
    v_mfma_f32_16x16x32_bf16 v[108:111], v[212:215], v[128:131], 0
    v_mfma_f32_16x16x32_bf16 v[112:115], v[212:215], v[132:135], 0
    s_waitcnt vmcnt(0) lgkmcnt(0)
    v_add_u32 v190, -61440, v190
    v_add_u32 v191, -61440, v191
    v_add_u32 v192, -61440, v192
    v_add_u32 v193, -61440, v193
    s_barrier
    s_getreg_b32 s3, hwreg(HW_REG_XCC_ID)
    s_and_b32 s3, s3, 7
    s_add_u32 s3, s3, 1
    s_add_u32 s3, s3, s66
    s_mov_b32 s62, 1
    v_readfirstlane_b32 s4, v176
    s_nop 0
    s_cmp_eq_u32 s4, s3
    s_cselect_b32 s62, s62, 0
    v_readfirstlane_b32 s4, v177
    s_nop 0
    s_cmp_eq_u32 s4, s3
    s_cselect_b32 s62, s62, 0
    v_readfirstlane_b32 s4, v178
    s_nop 0
    s_cmp_eq_u32 s4, s3
    s_cselect_b32 s62, s62, 0
    v_readfirstlane_b32 s4, v179
    s_nop 0
    s_cmp_eq_u32 s4, s3
    s_cselect_b32 s62, s62, 0
    s_cmp_lg_u32 s32, 3
    s_cbranch_scc1 KF_NW_10
KF_NW_10:
    s_and_b32 s61, s57, 3
    s_cmp_lg_u32 s32, 3
    s_cbranch_scc1 KF_SIG_11
    s_lshl_b32 s3, s47, 7
    s_lshl_b32 s4, s61, 2
    s_add_u32 s3, s3, s4
    v_mov_b32 v5, s3
    v_mov_b32 v6, s66
    v_cmp_eq_u32 vcc, 0, v1
    s_and_saveexec_b64 s[70:71], vcc
    s_cmp_eq_u32 s62, 1
    s_cbranch_scc0 KF_FL_12
    global_store_dword v5, v6, s[58:59]
    s_branch KF_FM_13
KF_FL_12:
    global_store_dword v5, v6, s[58:59] sc0 sc1
KF_FM_13:
    s_mov_b64 exec, s[70:71]
KF_SIG_11:
    ds_read_b128 v[116:119], v190 offset:0
    s_lshr_b32 s3, s60, 1
    v_mfma_f32_16x16x32_bf16 v[16:19], v[216:219], v[136:139], v[16:19]
    ds_read_b128 v[120:123], v190 offset:2048
    s_add_u32 s3, s3, s42
    v_mfma_f32_16x16x32_bf16 v[20:23], v[216:219], v[140:143], v[20:23]
    ds_read_b128 v[124:127], v190 offset:4096
    s_and_b32 s3, s3, 7
    v_mfma_f32_16x16x32_bf16 v[24:27], v[216:219], v[144:147], v[24:27]
    v_mfma_f32_16x16x32_bf16 v[28:31], v[216:219], v[148:151], v[28:31]
    ds_read_b128 v[128:131], v190 offset:6144
    s_and_b32 s4, s60, 1
    v_mfma_f32_16x16x32_bf16 v[32:35], v[216:219], v[152:155], v[32:35]
    ds_read_b128 v[132:135], v190 offset:8192
    s_lshl_b32 s3, s3, 1
    v_mfma_f32_16x16x32_bf16 v[36:39], v[220:223], v[136:139], v[36:39]
    ds_read_b64_tr_b16 v[196:197], v192 offset:0
    s_add_u32 s3, s3, s4
    v_mfma_f32_16x16x32_bf16 v[40:43], v[220:223], v[140:143], v[40:43]
    ds_read_b64_tr_b16 v[198:199], v192 offset:5120
    s_mul_i32 s44, s3, 73728
    v_mfma_f32_16x16x32_bf16 v[44:47], v[220:223], v[144:147], v[44:47]
    ds_read_b64_tr_b16 v[200:201], v193 offset:32
    s_cmp_lt_u32 s60, 16
    v_mfma_f32_16x16x32_bf16 v[48:51], v[220:223], v[148:151], v[48:51]
    ds_read_b64_tr_b16 v[202:203], v193 offset:5152
    v_mfma_f32_16x16x32_bf16 v[52:55], v[220:223], v[152:155], v[52:55]
    s_cselect_b32 s10, s39, 0
    v_mfma_f32_16x16x32_bf16 v[56:59], v[224:227], v[136:139], v[56:59]
    ds_read_b64_tr_b16 v[204:205], v192 offset:64
    s_add_u32 s60, s60, 1
    v_mfma_f32_16x16x32_bf16 v[60:63], v[224:227], v[140:143], v[60:63]
    ds_read_b64_tr_b16 v[206:207], v192 offset:5184
    s_add_u32 m0, s36, 61440
    v_mfma_f32_16x16x32_bf16 v[64:67], v[224:227], v[144:147], v[64:67]
    ds_read_b64_tr_b16 v[208:209], v193 offset:96
    s_nop 0
    v_mfma_f32_16x16x32_bf16 v[68:71], v[224:227], v[148:151], v[68:71]
    ds_read_b64_tr_b16 v[210:211], v193 offset:5216
    buffer_load_dwordx4 v240, s[8:11], s44 offen offset:0 lds
    v_mfma_f32_16x16x32_bf16 v[72:75], v[224:227], v[152:155], v[72:75]
    ds_read_b64_tr_b16 v[212:213], v192 offset:128
    buffer_load_dwordx4 v241, s[8:11], s44 offen offset:1024 lds
    v_mfma_f32_16x16x32_bf16 v[76:79], v[228:231], v[136:139], v[76:79]
    ds_read_b64_tr_b16 v[214:215], v192 offset:5248
    v_mfma_f32_16x16x32_bf16 v[80:83], v[228:231], v[140:143], v[80:83]
    buffer_load_dwordx4 v242, s[8:11], s44 offen offset:2048 lds
    v_mfma_f32_16x16x32_bf16 v[84:87], v[228:231], v[144:147], v[84:87]
    buffer_load_dwordx4 v243, s[8:11], s44 offen offset:3072 lds
    v_mfma_f32_16x16x32_bf16 v[88:91], v[228:231], v[148:151], v[88:91]
    s_add_u32 m0, s36, 65536
    v_mfma_f32_16x16x32_bf16 v[92:95], v[228:231], v[152:155], v[92:95]
    s_nop 0
    v_mfma_f32_16x16x32_bf16 v[96:99], v[232:235], v[136:139], v[96:99]
    buffer_load_dwordx4 v253, s[8:11], s44 offen offset:0 lds
    v_mfma_f32_16x16x32_bf16 v[100:103], v[232:235], v[140:143], v[100:103]
    v_mfma_f32_16x16x32_bf16 v[104:107], v[232:235], v[144:147], v[104:107]
    v_mfma_f32_16x16x32_bf16 v[108:111], v[232:235], v[148:151], v[108:111]
    v_mfma_f32_16x16x32_bf16 v[112:115], v[232:235], v[152:155], v[112:115]
    s_waitcnt lgkmcnt(0)
    ds_read_b128 v[136:139], v191 offset:0
    v_mfma_f32_16x16x32_bf16 v[16:19], v[196:199], v[116:119], v[16:19]
    ds_read_b128 v[140:143], v191 offset:2048
    v_mfma_f32_16x16x32_bf16 v[20:23], v[196:199], v[120:123], v[20:23]
    ds_read_b128 v[144:147], v191 offset:4096
    v_mfma_f32_16x16x32_bf16 v[24:27], v[196:199], v[124:127], v[24:27]
    v_mfma_f32_16x16x32_bf16 v[28:31], v[196:199], v[128:131], v[28:31]
    ds_read_b128 v[148:151], v191 offset:6144
    v_mfma_f32_16x16x32_bf16 v[32:35], v[196:199], v[132:135], v[32:35]
    ds_read_b128 v[152:155], v191 offset:8192
    v_mfma_f32_16x16x32_bf16 v[36:39], v[200:203], v[116:119], v[36:39]
    ds_read_b64_tr_b16 v[216:217], v192 offset:10240
    v_mfma_f32_16x16x32_bf16 v[40:43], v[200:203], v[120:123], v[40:43]
    ds_read_b64_tr_b16 v[218:219], v192 offset:15360
    v_mfma_f32_16x16x32_bf16 v[44:47], v[200:203], v[124:127], v[44:47]
    ds_read_b64_tr_b16 v[220:221], v193 offset:10272
    v_mfma_f32_16x16x32_bf16 v[48:51], v[200:203], v[128:131], v[48:51]
    ds_read_b64_tr_b16 v[222:223], v193 offset:15392
    v_mfma_f32_16x16x32_bf16 v[52:55], v[200:203], v[132:135], v[52:55]
    v_mfma_f32_16x16x32_bf16 v[56:59], v[204:207], v[116:119], v[56:59]
    ds_read_b64_tr_b16 v[224:225], v192 offset:10304
    v_mfma_f32_16x16x32_bf16 v[60:63], v[204:207], v[120:123], v[60:63]
    ds_read_b64_tr_b16 v[226:227], v192 offset:15424
    v_mfma_f32_16x16x32_bf16 v[64:67], v[204:207], v[124:127], v[64:67]
    ds_read_b64_tr_b16 v[228:229], v193 offset:10336
    v_mfma_f32_16x16x32_bf16 v[68:71], v[204:207], v[128:131], v[68:71]
    ds_read_b64_tr_b16 v[230:231], v193 offset:15456
    v_mfma_f32_16x16x32_bf16 v[72:75], v[204:207], v[132:135], v[72:75]
    ds_read_b64_tr_b16 v[232:233], v192 offset:10368
    v_mfma_f32_16x16x32_bf16 v[76:79], v[208:211], v[116:119], v[76:79]
    ds_read_b64_tr_b16 v[234:235], v192 offset:15488
    v_mfma_f32_16x16x32_bf16 v[80:83], v[208:211], v[120:123], v[80:83]
    v_mfma_f32_16x16x32_bf16 v[84:87], v[208:211], v[124:127], v[84:87]
    v_mfma_f32_16x16x32_bf16 v[88:91], v[208:211], v[128:131], v[88:91]
    v_mfma_f32_16x16x32_bf16 v[92:95], v[208:211], v[132:135], v[92:95]
    v_mfma_f32_16x16x32_bf16 v[96:99], v[212:215], v[116:119], v[96:99]
    v_mfma_f32_16x16x32_bf16 v[100:103], v[212:215], v[120:123], v[100:103]
    v_mfma_f32_16x16x32_bf16 v[104:107], v[212:215], v[124:127], v[104:107]
    v_mfma_f32_16x16x32_bf16 v[108:111], v[212:215], v[128:131], v[108:111]
    v_mfma_f32_16x16x32_bf16 v[112:115], v[212:215], v[132:135], v[112:115]
    s_cmp_lg_u32 s32, 3
    s_cbranch_scc1 KF_PD_16
    s_and_b32 s3, s57, 3
    s_add_u32 s3, s3, 1
    s_and_b32 s3, s3, 3
    s_lshl_b32 s3, s3, 2
    s_lshl_b32 s4, s47, 7
    s_add_u32 s3, s3, s4
    v_mov_b32 v5, s3
    s_mov_b32 s65, 0
KF_PL_14:
    s_cmp_eq_u32 s62, 1
    s_cbranch_scc0 KF_PS_17
    global_load_dword v7, v5, s[58:59] sc1
    s_branch KF_PC_18
KF_PS_17:
    global_load_dword v7, v5, s[58:59] sc0 sc1
KF_PC_18:
    s_waitcnt vmcnt(0)
    v_readfirstlane_b32 s3, v7
    s_add_u32 s65, s65, 1
    s_cmp_eq_u32 s3, s66
    s_cbranch_scc1 KF_PX_15
    s_sleep 1
    s_cmp_lt_u32 s65, 0x8000
    s_cbranch_scc1 KF_PL_14
KF_PX_15:
    s_cmp_eq_u32 s62, 1
    s_cbranch_scc1 KF_PD_16
    buffer_inv sc1
    s_waitcnt vmcnt(0)
KF_PD_16:
    s_waitcnt lgkmcnt(0)
    v_add_u32 v190, 20480, v190
    v_add_u32 v191, 20480, v191
    v_add_u32 v192, 20480, v192
    v_add_u32 v193, 20480, v193
    s_barrier
    s_lshr_b32 s3, s41, 1
    ds_read_b128 v[116:119], v190 offset:0
    s_add_u32 s3, s3, s42
    v_mfma_f32_16x16x32_bf16 v[16:19], v[216:219], v[136:139], v[16:19]
    s_and_b32 s3, s3, 7
    ds_read_b128 v[120:123], v190 offset:2048
    s_and_b32 s4, s41, 1
    v_mfma_f32_16x16x32_bf16 v[20:23], v[216:219], v[140:143], v[20:23]
    s_mul_i32 s43, s3, 40960
    s_lshl_b32 s4, s4, 11
    ds_read_b128 v[124:127], v190 offset:4096
    v_mfma_f32_16x16x32_bf16 v[24:27], v[216:219], v[144:147], v[24:27]
    s_add_u32 s43, s43, s4
    s_cmp_lt_u32 s41, 16
    v_mfma_f32_16x16x32_bf16 v[28:31], v[216:219], v[148:151], v[28:31]
    ds_read_b128 v[128:131], v190 offset:6144
    s_cselect_b32 s14, 327680, 0
    s_add_u32 s41, s41, 1
    v_mfma_f32_16x16x32_bf16 v[32:35], v[216:219], v[152:155], v[32:35]
    ds_read_b128 v[132:135], v190 offset:8192
    s_add_u32 m0, s37, 61440
    s_nop 0
    v_mfma_f32_16x16x32_bf16 v[36:39], v[220:223], v[136:139], v[36:39]
    buffer_load_dwordx4 v181, s[12:15], s43 offen lds
    ds_read_b64_tr_b16 v[196:197], v192 offset:0
    s_add_u32 m0, s37, 62464
    v_mfma_f32_16x16x32_bf16 v[40:43], v[220:223], v[140:143], v[40:43]
    s_nop 0
    ds_read_b64_tr_b16 v[198:199], v192 offset:5120
    buffer_load_dwordx4 v182, s[12:15], s43 offen lds
    v_mfma_f32_16x16x32_bf16 v[44:47], v[220:223], v[144:147], v[44:47]
    s_add_u32 m0, s37, 63488
    ds_read_b64_tr_b16 v[200:201], v193 offset:32
    s_nop 0
    v_mfma_f32_16x16x32_bf16 v[48:51], v[220:223], v[148:151], v[48:51]
    buffer_load_dwordx4 v183, s[12:15], s43 offen lds
    ds_read_b64_tr_b16 v[202:203], v193 offset:5152
    s_add_u32 m0, s37, 64512
    v_mfma_f32_16x16x32_bf16 v[52:55], v[220:223], v[152:155], v[52:55]
    s_nop 0
    buffer_load_dwordx4 v184, s[12:15], s43 offen lds
    v_mfma_f32_16x16x32_bf16 v[56:59], v[224:227], v[136:139], v[56:59]
    ds_read_b64_tr_b16 v[204:205], v192 offset:64
    s_add_u32 m0, s37, 65536
    v_mfma_f32_16x16x32_bf16 v[60:63], v[224:227], v[140:143], v[60:63]
    s_nop 0
    ds_read_b64_tr_b16 v[206:207], v192 offset:5184
    buffer_load_dwordx4 v185, s[12:15], s43 offen lds
    v_mfma_f32_16x16x32_bf16 v[64:67], v[224:227], v[144:147], v[64:67]
    s_lshr_b32 s3, s60, 1
    ds_read_b64_tr_b16 v[208:209], v193 offset:96
    s_add_u32 s3, s3, s42
    v_mfma_f32_16x16x32_bf16 v[68:71], v[224:227], v[148:151], v[68:71]
    s_and_b32 s3, s3, 7
    s_and_b32 s4, s60, 1
    ds_read_b64_tr_b16 v[210:211], v193 offset:5216
    v_mfma_f32_16x16x32_bf16 v[72:75], v[224:227], v[152:155], v[72:75]
    s_lshl_b32 s3, s3, 1
    s_add_u32 s3, s3, s4
    ds_read_b64_tr_b16 v[212:213], v192 offset:128
    v_mfma_f32_16x16x32_bf16 v[76:79], v[228:231], v[136:139], v[76:79]
    s_mul_i32 s44, s3, 73728
    s_cmp_lt_u32 s60, 16
    ds_read_b64_tr_b16 v[214:215], v192 offset:5248
    v_mfma_f32_16x16x32_bf16 v[80:83], v[228:231], v[140:143], v[80:83]
    s_cselect_b32 s10, s39, 0
    s_add_u32 s60, s60, 1
    v_mfma_f32_16x16x32_bf16 v[84:87], v[228:231], v[144:147], v[84:87]
    s_add_u32 m0, s36, 0
    s_nop 0
    v_mfma_f32_16x16x32_bf16 v[88:91], v[228:231], v[148:151], v[88:91]
    buffer_load_dwordx4 v240, s[8:11], s44 offen offset:0 lds
    buffer_load_dwordx4 v241, s[8:11], s44 offen offset:1024 lds
    v_mfma_f32_16x16x32_bf16 v[92:95], v[228:231], v[152:155], v[92:95]
    buffer_load_dwordx4 v242, s[8:11], s44 offen offset:2048 lds
    buffer_load_dwordx4 v243, s[8:11], s44 offen offset:3072 lds
    v_mfma_f32_16x16x32_bf16 v[96:99], v[232:235], v[136:139], v[96:99]
    s_add_u32 m0, s36, 4096
    s_nop 0
    v_mfma_f32_16x16x32_bf16 v[100:103], v[232:235], v[140:143], v[100:103]
    buffer_load_dwordx4 v253, s[8:11], s44 offen offset:0 lds
    v_mfma_f32_16x16x32_bf16 v[104:107], v[232:235], v[144:147], v[104:107]
    v_mfma_f32_16x16x32_bf16 v[108:111], v[232:235], v[148:151], v[108:111]
    v_mfma_f32_16x16x32_bf16 v[112:115], v[232:235], v[152:155], v[112:115]
    s_waitcnt lgkmcnt(0)
    s_lshr_b32 s3, s41, 1
    ds_read_b128 v[136:139], v191 offset:0
    v_mfma_f32_16x16x32_bf16 v[16:19], v[196:199], v[116:119], v[16:19]
    s_add_u32 s3, s3, s42
    ds_read_b128 v[140:143], v191 offset:2048
    v_mfma_f32_16x16x32_bf16 v[20:23], v[196:199], v[120:123], v[20:23]
    s_and_b32 s3, s3, 7
    ds_read_b128 v[144:147], v191 offset:4096
    v_mfma_f32_16x16x32_bf16 v[24:27], v[196:199], v[124:127], v[24:27]
    s_and_b32 s4, s41, 1
    v_mfma_f32_16x16x32_bf16 v[28:31], v[196:199], v[128:131], v[28:31]
    s_mul_i32 s43, s3, 40960
    ds_read_b128 v[148:151], v191 offset:6144
    s_lshl_b32 s4, s4, 11
    v_mfma_f32_16x16x32_bf16 v[32:35], v[196:199], v[132:135], v[32:35]
    ds_read_b128 v[152:155], v191 offset:8192
    s_add_u32 s43, s43, s4
    v_mfma_f32_16x16x32_bf16 v[36:39], v[200:203], v[116:119], v[36:39]
    ds_read_b64_tr_b16 v[216:217], v192 offset:10240
    s_cmp_lt_u32 s41, 16
    v_mfma_f32_16x16x32_bf16 v[40:43], v[200:203], v[120:123], v[40:43]
    ds_read_b64_tr_b16 v[218:219], v192 offset:15360
    s_cselect_b32 s14, 327680, 0
    v_mfma_f32_16x16x32_bf16 v[44:47], v[200:203], v[124:127], v[44:47]
    s_add_u32 s41, s41, 1
    ds_read_b64_tr_b16 v[220:221], v193 offset:10272
    v_mfma_f32_16x16x32_bf16 v[48:51], v[200:203], v[128:131], v[48:51]
    s_add_u32 m0, s37, 0
    ds_read_b64_tr_b16 v[222:223], v193 offset:15392
    v_mfma_f32_16x16x32_bf16 v[52:55], v[200:203], v[132:135], v[52:55]
    s_nop 0
    v_mfma_f32_16x16x32_bf16 v[56:59], v[204:207], v[116:119], v[56:59]
    ds_read_b64_tr_b16 v[224:225], v192 offset:10304
    buffer_load_dwordx4 v181, s[12:15], s43 offen lds
    v_mfma_f32_16x16x32_bf16 v[60:63], v[204:207], v[120:123], v[60:63]
    s_add_u32 m0, s37, 1024
    ds_read_b64_tr_b16 v[226:227], v192 offset:15424
    v_mfma_f32_16x16x32_bf16 v[64:67], v[204:207], v[124:127], v[64:67]
    s_nop 0
    ds_read_b64_tr_b16 v[228:229], v193 offset:10336
    buffer_load_dwordx4 v182, s[12:15], s43 offen lds
    v_mfma_f32_16x16x32_bf16 v[68:71], v[204:207], v[128:131], v[68:71]
    ds_read_b64_tr_b16 v[230:231], v193 offset:15456
    s_add_u32 m0, s37, 2048
    v_mfma_f32_16x16x32_bf16 v[72:75], v[204:207], v[132:135], v[72:75]
    ds_read_b64_tr_b16 v[232:233], v192 offset:10368
    s_nop 0
    v_mfma_f32_16x16x32_bf16 v[76:79], v[208:211], v[116:119], v[76:79]
    buffer_load_dwordx4 v183, s[12:15], s43 offen lds
    ds_read_b64_tr_b16 v[234:235], v192 offset:15488
    v_mfma_f32_16x16x32_bf16 v[80:83], v[208:211], v[120:123], v[80:83]
    s_add_u32 m0, s37, 3072
    v_mfma_f32_16x16x32_bf16 v[84:87], v[208:211], v[124:127], v[84:87]
    s_nop 0
    v_mfma_f32_16x16x32_bf16 v[88:91], v[208:211], v[128:131], v[88:91]
    buffer_load_dwordx4 v184, s[12:15], s43 offen lds
    v_mfma_f32_16x16x32_bf16 v[92:95], v[208:211], v[132:135], v[92:95]
    s_add_u32 m0, s37, 4096
    v_mfma_f32_16x16x32_bf16 v[96:99], v[212:215], v[116:119], v[96:99]
    s_nop 0
    v_mfma_f32_16x16x32_bf16 v[100:103], v[212:215], v[120:123], v[100:103]
    buffer_load_dwordx4 v185, s[12:15], s43 offen lds
    v_mfma_f32_16x16x32_bf16 v[104:107], v[212:215], v[124:127], v[104:107]
    v_mfma_f32_16x16x32_bf16 v[108:111], v[212:215], v[128:131], v[108:111]
    v_mfma_f32_16x16x32_bf16 v[112:115], v[212:215], v[132:135], v[112:115]
    s_waitcnt lgkmcnt(0)
    v_add_u32 v190, 20480, v190
    v_add_u32 v191, 20480, v191
    v_add_u32 v192, 20480, v192
    v_add_u32 v193, 20480, v193
    s_barrier
    ds_read_b128 v[116:119], v190 offset:0
    s_lshr_b32 s3, s60, 1
    v_mfma_f32_16x16x32_bf16 v[16:19], v[216:219], v[136:139], v[16:19]
    ds_read_b128 v[120:123], v190 offset:2048
    s_add_u32 s3, s3, s42
    v_mfma_f32_16x16x32_bf16 v[20:23], v[216:219], v[140:143], v[20:23]
    ds_read_b128 v[124:127], v190 offset:4096
    s_and_b32 s3, s3, 7
    v_mfma_f32_16x16x32_bf16 v[24:27], v[216:219], v[144:147], v[24:27]
    v_mfma_f32_16x16x32_bf16 v[28:31], v[216:219], v[148:151], v[28:31]
    ds_read_b128 v[128:131], v190 offset:6144
    s_and_b32 s4, s60, 1
    v_mfma_f32_16x16x32_bf16 v[32:35], v[216:219], v[152:155], v[32:35]
    ds_read_b128 v[132:135], v190 offset:8192
    s_lshl_b32 s3, s3, 1
    v_mfma_f32_16x16x32_bf16 v[36:39], v[220:223], v[136:139], v[36:39]
    ds_read_b64_tr_b16 v[196:197], v192 offset:0
    s_add_u32 s3, s3, s4
    v_mfma_f32_16x16x32_bf16 v[40:43], v[220:223], v[140:143], v[40:43]
    ds_read_b64_tr_b16 v[198:199], v192 offset:5120
    s_mul_i32 s44, s3, 73728
    v_mfma_f32_16x16x32_bf16 v[44:47], v[220:223], v[144:147], v[44:47]
    ds_read_b64_tr_b16 v[200:201], v193 offset:32
    s_cmp_lt_u32 s60, 16
    v_mfma_f32_16x16x32_bf16 v[48:51], v[220:223], v[148:151], v[48:51]
    ds_read_b64_tr_b16 v[202:203], v193 offset:5152
    v_mfma_f32_16x16x32_bf16 v[52:55], v[220:223], v[152:155], v[52:55]
    s_cselect_b32 s10, s39, 0
    v_mfma_f32_16x16x32_bf16 v[56:59], v[224:227], v[136:139], v[56:59]
    ds_read_b64_tr_b16 v[204:205], v192 offset:64
    s_add_u32 s60, s60, 1
    v_mfma_f32_16x16x32_bf16 v[60:63], v[224:227], v[140:143], v[60:63]
    ds_read_b64_tr_b16 v[206:207], v192 offset:5184
    s_add_u32 m0, s36, 20480
    v_mfma_f32_16x16x32_bf16 v[64:67], v[224:227], v[144:147], v[64:67]
    ds_read_b64_tr_b16 v[208:209], v193 offset:96
    s_nop 0
    v_mfma_f32_16x16x32_bf16 v[68:71], v[224:227], v[148:151], v[68:71]
    ds_read_b64_tr_b16 v[210:211], v193 offset:5216
    buffer_load_dwordx4 v240, s[8:11], s44 offen offset:0 lds
    v_mfma_f32_16x16x32_bf16 v[72:75], v[224:227], v[152:155], v[72:75]
    ds_read_b64_tr_b16 v[212:213], v192 offset:128
    buffer_load_dwordx4 v241, s[8:11], s44 offen offset:1024 lds
    v_mfma_f32_16x16x32_bf16 v[76:79], v[228:231], v[136:139], v[76:79]
    ds_read_b64_tr_b16 v[214:215], v192 offset:5248
    v_mfma_f32_16x16x32_bf16 v[80:83], v[228:231], v[140:143], v[80:83]
    buffer_load_dwordx4 v242, s[8:11], s44 offen offset:2048 lds
    v_mfma_f32_16x16x32_bf16 v[84:87], v[228:231], v[144:147], v[84:87]
    buffer_load_dwordx4 v243, s[8:11], s44 offen offset:3072 lds
    v_mfma_f32_16x16x32_bf16 v[88:91], v[228:231], v[148:151], v[88:91]
    s_add_u32 m0, s36, 24576
    v_mfma_f32_16x16x32_bf16 v[92:95], v[228:231], v[152:155], v[92:95]
    s_nop 0
    v_mfma_f32_16x16x32_bf16 v[96:99], v[232:235], v[136:139], v[96:99]
    buffer_load_dwordx4 v253, s[8:11], s44 offen offset:0 lds
    v_mfma_f32_16x16x32_bf16 v[100:103], v[232:235], v[140:143], v[100:103]
    v_mfma_f32_16x16x32_bf16 v[104:107], v[232:235], v[144:147], v[104:107]
    v_mfma_f32_16x16x32_bf16 v[108:111], v[232:235], v[148:151], v[108:111]
    v_mfma_f32_16x16x32_bf16 v[112:115], v[232:235], v[152:155], v[112:115]
    s_waitcnt lgkmcnt(0)
    s_lshr_b32 s3, s41, 1
    ds_read_b128 v[136:139], v191 offset:0
    v_mfma_f32_16x16x32_bf16 v[16:19], v[196:199], v[116:119], v[16:19]
    s_add_u32 s3, s3, s42
    ds_read_b128 v[140:143], v191 offset:2048
    v_mfma_f32_16x16x32_bf16 v[20:23], v[196:199], v[120:123], v[20:23]
    s_and_b32 s3, s3, 7
    ds_read_b128 v[144:147], v191 offset:4096
    v_mfma_f32_16x16x32_bf16 v[24:27], v[196:199], v[124:127], v[24:27]
    s_and_b32 s4, s41, 1
    v_mfma_f32_16x16x32_bf16 v[28:31], v[196:199], v[128:131], v[28:31]
    s_mul_i32 s43, s3, 40960
    ds_read_b128 v[148:151], v191 offset:6144
    s_lshl_b32 s4, s4, 11
    v_mfma_f32_16x16x32_bf16 v[32:35], v[196:199], v[132:135], v[32:35]
    ds_read_b128 v[152:155], v191 offset:8192
    s_add_u32 s43, s43, s4
    v_mfma_f32_16x16x32_bf16 v[36:39], v[200:203], v[116:119], v[36:39]
    ds_read_b64_tr_b16 v[216:217], v192 offset:10240
    s_cmp_lt_u32 s41, 16
    v_mfma_f32_16x16x32_bf16 v[40:43], v[200:203], v[120:123], v[40:43]
    ds_read_b64_tr_b16 v[218:219], v192 offset:15360
    s_cselect_b32 s14, 327680, 0
    v_mfma_f32_16x16x32_bf16 v[44:47], v[200:203], v[124:127], v[44:47]
    s_add_u32 s41, s41, 1
    ds_read_b64_tr_b16 v[220:221], v193 offset:10272
    v_mfma_f32_16x16x32_bf16 v[48:51], v[200:203], v[128:131], v[48:51]
    s_add_u32 m0, s37, 20480
    ds_read_b64_tr_b16 v[222:223], v193 offset:15392
    v_mfma_f32_16x16x32_bf16 v[52:55], v[200:203], v[132:135], v[52:55]
    s_nop 0
    v_mfma_f32_16x16x32_bf16 v[56:59], v[204:207], v[116:119], v[56:59]
    ds_read_b64_tr_b16 v[224:225], v192 offset:10304
    buffer_load_dwordx4 v181, s[12:15], s43 offen lds
    v_mfma_f32_16x16x32_bf16 v[60:63], v[204:207], v[120:123], v[60:63]
    s_add_u32 m0, s37, 21504
    ds_read_b64_tr_b16 v[226:227], v192 offset:15424
    v_mfma_f32_16x16x32_bf16 v[64:67], v[204:207], v[124:127], v[64:67]
    s_nop 0
    ds_read_b64_tr_b16 v[228:229], v193 offset:10336
    buffer_load_dwordx4 v182, s[12:15], s43 offen lds
    v_mfma_f32_16x16x32_bf16 v[68:71], v[204:207], v[128:131], v[68:71]
    ds_read_b64_tr_b16 v[230:231], v193 offset:15456
    s_add_u32 m0, s37, 22528
    v_mfma_f32_16x16x32_bf16 v[72:75], v[204:207], v[132:135], v[72:75]
    ds_read_b64_tr_b16 v[232:233], v192 offset:10368
    s_nop 0
    v_mfma_f32_16x16x32_bf16 v[76:79], v[208:211], v[116:119], v[76:79]
    buffer_load_dwordx4 v183, s[12:15], s43 offen lds
    ds_read_b64_tr_b16 v[234:235], v192 offset:15488
    v_mfma_f32_16x16x32_bf16 v[80:83], v[208:211], v[120:123], v[80:83]
    s_add_u32 m0, s37, 23552
    v_mfma_f32_16x16x32_bf16 v[84:87], v[208:211], v[124:127], v[84:87]
    s_nop 0
    v_mfma_f32_16x16x32_bf16 v[88:91], v[208:211], v[128:131], v[88:91]
    buffer_load_dwordx4 v184, s[12:15], s43 offen lds
    v_mfma_f32_16x16x32_bf16 v[92:95], v[208:211], v[132:135], v[92:95]
    s_add_u32 m0, s37, 24576
    v_mfma_f32_16x16x32_bf16 v[96:99], v[212:215], v[116:119], v[96:99]
    s_nop 0
    v_mfma_f32_16x16x32_bf16 v[100:103], v[212:215], v[120:123], v[100:103]
    buffer_load_dwordx4 v185, s[12:15], s43 offen lds
    v_mfma_f32_16x16x32_bf16 v[104:107], v[212:215], v[124:127], v[104:107]
    v_mfma_f32_16x16x32_bf16 v[108:111], v[212:215], v[128:131], v[108:111]
    v_mfma_f32_16x16x32_bf16 v[112:115], v[212:215], v[132:135], v[112:115]
    s_waitcnt vmcnt(20) lgkmcnt(0)
    v_add_u32 v190, 20480, v190
    v_add_u32 v191, 20480, v191
    v_add_u32 v192, 20480, v192
    v_add_u32 v193, 20480, v193
    s_barrier
    ds_read_b128 v[116:119], v190 offset:0
    s_lshr_b32 s3, s60, 1
    v_mfma_f32_16x16x32_bf16 v[16:19], v[216:219], v[136:139], v[16:19]
    ds_read_b128 v[120:123], v190 offset:2048
    s_add_u32 s3, s3, s42
    v_mfma_f32_16x16x32_bf16 v[20:23], v[216:219], v[140:143], v[20:23]
    ds_read_b128 v[124:127], v190 offset:4096
    s_and_b32 s3, s3, 7
    v_mfma_f32_16x16x32_bf16 v[24:27], v[216:219], v[144:147], v[24:27]
    v_mfma_f32_16x16x32_bf16 v[28:31], v[216:219], v[148:151], v[28:31]
    ds_read_b128 v[128:131], v190 offset:6144
    s_and_b32 s4, s60, 1
    v_mfma_f32_16x16x32_bf16 v[32:35], v[216:219], v[152:155], v[32:35]
    ds_read_b128 v[132:135], v190 offset:8192
    s_lshl_b32 s3, s3, 1
    v_mfma_f32_16x16x32_bf16 v[36:39], v[220:223], v[136:139], v[36:39]
    ds_read_b64_tr_b16 v[196:197], v192 offset:0
    s_add_u32 s3, s3, s4
    v_mfma_f32_16x16x32_bf16 v[40:43], v[220:223], v[140:143], v[40:43]
    ds_read_b64_tr_b16 v[198:199], v192 offset:5120
    s_mul_i32 s44, s3, 73728
    v_mfma_f32_16x16x32_bf16 v[44:47], v[220:223], v[144:147], v[44:47]
    ds_read_b64_tr_b16 v[200:201], v193 offset:32
    s_cmp_lt_u32 s60, 16
    v_mfma_f32_16x16x32_bf16 v[48:51], v[220:223], v[148:151], v[48:51]
    ds_read_b64_tr_b16 v[202:203], v193 offset:5152
    v_mfma_f32_16x16x32_bf16 v[52:55], v[220:223], v[152:155], v[52:55]
    s_cselect_b32 s10, s39, 0
    v_mfma_f32_16x16x32_bf16 v[56:59], v[224:227], v[136:139], v[56:59]
    ds_read_b64_tr_b16 v[204:205], v192 offset:64
    s_add_u32 s60, s60, 1
    v_mfma_f32_16x16x32_bf16 v[60:63], v[224:227], v[140:143], v[60:63]
    ds_read_b64_tr_b16 v[206:207], v192 offset:5184
    s_add_u32 m0, s36, 40960
    v_mfma_f32_16x16x32_bf16 v[64:67], v[224:227], v[144:147], v[64:67]
    ds_read_b64_tr_b16 v[208:209], v193 offset:96
    s_nop 0
    v_mfma_f32_16x16x32_bf16 v[68:71], v[224:227], v[148:151], v[68:71]
    ds_read_b64_tr_b16 v[210:211], v193 offset:5216
    buffer_load_dwordx4 v240, s[8:11], s44 offen offset:0 lds
    v_mfma_f32_16x16x32_bf16 v[72:75], v[224:227], v[152:155], v[72:75]
    ds_read_b64_tr_b16 v[212:213], v192 offset:128
    buffer_load_dwordx4 v241, s[8:11], s44 offen offset:1024 lds
    v_mfma_f32_16x16x32_bf16 v[76:79], v[228:231], v[136:139], v[76:79]
    ds_read_b64_tr_b16 v[214:215], v192 offset:5248
    v_mfma_f32_16x16x32_bf16 v[80:83], v[228:231], v[140:143], v[80:83]
    buffer_load_dwordx4 v242, s[8:11], s44 offen offset:2048 lds
    v_mfma_f32_16x16x32_bf16 v[84:87], v[228:231], v[144:147], v[84:87]
    buffer_load_dwordx4 v243, s[8:11], s44 offen offset:3072 lds
    v_mfma_f32_16x16x32_bf16 v[88:91], v[228:231], v[148:151], v[88:91]
    s_add_u32 m0, s36, 45056
    v_mfma_f32_16x16x32_bf16 v[92:95], v[228:231], v[152:155], v[92:95]
    s_nop 0
    v_mfma_f32_16x16x32_bf16 v[96:99], v[232:235], v[136:139], v[96:99]
    buffer_load_dwordx4 v253, s[8:11], s44 offen offset:0 lds
    v_mfma_f32_16x16x32_bf16 v[100:103], v[232:235], v[140:143], v[100:103]
    v_mfma_f32_16x16x32_bf16 v[104:107], v[232:235], v[144:147], v[104:107]
    v_mfma_f32_16x16x32_bf16 v[108:111], v[232:235], v[148:151], v[108:111]
    v_mfma_f32_16x16x32_bf16 v[112:115], v[232:235], v[152:155], v[112:115]
    s_mov_b32 s45, 0
KF_L0:
    s_waitcnt lgkmcnt(0)
    s_lshr_b32 s3, s41, 1
    ds_read_b128 v[136:139], v191 offset:0
    v_mfma_f32_16x16x32_bf16 v[16:19], v[196:199], v[116:119], v[16:19]
    s_add_u32 s3, s3, s42
    ds_read_b128 v[140:143], v191 offset:2048
    v_mfma_f32_16x16x32_bf16 v[20:23], v[196:199], v[120:123], v[20:23]
    s_and_b32 s3, s3, 7
    ds_read_b128 v[144:147], v191 offset:4096
    v_mfma_f32_16x16x32_bf16 v[24:27], v[196:199], v[124:127], v[24:27]
    s_and_b32 s4, s41, 1
    v_mfma_f32_16x16x32_bf16 v[28:31], v[196:199], v[128:131], v[28:31]
    s_mul_i32 s43, s3, 40960
    ds_read_b128 v[148:151], v191 offset:6144
    s_lshl_b32 s4, s4, 11
    v_mfma_f32_16x16x32_bf16 v[32:35], v[196:199], v[132:135], v[32:35]
    ds_read_b128 v[152:155], v191 offset:8192
    s_add_u32 s43, s43, s4
    v_mfma_f32_16x16x32_bf16 v[36:39], v[200:203], v[116:119], v[36:39]
    ds_read_b64_tr_b16 v[216:217], v192 offset:10240
    s_cmp_lt_u32 s41, 16
    v_mfma_f32_16x16x32_bf16 v[40:43], v[200:203], v[120:123], v[40:43]
    ds_read_b64_tr_b16 v[218:219], v192 offset:15360
    s_cselect_b32 s14, 327680, 0
    v_mfma_f32_16x16x32_bf16 v[44:47], v[200:203], v[124:127], v[44:47]
    s_add_u32 s41, s41, 1
    ds_read_b64_tr_b16 v[220:221], v193 offset:10272
    v_mfma_f32_16x16x32_bf16 v[48:51], v[200:203], v[128:131], v[48:51]
    s_add_u32 m0, s37, 40960
    ds_read_b64_tr_b16 v[222:223], v193 offset:15392
    v_mfma_f32_16x16x32_bf16 v[52:55], v[200:203], v[132:135], v[52:55]
    s_nop 0
    v_mfma_f32_16x16x32_bf16 v[56:59], v[204:207], v[116:119], v[56:59]
    ds_read_b64_tr_b16 v[224:225], v192 offset:10304
    buffer_load_dwordx4 v181, s[12:15], s43 offen lds
    v_mfma_f32_16x16x32_bf16 v[60:63], v[204:207], v[120:123], v[60:63]
    s_add_u32 m0, s37, 41984
    ds_read_b64_tr_b16 v[226:227], v192 offset:15424
    v_mfma_f32_16x16x32_bf16 v[64:67], v[204:207], v[124:127], v[64:67]
    s_nop 0
    ds_read_b64_tr_b16 v[228:229], v193 offset:10336
    buffer_load_dwordx4 v182, s[12:15], s43 offen lds
    v_mfma_f32_16x16x32_bf16 v[68:71], v[204:207], v[128:131], v[68:71]
    ds_read_b64_tr_b16 v[230:231], v193 offset:15456
    s_add_u32 m0, s37, 43008
    v_mfma_f32_16x16x32_bf16 v[72:75], v[204:207], v[132:135], v[72:75]
    ds_read_b64_tr_b16 v[232:233], v192 offset:10368
    s_nop 0
    v_mfma_f32_16x16x32_bf16 v[76:79], v[208:211], v[116:119], v[76:79]
    buffer_load_dwordx4 v183, s[12:15], s43 offen lds
    ds_read_b64_tr_b16 v[234:235], v192 offset:15488
    v_mfma_f32_16x16x32_bf16 v[80:83], v[208:211], v[120:123], v[80:83]
    s_add_u32 m0, s37, 44032
    v_mfma_f32_16x16x32_bf16 v[84:87], v[208:211], v[124:127], v[84:87]
    s_nop 0
    v_mfma_f32_16x16x32_bf16 v[88:91], v[208:211], v[128:131], v[88:91]
    buffer_load_dwordx4 v184, s[12:15], s43 offen lds
    v_mfma_f32_16x16x32_bf16 v[92:95], v[208:211], v[132:135], v[92:95]
    s_add_u32 m0, s37, 45056
    v_mfma_f32_16x16x32_bf16 v[96:99], v[212:215], v[116:119], v[96:99]
    s_nop 0
    v_mfma_f32_16x16x32_bf16 v[100:103], v[212:215], v[120:123], v[100:103]
    buffer_load_dwordx4 v185, s[12:15], s43 offen lds
    v_mfma_f32_16x16x32_bf16 v[104:107], v[212:215], v[124:127], v[104:107]
    v_mfma_f32_16x16x32_bf16 v[108:111], v[212:215], v[128:131], v[108:111]
    v_mfma_f32_16x16x32_bf16 v[112:115], v[212:215], v[132:135], v[112:115]
    s_cmp_eq_u32 s45, 0
    s_cbranch_scc0 KF_WN_19a
    s_cmp_lg_u32 s32, 3
    s_cbranch_scc1 KF_PD_22
    s_and_b32 s3, s57, 3
    s_add_u32 s3, s3, 2
    s_and_b32 s3, s3, 3
    s_lshl_b32 s3, s3, 2
    s_lshl_b32 s4, s47, 7
    s_add_u32 s3, s3, s4
    v_mov_b32 v5, s3
    s_mov_b32 s65, 0
KF_PL_20:
    s_cmp_eq_u32 s62, 1
    s_cbranch_scc0 KF_PS_23
    global_load_dword v7, v5, s[58:59] sc1
    s_branch KF_PC_24
KF_PS_23:
    global_load_dword v7, v5, s[58:59] sc0 sc1
KF_PC_24:
    s_waitcnt vmcnt(0)
    v_readfirstlane_b32 s3, v7
    s_add_u32 s65, s65, 1
    s_cmp_eq_u32 s3, s66
    s_cbranch_scc1 KF_PX_21
    s_sleep 1
    s_cmp_lt_u32 s65, 0x8000
    s_cbranch_scc1 KF_PL_20
KF_PX_21:
    s_cmp_eq_u32 s62, 1
    s_cbranch_scc1 KF_PD_22
    buffer_inv sc1
    s_waitcnt vmcnt(0)
KF_PD_22:
    s_branch KF_WN_19
KF_WN_19a:
    s_cmp_eq_u32 s45, 1
    s_cbranch_scc0 KF_WN_19
    s_cmp_lg_u32 s32, 3
    s_cbranch_scc1 KF_PD_27
    s_and_b32 s3, s57, 3
    s_add_u32 s3, s3, 3
    s_and_b32 s3, s3, 3
    s_lshl_b32 s3, s3, 2
    s_lshl_b32 s4, s47, 7
    s_add_u32 s3, s3, s4
    v_mov_b32 v5, s3
    s_mov_b32 s65, 0
KF_PL_25:
    s_cmp_eq_u32 s62, 1
    s_cbranch_scc0 KF_PS_28
    global_load_dword v7, v5, s[58:59] sc1
    s_branch KF_PC_29
KF_PS_28:
    global_load_dword v7, v5, s[58:59] sc0 sc1
KF_PC_29:
    s_waitcnt vmcnt(0)
    v_readfirstlane_b32 s3, v7
    s_add_u32 s65, s65, 1
    s_cmp_eq_u32 s3, s66
    s_cbranch_scc1 KF_PX_26
    s_sleep 1
    s_cmp_lt_u32 s65, 0x8000
    s_cbranch_scc1 KF_PL_25
KF_PX_26:
    s_cmp_eq_u32 s62, 1
    s_cbranch_scc1 KF_PD_27
    buffer_inv sc1
    s_waitcnt vmcnt(0)
KF_PD_27:
KF_WN_19:
    s_waitcnt vmcnt(20) lgkmcnt(0)
    v_add_u32 v190, -61440, v190
    v_add_u32 v191, -61440, v191
    v_add_u32 v192, -61440, v192
    v_add_u32 v193, -61440, v193
    s_barrier
    ds_read_b128 v[116:119], v190 offset:0
    s_lshr_b32 s3, s60, 1
    v_mfma_f32_16x16x32_bf16 v[16:19], v[216:219], v[136:139], v[16:19]
    ds_read_b128 v[120:123], v190 offset:2048
    s_add_u32 s3, s3, s42
    v_mfma_f32_16x16x32_bf16 v[20:23], v[216:219], v[140:143], v[20:23]
    ds_read_b128 v[124:127], v190 offset:4096
    s_and_b32 s3, s3, 7
    v_mfma_f32_16x16x32_bf16 v[24:27], v[216:219], v[144:147], v[24:27]
    v_mfma_f32_16x16x32_bf16 v[28:31], v[216:219], v[148:151], v[28:31]
    ds_read_b128 v[128:131], v190 offset:6144
    s_and_b32 s4, s60, 1
    v_mfma_f32_16x16x32_bf16 v[32:35], v[216:219], v[152:155], v[32:35]
    ds_read_b128 v[132:135], v190 offset:8192
    s_lshl_b32 s3, s3, 1
    v_mfma_f32_16x16x32_bf16 v[36:39], v[220:223], v[136:139], v[36:39]
    ds_read_b64_tr_b16 v[196:197], v192 offset:0
    s_add_u32 s3, s3, s4
    v_mfma_f32_16x16x32_bf16 v[40:43], v[220:223], v[140:143], v[40:43]
    ds_read_b64_tr_b16 v[198:199], v192 offset:5120
    s_mul_i32 s44, s3, 73728
    v_mfma_f32_16x16x32_bf16 v[44:47], v[220:223], v[144:147], v[44:47]
    ds_read_b64_tr_b16 v[200:201], v193 offset:32
    s_cmp_lt_u32 s60, 16
    v_mfma_f32_16x16x32_bf16 v[48:51], v[220:223], v[148:151], v[48:51]
    ds_read_b64_tr_b16 v[202:203], v193 offset:5152
    v_mfma_f32_16x16x32_bf16 v[52:55], v[220:223], v[152:155], v[52:55]
    s_cselect_b32 s10, s39, 0
    v_mfma_f32_16x16x32_bf16 v[56:59], v[224:227], v[136:139], v[56:59]
    ds_read_b64_tr_b16 v[204:205], v192 offset:64
    s_add_u32 s60, s60, 1
    v_mfma_f32_16x16x32_bf16 v[60:63], v[224:227], v[140:143], v[60:63]
    ds_read_b64_tr_b16 v[206:207], v192 offset:5184
    s_add_u32 m0, s36, 61440
    v_mfma_f32_16x16x32_bf16 v[64:67], v[224:227], v[144:147], v[64:67]
    ds_read_b64_tr_b16 v[208:209], v193 offset:96
    s_nop 0
    v_mfma_f32_16x16x32_bf16 v[68:71], v[224:227], v[148:151], v[68:71]
    ds_read_b64_tr_b16 v[210:211], v193 offset:5216
    buffer_load_dwordx4 v240, s[8:11], s44 offen offset:0 lds
    v_mfma_f32_16x16x32_bf16 v[72:75], v[224:227], v[152:155], v[72:75]
    ds_read_b64_tr_b16 v[212:213], v192 offset:128
    buffer_load_dwordx4 v241, s[8:11], s44 offen offset:1024 lds
    v_mfma_f32_16x16x32_bf16 v[76:79], v[228:231], v[136:139], v[76:79]
    ds_read_b64_tr_b16 v[214:215], v192 offset:5248
    v_mfma_f32_16x16x32_bf16 v[80:83], v[228:231], v[140:143], v[80:83]
    buffer_load_dwordx4 v242, s[8:11], s44 offen offset:2048 lds
    v_mfma_f32_16x16x32_bf16 v[84:87], v[228:231], v[144:147], v[84:87]
    buffer_load_dwordx4 v243, s[8:11], s44 offen offset:3072 lds
    v_mfma_f32_16x16x32_bf16 v[88:91], v[228:231], v[148:151], v[88:91]
    s_add_u32 m0, s36, 65536
    v_mfma_f32_16x16x32_bf16 v[92:95], v[228:231], v[152:155], v[92:95]
    s_nop 0
    v_mfma_f32_16x16x32_bf16 v[96:99], v[232:235], v[136:139], v[96:99]
    buffer_load_dwordx4 v253, s[8:11], s44 offen offset:0 lds
    v_mfma_f32_16x16x32_bf16 v[100:103], v[232:235], v[140:143], v[100:103]
    v_mfma_f32_16x16x32_bf16 v[104:107], v[232:235], v[144:147], v[104:107]
    v_mfma_f32_16x16x32_bf16 v[108:111], v[232:235], v[148:151], v[108:111]
    v_mfma_f32_16x16x32_bf16 v[112:115], v[232:235], v[152:155], v[112:115]
    s_waitcnt lgkmcnt(0)
    s_lshr_b32 s3, s41, 1
    ds_read_b128 v[136:139], v191 offset:0
    v_mfma_f32_16x16x32_bf16 v[16:19], v[196:199], v[116:119], v[16:19]
    s_add_u32 s3, s3, s42
    ds_read_b128 v[140:143], v191 offset:2048
    v_mfma_f32_16x16x32_bf16 v[20:23], v[196:199], v[120:123], v[20:23]
    s_and_b32 s3, s3, 7
    ds_read_b128 v[144:147], v191 offset:4096
    v_mfma_f32_16x16x32_bf16 v[24:27], v[196:199], v[124:127], v[24:27]
    s_and_b32 s4, s41, 1
    v_mfma_f32_16x16x32_bf16 v[28:31], v[196:199], v[128:131], v[28:31]
    s_mul_i32 s43, s3, 40960
    ds_read_b128 v[148:151], v191 offset:6144
    s_lshl_b32 s4, s4, 11
    v_mfma_f32_16x16x32_bf16 v[32:35], v[196:199], v[132:135], v[32:35]
    ds_read_b128 v[152:155], v191 offset:8192
    s_add_u32 s43, s43, s4
    v_mfma_f32_16x16x32_bf16 v[36:39], v[200:203], v[116:119], v[36:39]
    ds_read_b64_tr_b16 v[216:217], v192 offset:10240
    s_cmp_lt_u32 s41, 16
    v_mfma_f32_16x16x32_bf16 v[40:43], v[200:203], v[120:123], v[40:43]
    ds_read_b64_tr_b16 v[218:219], v192 offset:15360
    s_cselect_b32 s14, 327680, 0
    v_mfma_f32_16x16x32_bf16 v[44:47], v[200:203], v[124:127], v[44:47]
    s_add_u32 s41, s41, 1
    ds_read_b64_tr_b16 v[220:221], v193 offset:10272
    v_mfma_f32_16x16x32_bf16 v[48:51], v[200:203], v[128:131], v[48:51]
    s_add_u32 m0, s37, 61440
    ds_read_b64_tr_b16 v[222:223], v193 offset:15392
    v_mfma_f32_16x16x32_bf16 v[52:55], v[200:203], v[132:135], v[52:55]
    s_nop 0
    v_mfma_f32_16x16x32_bf16 v[56:59], v[204:207], v[116:119], v[56:59]
    ds_read_b64_tr_b16 v[224:225], v192 offset:10304
    buffer_load_dwordx4 v181, s[12:15], s43 offen lds
    v_mfma_f32_16x16x32_bf16 v[60:63], v[204:207], v[120:123], v[60:63]
    s_add_u32 m0, s37, 62464
    ds_read_b64_tr_b16 v[226:227], v192 offset:15424
    v_mfma_f32_16x16x32_bf16 v[64:67], v[204:207], v[124:127], v[64:67]
    s_nop 0
    ds_read_b64_tr_b16 v[228:229], v193 offset:10336
    buffer_load_dwordx4 v182, s[12:15], s43 offen lds
    v_mfma_f32_16x16x32_bf16 v[68:71], v[204:207], v[128:131], v[68:71]
    ds_read_b64_tr_b16 v[230:231], v193 offset:15456
    s_add_u32 m0, s37, 63488
    v_mfma_f32_16x16x32_bf16 v[72:75], v[204:207], v[132:135], v[72:75]
    ds_read_b64_tr_b16 v[232:233], v192 offset:10368
    s_nop 0
    v_mfma_f32_16x16x32_bf16 v[76:79], v[208:211], v[116:119], v[76:79]
    buffer_load_dwordx4 v183, s[12:15], s43 offen lds
    ds_read_b64_tr_b16 v[234:235], v192 offset:15488
    v_mfma_f32_16x16x32_bf16 v[80:83], v[208:211], v[120:123], v[80:83]
    s_add_u32 m0, s37, 64512
    v_mfma_f32_16x16x32_bf16 v[84:87], v[208:211], v[124:127], v[84:87]
    s_nop 0
    v_mfma_f32_16x16x32_bf16 v[88:91], v[208:211], v[128:131], v[88:91]
    buffer_load_dwordx4 v184, s[12:15], s43 offen lds
    v_mfma_f32_16x16x32_bf16 v[92:95], v[208:211], v[132:135], v[92:95]
    s_add_u32 m0, s37, 65536
    v_mfma_f32_16x16x32_bf16 v[96:99], v[212:215], v[116:119], v[96:99]
    s_nop 0
    v_mfma_f32_16x16x32_bf16 v[100:103], v[212:215], v[120:123], v[100:103]
    buffer_load_dwordx4 v185, s[12:15], s43 offen lds
    v_mfma_f32_16x16x32_bf16 v[104:107], v[212:215], v[124:127], v[104:107]
    v_mfma_f32_16x16x32_bf16 v[108:111], v[212:215], v[128:131], v[108:111]
    v_mfma_f32_16x16x32_bf16 v[112:115], v[212:215], v[132:135], v[112:115]
    s_waitcnt vmcnt(20) lgkmcnt(0)
    v_add_u32 v190, 20480, v190
    v_add_u32 v191, 20480, v191
    v_add_u32 v192, 20480, v192
    v_add_u32 v193, 20480, v193
    s_barrier
    ds_read_b128 v[116:119], v190 offset:0
    s_lshr_b32 s3, s60, 1
    v_mfma_f32_16x16x32_bf16 v[16:19], v[216:219], v[136:139], v[16:19]
    ds_read_b128 v[120:123], v190 offset:2048
    s_add_u32 s3, s3, s42
    v_mfma_f32_16x16x32_bf16 v[20:23], v[216:219], v[140:143], v[20:23]
    ds_read_b128 v[124:127], v190 offset:4096
    s_and_b32 s3, s3, 7
    v_mfma_f32_16x16x32_bf16 v[24:27], v[216:219], v[144:147], v[24:27]
    v_mfma_f32_16x16x32_bf16 v[28:31], v[216:219], v[148:151], v[28:31]
    ds_read_b128 v[128:131], v190 offset:6144
    s_and_b32 s4, s60, 1
    v_mfma_f32_16x16x32_bf16 v[32:35], v[216:219], v[152:155], v[32:35]
    ds_read_b128 v[132:135], v190 offset:8192
    s_lshl_b32 s3, s3, 1
    v_mfma_f32_16x16x32_bf16 v[36:39], v[220:223], v[136:139], v[36:39]
    ds_read_b64_tr_b16 v[196:197], v192 offset:0
    s_add_u32 s3, s3, s4
    v_mfma_f32_16x16x32_bf16 v[40:43], v[220:223], v[140:143], v[40:43]
    ds_read_b64_tr_b16 v[198:199], v192 offset:5120
    s_mul_i32 s44, s3, 73728
    v_mfma_f32_16x16x32_bf16 v[44:47], v[220:223], v[144:147], v[44:47]
    ds_read_b64_tr_b16 v[200:201], v193 offset:32
    s_cmp_lt_u32 s60, 16
    v_mfma_f32_16x16x32_bf16 v[48:51], v[220:223], v[148:151], v[48:51]
    ds_read_b64_tr_b16 v[202:203], v193 offset:5152
    v_mfma_f32_16x16x32_bf16 v[52:55], v[220:223], v[152:155], v[52:55]
    s_cselect_b32 s10, s39, 0
    v_mfma_f32_16x16x32_bf16 v[56:59], v[224:227], v[136:139], v[56:59]
    ds_read_b64_tr_b16 v[204:205], v192 offset:64
    s_add_u32 s60, s60, 1
    v_mfma_f32_16x16x32_bf16 v[60:63], v[224:227], v[140:143], v[60:63]
    ds_read_b64_tr_b16 v[206:207], v192 offset:5184
    s_add_u32 m0, s36, 0
    v_mfma_f32_16x16x32_bf16 v[64:67], v[224:227], v[144:147], v[64:67]
    ds_read_b64_tr_b16 v[208:209], v193 offset:96
    s_nop 0
    v_mfma_f32_16x16x32_bf16 v[68:71], v[224:227], v[148:151], v[68:71]
    ds_read_b64_tr_b16 v[210:211], v193 offset:5216
    buffer_load_dwordx4 v240, s[8:11], s44 offen offset:0 lds
    v_mfma_f32_16x16x32_bf16 v[72:75], v[224:227], v[152:155], v[72:75]
    ds_read_b64_tr_b16 v[212:213], v192 offset:128
    buffer_load_dwordx4 v241, s[8:11], s44 offen offset:1024 lds
    v_mfma_f32_16x16x32_bf16 v[76:79], v[228:231], v[136:139], v[76:79]
    ds_read_b64_tr_b16 v[214:215], v192 offset:5248
    v_mfma_f32_16x16x32_bf16 v[80:83], v[228:231], v[140:143], v[80:83]
    buffer_load_dwordx4 v242, s[8:11], s44 offen offset:2048 lds
    v_mfma_f32_16x16x32_bf16 v[84:87], v[228:231], v[144:147], v[84:87]
    buffer_load_dwordx4 v243, s[8:11], s44 offen offset:3072 lds
    v_mfma_f32_16x16x32_bf16 v[88:91], v[228:231], v[148:151], v[88:91]
    s_add_u32 m0, s36, 4096
    v_mfma_f32_16x16x32_bf16 v[92:95], v[228:231], v[152:155], v[92:95]
    s_nop 0
    v_mfma_f32_16x16x32_bf16 v[96:99], v[232:235], v[136:139], v[96:99]
    buffer_load_dwordx4 v253, s[8:11], s44 offen offset:0 lds
    v_mfma_f32_16x16x32_bf16 v[100:103], v[232:235], v[140:143], v[100:103]
    v_mfma_f32_16x16x32_bf16 v[104:107], v[232:235], v[144:147], v[104:107]
    v_mfma_f32_16x16x32_bf16 v[108:111], v[232:235], v[148:151], v[108:111]
    v_mfma_f32_16x16x32_bf16 v[112:115], v[232:235], v[152:155], v[112:115]
    s_waitcnt lgkmcnt(0)
    s_lshr_b32 s3, s41, 1
    ds_read_b128 v[136:139], v191 offset:0
    v_mfma_f32_16x16x32_bf16 v[16:19], v[196:199], v[116:119], v[16:19]
    s_add_u32 s3, s3, s42
    ds_read_b128 v[140:143], v191 offset:2048
    v_mfma_f32_16x16x32_bf16 v[20:23], v[196:199], v[120:123], v[20:23]
    s_and_b32 s3, s3, 7
    ds_read_b128 v[144:147], v191 offset:4096
    v_mfma_f32_16x16x32_bf16 v[24:27], v[196:199], v[124:127], v[24:27]
    s_and_b32 s4, s41, 1
    v_mfma_f32_16x16x32_bf16 v[28:31], v[196:199], v[128:131], v[28:31]
    s_mul_i32 s43, s3, 40960
    ds_read_b128 v[148:151], v191 offset:6144
    s_lshl_b32 s4, s4, 11
    v_mfma_f32_16x16x32_bf16 v[32:35], v[196:199], v[132:135], v[32:35]
    ds_read_b128 v[152:155], v191 offset:8192
    s_add_u32 s43, s43, s4
    v_mfma_f32_16x16x32_bf16 v[36:39], v[200:203], v[116:119], v[36:39]
    ds_read_b64_tr_b16 v[216:217], v192 offset:10240
    s_cmp_lt_u32 s41, 16
    v_mfma_f32_16x16x32_bf16 v[40:43], v[200:203], v[120:123], v[40:43]
    ds_read_b64_tr_b16 v[218:219], v192 offset:15360
    s_cselect_b32 s14, 327680, 0
    v_mfma_f32_16x16x32_bf16 v[44:47], v[200:203], v[124:127], v[44:47]
    s_add_u32 s41, s41, 1
    ds_read_b64_tr_b16 v[220:221], v193 offset:10272
    v_mfma_f32_16x16x32_bf16 v[48:51], v[200:203], v[128:131], v[48:51]
    s_add_u32 m0, s37, 0
    ds_read_b64_tr_b16 v[222:223], v193 offset:15392
    v_mfma_f32_16x16x32_bf16 v[52:55], v[200:203], v[132:135], v[52:55]
    s_nop 0
    v_mfma_f32_16x16x32_bf16 v[56:59], v[204:207], v[116:119], v[56:59]
    ds_read_b64_tr_b16 v[224:225], v192 offset:10304
    buffer_load_dwordx4 v181, s[12:15], s43 offen lds
    v_mfma_f32_16x16x32_bf16 v[60:63], v[204:207], v[120:123], v[60:63]
    s_add_u32 m0, s37, 1024
    ds_read_b64_tr_b16 v[226:227], v192 offset:15424
    v_mfma_f32_16x16x32_bf16 v[64:67], v[204:207], v[124:127], v[64:67]
    s_nop 0
    ds_read_b64_tr_b16 v[228:229], v193 offset:10336
    buffer_load_dwordx4 v182, s[12:15], s43 offen lds
    v_mfma_f32_16x16x32_bf16 v[68:71], v[204:207], v[128:131], v[68:71]
    ds_read_b64_tr_b16 v[230:231], v193 offset:15456
    s_add_u32 m0, s37, 2048
    v_mfma_f32_16x16x32_bf16 v[72:75], v[204:207], v[132:135], v[72:75]
    ds_read_b64_tr_b16 v[232:233], v192 offset:10368
    s_nop 0
    v_mfma_f32_16x16x32_bf16 v[76:79], v[208:211], v[116:119], v[76:79]
    buffer_load_dwordx4 v183, s[12:15], s43 offen lds
    ds_read_b64_tr_b16 v[234:235], v192 offset:15488
    v_mfma_f32_16x16x32_bf16 v[80:83], v[208:211], v[120:123], v[80:83]
    s_add_u32 m0, s37, 3072
    v_mfma_f32_16x16x32_bf16 v[84:87], v[208:211], v[124:127], v[84:87]
    s_nop 0
    v_mfma_f32_16x16x32_bf16 v[88:91], v[208:211], v[128:131], v[88:91]
    buffer_load_dwordx4 v184, s[12:15], s43 offen lds
    v_mfma_f32_16x16x32_bf16 v[92:95], v[208:211], v[132:135], v[92:95]
    s_add_u32 m0, s37, 4096
    v_mfma_f32_16x16x32_bf16 v[96:99], v[212:215], v[116:119], v[96:99]
    s_nop 0
    v_mfma_f32_16x16x32_bf16 v[100:103], v[212:215], v[120:123], v[100:103]
    buffer_load_dwordx4 v185, s[12:15], s43 offen lds
    v_mfma_f32_16x16x32_bf16 v[104:107], v[212:215], v[124:127], v[104:107]
    v_mfma_f32_16x16x32_bf16 v[108:111], v[212:215], v[128:131], v[108:111]
    v_mfma_f32_16x16x32_bf16 v[112:115], v[212:215], v[132:135], v[112:115]
    s_waitcnt vmcnt(20) lgkmcnt(0)
    v_add_u32 v190, 20480, v190
    v_add_u32 v191, 20480, v191
    v_add_u32 v192, 20480, v192
    v_add_u32 v193, 20480, v193
    s_barrier
    ds_read_b128 v[116:119], v190 offset:0
    s_lshr_b32 s3, s60, 1
    v_mfma_f32_16x16x32_bf16 v[16:19], v[216:219], v[136:139], v[16:19]
    ds_read_b128 v[120:123], v190 offset:2048
    s_add_u32 s3, s3, s42
    v_mfma_f32_16x16x32_bf16 v[20:23], v[216:219], v[140:143], v[20:23]
    ds_read_b128 v[124:127], v190 offset:4096
    s_and_b32 s3, s3, 7
    v_mfma_f32_16x16x32_bf16 v[24:27], v[216:219], v[144:147], v[24:27]
    v_mfma_f32_16x16x32_bf16 v[28:31], v[216:219], v[148:151], v[28:31]
    ds_read_b128 v[128:131], v190 offset:6144
    s_and_b32 s4, s60, 1
    v_mfma_f32_16x16x32_bf16 v[32:35], v[216:219], v[152:155], v[32:35]
    ds_read_b128 v[132:135], v190 offset:8192
    s_lshl_b32 s3, s3, 1
    v_mfma_f32_16x16x32_bf16 v[36:39], v[220:223], v[136:139], v[36:39]
    ds_read_b64_tr_b16 v[196:197], v192 offset:0
    s_add_u32 s3, s3, s4
    v_mfma_f32_16x16x32_bf16 v[40:43], v[220:223], v[140:143], v[40:43]
    ds_read_b64_tr_b16 v[198:199], v192 offset:5120
    s_mul_i32 s44, s3, 73728
    v_mfma_f32_16x16x32_bf16 v[44:47], v[220:223], v[144:147], v[44:47]
    ds_read_b64_tr_b16 v[200:201], v193 offset:32
    s_cmp_lt_u32 s60, 16
    v_mfma_f32_16x16x32_bf16 v[48:51], v[220:223], v[148:151], v[48:51]
    ds_read_b64_tr_b16 v[202:203], v193 offset:5152
    v_mfma_f32_16x16x32_bf16 v[52:55], v[220:223], v[152:155], v[52:55]
    s_cselect_b32 s10, s39, 0
    v_mfma_f32_16x16x32_bf16 v[56:59], v[224:227], v[136:139], v[56:59]
    ds_read_b64_tr_b16 v[204:205], v192 offset:64
    s_add_u32 s60, s60, 1
    v_mfma_f32_16x16x32_bf16 v[60:63], v[224:227], v[140:143], v[60:63]
    ds_read_b64_tr_b16 v[206:207], v192 offset:5184
    s_add_u32 m0, s36, 20480
    v_mfma_f32_16x16x32_bf16 v[64:67], v[224:227], v[144:147], v[64:67]
    ds_read_b64_tr_b16 v[208:209], v193 offset:96
    s_nop 0
    v_mfma_f32_16x16x32_bf16 v[68:71], v[224:227], v[148:151], v[68:71]
    ds_read_b64_tr_b16 v[210:211], v193 offset:5216
    buffer_load_dwordx4 v240, s[8:11], s44 offen offset:0 lds
    v_mfma_f32_16x16x32_bf16 v[72:75], v[224:227], v[152:155], v[72:75]
    ds_read_b64_tr_b16 v[212:213], v192 offset:128
    buffer_load_dwordx4 v241, s[8:11], s44 offen offset:1024 lds
    v_mfma_f32_16x16x32_bf16 v[76:79], v[228:231], v[136:139], v[76:79]
    ds_read_b64_tr_b16 v[214:215], v192 offset:5248
    v_mfma_f32_16x16x32_bf16 v[80:83], v[228:231], v[140:143], v[80:83]
    buffer_load_dwordx4 v242, s[8:11], s44 offen offset:2048 lds
    v_mfma_f32_16x16x32_bf16 v[84:87], v[228:231], v[144:147], v[84:87]
    buffer_load_dwordx4 v243, s[8:11], s44 offen offset:3072 lds
    v_mfma_f32_16x16x32_bf16 v[88:91], v[228:231], v[148:151], v[88:91]
    s_add_u32 m0, s36, 24576
    v_mfma_f32_16x16x32_bf16 v[92:95], v[228:231], v[152:155], v[92:95]
    s_nop 0
    v_mfma_f32_16x16x32_bf16 v[96:99], v[232:235], v[136:139], v[96:99]
    buffer_load_dwordx4 v253, s[8:11], s44 offen offset:0 lds
    v_mfma_f32_16x16x32_bf16 v[100:103], v[232:235], v[140:143], v[100:103]
    v_mfma_f32_16x16x32_bf16 v[104:107], v[232:235], v[144:147], v[104:107]
    v_mfma_f32_16x16x32_bf16 v[108:111], v[232:235], v[148:151], v[108:111]
    v_mfma_f32_16x16x32_bf16 v[112:115], v[232:235], v[152:155], v[112:115]
    s_waitcnt lgkmcnt(0)
    s_lshr_b32 s3, s41, 1
    ds_read_b128 v[136:139], v191 offset:0
    v_mfma_f32_16x16x32_bf16 v[16:19], v[196:199], v[116:119], v[16:19]
    s_add_u32 s3, s3, s42
    ds_read_b128 v[140:143], v191 offset:2048
    v_mfma_f32_16x16x32_bf16 v[20:23], v[196:199], v[120:123], v[20:23]
    s_and_b32 s3, s3, 7
    ds_read_b128 v[144:147], v191 offset:4096
    v_mfma_f32_16x16x32_bf16 v[24:27], v[196:199], v[124:127], v[24:27]
    s_and_b32 s4, s41, 1
    v_mfma_f32_16x16x32_bf16 v[28:31], v[196:199], v[128:131], v[28:31]
    s_mul_i32 s43, s3, 40960
    ds_read_b128 v[148:151], v191 offset:6144
    s_lshl_b32 s4, s4, 11
    v_mfma_f32_16x16x32_bf16 v[32:35], v[196:199], v[132:135], v[32:35]
    ds_read_b128 v[152:155], v191 offset:8192
    s_add_u32 s43, s43, s4
    v_mfma_f32_16x16x32_bf16 v[36:39], v[200:203], v[116:119], v[36:39]
    ds_read_b64_tr_b16 v[216:217], v192 offset:10240
    s_cmp_lt_u32 s41, 16
    v_mfma_f32_16x16x32_bf16 v[40:43], v[200:203], v[120:123], v[40:43]
    ds_read_b64_tr_b16 v[218:219], v192 offset:15360
    s_cselect_b32 s14, 327680, 0
    v_mfma_f32_16x16x32_bf16 v[44:47], v[200:203], v[124:127], v[44:47]
    s_add_u32 s41, s41, 1
    ds_read_b64_tr_b16 v[220:221], v193 offset:10272
    v_mfma_f32_16x16x32_bf16 v[48:51], v[200:203], v[128:131], v[48:51]
    s_add_u32 m0, s37, 20480
    ds_read_b64_tr_b16 v[222:223], v193 offset:15392
    v_mfma_f32_16x16x32_bf16 v[52:55], v[200:203], v[132:135], v[52:55]
    s_nop 0
    v_mfma_f32_16x16x32_bf16 v[56:59], v[204:207], v[116:119], v[56:59]
    ds_read_b64_tr_b16 v[224:225], v192 offset:10304
    buffer_load_dwordx4 v181, s[12:15], s43 offen lds
    v_mfma_f32_16x16x32_bf16 v[60:63], v[204:207], v[120:123], v[60:63]
    s_add_u32 m0, s37, 21504
    ds_read_b64_tr_b16 v[226:227], v192 offset:15424
    v_mfma_f32_16x16x32_bf16 v[64:67], v[204:207], v[124:127], v[64:67]
    s_nop 0
    ds_read_b64_tr_b16 v[228:229], v193 offset:10336
    buffer_load_dwordx4 v182, s[12:15], s43 offen lds
    v_mfma_f32_16x16x32_bf16 v[68:71], v[204:207], v[128:131], v[68:71]
    ds_read_b64_tr_b16 v[230:231], v193 offset:15456
    s_add_u32 m0, s37, 22528
    v_mfma_f32_16x16x32_bf16 v[72:75], v[204:207], v[132:135], v[72:75]
    ds_read_b64_tr_b16 v[232:233], v192 offset:10368
    s_nop 0
    v_mfma_f32_16x16x32_bf16 v[76:79], v[208:211], v[116:119], v[76:79]
    buffer_load_dwordx4 v183, s[12:15], s43 offen lds
    ds_read_b64_tr_b16 v[234:235], v192 offset:15488
    v_mfma_f32_16x16x32_bf16 v[80:83], v[208:211], v[120:123], v[80:83]
    s_add_u32 m0, s37, 23552
    v_mfma_f32_16x16x32_bf16 v[84:87], v[208:211], v[124:127], v[84:87]
    s_nop 0
    v_mfma_f32_16x16x32_bf16 v[88:91], v[208:211], v[128:131], v[88:91]
    buffer_load_dwordx4 v184, s[12:15], s43 offen lds
    v_mfma_f32_16x16x32_bf16 v[92:95], v[208:211], v[132:135], v[92:95]
    s_add_u32 m0, s37, 24576
    v_mfma_f32_16x16x32_bf16 v[96:99], v[212:215], v[116:119], v[96:99]
    s_nop 0
    v_mfma_f32_16x16x32_bf16 v[100:103], v[212:215], v[120:123], v[100:103]
    buffer_load_dwordx4 v185, s[12:15], s43 offen lds
    v_mfma_f32_16x16x32_bf16 v[104:107], v[212:215], v[124:127], v[104:107]
    v_mfma_f32_16x16x32_bf16 v[108:111], v[212:215], v[128:131], v[108:111]
    v_mfma_f32_16x16x32_bf16 v[112:115], v[212:215], v[132:135], v[112:115]
    s_waitcnt vmcnt(20) lgkmcnt(0)
    v_add_u32 v190, 20480, v190
    v_add_u32 v191, 20480, v191
    v_add_u32 v192, 20480, v192
    v_add_u32 v193, 20480, v193
    s_barrier
    ds_read_b128 v[116:119], v190 offset:0
    s_lshr_b32 s3, s60, 1
    v_mfma_f32_16x16x32_bf16 v[16:19], v[216:219], v[136:139], v[16:19]
    ds_read_b128 v[120:123], v190 offset:2048
    s_add_u32 s3, s3, s42
    v_mfma_f32_16x16x32_bf16 v[20:23], v[216:219], v[140:143], v[20:23]
    ds_read_b128 v[124:127], v190 offset:4096
    s_and_b32 s3, s3, 7
    v_mfma_f32_16x16x32_bf16 v[24:27], v[216:219], v[144:147], v[24:27]
    v_mfma_f32_16x16x32_bf16 v[28:31], v[216:219], v[148:151], v[28:31]
    ds_read_b128 v[128:131], v190 offset:6144
    s_and_b32 s4, s60, 1
    v_mfma_f32_16x16x32_bf16 v[32:35], v[216:219], v[152:155], v[32:35]
    ds_read_b128 v[132:135], v190 offset:8192
    s_lshl_b32 s3, s3, 1
    v_mfma_f32_16x16x32_bf16 v[36:39], v[220:223], v[136:139], v[36:39]
    ds_read_b64_tr_b16 v[196:197], v192 offset:0
    s_add_u32 s3, s3, s4
    v_mfma_f32_16x16x32_bf16 v[40:43], v[220:223], v[140:143], v[40:43]
    ds_read_b64_tr_b16 v[198:199], v192 offset:5120
    s_mul_i32 s44, s3, 73728
    v_mfma_f32_16x16x32_bf16 v[44:47], v[220:223], v[144:147], v[44:47]
    ds_read_b64_tr_b16 v[200:201], v193 offset:32
    s_cmp_lt_u32 s60, 16
    v_mfma_f32_16x16x32_bf16 v[48:51], v[220:223], v[148:151], v[48:51]
    ds_read_b64_tr_b16 v[202:203], v193 offset:5152
    v_mfma_f32_16x16x32_bf16 v[52:55], v[220:223], v[152:155], v[52:55]
    s_cselect_b32 s10, s39, 0
    v_mfma_f32_16x16x32_bf16 v[56:59], v[224:227], v[136:139], v[56:59]
    ds_read_b64_tr_b16 v[204:205], v192 offset:64
    s_add_u32 s60, s60, 1
    v_mfma_f32_16x16x32_bf16 v[60:63], v[224:227], v[140:143], v[60:63]
    ds_read_b64_tr_b16 v[206:207], v192 offset:5184
    s_add_u32 m0, s36, 40960
    v_mfma_f32_16x16x32_bf16 v[64:67], v[224:227], v[144:147], v[64:67]
    ds_read_b64_tr_b16 v[208:209], v193 offset:96
    s_nop 0
    v_mfma_f32_16x16x32_bf16 v[68:71], v[224:227], v[148:151], v[68:71]
    ds_read_b64_tr_b16 v[210:211], v193 offset:5216
    buffer_load_dwordx4 v240, s[8:11], s44 offen offset:0 lds
    v_mfma_f32_16x16x32_bf16 v[72:75], v[224:227], v[152:155], v[72:75]
    ds_read_b64_tr_b16 v[212:213], v192 offset:128
    buffer_load_dwordx4 v241, s[8:11], s44 offen offset:1024 lds
    v_mfma_f32_16x16x32_bf16 v[76:79], v[228:231], v[136:139], v[76:79]
    ds_read_b64_tr_b16 v[214:215], v192 offset:5248
    v_mfma_f32_16x16x32_bf16 v[80:83], v[228:231], v[140:143], v[80:83]
    buffer_load_dwordx4 v242, s[8:11], s44 offen offset:2048 lds
    v_mfma_f32_16x16x32_bf16 v[84:87], v[228:231], v[144:147], v[84:87]
    buffer_load_dwordx4 v243, s[8:11], s44 offen offset:3072 lds
    v_mfma_f32_16x16x32_bf16 v[88:91], v[228:231], v[148:151], v[88:91]
    s_add_u32 m0, s36, 45056
    v_mfma_f32_16x16x32_bf16 v[92:95], v[228:231], v[152:155], v[92:95]
    s_nop 0
    v_mfma_f32_16x16x32_bf16 v[96:99], v[232:235], v[136:139], v[96:99]
    buffer_load_dwordx4 v253, s[8:11], s44 offen offset:0 lds
    v_mfma_f32_16x16x32_bf16 v[100:103], v[232:235], v[140:143], v[100:103]
    v_mfma_f32_16x16x32_bf16 v[104:107], v[232:235], v[144:147], v[104:107]
    v_mfma_f32_16x16x32_bf16 v[108:111], v[232:235], v[148:151], v[108:111]
    v_mfma_f32_16x16x32_bf16 v[112:115], v[232:235], v[152:155], v[112:115]
    s_add_u32 s45, s45, 1
    s_cmp_lt_u32 s45, 3
    s_cbranch_scc1 KF_L0
    s_nop 7
    v_lshlrev_b32 v4, 3, v1
    s_lshl_b32 s3, s68, 2
    s_add_u32 s3, s3, s32
    s_mul_i32 s38, s3, 12800
    s_cmp_eq_u32 s68, 0
    s_cbranch_scc1 KF_SA_30
    s_add_u32 s4, s38, 0
    v_cvt_pk_bf16_f32 v16, v16, v17
    v_cvt_pk_bf16_f32 v17, v18, v19
    buffer_store_dwordx2 v[16:17], v4, s[16:19], s4 offen sc0 sc1
    s_add_u32 s4, s38, 2048
    v_cvt_pk_bf16_f32 v32, v32, v33
    v_cvt_pk_bf16_f32 v33, v34, v35
    buffer_store_dwordx2 v[32:33], v4, s[16:19], s4 offen sc0 sc1
    s_add_u32 s4, s38, 4096
    v_cvt_pk_bf16_f32 v48, v48, v49
    v_cvt_pk_bf16_f32 v49, v50, v51
    buffer_store_dwordx2 v[48:49], v4, s[16:19], s4 offen sc0 sc1
    s_add_u32 s4, s38, 6144
    v_cvt_pk_bf16_f32 v64, v64, v65
    v_cvt_pk_bf16_f32 v65, v66, v67
    buffer_store_dwordx2 v[64:65], v4, s[16:19], s4 offen sc0 sc1
    s_add_u32 s4, s38, 8192
    v_cvt_pk_bf16_f32 v80, v80, v81
    v_cvt_pk_bf16_f32 v81, v82, v83
    buffer_store_dwordx2 v[80:81], v4, s[16:19], s4 offen sc0 sc1
    s_add_u32 s4, s38, 10240
    v_cvt_pk_bf16_f32 v96, v96, v97
    v_cvt_pk_bf16_f32 v97, v98, v99
    buffer_store_dwordx2 v[96:97], v4, s[16:19], s4 offen sc0 sc1
    s_add_u32 s4, s38, 12288
    v_cvt_pk_bf16_f32 v112, v112, v113
    v_cvt_pk_bf16_f32 v113, v114, v115
    buffer_store_dwordx2 v[112:113], v4, s[16:19], s4 offen sc0 sc1
KF_SA_30:
    s_cmp_eq_u32 s68, 1
    s_cbranch_scc1 KF_SA_31
    s_add_u32 s4, s38, 512
    v_cvt_pk_bf16_f32 v20, v20, v21
    v_cvt_pk_bf16_f32 v21, v22, v23
    buffer_store_dwordx2 v[20:21], v4, s[16:19], s4 offen sc0 sc1
    s_add_u32 s4, s38, 2560
    v_cvt_pk_bf16_f32 v36, v36, v37
    v_cvt_pk_bf16_f32 v37, v38, v39
    buffer_store_dwordx2 v[36:37], v4, s[16:19], s4 offen sc0 sc1
    s_add_u32 s4, s38, 4608
    v_cvt_pk_bf16_f32 v52, v52, v53
    v_cvt_pk_bf16_f32 v53, v54, v55
    buffer_store_dwordx2 v[52:53], v4, s[16:19], s4 offen sc0 sc1
    s_add_u32 s4, s38, 6656
    v_cvt_pk_bf16_f32 v68, v68, v69
    v_cvt_pk_bf16_f32 v69, v70, v71
    buffer_store_dwordx2 v[68:69], v4, s[16:19], s4 offen sc0 sc1
    s_add_u32 s4, s38, 8704
    v_cvt_pk_bf16_f32 v84, v84, v85
    v_cvt_pk_bf16_f32 v85, v86, v87
    buffer_store_dwordx2 v[84:85], v4, s[16:19], s4 offen sc0 sc1
    s_add_u32 s4, s38, 10752
    v_cvt_pk_bf16_f32 v100, v100, v101
    v_cvt_pk_bf16_f32 v101, v102, v103
    buffer_store_dwordx2 v[100:101], v4, s[16:19], s4 offen sc0 sc1
KF_SA_31:
    s_cmp_eq_u32 s68, 2
    s_cbranch_scc1 KF_SA_32
    s_add_u32 s4, s38, 1024
    v_cvt_pk_bf16_f32 v24, v24, v25
    v_cvt_pk_bf16_f32 v25, v26, v27
    buffer_store_dwordx2 v[24:25], v4, s[16:19], s4 offen sc0 sc1
    s_add_u32 s4, s38, 3072
    v_cvt_pk_bf16_f32 v40, v40, v41
    v_cvt_pk_bf16_f32 v41, v42, v43
    buffer_store_dwordx2 v[40:41], v4, s[16:19], s4 offen sc0 sc1
    s_add_u32 s4, s38, 5120
    v_cvt_pk_bf16_f32 v56, v56, v57
    v_cvt_pk_bf16_f32 v57, v58, v59
    buffer_store_dwordx2 v[56:57], v4, s[16:19], s4 offen sc0 sc1
    s_add_u32 s4, s38, 7168
    v_cvt_pk_bf16_f32 v72, v72, v73
    v_cvt_pk_bf16_f32 v73, v74, v75
    buffer_store_dwordx2 v[72:73], v4, s[16:19], s4 offen sc0 sc1
    s_add_u32 s4, s38, 9216
    v_cvt_pk_bf16_f32 v88, v88, v89
    v_cvt_pk_bf16_f32 v89, v90, v91
    buffer_store_dwordx2 v[88:89], v4, s[16:19], s4 offen sc0 sc1
    s_add_u32 s4, s38, 11264
    v_cvt_pk_bf16_f32 v104, v104, v105
    v_cvt_pk_bf16_f32 v105, v106, v107
    buffer_store_dwordx2 v[104:105], v4, s[16:19], s4 offen sc0 sc1
KF_SA_32:
    s_cmp_eq_u32 s68, 3
    s_cbranch_scc1 KF_SA_33
    s_add_u32 s4, s38, 1536
    v_cvt_pk_bf16_f32 v28, v28, v29
    v_cvt_pk_bf16_f32 v29, v30, v31
    buffer_store_dwordx2 v[28:29], v4, s[16:19], s4 offen sc0 sc1
    s_add_u32 s4, s38, 3584
    v_cvt_pk_bf16_f32 v44, v44, v45
    v_cvt_pk_bf16_f32 v45, v46, v47
    buffer_store_dwordx2 v[44:45], v4, s[16:19], s4 offen sc0 sc1
    s_add_u32 s4, s38, 5632
    v_cvt_pk_bf16_f32 v60, v60, v61
    v_cvt_pk_bf16_f32 v61, v62, v63
    buffer_store_dwordx2 v[60:61], v4, s[16:19], s4 offen sc0 sc1
    s_add_u32 s4, s38, 7680
    v_cvt_pk_bf16_f32 v76, v76, v77
    v_cvt_pk_bf16_f32 v77, v78, v79
    buffer_store_dwordx2 v[76:77], v4, s[16:19], s4 offen sc0 sc1
    s_add_u32 s4, s38, 9728
    v_cvt_pk_bf16_f32 v92, v92, v93
    v_cvt_pk_bf16_f32 v93, v94, v95
    buffer_store_dwordx2 v[92:93], v4, s[16:19], s4 offen sc0 sc1
    s_add_u32 s4, s38, 11776
    v_cvt_pk_bf16_f32 v108, v108, v109
    v_cvt_pk_bf16_f32 v109, v110, v111
    buffer_store_dwordx2 v[108:109], v4, s[16:19], s4 offen sc0 sc1
KF_SA_33:
    s_waitcnt vmcnt(0)
    s_barrier
    s_cmp_lg_u32 s32, 3
    s_cbranch_scc1 KF_SIG_34
    s_lshl_b32 s3, s46, 7
    s_lshl_b32 s4, s68, 2
    s_add_u32 s3, s3, s4
    s_add_u32 s3, s3, 8192
    v_mov_b32 v5, s3
    v_mov_b32 v6, s66
    v_cmp_eq_u32 vcc, 0, v1
    s_and_saveexec_b64 s[70:71], vcc
    global_store_dword v5, v6, s[58:59] sc0 sc1
    s_mov_b64 exec, s[70:71]
KF_SIG_34:
    s_cmp_lg_u32 s32, 3
    s_cbranch_scc1 KF_PD_35
    s_lshl_b32 s3, s46, 7
    s_add_u32 s3, s3, 8192
    v_mov_b32 v5, s3
    s_mov_b32 s65, 0
KF_PL_36:
    global_load_dwordx4 v[176:179], v5, s[58:59] sc0 sc1
    s_waitcnt vmcnt(0)
    s_mov_b32 s3, 0
    v_readfirstlane_b32 s4, v176
    s_nop 0
    s_cmp_eq_u32 s4, s66
    s_cselect_b32 s4, 1, 0
    s_or_b32 s3, s3, s4
    v_readfirstlane_b32 s4, v177
    s_nop 0
    s_cmp_eq_u32 s4, s66
    s_cselect_b32 s4, 2, 0
    s_or_b32 s3, s3, s4
    v_readfirstlane_b32 s4, v178
    s_nop 0
    s_cmp_eq_u32 s4, s66
    s_cselect_b32 s4, 4, 0
    s_or_b32 s3, s3, s4
    v_readfirstlane_b32 s4, v179
    s_nop 0
    s_cmp_eq_u32 s4, s66
    s_cselect_b32 s4, 8, 0
    s_or_b32 s3, s3, s4
    s_add_u32 s65, s65, 1
    s_cmp_eq_u32 s3, 15
    s_cbranch_scc1 KF_PX_37
    s_sleep 1
    s_cmp_lt_u32 s65, 0x8000
    s_cbranch_scc1 KF_PL_36
KF_PX_37:
KF_PD_35:
    s_barrier
    s_cmp_lg_u32 s68, 0
    s_cbranch_scc1 KF_SB_38
    s_mul_i32 s38, s32, 12800
    s_add_u32 s4, s38, 51200
    buffer_load_dwordx2 v[116:117], v4, s[16:19], s4 offen sc0 sc1
    s_add_u32 s4, s38, 102400
    buffer_load_dwordx2 v[118:119], v4, s[16:19], s4 offen sc0 sc1
    s_add_u32 s4, s38, 153600
    buffer_load_dwordx2 v[120:121], v4, s[16:19], s4 offen sc0 sc1
    s_add_u32 s4, s38, 53248
    buffer_load_dwordx2 v[122:123], v4, s[16:19], s4 offen sc0 sc1
    s_add_u32 s4, s38, 104448
    buffer_load_dwordx2 v[124:125], v4, s[16:19], s4 offen sc0 sc1
    s_add_u32 s4, s38, 155648
    buffer_load_dwordx2 v[126:127], v4, s[16:19], s4 offen sc0 sc1
    s_add_u32 s4, s38, 55296
    buffer_load_dwordx2 v[128:129], v4, s[16:19], s4 offen sc0 sc1
    s_add_u32 s4, s38, 106496
    buffer_load_dwordx2 v[130:131], v4, s[16:19], s4 offen sc0 sc1
    s_add_u32 s4, s38, 157696
    buffer_load_dwordx2 v[132:133], v4, s[16:19], s4 offen sc0 sc1
    s_add_u32 s4, s38, 57344
    buffer_load_dwordx2 v[134:135], v4, s[16:19], s4 offen sc0 sc1
    s_add_u32 s4, s38, 108544
    buffer_load_dwordx2 v[136:137], v4, s[16:19], s4 offen sc0 sc1
    s_add_u32 s4, s38, 159744
    buffer_load_dwordx2 v[138:139], v4, s[16:19], s4 offen sc0 sc1
    s_add_u32 s4, s38, 59392
    buffer_load_dwordx2 v[140:141], v4, s[16:19], s4 offen sc0 sc1
    s_add_u32 s4, s38, 110592
    buffer_load_dwordx2 v[142:143], v4, s[16:19], s4 offen sc0 sc1
    s_add_u32 s4, s38, 161792
    buffer_load_dwordx2 v[144:145], v4, s[16:19], s4 offen sc0 sc1
    s_add_u32 s4, s38, 61440
    buffer_load_dwordx2 v[146:147], v4, s[16:19], s4 offen sc0 sc1
    s_add_u32 s4, s38, 112640
    buffer_load_dwordx2 v[148:149], v4, s[16:19], s4 offen sc0 sc1
    s_add_u32 s4, s38, 163840
    buffer_load_dwordx2 v[150:151], v4, s[16:19], s4 offen sc0 sc1
    s_add_u32 s4, s38, 63488
    buffer_load_dwordx2 v[152:153], v4, s[16:19], s4 offen sc0 sc1
    s_add_u32 s4, s38, 114688
    buffer_load_dwordx2 v[154:155], v4, s[16:19], s4 offen sc0 sc1
    s_add_u32 s4, s38, 165888
    buffer_load_dwordx2 v[156:157], v4, s[16:19], s4 offen sc0 sc1
    s_waitcnt vmcnt(18)
    v_lshlrev_b32 v6, 16, v116
    v_and_b32 v7, 0xffff0000, v116
    v_add_f32 v16, v16, v6
    v_add_f32 v17, v17, v7
    v_lshlrev_b32 v6, 16, v117
    v_and_b32 v7, 0xffff0000, v117
    v_add_f32 v18, v18, v6
    v_add_f32 v19, v19, v7
    v_lshlrev_b32 v6, 16, v118
    v_and_b32 v7, 0xffff0000, v118
    v_add_f32 v16, v16, v6
    v_add_f32 v17, v17, v7
    v_lshlrev_b32 v6, 16, v119
    v_and_b32 v7, 0xffff0000, v119
    v_add_f32 v18, v18, v6
    v_add_f32 v19, v19, v7
    v_lshlrev_b32 v6, 16, v120
    v_and_b32 v7, 0xffff0000, v120
    v_add_f32 v16, v16, v6
    v_add_f32 v17, v17, v7
    v_lshlrev_b32 v6, 16, v121
    v_and_b32 v7, 0xffff0000, v121
    v_add_f32 v18, v18, v6
    v_add_f32 v19, v19, v7
    v_cvt_pk_bf16_f32 v16, v16, v17
    v_cvt_pk_bf16_f32 v17, v18, v19
    s_mov_b32 s4, 0
    buffer_store_dwordx2 v[16:17], v254, s[20:23], s4 offen nt
    s_waitcnt vmcnt(16)
    v_lshlrev_b32 v6, 16, v122
    v_and_b32 v7, 0xffff0000, v122
    v_add_f32 v32, v32, v6
    v_add_f32 v33, v33, v7
    v_lshlrev_b32 v6, 16, v123
    v_and_b32 v7, 0xffff0000, v123
    v_add_f32 v34, v34, v6
    v_add_f32 v35, v35, v7
    v_lshlrev_b32 v6, 16, v124
    v_and_b32 v7, 0xffff0000, v124
    v_add_f32 v32, v32, v6
    v_add_f32 v33, v33, v7
    v_lshlrev_b32 v6, 16, v125
    v_and_b32 v7, 0xffff0000, v125
    v_add_f32 v34, v34, v6
    v_add_f32 v35, v35, v7
    v_lshlrev_b32 v6, 16, v126
    v_and_b32 v7, 0xffff0000, v126
    v_add_f32 v32, v32, v6
    v_add_f32 v33, v33, v7
    v_lshlrev_b32 v6, 16, v127
    v_and_b32 v7, 0xffff0000, v127
    v_add_f32 v34, v34, v6
    v_add_f32 v35, v35, v7
    v_cvt_pk_bf16_f32 v32, v32, v33
    v_cvt_pk_bf16_f32 v33, v34, v35
    s_mov_b32 s4, 147456
    buffer_store_dwordx2 v[32:33], v254, s[20:23], s4 offen nt
    s_waitcnt vmcnt(14)
    v_lshlrev_b32 v6, 16, v128
    v_and_b32 v7, 0xffff0000, v128
    v_add_f32 v48, v48, v6
    v_add_f32 v49, v49, v7
    v_lshlrev_b32 v6, 16, v129
    v_and_b32 v7, 0xffff0000, v129
    v_add_f32 v50, v50, v6
    v_add_f32 v51, v51, v7
    v_lshlrev_b32 v6, 16, v130
    v_and_b32 v7, 0xffff0000, v130
    v_add_f32 v48, v48, v6
    v_add_f32 v49, v49, v7
    v_lshlrev_b32 v6, 16, v131
    v_and_b32 v7, 0xffff0000, v131
    v_add_f32 v50, v50, v6
    v_add_f32 v51, v51, v7
    v_lshlrev_b32 v6, 16, v132
    v_and_b32 v7, 0xffff0000, v132
    v_add_f32 v48, v48, v6
    v_add_f32 v49, v49, v7
    v_lshlrev_b32 v6, 16, v133
    v_and_b32 v7, 0xffff0000, v133
    v_add_f32 v50, v50, v6
    v_add_f32 v51, v51, v7
    v_cvt_pk_bf16_f32 v48, v48, v49
    v_cvt_pk_bf16_f32 v49, v50, v51
    s_mov_b32 s4, 110624
    buffer_store_dwordx2 v[48:49], v254, s[20:23], s4 offen nt
    s_waitcnt vmcnt(12)
    v_lshlrev_b32 v6, 16, v134
    v_and_b32 v7, 0xffff0000, v134
    v_add_f32 v64, v64, v6
    v_add_f32 v65, v65, v7
    v_lshlrev_b32 v6, 16, v135
    v_and_b32 v7, 0xffff0000, v135
    v_add_f32 v66, v66, v6
    v_add_f32 v67, v67, v7
    v_lshlrev_b32 v6, 16, v136
    v_and_b32 v7, 0xffff0000, v136
    v_add_f32 v64, v64, v6
    v_add_f32 v65, v65, v7
    v_lshlrev_b32 v6, 16, v137
    v_and_b32 v7, 0xffff0000, v137
    v_add_f32 v66, v66, v6
    v_add_f32 v67, v67, v7
    v_lshlrev_b32 v6, 16, v138
    v_and_b32 v7, 0xffff0000, v138
    v_add_f32 v64, v64, v6
    v_add_f32 v65, v65, v7
    v_lshlrev_b32 v6, 16, v139
    v_and_b32 v7, 0xffff0000, v139
    v_add_f32 v66, v66, v6
    v_add_f32 v67, v67, v7
    v_cvt_pk_bf16_f32 v64, v64, v65
    v_cvt_pk_bf16_f32 v65, v66, v67
    s_mov_b32 s4, 73792
    buffer_store_dwordx2 v[64:65], v254, s[20:23], s4 offen nt
    s_waitcnt vmcnt(10)
    v_lshlrev_b32 v6, 16, v140
    v_and_b32 v7, 0xffff0000, v140
    v_add_f32 v80, v80, v6
    v_add_f32 v81, v81, v7
    v_lshlrev_b32 v6, 16, v141
    v_and_b32 v7, 0xffff0000, v141
    v_add_f32 v82, v82, v6
    v_add_f32 v83, v83, v7
    v_lshlrev_b32 v6, 16, v142
    v_and_b32 v7, 0xffff0000, v142
    v_add_f32 v80, v80, v6
    v_add_f32 v81, v81, v7
    v_lshlrev_b32 v6, 16, v143
    v_and_b32 v7, 0xffff0000, v143
    v_add_f32 v82, v82, v6
    v_add_f32 v83, v83, v7
    v_lshlrev_b32 v6, 16, v144
    v_and_b32 v7, 0xffff0000, v144
    v_add_f32 v80, v80, v6
    v_add_f32 v81, v81, v7
    v_lshlrev_b32 v6, 16, v145
    v_and_b32 v7, 0xffff0000, v145
    v_add_f32 v82, v82, v6
    v_add_f32 v83, v83, v7
    v_cvt_pk_bf16_f32 v80, v80, v81
    v_cvt_pk_bf16_f32 v81, v82, v83
    s_mov_b32 s4, 36960
    buffer_store_dwordx2 v[80:81], v254, s[20:23], s4 offen nt
    s_waitcnt vmcnt(8)
    v_lshlrev_b32 v6, 16, v146
    v_and_b32 v7, 0xffff0000, v146
    v_add_f32 v96, v96, v6
    v_add_f32 v97, v97, v7
    v_lshlrev_b32 v6, 16, v147
    v_and_b32 v7, 0xffff0000, v147
    v_add_f32 v98, v98, v6
    v_add_f32 v99, v99, v7
    v_lshlrev_b32 v6, 16, v148
    v_and_b32 v7, 0xffff0000, v148
    v_add_f32 v96, v96, v6
    v_add_f32 v97, v97, v7
    v_lshlrev_b32 v6, 16, v149
    v_and_b32 v7, 0xffff0000, v149
    v_add_f32 v98, v98, v6
    v_add_f32 v99, v99, v7
    v_lshlrev_b32 v6, 16, v150
    v_and_b32 v7, 0xffff0000, v150
    v_add_f32 v96, v96, v6
    v_add_f32 v97, v97, v7
    v_lshlrev_b32 v6, 16, v151
    v_and_b32 v7, 0xffff0000, v151
    v_add_f32 v98, v98, v6
    v_add_f32 v99, v99, v7
    v_cvt_pk_bf16_f32 v96, v96, v97
    v_cvt_pk_bf16_f32 v97, v98, v99
    s_mov_b32 s4, 128
    buffer_store_dwordx2 v[96:97], v254, s[20:23], s4 offen nt
    s_waitcnt vmcnt(6)
    v_lshlrev_b32 v6, 16, v152
    v_and_b32 v7, 0xffff0000, v152
    v_add_f32 v112, v112, v6
    v_add_f32 v113, v113, v7
    v_lshlrev_b32 v6, 16, v153
    v_and_b32 v7, 0xffff0000, v153
    v_add_f32 v114, v114, v6
    v_add_f32 v115, v115, v7
    v_lshlrev_b32 v6, 16, v154
    v_and_b32 v7, 0xffff0000, v154
    v_add_f32 v112, v112, v6
    v_add_f32 v113, v113, v7
    v_lshlrev_b32 v6, 16, v155
    v_and_b32 v7, 0xffff0000, v155
    v_add_f32 v114, v114, v6
    v_add_f32 v115, v115, v7
    v_lshlrev_b32 v6, 16, v156
    v_and_b32 v7, 0xffff0000, v156
    v_add_f32 v112, v112, v6
    v_add_f32 v113, v113, v7
    v_lshlrev_b32 v6, 16, v157
    v_and_b32 v7, 0xffff0000, v157
    v_add_f32 v114, v114, v6
    v_add_f32 v115, v115, v7
    v_cvt_pk_bf16_f32 v112, v112, v113
    v_cvt_pk_bf16_f32 v113, v114, v115
    s_mov_b32 s4, 147584
    buffer_store_dwordx2 v[112:113], v254, s[20:23], s4 offen nt
KF_SB_38:
    s_cmp_lg_u32 s68, 1
    s_cbranch_scc1 KF_SB_39
    s_mul_i32 s38, s32, 12800
    s_add_u32 s4, s38, 102912
    buffer_load_dwordx2 v[116:117], v4, s[16:19], s4 offen sc0 sc1
    s_add_u32 s4, s38, 154112
    buffer_load_dwordx2 v[118:119], v4, s[16:19], s4 offen sc0 sc1
    s_add_u32 s4, s38, 512
    buffer_load_dwordx2 v[120:121], v4, s[16:19], s4 offen sc0 sc1
    s_add_u32 s4, s38, 104960
    buffer_load_dwordx2 v[122:123], v4, s[16:19], s4 offen sc0 sc1
    s_add_u32 s4, s38, 156160
    buffer_load_dwordx2 v[124:125], v4, s[16:19], s4 offen sc0 sc1
    s_add_u32 s4, s38, 2560
    buffer_load_dwordx2 v[126:127], v4, s[16:19], s4 offen sc0 sc1
    s_add_u32 s4, s38, 107008
    buffer_load_dwordx2 v[128:129], v4, s[16:19], s4 offen sc0 sc1
    s_add_u32 s4, s38, 158208
    buffer_load_dwordx2 v[130:131], v4, s[16:19], s4 offen sc0 sc1
    s_add_u32 s4, s38, 4608
    buffer_load_dwordx2 v[132:133], v4, s[16:19], s4 offen sc0 sc1
    s_add_u32 s4, s38, 109056
    buffer_load_dwordx2 v[134:135], v4, s[16:19], s4 offen sc0 sc1
    s_add_u32 s4, s38, 160256
    buffer_load_dwordx2 v[136:137], v4, s[16:19], s4 offen sc0 sc1
    s_add_u32 s4, s38, 6656
    buffer_load_dwordx2 v[138:139], v4, s[16:19], s4 offen sc0 sc1
    s_add_u32 s4, s38, 111104
    buffer_load_dwordx2 v[140:141], v4, s[16:19], s4 offen sc0 sc1
    s_add_u32 s4, s38, 162304
    buffer_load_dwordx2 v[142:143], v4, s[16:19], s4 offen sc0 sc1
    s_add_u32 s4, s38, 8704
    buffer_load_dwordx2 v[144:145], v4, s[16:19], s4 offen sc0 sc1
    s_add_u32 s4, s38, 113152
    buffer_load_dwordx2 v[146:147], v4, s[16:19], s4 offen sc0 sc1
    s_add_u32 s4, s38, 164352
    buffer_load_dwordx2 v[148:149], v4, s[16:19], s4 offen sc0 sc1
    s_add_u32 s4, s38, 10752
    buffer_load_dwordx2 v[150:151], v4, s[16:19], s4 offen sc0 sc1
    s_waitcnt vmcnt(15)
    v_lshlrev_b32 v6, 16, v116
    v_and_b32 v7, 0xffff0000, v116
    v_add_f32 v20, v20, v6
    v_add_f32 v21, v21, v7
    v_lshlrev_b32 v6, 16, v117
    v_and_b32 v7, 0xffff0000, v117
    v_add_f32 v22, v22, v6
    v_add_f32 v23, v23, v7
    v_lshlrev_b32 v6, 16, v118
    v_and_b32 v7, 0xffff0000, v118
    v_add_f32 v20, v20, v6
    v_add_f32 v21, v21, v7
    v_lshlrev_b32 v6, 16, v119
    v_and_b32 v7, 0xffff0000, v119
    v_add_f32 v22, v22, v6
    v_add_f32 v23, v23, v7
    v_lshlrev_b32 v6, 16, v120
    v_and_b32 v7, 0xffff0000, v120
    v_add_f32 v20, v20, v6
    v_add_f32 v21, v21, v7
    v_lshlrev_b32 v6, 16, v121
    v_and_b32 v7, 0xffff0000, v121
    v_add_f32 v22, v22, v6
    v_add_f32 v23, v23, v7
    v_cvt_pk_bf16_f32 v20, v20, v21
    v_cvt_pk_bf16_f32 v21, v22, v23
    s_mov_b32 s4, 36864
    buffer_store_dwordx2 v[20:21], v254, s[20:23], s4 offen nt
    s_waitcnt vmcnt(13)
    v_lshlrev_b32 v6, 16, v122
    v_and_b32 v7, 0xffff0000, v122
    v_add_f32 v36, v36, v6
    v_add_f32 v37, v37, v7
    v_lshlrev_b32 v6, 16, v123
    v_and_b32 v7, 0xffff0000, v123
    v_add_f32 v38, v38, v6
    v_add_f32 v39, v39, v7
    v_lshlrev_b32 v6, 16, v124
    v_and_b32 v7, 0xffff0000, v124
    v_add_f32 v36, v36, v6
    v_add_f32 v37, v37, v7
    v_lshlrev_b32 v6, 16, v125
    v_and_b32 v7, 0xffff0000, v125
    v_add_f32 v38, v38, v6
    v_add_f32 v39, v39, v7
    v_lshlrev_b32 v6, 16, v126
    v_and_b32 v7, 0xffff0000, v126
    v_add_f32 v36, v36, v6
    v_add_f32 v37, v37, v7
    v_lshlrev_b32 v6, 16, v127
    v_and_b32 v7, 0xffff0000, v127
    v_add_f32 v38, v38, v6
    v_add_f32 v39, v39, v7
    v_cvt_pk_bf16_f32 v36, v36, v37
    v_cvt_pk_bf16_f32 v37, v38, v39
    s_mov_b32 s4, 32
    buffer_store_dwordx2 v[36:37], v254, s[20:23], s4 offen nt
    s_waitcnt vmcnt(11)
    v_lshlrev_b32 v6, 16, v128
    v_and_b32 v7, 0xffff0000, v128
    v_add_f32 v52, v52, v6
    v_add_f32 v53, v53, v7
    v_lshlrev_b32 v6, 16, v129
    v_and_b32 v7, 0xffff0000, v129
    v_add_f32 v54, v54, v6
    v_add_f32 v55, v55, v7
    v_lshlrev_b32 v6, 16, v130
    v_and_b32 v7, 0xffff0000, v130
    v_add_f32 v52, v52, v6
    v_add_f32 v53, v53, v7
    v_lshlrev_b32 v6, 16, v131
    v_and_b32 v7, 0xffff0000, v131
    v_add_f32 v54, v54, v6
    v_add_f32 v55, v55, v7
    v_lshlrev_b32 v6, 16, v132
    v_and_b32 v7, 0xffff0000, v132
    v_add_f32 v52, v52, v6
    v_add_f32 v53, v53, v7
    v_lshlrev_b32 v6, 16, v133
    v_and_b32 v7, 0xffff0000, v133
    v_add_f32 v54, v54, v6
    v_add_f32 v55, v55, v7
    v_cvt_pk_bf16_f32 v52, v52, v53
    v_cvt_pk_bf16_f32 v53, v54, v55
    s_mov_b32 s4, 147488
    buffer_store_dwordx2 v[52:53], v254, s[20:23], s4 offen nt
    s_waitcnt vmcnt(9)
    v_lshlrev_b32 v6, 16, v134
    v_and_b32 v7, 0xffff0000, v134
    v_add_f32 v68, v68, v6
    v_add_f32 v69, v69, v7
    v_lshlrev_b32 v6, 16, v135
    v_and_b32 v7, 0xffff0000, v135
    v_add_f32 v70, v70, v6
    v_add_f32 v71, v71, v7
    v_lshlrev_b32 v6, 16, v136
    v_and_b32 v7, 0xffff0000, v136
    v_add_f32 v68, v68, v6
    v_add_f32 v69, v69, v7
    v_lshlrev_b32 v6, 16, v137
    v_and_b32 v7, 0xffff0000, v137
    v_add_f32 v70, v70, v6
    v_add_f32 v71, v71, v7
    v_lshlrev_b32 v6, 16, v138
    v_and_b32 v7, 0xffff0000, v138
    v_add_f32 v68, v68, v6
    v_add_f32 v69, v69, v7
    v_lshlrev_b32 v6, 16, v139
    v_and_b32 v7, 0xffff0000, v139
    v_add_f32 v70, v70, v6
    v_add_f32 v71, v71, v7
    v_cvt_pk_bf16_f32 v68, v68, v69
    v_cvt_pk_bf16_f32 v69, v70, v71
    s_mov_b32 s4, 110656
    buffer_store_dwordx2 v[68:69], v254, s[20:23], s4 offen nt
    s_waitcnt vmcnt(7)
    v_lshlrev_b32 v6, 16, v140
    v_and_b32 v7, 0xffff0000, v140
    v_add_f32 v84, v84, v6
    v_add_f32 v85, v85, v7
    v_lshlrev_b32 v6, 16, v141
    v_and_b32 v7, 0xffff0000, v141
    v_add_f32 v86, v86, v6
    v_add_f32 v87, v87, v7
    v_lshlrev_b32 v6, 16, v142
    v_and_b32 v7, 0xffff0000, v142
    v_add_f32 v84, v84, v6
    v_add_f32 v85, v85, v7
    v_lshlrev_b32 v6, 16, v143
    v_and_b32 v7, 0xffff0000, v143
    v_add_f32 v86, v86, v6
    v_add_f32 v87, v87, v7
    v_lshlrev_b32 v6, 16, v144
    v_and_b32 v7, 0xffff0000, v144
    v_add_f32 v84, v84, v6
    v_add_f32 v85, v85, v7
    v_lshlrev_b32 v6, 16, v145
    v_and_b32 v7, 0xffff0000, v145
    v_add_f32 v86, v86, v6
    v_add_f32 v87, v87, v7
    v_cvt_pk_bf16_f32 v84, v84, v85
    v_cvt_pk_bf16_f32 v85, v86, v87
    s_mov_b32 s4, 73824
    buffer_store_dwordx2 v[84:85], v254, s[20:23], s4 offen nt
    s_waitcnt vmcnt(5)
    v_lshlrev_b32 v6, 16, v146
    v_and_b32 v7, 0xffff0000, v146
    v_add_f32 v100, v100, v6
    v_add_f32 v101, v101, v7
    v_lshlrev_b32 v6, 16, v147
    v_and_b32 v7, 0xffff0000, v147
    v_add_f32 v102, v102, v6
    v_add_f32 v103, v103, v7
    v_lshlrev_b32 v6, 16, v148
    v_and_b32 v7, 0xffff0000, v148
    v_add_f32 v100, v100, v6
    v_add_f32 v101, v101, v7
    v_lshlrev_b32 v6, 16, v149
    v_and_b32 v7, 0xffff0000, v149
    v_add_f32 v102, v102, v6
    v_add_f32 v103, v103, v7
    v_lshlrev_b32 v6, 16, v150
    v_and_b32 v7, 0xffff0000, v150
    v_add_f32 v100, v100, v6
    v_add_f32 v101, v101, v7
    v_lshlrev_b32 v6, 16, v151
    v_and_b32 v7, 0xffff0000, v151
    v_add_f32 v102, v102, v6
    v_add_f32 v103, v103, v7
    v_cvt_pk_bf16_f32 v100, v100, v101
    v_cvt_pk_bf16_f32 v101, v102, v103
    s_mov_b32 s4, 36992
    buffer_store_dwordx2 v[100:101], v254, s[20:23], s4 offen nt
KF_SB_39:
    s_cmp_lg_u32 s68, 2
    s_cbranch_scc1 KF_SB_40
    s_mul_i32 s38, s32, 12800
    s_add_u32 s4, s38, 154624
    buffer_load_dwordx2 v[116:117], v4, s[16:19], s4 offen sc0 sc1
    s_add_u32 s4, s38, 1024
    buffer_load_dwordx2 v[118:119], v4, s[16:19], s4 offen sc0 sc1
    s_add_u32 s4, s38, 52224
    buffer_load_dwordx2 v[120:121], v4, s[16:19], s4 offen sc0 sc1
    s_add_u32 s4, s38, 156672
    buffer_load_dwordx2 v[122:123], v4, s[16:19], s4 offen sc0 sc1
    s_add_u32 s4, s38, 3072
    buffer_load_dwordx2 v[124:125], v4, s[16:19], s4 offen sc0 sc1
    s_add_u32 s4, s38, 54272
    buffer_load_dwordx2 v[126:127], v4, s[16:19], s4 offen sc0 sc1
    s_add_u32 s4, s38, 158720
    buffer_load_dwordx2 v[128:129], v4, s[16:19], s4 offen sc0 sc1
    s_add_u32 s4, s38, 5120
    buffer_load_dwordx2 v[130:131], v4, s[16:19], s4 offen sc0 sc1
    s_add_u32 s4, s38, 56320
    buffer_load_dwordx2 v[132:133], v4, s[16:19], s4 offen sc0 sc1
    s_add_u32 s4, s38, 160768
    buffer_load_dwordx2 v[134:135], v4, s[16:19], s4 offen sc0 sc1
    s_add_u32 s4, s38, 7168
    buffer_load_dwordx2 v[136:137], v4, s[16:19], s4 offen sc0 sc1
    s_add_u32 s4, s38, 58368
    buffer_load_dwordx2 v[138:139], v4, s[16:19], s4 offen sc0 sc1
    s_add_u32 s4, s38, 162816
    buffer_load_dwordx2 v[140:141], v4, s[16:19], s4 offen sc0 sc1
    s_add_u32 s4, s38, 9216
    buffer_load_dwordx2 v[142:143], v4, s[16:19], s4 offen sc0 sc1
    s_add_u32 s4, s38, 60416
    buffer_load_dwordx2 v[144:145], v4, s[16:19], s4 offen sc0 sc1
    s_add_u32 s4, s38, 164864
    buffer_load_dwordx2 v[146:147], v4, s[16:19], s4 offen sc0 sc1
    s_add_u32 s4, s38, 11264
    buffer_load_dwordx2 v[148:149], v4, s[16:19], s4 offen sc0 sc1
    s_add_u32 s4, s38, 62464
    buffer_load_dwordx2 v[150:151], v4, s[16:19], s4 offen sc0 sc1
    s_waitcnt vmcnt(15)
    v_lshlrev_b32 v6, 16, v116
    v_and_b32 v7, 0xffff0000, v116
    v_add_f32 v24, v24, v6
    v_add_f32 v25, v25, v7
    v_lshlrev_b32 v6, 16, v117
    v_and_b32 v7, 0xffff0000, v117
    v_add_f32 v26, v26, v6
    v_add_f32 v27, v27, v7
    v_lshlrev_b32 v6, 16, v118
    v_and_b32 v7, 0xffff0000, v118
    v_add_f32 v24, v24, v6
    v_add_f32 v25, v25, v7
    v_lshlrev_b32 v6, 16, v119
    v_and_b32 v7, 0xffff0000, v119
    v_add_f32 v26, v26, v6
    v_add_f32 v27, v27, v7
    v_lshlrev_b32 v6, 16, v120
    v_and_b32 v7, 0xffff0000, v120
    v_add_f32 v24, v24, v6
    v_add_f32 v25, v25, v7
    v_lshlrev_b32 v6, 16, v121
    v_and_b32 v7, 0xffff0000, v121
    v_add_f32 v26, v26, v6
    v_add_f32 v27, v27, v7
    v_cvt_pk_bf16_f32 v24, v24, v25
    v_cvt_pk_bf16_f32 v25, v26, v27
    s_mov_b32 s4, 73728
    buffer_store_dwordx2 v[24:25], v254, s[20:23], s4 offen nt
    s_waitcnt vmcnt(13)
    v_lshlrev_b32 v6, 16, v122
    v_and_b32 v7, 0xffff0000, v122
    v_add_f32 v40, v40, v6
    v_add_f32 v41, v41, v7
    v_lshlrev_b32 v6, 16, v123
    v_and_b32 v7, 0xffff0000, v123
    v_add_f32 v42, v42, v6
    v_add_f32 v43, v43, v7
    v_lshlrev_b32 v6, 16, v124
    v_and_b32 v7, 0xffff0000, v124
    v_add_f32 v40, v40, v6
    v_add_f32 v41, v41, v7
    v_lshlrev_b32 v6, 16, v125
    v_and_b32 v7, 0xffff0000, v125
    v_add_f32 v42, v42, v6
    v_add_f32 v43, v43, v7
    v_lshlrev_b32 v6, 16, v126
    v_and_b32 v7, 0xffff0000, v126
    v_add_f32 v40, v40, v6
    v_add_f32 v41, v41, v7
    v_lshlrev_b32 v6, 16, v127
    v_and_b32 v7, 0xffff0000, v127
    v_add_f32 v42, v42, v6
    v_add_f32 v43, v43, v7
    v_cvt_pk_bf16_f32 v40, v40, v41
    v_cvt_pk_bf16_f32 v41, v42, v43
    s_mov_b32 s4, 36896
    buffer_store_dwordx2 v[40:41], v254, s[20:23], s4 offen nt
    s_waitcnt vmcnt(11)
    v_lshlrev_b32 v6, 16, v128
    v_and_b32 v7, 0xffff0000, v128
    v_add_f32 v56, v56, v6
    v_add_f32 v57, v57, v7
    v_lshlrev_b32 v6, 16, v129
    v_and_b32 v7, 0xffff0000, v129
    v_add_f32 v58, v58, v6
    v_add_f32 v59, v59, v7
    v_lshlrev_b32 v6, 16, v130
    v_and_b32 v7, 0xffff0000, v130
    v_add_f32 v56, v56, v6
    v_add_f32 v57, v57, v7
    v_lshlrev_b32 v6, 16, v131
    v_and_b32 v7, 0xffff0000, v131
    v_add_f32 v58, v58, v6
    v_add_f32 v59, v59, v7
    v_lshlrev_b32 v6, 16, v132
    v_and_b32 v7, 0xffff0000, v132
    v_add_f32 v56, v56, v6
    v_add_f32 v57, v57, v7
    v_lshlrev_b32 v6, 16, v133
    v_and_b32 v7, 0xffff0000, v133
    v_add_f32 v58, v58, v6
    v_add_f32 v59, v59, v7
    v_cvt_pk_bf16_f32 v56, v56, v57
    v_cvt_pk_bf16_f32 v57, v58, v59
    s_mov_b32 s4, 64
    buffer_store_dwordx2 v[56:57], v254, s[20:23], s4 offen nt
    s_waitcnt vmcnt(9)
    v_lshlrev_b32 v6, 16, v134
    v_and_b32 v7, 0xffff0000, v134
    v_add_f32 v72, v72, v6
    v_add_f32 v73, v73, v7
    v_lshlrev_b32 v6, 16, v135
    v_and_b32 v7, 0xffff0000, v135
    v_add_f32 v74, v74, v6
    v_add_f32 v75, v75, v7
    v_lshlrev_b32 v6, 16, v136
    v_and_b32 v7, 0xffff0000, v136
    v_add_f32 v72, v72, v6
    v_add_f32 v73, v73, v7
    v_lshlrev_b32 v6, 16, v137
    v_and_b32 v7, 0xffff0000, v137
    v_add_f32 v74, v74, v6
    v_add_f32 v75, v75, v7
    v_lshlrev_b32 v6, 16, v138
    v_and_b32 v7, 0xffff0000, v138
    v_add_f32 v72, v72, v6
    v_add_f32 v73, v73, v7
    v_lshlrev_b32 v6, 16, v139
    v_and_b32 v7, 0xffff0000, v139
    v_add_f32 v74, v74, v6
    v_add_f32 v75, v75, v7
    v_cvt_pk_bf16_f32 v72, v72, v73
    v_cvt_pk_bf16_f32 v73, v74, v75
    s_mov_b32 s4, 147520
    buffer_store_dwordx2 v[72:73], v254, s[20:23], s4 offen nt
    s_waitcnt vmcnt(7)
    v_lshlrev_b32 v6, 16, v140
    v_and_b32 v7, 0xffff0000, v140
    v_add_f32 v88, v88, v6
    v_add_f32 v89, v89, v7
    v_lshlrev_b32 v6, 16, v141
    v_and_b32 v7, 0xffff0000, v141
    v_add_f32 v90, v90, v6
    v_add_f32 v91, v91, v7
    v_lshlrev_b32 v6, 16, v142
    v_and_b32 v7, 0xffff0000, v142
    v_add_f32 v88, v88, v6
    v_add_f32 v89, v89, v7
    v_lshlrev_b32 v6, 16, v143
    v_and_b32 v7, 0xffff0000, v143
    v_add_f32 v90, v90, v6
    v_add_f32 v91, v91, v7
    v_lshlrev_b32 v6, 16, v144
    v_and_b32 v7, 0xffff0000, v144
    v_add_f32 v88, v88, v6
    v_add_f32 v89, v89, v7
    v_lshlrev_b32 v6, 16, v145
    v_and_b32 v7, 0xffff0000, v145
    v_add_f32 v90, v90, v6
    v_add_f32 v91, v91, v7
    v_cvt_pk_bf16_f32 v88, v88, v89
    v_cvt_pk_bf16_f32 v89, v90, v91
    s_mov_b32 s4, 110688
    buffer_store_dwordx2 v[88:89], v254, s[20:23], s4 offen nt
    s_waitcnt vmcnt(5)
    v_lshlrev_b32 v6, 16, v146
    v_and_b32 v7, 0xffff0000, v146
    v_add_f32 v104, v104, v6
    v_add_f32 v105, v105, v7
    v_lshlrev_b32 v6, 16, v147
    v_and_b32 v7, 0xffff0000, v147
    v_add_f32 v106, v106, v6
    v_add_f32 v107, v107, v7
    v_lshlrev_b32 v6, 16, v148
    v_and_b32 v7, 0xffff0000, v148
    v_add_f32 v104, v104, v6
    v_add_f32 v105, v105, v7
    v_lshlrev_b32 v6, 16, v149
    v_and_b32 v7, 0xffff0000, v149
    v_add_f32 v106, v106, v6
    v_add_f32 v107, v107, v7
    v_lshlrev_b32 v6, 16, v150
    v_and_b32 v7, 0xffff0000, v150
    v_add_f32 v104, v104, v6
    v_add_f32 v105, v105, v7
    v_lshlrev_b32 v6, 16, v151
    v_and_b32 v7, 0xffff0000, v151
    v_add_f32 v106, v106, v6
    v_add_f32 v107, v107, v7
    v_cvt_pk_bf16_f32 v104, v104, v105
    v_cvt_pk_bf16_f32 v105, v106, v107
    s_mov_b32 s4, 73856
    buffer_store_dwordx2 v[104:105], v254, s[20:23], s4 offen nt
KF_SB_40:
    s_cmp_lg_u32 s68, 3
    s_cbranch_scc1 KF_SB_41
    s_mul_i32 s38, s32, 12800
    s_add_u32 s4, s38, 1536
    buffer_load_dwordx2 v[116:117], v4, s[16:19], s4 offen sc0 sc1
    s_add_u32 s4, s38, 52736
    buffer_load_dwordx2 v[118:119], v4, s[16:19], s4 offen sc0 sc1
    s_add_u32 s4, s38, 103936
    buffer_load_dwordx2 v[120:121], v4, s[16:19], s4 offen sc0 sc1
    s_add_u32 s4, s38, 3584
    buffer_load_dwordx2 v[122:123], v4, s[16:19], s4 offen sc0 sc1
    s_add_u32 s4, s38, 54784
    buffer_load_dwordx2 v[124:125], v4, s[16:19], s4 offen sc0 sc1
    s_add_u32 s4, s38, 105984
    buffer_load_dwordx2 v[126:127], v4, s[16:19], s4 offen sc0 sc1
    s_add_u32 s4, s38, 5632
    buffer_load_dwordx2 v[128:129], v4, s[16:19], s4 offen sc0 sc1
    s_add_u32 s4, s38, 56832
    buffer_load_dwordx2 v[130:131], v4, s[16:19], s4 offen sc0 sc1
    s_add_u32 s4, s38, 108032
    buffer_load_dwordx2 v[132:133], v4, s[16:19], s4 offen sc0 sc1
    s_add_u32 s4, s38, 7680
    buffer_load_dwordx2 v[134:135], v4, s[16:19], s4 offen sc0 sc1
    s_add_u32 s4, s38, 58880
    buffer_load_dwordx2 v[136:137], v4, s[16:19], s4 offen sc0 sc1
    s_add_u32 s4, s38, 110080
    buffer_load_dwordx2 v[138:139], v4, s[16:19], s4 offen sc0 sc1
    s_add_u32 s4, s38, 9728
    buffer_load_dwordx2 v[140:141], v4, s[16:19], s4 offen sc0 sc1
    s_add_u32 s4, s38, 60928
    buffer_load_dwordx2 v[142:143], v4, s[16:19], s4 offen sc0 sc1
    s_add_u32 s4, s38, 112128
    buffer_load_dwordx2 v[144:145], v4, s[16:19], s4 offen sc0 sc1
    s_add_u32 s4, s38, 11776
    buffer_load_dwordx2 v[146:147], v4, s[16:19], s4 offen sc0 sc1
    s_add_u32 s4, s38, 62976
    buffer_load_dwordx2 v[148:149], v4, s[16:19], s4 offen sc0 sc1
    s_add_u32 s4, s38, 114176
    buffer_load_dwordx2 v[150:151], v4, s[16:19], s4 offen sc0 sc1
    s_waitcnt vmcnt(15)
    v_lshlrev_b32 v6, 16, v116
    v_and_b32 v7, 0xffff0000, v116
    v_add_f32 v28, v28, v6
    v_add_f32 v29, v29, v7
    v_lshlrev_b32 v6, 16, v117
    v_and_b32 v7, 0xffff0000, v117
    v_add_f32 v30, v30, v6
    v_add_f32 v31, v31, v7
    v_lshlrev_b32 v6, 16, v118
    v_and_b32 v7, 0xffff0000, v118
    v_add_f32 v28, v28, v6
    v_add_f32 v29, v29, v7
    v_lshlrev_b32 v6, 16, v119
    v_and_b32 v7, 0xffff0000, v119
    v_add_f32 v30, v30, v6
    v_add_f32 v31, v31, v7
    v_lshlrev_b32 v6, 16, v120
    v_and_b32 v7, 0xffff0000, v120
    v_add_f32 v28, v28, v6
    v_add_f32 v29, v29, v7
    v_lshlrev_b32 v6, 16, v121
    v_and_b32 v7, 0xffff0000, v121
    v_add_f32 v30, v30, v6
    v_add_f32 v31, v31, v7
    v_cvt_pk_bf16_f32 v28, v28, v29
    v_cvt_pk_bf16_f32 v29, v30, v31
    s_mov_b32 s4, 110592
    buffer_store_dwordx2 v[28:29], v254, s[20:23], s4 offen nt
    s_waitcnt vmcnt(13)
    v_lshlrev_b32 v6, 16, v122
    v_and_b32 v7, 0xffff0000, v122
    v_add_f32 v44, v44, v6
    v_add_f32 v45, v45, v7
    v_lshlrev_b32 v6, 16, v123
    v_and_b32 v7, 0xffff0000, v123
    v_add_f32 v46, v46, v6
    v_add_f32 v47, v47, v7
    v_lshlrev_b32 v6, 16, v124
    v_and_b32 v7, 0xffff0000, v124
    v_add_f32 v44, v44, v6
    v_add_f32 v45, v45, v7
    v_lshlrev_b32 v6, 16, v125
    v_and_b32 v7, 0xffff0000, v125
    v_add_f32 v46, v46, v6
    v_add_f32 v47, v47, v7
    v_lshlrev_b32 v6, 16, v126
    v_and_b32 v7, 0xffff0000, v126
    v_add_f32 v44, v44, v6
    v_add_f32 v45, v45, v7
    v_lshlrev_b32 v6, 16, v127
    v_and_b32 v7, 0xffff0000, v127
    v_add_f32 v46, v46, v6
    v_add_f32 v47, v47, v7
    v_cvt_pk_bf16_f32 v44, v44, v45
    v_cvt_pk_bf16_f32 v45, v46, v47
    s_mov_b32 s4, 73760
    buffer_store_dwordx2 v[44:45], v254, s[20:23], s4 offen nt
    s_waitcnt vmcnt(11)
    v_lshlrev_b32 v6, 16, v128
    v_and_b32 v7, 0xffff0000, v128
    v_add_f32 v60, v60, v6
    v_add_f32 v61, v61, v7
    v_lshlrev_b32 v6, 16, v129
    v_and_b32 v7, 0xffff0000, v129
    v_add_f32 v62, v62, v6
    v_add_f32 v63, v63, v7
    v_lshlrev_b32 v6, 16, v130
    v_and_b32 v7, 0xffff0000, v130
    v_add_f32 v60, v60, v6
    v_add_f32 v61, v61, v7
    v_lshlrev_b32 v6, 16, v131
    v_and_b32 v7, 0xffff0000, v131
    v_add_f32 v62, v62, v6
    v_add_f32 v63, v63, v7
    v_lshlrev_b32 v6, 16, v132
    v_and_b32 v7, 0xffff0000, v132
    v_add_f32 v60, v60, v6
    v_add_f32 v61, v61, v7
    v_lshlrev_b32 v6, 16, v133
    v_and_b32 v7, 0xffff0000, v133
    v_add_f32 v62, v62, v6
    v_add_f32 v63, v63, v7
    v_cvt_pk_bf16_f32 v60, v60, v61
    v_cvt_pk_bf16_f32 v61, v62, v63
    s_mov_b32 s4, 36928
    buffer_store_dwordx2 v[60:61], v254, s[20:23], s4 offen nt
    s_waitcnt vmcnt(9)
    v_lshlrev_b32 v6, 16, v134
    v_and_b32 v7, 0xffff0000, v134
    v_add_f32 v76, v76, v6
    v_add_f32 v77, v77, v7
    v_lshlrev_b32 v6, 16, v135
    v_and_b32 v7, 0xffff0000, v135
    v_add_f32 v78, v78, v6
    v_add_f32 v79, v79, v7
    v_lshlrev_b32 v6, 16, v136
    v_and_b32 v7, 0xffff0000, v136
    v_add_f32 v76, v76, v6
    v_add_f32 v77, v77, v7
    v_lshlrev_b32 v6, 16, v137
    v_and_b32 v7, 0xffff0000, v137
    v_add_f32 v78, v78, v6
    v_add_f32 v79, v79, v7
    v_lshlrev_b32 v6, 16, v138
    v_and_b32 v7, 0xffff0000, v138
    v_add_f32 v76, v76, v6
    v_add_f32 v77, v77, v7
    v_lshlrev_b32 v6, 16, v139
    v_and_b32 v7, 0xffff0000, v139
    v_add_f32 v78, v78, v6
    v_add_f32 v79, v79, v7
    v_cvt_pk_bf16_f32 v76, v76, v77
    v_cvt_pk_bf16_f32 v77, v78, v79
    s_mov_b32 s4, 96
    buffer_store_dwordx2 v[76:77], v254, s[20:23], s4 offen nt
    s_waitcnt vmcnt(7)
    v_lshlrev_b32 v6, 16, v140
    v_and_b32 v7, 0xffff0000, v140
    v_add_f32 v92, v92, v6
    v_add_f32 v93, v93, v7
    v_lshlrev_b32 v6, 16, v141
    v_and_b32 v7, 0xffff0000, v141
    v_add_f32 v94, v94, v6
    v_add_f32 v95, v95, v7
    v_lshlrev_b32 v6, 16, v142
    v_and_b32 v7, 0xffff0000, v142
    v_add_f32 v92, v92, v6
    v_add_f32 v93, v93, v7
    v_lshlrev_b32 v6, 16, v143
    v_and_b32 v7, 0xffff0000, v143
    v_add_f32 v94, v94, v6
    v_add_f32 v95, v95, v7
    v_lshlrev_b32 v6, 16, v144
    v_and_b32 v7, 0xffff0000, v144
    v_add_f32 v92, v92, v6
    v_add_f32 v93, v93, v7
    v_lshlrev_b32 v6, 16, v145
    v_and_b32 v7, 0xffff0000, v145
    v_add_f32 v94, v94, v6
    v_add_f32 v95, v95, v7
    v_cvt_pk_bf16_f32 v92, v92, v93
    v_cvt_pk_bf16_f32 v93, v94, v95
    s_mov_b32 s4, 147552
    buffer_store_dwordx2 v[92:93], v254, s[20:23], s4 offen nt
    s_waitcnt vmcnt(5)
    v_lshlrev_b32 v6, 16, v146
    v_and_b32 v7, 0xffff0000, v146
    v_add_f32 v108, v108, v6
    v_add_f32 v109, v109, v7
    v_lshlrev_b32 v6, 16, v147
    v_and_b32 v7, 0xffff0000, v147
    v_add_f32 v110, v110, v6
    v_add_f32 v111, v111, v7
    v_lshlrev_b32 v6, 16, v148
    v_and_b32 v7, 0xffff0000, v148
    v_add_f32 v108, v108, v6
    v_add_f32 v109, v109, v7
    v_lshlrev_b32 v6, 16, v149
    v_and_b32 v7, 0xffff0000, v149
    v_add_f32 v110, v110, v6
    v_add_f32 v111, v111, v7
    v_lshlrev_b32 v6, 16, v150
    v_and_b32 v7, 0xffff0000, v150
    v_add_f32 v108, v108, v6
    v_add_f32 v109, v109, v7
    v_lshlrev_b32 v6, 16, v151
    v_and_b32 v7, 0xffff0000, v151
    v_add_f32 v110, v110, v6
    v_add_f32 v111, v111, v7
    v_cvt_pk_bf16_f32 v108, v108, v109
    v_cvt_pk_bf16_f32 v109, v110, v111
    s_mov_b32 s4, 110720
    buffer_store_dwordx2 v[108:109], v254, s[20:23], s4 offen nt
KF_SB_41:
    s_branch KF_DONE
KF_V1:
    ds_read_b128 v[116:119], v190 offset:0
    ds_read_b128 v[120:123], v190 offset:2048
    ds_read_b128 v[124:127], v190 offset:4096
    ds_read_b128 v[128:131], v190 offset:6144
    ds_read_b128 v[132:135], v190 offset:8192
    ds_read_b64_tr_b16 v[196:197], v192 offset:0
    ds_read_b64_tr_b16 v[198:199], v192 offset:5120
    ds_read_b64_tr_b16 v[200:201], v193 offset:32
    ds_read_b64_tr_b16 v[202:203], v193 offset:5152
    ds_read_b64_tr_b16 v[204:205], v192 offset:64
    ds_read_b64_tr_b16 v[206:207], v192 offset:5184
    ds_read_b64_tr_b16 v[208:209], v193 offset:96
    ds_read_b64_tr_b16 v[210:211], v193 offset:5216
    s_waitcnt lgkmcnt(0)
    ds_read_b128 v[136:139], v191 offset:0
    v_mfma_f32_16x16x32_bf16 v[16:19], v[196:199], v[116:119], 0
    ds_read_b128 v[140:143], v191 offset:2048
    v_mfma_f32_16x16x32_bf16 v[20:23], v[196:199], v[120:123], 0
    ds_read_b128 v[144:147], v191 offset:4096
    v_mfma_f32_16x16x32_bf16 v[24:27], v[196:199], v[124:127], 0
    ds_read_b128 v[148:151], v191 offset:6144
    v_mfma_f32_16x16x32_bf16 v[28:31], v[196:199], v[128:131], 0
    ds_read_b128 v[152:155], v191 offset:8192
    v_mfma_f32_16x16x32_bf16 v[32:35], v[196:199], v[132:135], 0
    ds_read_b64_tr_b16 v[216:217], v192 offset:10240
    v_mfma_f32_16x16x32_bf16 v[36:39], v[200:203], v[116:119], 0
    v_mfma_f32_16x16x32_bf16 v[40:43], v[200:203], v[120:123], 0
    ds_read_b64_tr_b16 v[218:219], v192 offset:15360
    v_mfma_f32_16x16x32_bf16 v[44:47], v[200:203], v[124:127], 0
    ds_read_b64_tr_b16 v[220:221], v193 offset:10272
    v_mfma_f32_16x16x32_bf16 v[48:51], v[200:203], v[128:131], 0
    ds_read_b64_tr_b16 v[222:223], v193 offset:15392
    v_mfma_f32_16x16x32_bf16 v[52:55], v[200:203], v[132:135], 0
    ds_read_b64_tr_b16 v[224:225], v192 offset:10304
    v_mfma_f32_16x16x32_bf16 v[56:59], v[204:207], v[116:119], 0
    ds_read_b64_tr_b16 v[226:227], v192 offset:15424
    v_mfma_f32_16x16x32_bf16 v[60:63], v[204:207], v[120:123], 0
    ds_read_b64_tr_b16 v[228:229], v193 offset:10336
    v_mfma_f32_16x16x32_bf16 v[64:67], v[204:207], v[124:127], 0
    ds_read_b64_tr_b16 v[230:231], v193 offset:15456
    v_mfma_f32_16x16x32_bf16 v[68:71], v[204:207], v[128:131], 0
    v_mfma_f32_16x16x32_bf16 v[72:75], v[204:207], v[132:135], 0
    v_mfma_f32_16x16x32_bf16 v[76:79], v[208:211], v[116:119], 0
    v_mfma_f32_16x16x32_bf16 v[80:83], v[208:211], v[120:123], 0
    v_mfma_f32_16x16x32_bf16 v[84:87], v[208:211], v[124:127], 0
    v_mfma_f32_16x16x32_bf16 v[88:91], v[208:211], v[128:131], 0
    v_mfma_f32_16x16x32_bf16 v[92:95], v[208:211], v[132:135], 0
    s_waitcnt vmcnt(0) lgkmcnt(0)
    v_add_u32 v190, -61440, v190
    v_add_u32 v191, -61440, v191
    v_add_u32 v192, -61440, v192
    v_add_u32 v193, -61440, v193
    s_barrier
    s_getreg_b32 s3, hwreg(HW_REG_XCC_ID)
    s_and_b32 s3, s3, 7
    s_add_u32 s3, s3, 1
    s_add_u32 s3, s3, s66
    s_mov_b32 s62, 1
    v_readfirstlane_b32 s4, v176
    s_nop 0
    s_cmp_eq_u32 s4, s3
    s_cselect_b32 s62, s62, 0
    v_readfirstlane_b32 s4, v177
    s_nop 0
    s_cmp_eq_u32 s4, s3
    s_cselect_b32 s62, s62, 0
    v_readfirstlane_b32 s4, v178
    s_nop 0
    s_cmp_eq_u32 s4, s3
    s_cselect_b32 s62, s62, 0
    v_readfirstlane_b32 s4, v179
    s_nop 0
    s_cmp_eq_u32 s4, s3
    s_cselect_b32 s62, s62, 0
    s_cmp_lg_u32 s32, 3
    s_cbranch_scc1 KF_NW_42
KF_NW_42:
    s_and_b32 s61, s57, 3
    s_cmp_lg_u32 s32, 3
    s_cbranch_scc1 KF_SIG_43
    s_lshl_b32 s3, s47, 7
    s_lshl_b32 s4, s61, 2
    s_add_u32 s3, s3, s4
    v_mov_b32 v5, s3
    v_mov_b32 v6, s66
    v_cmp_eq_u32 vcc, 0, v1
    s_and_saveexec_b64 s[70:71], vcc
    s_cmp_eq_u32 s62, 1
    s_cbranch_scc0 KF_FL_44
    global_store_dword v5, v6, s[58:59]
    s_branch KF_FM_45
KF_FL_44:
    global_store_dword v5, v6, s[58:59] sc0 sc1
KF_FM_45:
    s_mov_b64 exec, s[70:71]
KF_SIG_43:
    s_lshr_b32 s3, s60, 1
    ds_read_b128 v[116:119], v190 offset:0
    v_mfma_f32_16x16x32_bf16 v[16:19], v[216:219], v[136:139], v[16:19]
    s_add_u32 s3, s3, s42
    ds_read_b128 v[120:123], v190 offset:2048
    v_mfma_f32_16x16x32_bf16 v[20:23], v[216:219], v[140:143], v[20:23]
    s_and_b32 s3, s3, 7
    ds_read_b128 v[124:127], v190 offset:4096
    v_mfma_f32_16x16x32_bf16 v[24:27], v[216:219], v[144:147], v[24:27]
    s_and_b32 s4, s60, 1
    ds_read_b128 v[128:131], v190 offset:6144
    v_mfma_f32_16x16x32_bf16 v[28:31], v[216:219], v[148:151], v[28:31]
    s_lshl_b32 s3, s3, 1
    ds_read_b128 v[132:135], v190 offset:8192
    v_mfma_f32_16x16x32_bf16 v[32:35], v[216:219], v[152:155], v[32:35]
    s_add_u32 s3, s3, s4
    ds_read_b64_tr_b16 v[196:197], v192 offset:0
    v_mfma_f32_16x16x32_bf16 v[36:39], v[220:223], v[136:139], v[36:39]
    s_mul_i32 s44, s3, 73728
    v_mfma_f32_16x16x32_bf16 v[40:43], v[220:223], v[140:143], v[40:43]
    ds_read_b64_tr_b16 v[198:199], v192 offset:5120
    s_cmp_lt_u32 s60, 16
    v_mfma_f32_16x16x32_bf16 v[44:47], v[220:223], v[144:147], v[44:47]
    s_cselect_b32 s10, s39, 0
    ds_read_b64_tr_b16 v[200:201], v193 offset:32
    v_mfma_f32_16x16x32_bf16 v[48:51], v[220:223], v[148:151], v[48:51]
    s_add_u32 s60, s60, 1
    ds_read_b64_tr_b16 v[202:203], v193 offset:5152
    s_add_u32 m0, s36, 61440
    v_mfma_f32_16x16x32_bf16 v[52:55], v[220:223], v[152:155], v[52:55]
    ds_read_b64_tr_b16 v[204:205], v192 offset:64
    s_nop 0
    v_mfma_f32_16x16x32_bf16 v[56:59], v[224:227], v[136:139], v[56:59]
    ds_read_b64_tr_b16 v[206:207], v192 offset:5184
    buffer_load_dwordx4 v240, s[8:11], s44 offen offset:0 lds
    v_mfma_f32_16x16x32_bf16 v[60:63], v[224:227], v[140:143], v[60:63]
    ds_read_b64_tr_b16 v[208:209], v193 offset:96
    buffer_load_dwordx4 v241, s[8:11], s44 offen offset:1024 lds
    v_mfma_f32_16x16x32_bf16 v[64:67], v[224:227], v[144:147], v[64:67]
    ds_read_b64_tr_b16 v[210:211], v193 offset:5216
    buffer_load_dwordx4 v242, s[8:11], s44 offen offset:2048 lds
    v_mfma_f32_16x16x32_bf16 v[68:71], v[224:227], v[148:151], v[68:71]
    buffer_load_dwordx4 v243, s[8:11], s44 offen offset:3072 lds
    v_mfma_f32_16x16x32_bf16 v[72:75], v[224:227], v[152:155], v[72:75]
    s_add_u32 m0, s36, 65536
    v_mfma_f32_16x16x32_bf16 v[76:79], v[228:231], v[136:139], v[76:79]
    s_nop 0
    v_mfma_f32_16x16x32_bf16 v[80:83], v[228:231], v[140:143], v[80:83]
    buffer_load_dwordx4 v253, s[8:11], s44 offen offset:0 lds
    v_mfma_f32_16x16x32_bf16 v[84:87], v[228:231], v[144:147], v[84:87]
    v_mfma_f32_16x16x32_bf16 v[88:91], v[228:231], v[148:151], v[88:91]
    v_mfma_f32_16x16x32_bf16 v[92:95], v[228:231], v[152:155], v[92:95]
    s_waitcnt lgkmcnt(0)
    ds_read_b128 v[136:139], v191 offset:0
    v_mfma_f32_16x16x32_bf16 v[16:19], v[196:199], v[116:119], v[16:19]
    ds_read_b128 v[140:143], v191 offset:2048
    v_mfma_f32_16x16x32_bf16 v[20:23], v[196:199], v[120:123], v[20:23]
    ds_read_b128 v[144:147], v191 offset:4096
    v_mfma_f32_16x16x32_bf16 v[24:27], v[196:199], v[124:127], v[24:27]
    ds_read_b128 v[148:151], v191 offset:6144
    v_mfma_f32_16x16x32_bf16 v[28:31], v[196:199], v[128:131], v[28:31]
    ds_read_b128 v[152:155], v191 offset:8192
    v_mfma_f32_16x16x32_bf16 v[32:35], v[196:199], v[132:135], v[32:35]
    ds_read_b64_tr_b16 v[216:217], v192 offset:10240
    v_mfma_f32_16x16x32_bf16 v[36:39], v[200:203], v[116:119], v[36:39]
    v_mfma_f32_16x16x32_bf16 v[40:43], v[200:203], v[120:123], v[40:43]
    ds_read_b64_tr_b16 v[218:219], v192 offset:15360
    v_mfma_f32_16x16x32_bf16 v[44:47], v[200:203], v[124:127], v[44:47]
    ds_read_b64_tr_b16 v[220:221], v193 offset:10272
    v_mfma_f32_16x16x32_bf16 v[48:51], v[200:203], v[128:131], v[48:51]
    ds_read_b64_tr_b16 v[222:223], v193 offset:15392
    v_mfma_f32_16x16x32_bf16 v[52:55], v[200:203], v[132:135], v[52:55]
    ds_read_b64_tr_b16 v[224:225], v192 offset:10304
    v_mfma_f32_16x16x32_bf16 v[56:59], v[204:207], v[116:119], v[56:59]
    ds_read_b64_tr_b16 v[226:227], v192 offset:15424
    v_mfma_f32_16x16x32_bf16 v[60:63], v[204:207], v[120:123], v[60:63]
    ds_read_b64_tr_b16 v[228:229], v193 offset:10336
    v_mfma_f32_16x16x32_bf16 v[64:67], v[204:207], v[124:127], v[64:67]
    ds_read_b64_tr_b16 v[230:231], v193 offset:15456
    v_mfma_f32_16x16x32_bf16 v[68:71], v[204:207], v[128:131], v[68:71]
    v_mfma_f32_16x16x32_bf16 v[72:75], v[204:207], v[132:135], v[72:75]
    v_mfma_f32_16x16x32_bf16 v[76:79], v[208:211], v[116:119], v[76:79]
    v_mfma_f32_16x16x32_bf16 v[80:83], v[208:211], v[120:123], v[80:83]
    v_mfma_f32_16x16x32_bf16 v[84:87], v[208:211], v[124:127], v[84:87]
    v_mfma_f32_16x16x32_bf16 v[88:91], v[208:211], v[128:131], v[88:91]
    v_mfma_f32_16x16x32_bf16 v[92:95], v[208:211], v[132:135], v[92:95]
    s_cmp_lg_u32 s32, 3
    s_cbranch_scc1 KF_PD_48
    s_and_b32 s3, s57, 3
    s_add_u32 s3, s3, 1
    s_and_b32 s3, s3, 3
    s_lshl_b32 s3, s3, 2
    s_lshl_b32 s4, s47, 7
    s_add_u32 s3, s3, s4
    v_mov_b32 v5, s3
    s_mov_b32 s65, 0
KF_PL_46:
    s_cmp_eq_u32 s62, 1
    s_cbranch_scc0 KF_PS_49
    global_load_dword v7, v5, s[58:59] sc1
    s_branch KF_PC_50
KF_PS_49:
    global_load_dword v7, v5, s[58:59] sc0 sc1
KF_PC_50:
    s_waitcnt vmcnt(0)
    v_readfirstlane_b32 s3, v7
    s_add_u32 s65, s65, 1
    s_cmp_eq_u32 s3, s66
    s_cbranch_scc1 KF_PX_47
    s_sleep 1
    s_cmp_lt_u32 s65, 0x8000
    s_cbranch_scc1 KF_PL_46
KF_PX_47:
    s_cmp_eq_u32 s62, 1
    s_cbranch_scc1 KF_PD_48
    buffer_inv sc1
    s_waitcnt vmcnt(0)
KF_PD_48:
    s_waitcnt lgkmcnt(0)
    v_add_u32 v190, 20480, v190
    v_add_u32 v191, 20480, v191
    v_add_u32 v192, 20480, v192
    v_add_u32 v193, 20480, v193
    s_barrier
    s_lshr_b32 s3, s41, 1
    ds_read_b128 v[116:119], v190 offset:0
    s_add_u32 s3, s3, s42
    v_mfma_f32_16x16x32_bf16 v[16:19], v[216:219], v[136:139], v[16:19]
    s_and_b32 s3, s3, 7
    s_and_b32 s4, s41, 1
    ds_read_b128 v[120:123], v190 offset:2048
    s_mul_i32 s43, s3, 40960
    v_mfma_f32_16x16x32_bf16 v[20:23], v[216:219], v[140:143], v[20:23]
    s_lshl_b32 s4, s4, 11
    s_add_u32 s43, s43, s4
    ds_read_b128 v[124:127], v190 offset:4096
    v_mfma_f32_16x16x32_bf16 v[24:27], v[216:219], v[144:147], v[24:27]
    s_cmp_lt_u32 s41, 16
    s_cselect_b32 s14, 327680, 0
    ds_read_b128 v[128:131], v190 offset:6144
    s_add_u32 s41, s41, 1
    v_mfma_f32_16x16x32_bf16 v[28:31], v[216:219], v[148:151], v[28:31]
    s_add_u32 m0, s37, 61440
    s_nop 0
    ds_read_b128 v[132:135], v190 offset:8192
    v_mfma_f32_16x16x32_bf16 v[32:35], v[216:219], v[152:155], v[32:35]
    buffer_load_dwordx4 v181, s[12:15], s43 offen lds
    s_add_u32 m0, s37, 62464
    ds_read_b64_tr_b16 v[196:197], v192 offset:0
    s_nop 0
    v_mfma_f32_16x16x32_bf16 v[36:39], v[220:223], v[136:139], v[36:39]
    buffer_load_dwordx4 v182, s[12:15], s43 offen lds
    s_add_u32 m0, s37, 63488
    v_mfma_f32_16x16x32_bf16 v[40:43], v[220:223], v[140:143], v[40:43]
    ds_read_b64_tr_b16 v[198:199], v192 offset:5120
    s_nop 0
    buffer_load_dwordx4 v183, s[12:15], s43 offen lds
    s_add_u32 m0, s37, 64512
    v_mfma_f32_16x16x32_bf16 v[44:47], v[220:223], v[144:147], v[44:47]
    ds_read_b64_tr_b16 v[200:201], v193 offset:32
    s_nop 0
    buffer_load_dwordx4 v184, s[12:15], s43 offen lds
    v_mfma_f32_16x16x32_bf16 v[48:51], v[220:223], v[148:151], v[48:51]
    ds_read_b64_tr_b16 v[202:203], v193 offset:5152
    s_add_u32 m0, s37, 65536
    s_nop 0
    v_mfma_f32_16x16x32_bf16 v[52:55], v[220:223], v[152:155], v[52:55]
    buffer_load_dwordx4 v185, s[12:15], s43 offen lds
    ds_read_b64_tr_b16 v[204:205], v192 offset:64
    s_lshr_b32 s3, s60, 1
    s_add_u32 s3, s3, s42
    v_mfma_f32_16x16x32_bf16 v[56:59], v[224:227], v[136:139], v[56:59]
    s_and_b32 s3, s3, 7
    ds_read_b64_tr_b16 v[206:207], v192 offset:5184
    s_and_b32 s4, s60, 1
    v_mfma_f32_16x16x32_bf16 v[60:63], v[224:227], v[140:143], v[60:63]
    s_lshl_b32 s3, s3, 1
    ds_read_b64_tr_b16 v[208:209], v193 offset:96
    s_add_u32 s3, s3, s4
    s_mul_i32 s44, s3, 73728
    v_mfma_f32_16x16x32_bf16 v[64:67], v[224:227], v[144:147], v[64:67]
    s_cmp_lt_u32 s60, 16
    ds_read_b64_tr_b16 v[210:211], v193 offset:5216
    s_cselect_b32 s10, s39, 0
    v_mfma_f32_16x16x32_bf16 v[68:71], v[224:227], v[148:151], v[68:71]
    s_add_u32 s60, s60, 1
    s_add_u32 m0, s36, 0
    s_nop 0
    v_mfma_f32_16x16x32_bf16 v[72:75], v[224:227], v[152:155], v[72:75]
    buffer_load_dwordx4 v240, s[8:11], s44 offen offset:0 lds
    buffer_load_dwordx4 v241, s[8:11], s44 offen offset:1024 lds
    v_mfma_f32_16x16x32_bf16 v[76:79], v[228:231], v[136:139], v[76:79]
    buffer_load_dwordx4 v242, s[8:11], s44 offen offset:2048 lds
    buffer_load_dwordx4 v243, s[8:11], s44 offen offset:3072 lds
    s_add_u32 m0, s36, 4096
    v_mfma_f32_16x16x32_bf16 v[80:83], v[228:231], v[140:143], v[80:83]
    s_nop 0
    buffer_load_dwordx4 v253, s[8:11], s44 offen offset:0 lds
    v_mfma_f32_16x16x32_bf16 v[84:87], v[228:231], v[144:147], v[84:87]
    v_mfma_f32_16x16x32_bf16 v[88:91], v[228:231], v[148:151], v[88:91]
    v_mfma_f32_16x16x32_bf16 v[92:95], v[228:231], v[152:155], v[92:95]
    s_waitcnt lgkmcnt(0)
    s_lshr_b32 s3, s41, 1
    ds_read_b128 v[136:139], v191 offset:0
    v_mfma_f32_16x16x32_bf16 v[16:19], v[196:199], v[116:119], v[16:19]
    s_add_u32 s3, s3, s42
    ds_read_b128 v[140:143], v191 offset:2048
    s_and_b32 s3, s3, 7
    v_mfma_f32_16x16x32_bf16 v[20:23], v[196:199], v[120:123], v[20:23]
    s_and_b32 s4, s41, 1
    ds_read_b128 v[144:147], v191 offset:4096
    v_mfma_f32_16x16x32_bf16 v[24:27], v[196:199], v[124:127], v[24:27]
    s_mul_i32 s43, s3, 40960
    ds_read_b128 v[148:151], v191 offset:6144
    s_lshl_b32 s4, s4, 11
    v_mfma_f32_16x16x32_bf16 v[28:31], v[196:199], v[128:131], v[28:31]
    s_add_u32 s43, s43, s4
    ds_read_b128 v[152:155], v191 offset:8192
    v_mfma_f32_16x16x32_bf16 v[32:35], v[196:199], v[132:135], v[32:35]
    s_cmp_lt_u32 s41, 16
    ds_read_b64_tr_b16 v[216:217], v192 offset:10240
    v_mfma_f32_16x16x32_bf16 v[36:39], v[200:203], v[116:119], v[36:39]
    s_cselect_b32 s14, 327680, 0
    s_add_u32 s41, s41, 1
    v_mfma_f32_16x16x32_bf16 v[40:43], v[200:203], v[120:123], v[40:43]
    ds_read_b64_tr_b16 v[218:219], v192 offset:15360
    s_add_u32 m0, s37, 0
    v_mfma_f32_16x16x32_bf16 v[44:47], v[200:203], v[124:127], v[44:47]
    ds_read_b64_tr_b16 v[220:221], v193 offset:10272
    s_nop 0
    v_mfma_f32_16x16x32_bf16 v[48:51], v[200:203], v[128:131], v[48:51]
    buffer_load_dwordx4 v181, s[12:15], s43 offen lds
    ds_read_b64_tr_b16 v[222:223], v193 offset:15392
    s_add_u32 m0, s37, 1024
    v_mfma_f32_16x16x32_bf16 v[52:55], v[200:203], v[132:135], v[52:55]
    ds_read_b64_tr_b16 v[224:225], v192 offset:10304
    s_nop 0
    v_mfma_f32_16x16x32_bf16 v[56:59], v[204:207], v[116:119], v[56:59]
    buffer_load_dwordx4 v182, s[12:15], s43 offen lds
    ds_read_b64_tr_b16 v[226:227], v192 offset:15424
    s_add_u32 m0, s37, 2048
    v_mfma_f32_16x16x32_bf16 v[60:63], v[204:207], v[120:123], v[60:63]
    ds_read_b64_tr_b16 v[228:229], v193 offset:10336
    s_nop 0
    v_mfma_f32_16x16x32_bf16 v[64:67], v[204:207], v[124:127], v[64:67]
    buffer_load_dwordx4 v183, s[12:15], s43 offen lds
    ds_read_b64_tr_b16 v[230:231], v193 offset:15456
    v_mfma_f32_16x16x32_bf16 v[68:71], v[204:207], v[128:131], v[68:71]
    s_add_u32 m0, s37, 3072
    s_nop 0
    v_mfma_f32_16x16x32_bf16 v[72:75], v[204:207], v[132:135], v[72:75]
    buffer_load_dwordx4 v184, s[12:15], s43 offen lds
    v_mfma_f32_16x16x32_bf16 v[76:79], v[208:211], v[116:119], v[76:79]
    s_add_u32 m0, s37, 4096
    s_nop 0
    v_mfma_f32_16x16x32_bf16 v[80:83], v[208:211], v[120:123], v[80:83]
    buffer_load_dwordx4 v185, s[12:15], s43 offen lds
    v_mfma_f32_16x16x32_bf16 v[84:87], v[208:211], v[124:127], v[84:87]
    v_mfma_f32_16x16x32_bf16 v[88:91], v[208:211], v[128:131], v[88:91]
    v_mfma_f32_16x16x32_bf16 v[92:95], v[208:211], v[132:135], v[92:95]
    s_waitcnt lgkmcnt(0)
    v_add_u32 v190, 20480, v190
    v_add_u32 v191, 20480, v191
    v_add_u32 v192, 20480, v192
    v_add_u32 v193, 20480, v193
    s_barrier
    s_lshr_b32 s3, s60, 1
    ds_read_b128 v[116:119], v190 offset:0
    v_mfma_f32_16x16x32_bf16 v[16:19], v[216:219], v[136:139], v[16:19]
    s_add_u32 s3, s3, s42
    ds_read_b128 v[120:123], v190 offset:2048
    v_mfma_f32_16x16x32_bf16 v[20:23], v[216:219], v[140:143], v[20:23]
    s_and_b32 s3, s3, 7
    ds_read_b128 v[124:127], v190 offset:4096
    v_mfma_f32_16x16x32_bf16 v[24:27], v[216:219], v[144:147], v[24:27]
    s_and_b32 s4, s60, 1
    ds_read_b128 v[128:131], v190 offset:6144
    v_mfma_f32_16x16x32_bf16 v[28:31], v[216:219], v[148:151], v[28:31]
    s_lshl_b32 s3, s3, 1
    ds_read_b128 v[132:135], v190 offset:8192
    v_mfma_f32_16x16x32_bf16 v[32:35], v[216:219], v[152:155], v[32:35]
    s_add_u32 s3, s3, s4
    ds_read_b64_tr_b16 v[196:197], v192 offset:0
    v_mfma_f32_16x16x32_bf16 v[36:39], v[220:223], v[136:139], v[36:39]
    s_mul_i32 s44, s3, 73728
    v_mfma_f32_16x16x32_bf16 v[40:43], v[220:223], v[140:143], v[40:43]
    ds_read_b64_tr_b16 v[198:199], v192 offset:5120
    s_cmp_lt_u32 s60, 16
    v_mfma_f32_16x16x32_bf16 v[44:47], v[220:223], v[144:147], v[44:47]
    s_cselect_b32 s10, s39, 0
    ds_read_b64_tr_b16 v[200:201], v193 offset:32
    v_mfma_f32_16x16x32_bf16 v[48:51], v[220:223], v[148:151], v[48:51]
    s_add_u32 s60, s60, 1
    ds_read_b64_tr_b16 v[202:203], v193 offset:5152
    s_add_u32 m0, s36, 20480
    v_mfma_f32_16x16x32_bf16 v[52:55], v[220:223], v[152:155], v[52:55]
    ds_read_b64_tr_b16 v[204:205], v192 offset:64
    s_nop 0
    v_mfma_f32_16x16x32_bf16 v[56:59], v[224:227], v[136:139], v[56:59]
    ds_read_b64_tr_b16 v[206:207], v192 offset:5184
    buffer_load_dwordx4 v240, s[8:11], s44 offen offset:0 lds
    v_mfma_f32_16x16x32_bf16 v[60:63], v[224:227], v[140:143], v[60:63]
    ds_read_b64_tr_b16 v[208:209], v193 offset:96
    buffer_load_dwordx4 v241, s[8:11], s44 offen offset:1024 lds
    v_mfma_f32_16x16x32_bf16 v[64:67], v[224:227], v[144:147], v[64:67]
    ds_read_b64_tr_b16 v[210:211], v193 offset:5216
    buffer_load_dwordx4 v242, s[8:11], s44 offen offset:2048 lds
    v_mfma_f32_16x16x32_bf16 v[68:71], v[224:227], v[148:151], v[68:71]
    buffer_load_dwordx4 v243, s[8:11], s44 offen offset:3072 lds
    v_mfma_f32_16x16x32_bf16 v[72:75], v[224:227], v[152:155], v[72:75]
    s_add_u32 m0, s36, 24576
    v_mfma_f32_16x16x32_bf16 v[76:79], v[228:231], v[136:139], v[76:79]
    s_nop 0
    v_mfma_f32_16x16x32_bf16 v[80:83], v[228:231], v[140:143], v[80:83]
    buffer_load_dwordx4 v253, s[8:11], s44 offen offset:0 lds
    v_mfma_f32_16x16x32_bf16 v[84:87], v[228:231], v[144:147], v[84:87]
    v_mfma_f32_16x16x32_bf16 v[88:91], v[228:231], v[148:151], v[88:91]
    v_mfma_f32_16x16x32_bf16 v[92:95], v[228:231], v[152:155], v[92:95]
    s_waitcnt lgkmcnt(0)
    s_lshr_b32 s3, s41, 1
    ds_read_b128 v[136:139], v191 offset:0
    v_mfma_f32_16x16x32_bf16 v[16:19], v[196:199], v[116:119], v[16:19]
    s_add_u32 s3, s3, s42
    ds_read_b128 v[140:143], v191 offset:2048
    s_and_b32 s3, s3, 7
    v_mfma_f32_16x16x32_bf16 v[20:23], v[196:199], v[120:123], v[20:23]
    s_and_b32 s4, s41, 1
    ds_read_b128 v[144:147], v191 offset:4096
    v_mfma_f32_16x16x32_bf16 v[24:27], v[196:199], v[124:127], v[24:27]
    s_mul_i32 s43, s3, 40960
    ds_read_b128 v[148:151], v191 offset:6144
    s_lshl_b32 s4, s4, 11
    v_mfma_f32_16x16x32_bf16 v[28:31], v[196:199], v[128:131], v[28:31]
    s_add_u32 s43, s43, s4
    ds_read_b128 v[152:155], v191 offset:8192
    v_mfma_f32_16x16x32_bf16 v[32:35], v[196:199], v[132:135], v[32:35]
    s_cmp_lt_u32 s41, 16
    ds_read_b64_tr_b16 v[216:217], v192 offset:10240
    v_mfma_f32_16x16x32_bf16 v[36:39], v[200:203], v[116:119], v[36:39]
    s_cselect_b32 s14, 327680, 0
    s_add_u32 s41, s41, 1
    v_mfma_f32_16x16x32_bf16 v[40:43], v[200:203], v[120:123], v[40:43]
    ds_read_b64_tr_b16 v[218:219], v192 offset:15360
    s_add_u32 m0, s37, 20480
    v_mfma_f32_16x16x32_bf16 v[44:47], v[200:203], v[124:127], v[44:47]
    ds_read_b64_tr_b16 v[220:221], v193 offset:10272
    s_nop 0
    v_mfma_f32_16x16x32_bf16 v[48:51], v[200:203], v[128:131], v[48:51]
    buffer_load_dwordx4 v181, s[12:15], s43 offen lds
    ds_read_b64_tr_b16 v[222:223], v193 offset:15392
    s_add_u32 m0, s37, 21504
    v_mfma_f32_16x16x32_bf16 v[52:55], v[200:203], v[132:135], v[52:55]
    ds_read_b64_tr_b16 v[224:225], v192 offset:10304
    s_nop 0
    v_mfma_f32_16x16x32_bf16 v[56:59], v[204:207], v[116:119], v[56:59]
    buffer_load_dwordx4 v182, s[12:15], s43 offen lds
    ds_read_b64_tr_b16 v[226:227], v192 offset:15424
    s_add_u32 m0, s37, 22528
    v_mfma_f32_16x16x32_bf16 v[60:63], v[204:207], v[120:123], v[60:63]
    ds_read_b64_tr_b16 v[228:229], v193 offset:10336
    s_nop 0
    v_mfma_f32_16x16x32_bf16 v[64:67], v[204:207], v[124:127], v[64:67]
    buffer_load_dwordx4 v183, s[12:15], s43 offen lds
    ds_read_b64_tr_b16 v[230:231], v193 offset:15456
    v_mfma_f32_16x16x32_bf16 v[68:71], v[204:207], v[128:131], v[68:71]
    s_add_u32 m0, s37, 23552
    s_nop 0
    v_mfma_f32_16x16x32_bf16 v[72:75], v[204:207], v[132:135], v[72:75]
    buffer_load_dwordx4 v184, s[12:15], s43 offen lds
    v_mfma_f32_16x16x32_bf16 v[76:79], v[208:211], v[116:119], v[76:79]
    s_add_u32 m0, s37, 24576
    s_nop 0
    v_mfma_f32_16x16x32_bf16 v[80:83], v[208:211], v[120:123], v[80:83]
    buffer_load_dwordx4 v185, s[12:15], s43 offen lds
    v_mfma_f32_16x16x32_bf16 v[84:87], v[208:211], v[124:127], v[84:87]
    v_mfma_f32_16x16x32_bf16 v[88:91], v[208:211], v[128:131], v[88:91]
    v_mfma_f32_16x16x32_bf16 v[92:95], v[208:211], v[132:135], v[92:95]
    s_waitcnt vmcnt(20) lgkmcnt(0)
    v_add_u32 v190, 20480, v190
    v_add_u32 v191, 20480, v191
    v_add_u32 v192, 20480, v192
    v_add_u32 v193, 20480, v193
    s_barrier
    s_lshr_b32 s3, s60, 1
    ds_read_b128 v[116:119], v190 offset:0
    v_mfma_f32_16x16x32_bf16 v[16:19], v[216:219], v[136:139], v[16:19]
    s_add_u32 s3, s3, s42
    ds_read_b128 v[120:123], v190 offset:2048
    v_mfma_f32_16x16x32_bf16 v[20:23], v[216:219], v[140:143], v[20:23]
    s_and_b32 s3, s3, 7
    ds_read_b128 v[124:127], v190 offset:4096
    v_mfma_f32_16x16x32_bf16 v[24:27], v[216:219], v[144:147], v[24:27]
    s_and_b32 s4, s60, 1
    ds_read_b128 v[128:131], v190 offset:6144
    v_mfma_f32_16x16x32_bf16 v[28:31], v[216:219], v[148:151], v[28:31]
    s_lshl_b32 s3, s3, 1
    ds_read_b128 v[132:135], v190 offset:8192
    v_mfma_f32_16x16x32_bf16 v[32:35], v[216:219], v[152:155], v[32:35]
    s_add_u32 s3, s3, s4
    ds_read_b64_tr_b16 v[196:197], v192 offset:0
    v_mfma_f32_16x16x32_bf16 v[36:39], v[220:223], v[136:139], v[36:39]
    s_mul_i32 s44, s3, 73728
    v_mfma_f32_16x16x32_bf16 v[40:43], v[220:223], v[140:143], v[40:43]
    ds_read_b64_tr_b16 v[198:199], v192 offset:5120
    s_cmp_lt_u32 s60, 16
    v_mfma_f32_16x16x32_bf16 v[44:47], v[220:223], v[144:147], v[44:47]
    s_cselect_b32 s10, s39, 0
    ds_read_b64_tr_b16 v[200:201], v193 offset:32
    v_mfma_f32_16x16x32_bf16 v[48:51], v[220:223], v[148:151], v[48:51]
    s_add_u32 s60, s60, 1
    ds_read_b64_tr_b16 v[202:203], v193 offset:5152
    s_add_u32 m0, s36, 40960
    v_mfma_f32_16x16x32_bf16 v[52:55], v[220:223], v[152:155], v[52:55]
    ds_read_b64_tr_b16 v[204:205], v192 offset:64
    s_nop 0
    v_mfma_f32_16x16x32_bf16 v[56:59], v[224:227], v[136:139], v[56:59]
    ds_read_b64_tr_b16 v[206:207], v192 offset:5184
    buffer_load_dwordx4 v240, s[8:11], s44 offen offset:0 lds
    v_mfma_f32_16x16x32_bf16 v[60:63], v[224:227], v[140:143], v[60:63]
    ds_read_b64_tr_b16 v[208:209], v193 offset:96
    buffer_load_dwordx4 v241, s[8:11], s44 offen offset:1024 lds
    v_mfma_f32_16x16x32_bf16 v[64:67], v[224:227], v[144:147], v[64:67]
    ds_read_b64_tr_b16 v[210:211], v193 offset:5216
    buffer_load_dwordx4 v242, s[8:11], s44 offen offset:2048 lds
    v_mfma_f32_16x16x32_bf16 v[68:71], v[224:227], v[148:151], v[68:71]
    buffer_load_dwordx4 v243, s[8:11], s44 offen offset:3072 lds
    v_mfma_f32_16x16x32_bf16 v[72:75], v[224:227], v[152:155], v[72:75]
    s_add_u32 m0, s36, 45056
    v_mfma_f32_16x16x32_bf16 v[76:79], v[228:231], v[136:139], v[76:79]
    s_nop 0
    v_mfma_f32_16x16x32_bf16 v[80:83], v[228:231], v[140:143], v[80:83]
    buffer_load_dwordx4 v253, s[8:11], s44 offen offset:0 lds
    v_mfma_f32_16x16x32_bf16 v[84:87], v[228:231], v[144:147], v[84:87]
    v_mfma_f32_16x16x32_bf16 v[88:91], v[228:231], v[148:151], v[88:91]
    v_mfma_f32_16x16x32_bf16 v[92:95], v[228:231], v[152:155], v[92:95]
    s_mov_b32 s45, 0
KF_L1:
    s_waitcnt lgkmcnt(0)
    s_lshr_b32 s3, s41, 1
    ds_read_b128 v[136:139], v191 offset:0
    v_mfma_f32_16x16x32_bf16 v[16:19], v[196:199], v[116:119], v[16:19]
    s_add_u32 s3, s3, s42
    ds_read_b128 v[140:143], v191 offset:2048
    s_and_b32 s3, s3, 7
    v_mfma_f32_16x16x32_bf16 v[20:23], v[196:199], v[120:123], v[20:23]
    s_and_b32 s4, s41, 1
    ds_read_b128 v[144:147], v191 offset:4096
    v_mfma_f32_16x16x32_bf16 v[24:27], v[196:199], v[124:127], v[24:27]
    s_mul_i32 s43, s3, 40960
    ds_read_b128 v[148:151], v191 offset:6144
    s_lshl_b32 s4, s4, 11
    v_mfma_f32_16x16x32_bf16 v[28:31], v[196:199], v[128:131], v[28:31]
    s_add_u32 s43, s43, s4
    ds_read_b128 v[152:155], v191 offset:8192
    v_mfma_f32_16x16x32_bf16 v[32:35], v[196:199], v[132:135], v[32:35]
    s_cmp_lt_u32 s41, 16
    ds_read_b64_tr_b16 v[216:217], v192 offset:10240
    v_mfma_f32_16x16x32_bf16 v[36:39], v[200:203], v[116:119], v[36:39]
    s_cselect_b32 s14, 327680, 0
    s_add_u32 s41, s41, 1
    v_mfma_f32_16x16x32_bf16 v[40:43], v[200:203], v[120:123], v[40:43]
    ds_read_b64_tr_b16 v[218:219], v192 offset:15360
    s_add_u32 m0, s37, 40960
    v_mfma_f32_16x16x32_bf16 v[44:47], v[200:203], v[124:127], v[44:47]
    ds_read_b64_tr_b16 v[220:221], v193 offset:10272
    s_nop 0
    v_mfma_f32_16x16x32_bf16 v[48:51], v[200:203], v[128:131], v[48:51]
    buffer_load_dwordx4 v181, s[12:15], s43 offen lds
    ds_read_b64_tr_b16 v[222:223], v193 offset:15392
    s_add_u32 m0, s37, 41984
    v_mfma_f32_16x16x32_bf16 v[52:55], v[200:203], v[132:135], v[52:55]
    ds_read_b64_tr_b16 v[224:225], v192 offset:10304
    s_nop 0
    v_mfma_f32_16x16x32_bf16 v[56:59], v[204:207], v[116:119], v[56:59]
    buffer_load_dwordx4 v182, s[12:15], s43 offen lds
    ds_read_b64_tr_b16 v[226:227], v192 offset:15424
    s_add_u32 m0, s37, 43008
    v_mfma_f32_16x16x32_bf16 v[60:63], v[204:207], v[120:123], v[60:63]
    ds_read_b64_tr_b16 v[228:229], v193 offset:10336
    s_nop 0
    v_mfma_f32_16x16x32_bf16 v[64:67], v[204:207], v[124:127], v[64:67]
    buffer_load_dwordx4 v183, s[12:15], s43 offen lds
    ds_read_b64_tr_b16 v[230:231], v193 offset:15456
    v_mfma_f32_16x16x32_bf16 v[68:71], v[204:207], v[128:131], v[68:71]
    s_add_u32 m0, s37, 44032
    s_nop 0
    v_mfma_f32_16x16x32_bf16 v[72:75], v[204:207], v[132:135], v[72:75]
    buffer_load_dwordx4 v184, s[12:15], s43 offen lds
    v_mfma_f32_16x16x32_bf16 v[76:79], v[208:211], v[116:119], v[76:79]
    s_add_u32 m0, s37, 45056
    s_nop 0
    v_mfma_f32_16x16x32_bf16 v[80:83], v[208:211], v[120:123], v[80:83]
    buffer_load_dwordx4 v185, s[12:15], s43 offen lds
    v_mfma_f32_16x16x32_bf16 v[84:87], v[208:211], v[124:127], v[84:87]
    v_mfma_f32_16x16x32_bf16 v[88:91], v[208:211], v[128:131], v[88:91]
    v_mfma_f32_16x16x32_bf16 v[92:95], v[208:211], v[132:135], v[92:95]
    s_cmp_eq_u32 s45, 0
    s_cbranch_scc0 KF_WN_51a
    s_cmp_lg_u32 s32, 3
    s_cbranch_scc1 KF_PD_54
    s_and_b32 s3, s57, 3
    s_add_u32 s3, s3, 2
    s_and_b32 s3, s3, 3
    s_lshl_b32 s3, s3, 2
    s_lshl_b32 s4, s47, 7
    s_add_u32 s3, s3, s4
    v_mov_b32 v5, s3
    s_mov_b32 s65, 0
KF_PL_52:
    s_cmp_eq_u32 s62, 1
    s_cbranch_scc0 KF_PS_55
    global_load_dword v7, v5, s[58:59] sc1
    s_branch KF_PC_56
KF_PS_55:
    global_load_dword v7, v5, s[58:59] sc0 sc1
KF_PC_56:
    s_waitcnt vmcnt(0)
    v_readfirstlane_b32 s3, v7
    s_add_u32 s65, s65, 1
    s_cmp_eq_u32 s3, s66
    s_cbranch_scc1 KF_PX_53
    s_sleep 1
    s_cmp_lt_u32 s65, 0x8000
    s_cbranch_scc1 KF_PL_52
KF_PX_53:
    s_cmp_eq_u32 s62, 1
    s_cbranch_scc1 KF_PD_54
    buffer_inv sc1
    s_waitcnt vmcnt(0)
KF_PD_54:
    s_branch KF_WN_51
KF_WN_51a:
    s_cmp_eq_u32 s45, 1
    s_cbranch_scc0 KF_WN_51
    s_cmp_lg_u32 s32, 3
    s_cbranch_scc1 KF_PD_59
    s_and_b32 s3, s57, 3
    s_add_u32 s3, s3, 3
    s_and_b32 s3, s3, 3
    s_lshl_b32 s3, s3, 2
    s_lshl_b32 s4, s47, 7
    s_add_u32 s3, s3, s4
    v_mov_b32 v5, s3
    s_mov_b32 s65, 0
KF_PL_57:
    s_cmp_eq_u32 s62, 1
    s_cbranch_scc0 KF_PS_60
    global_load_dword v7, v5, s[58:59] sc1
    s_branch KF_PC_61
KF_PS_60:
    global_load_dword v7, v5, s[58:59] sc0 sc1
KF_PC_61:
    s_waitcnt vmcnt(0)
    v_readfirstlane_b32 s3, v7
    s_add_u32 s65, s65, 1
    s_cmp_eq_u32 s3, s66
    s_cbranch_scc1 KF_PX_58
    s_sleep 1
    s_cmp_lt_u32 s65, 0x8000
    s_cbranch_scc1 KF_PL_57
KF_PX_58:
    s_cmp_eq_u32 s62, 1
    s_cbranch_scc1 KF_PD_59
    buffer_inv sc1
    s_waitcnt vmcnt(0)
KF_PD_59:
KF_WN_51:
    s_waitcnt vmcnt(20) lgkmcnt(0)
    v_add_u32 v190, -61440, v190
    v_add_u32 v191, -61440, v191
    v_add_u32 v192, -61440, v192
    v_add_u32 v193, -61440, v193
    s_barrier
    s_lshr_b32 s3, s60, 1
    ds_read_b128 v[116:119], v190 offset:0
    v_mfma_f32_16x16x32_bf16 v[16:19], v[216:219], v[136:139], v[16:19]
    s_add_u32 s3, s3, s42
    ds_read_b128 v[120:123], v190 offset:2048
    v_mfma_f32_16x16x32_bf16 v[20:23], v[216:219], v[140:143], v[20:23]
    s_and_b32 s3, s3, 7
    ds_read_b128 v[124:127], v190 offset:4096
    v_mfma_f32_16x16x32_bf16 v[24:27], v[216:219], v[144:147], v[24:27]
    s_and_b32 s4, s60, 1
    ds_read_b128 v[128:131], v190 offset:6144
    v_mfma_f32_16x16x32_bf16 v[28:31], v[216:219], v[148:151], v[28:31]
    s_lshl_b32 s3, s3, 1
    ds_read_b128 v[132:135], v190 offset:8192
    v_mfma_f32_16x16x32_bf16 v[32:35], v[216:219], v[152:155], v[32:35]
    s_add_u32 s3, s3, s4
    ds_read_b64_tr_b16 v[196:197], v192 offset:0
    v_mfma_f32_16x16x32_bf16 v[36:39], v[220:223], v[136:139], v[36:39]
    s_mul_i32 s44, s3, 73728
    v_mfma_f32_16x16x32_bf16 v[40:43], v[220:223], v[140:143], v[40:43]
    ds_read_b64_tr_b16 v[198:199], v192 offset:5120
    s_cmp_lt_u32 s60, 16
    v_mfma_f32_16x16x32_bf16 v[44:47], v[220:223], v[144:147], v[44:47]
    s_cselect_b32 s10, s39, 0
    ds_read_b64_tr_b16 v[200:201], v193 offset:32
    v_mfma_f32_16x16x32_bf16 v[48:51], v[220:223], v[148:151], v[48:51]
    s_add_u32 s60, s60, 1
    ds_read_b64_tr_b16 v[202:203], v193 offset:5152
    s_add_u32 m0, s36, 61440
    v_mfma_f32_16x16x32_bf16 v[52:55], v[220:223], v[152:155], v[52:55]
    ds_read_b64_tr_b16 v[204:205], v192 offset:64
    s_nop 0
    v_mfma_f32_16x16x32_bf16 v[56:59], v[224:227], v[136:139], v[56:59]
    ds_read_b64_tr_b16 v[206:207], v192 offset:5184
    buffer_load_dwordx4 v240, s[8:11], s44 offen offset:0 lds
    v_mfma_f32_16x16x32_bf16 v[60:63], v[224:227], v[140:143], v[60:63]
    ds_read_b64_tr_b16 v[208:209], v193 offset:96
    buffer_load_dwordx4 v241, s[8:11], s44 offen offset:1024 lds
    v_mfma_f32_16x16x32_bf16 v[64:67], v[224:227], v[144:147], v[64:67]
    ds_read_b64_tr_b16 v[210:211], v193 offset:5216
    buffer_load_dwordx4 v242, s[8:11], s44 offen offset:2048 lds
    v_mfma_f32_16x16x32_bf16 v[68:71], v[224:227], v[148:151], v[68:71]
    buffer_load_dwordx4 v243, s[8:11], s44 offen offset:3072 lds
    v_mfma_f32_16x16x32_bf16 v[72:75], v[224:227], v[152:155], v[72:75]
    s_add_u32 m0, s36, 65536
    v_mfma_f32_16x16x32_bf16 v[76:79], v[228:231], v[136:139], v[76:79]
    s_nop 0
    v_mfma_f32_16x16x32_bf16 v[80:83], v[228:231], v[140:143], v[80:83]
    buffer_load_dwordx4 v253, s[8:11], s44 offen offset:0 lds
    v_mfma_f32_16x16x32_bf16 v[84:87], v[228:231], v[144:147], v[84:87]
    v_mfma_f32_16x16x32_bf16 v[88:91], v[228:231], v[148:151], v[88:91]
    v_mfma_f32_16x16x32_bf16 v[92:95], v[228:231], v[152:155], v[92:95]
    s_waitcnt lgkmcnt(0)
    s_lshr_b32 s3, s41, 1
    ds_read_b128 v[136:139], v191 offset:0
    v_mfma_f32_16x16x32_bf16 v[16:19], v[196:199], v[116:119], v[16:19]
    s_add_u32 s3, s3, s42
    ds_read_b128 v[140:143], v191 offset:2048
    s_and_b32 s3, s3, 7
    v_mfma_f32_16x16x32_bf16 v[20:23], v[196:199], v[120:123], v[20:23]
    s_and_b32 s4, s41, 1
    ds_read_b128 v[144:147], v191 offset:4096
    v_mfma_f32_16x16x32_bf16 v[24:27], v[196:199], v[124:127], v[24:27]
    s_mul_i32 s43, s3, 40960
    ds_read_b128 v[148:151], v191 offset:6144
    s_lshl_b32 s4, s4, 11
    v_mfma_f32_16x16x32_bf16 v[28:31], v[196:199], v[128:131], v[28:31]
    s_add_u32 s43, s43, s4
    ds_read_b128 v[152:155], v191 offset:8192
    v_mfma_f32_16x16x32_bf16 v[32:35], v[196:199], v[132:135], v[32:35]
    s_cmp_lt_u32 s41, 16
    ds_read_b64_tr_b16 v[216:217], v192 offset:10240
    v_mfma_f32_16x16x32_bf16 v[36:39], v[200:203], v[116:119], v[36:39]
    s_cselect_b32 s14, 327680, 0
    s_add_u32 s41, s41, 1
    v_mfma_f32_16x16x32_bf16 v[40:43], v[200:203], v[120:123], v[40:43]
    ds_read_b64_tr_b16 v[218:219], v192 offset:15360
    s_add_u32 m0, s37, 61440
    v_mfma_f32_16x16x32_bf16 v[44:47], v[200:203], v[124:127], v[44:47]
    ds_read_b64_tr_b16 v[220:221], v193 offset:10272
    s_nop 0
    v_mfma_f32_16x16x32_bf16 v[48:51], v[200:203], v[128:131], v[48:51]
    buffer_load_dwordx4 v181, s[12:15], s43 offen lds
    ds_read_b64_tr_b16 v[222:223], v193 offset:15392
    s_add_u32 m0, s37, 62464
    v_mfma_f32_16x16x32_bf16 v[52:55], v[200:203], v[132:135], v[52:55]
    ds_read_b64_tr_b16 v[224:225], v192 offset:10304
    s_nop 0
    v_mfma_f32_16x16x32_bf16 v[56:59], v[204:207], v[116:119], v[56:59]
    buffer_load_dwordx4 v182, s[12:15], s43 offen lds
    ds_read_b64_tr_b16 v[226:227], v192 offset:15424
    s_add_u32 m0, s37, 63488
    v_mfma_f32_16x16x32_bf16 v[60:63], v[204:207], v[120:123], v[60:63]
    ds_read_b64_tr_b16 v[228:229], v193 offset:10336
    s_nop 0
    v_mfma_f32_16x16x32_bf16 v[64:67], v[204:207], v[124:127], v[64:67]
    buffer_load_dwordx4 v183, s[12:15], s43 offen lds
    ds_read_b64_tr_b16 v[230:231], v193 offset:15456
    v_mfma_f32_16x16x32_bf16 v[68:71], v[204:207], v[128:131], v[68:71]
    s_add_u32 m0, s37, 64512
    s_nop 0
    v_mfma_f32_16x16x32_bf16 v[72:75], v[204:207], v[132:135], v[72:75]
    buffer_load_dwordx4 v184, s[12:15], s43 offen lds
    v_mfma_f32_16x16x32_bf16 v[76:79], v[208:211], v[116:119], v[76:79]
    s_add_u32 m0, s37, 65536
    s_nop 0
    v_mfma_f32_16x16x32_bf16 v[80:83], v[208:211], v[120:123], v[80:83]
    buffer_load_dwordx4 v185, s[12:15], s43 offen lds
    v_mfma_f32_16x16x32_bf16 v[84:87], v[208:211], v[124:127], v[84:87]
    v_mfma_f32_16x16x32_bf16 v[88:91], v[208:211], v[128:131], v[88:91]
    v_mfma_f32_16x16x32_bf16 v[92:95], v[208:211], v[132:135], v[92:95]
    s_waitcnt vmcnt(20) lgkmcnt(0)
    v_add_u32 v190, 20480, v190
    v_add_u32 v191, 20480, v191
    v_add_u32 v192, 20480, v192
    v_add_u32 v193, 20480, v193
    s_barrier
    s_lshr_b32 s3, s60, 1
    ds_read_b128 v[116:119], v190 offset:0
    v_mfma_f32_16x16x32_bf16 v[16:19], v[216:219], v[136:139], v[16:19]
    s_add_u32 s3, s3, s42
    ds_read_b128 v[120:123], v190 offset:2048
    v_mfma_f32_16x16x32_bf16 v[20:23], v[216:219], v[140:143], v[20:23]
    s_and_b32 s3, s3, 7
    ds_read_b128 v[124:127], v190 offset:4096
    v_mfma_f32_16x16x32_bf16 v[24:27], v[216:219], v[144:147], v[24:27]
    s_and_b32 s4, s60, 1
    ds_read_b128 v[128:131], v190 offset:6144
    v_mfma_f32_16x16x32_bf16 v[28:31], v[216:219], v[148:151], v[28:31]
    s_lshl_b32 s3, s3, 1
    ds_read_b128 v[132:135], v190 offset:8192
    v_mfma_f32_16x16x32_bf16 v[32:35], v[216:219], v[152:155], v[32:35]
    s_add_u32 s3, s3, s4
    ds_read_b64_tr_b16 v[196:197], v192 offset:0
    v_mfma_f32_16x16x32_bf16 v[36:39], v[220:223], v[136:139], v[36:39]
    s_mul_i32 s44, s3, 73728
    v_mfma_f32_16x16x32_bf16 v[40:43], v[220:223], v[140:143], v[40:43]
    ds_read_b64_tr_b16 v[198:199], v192 offset:5120
    s_cmp_lt_u32 s60, 16
    v_mfma_f32_16x16x32_bf16 v[44:47], v[220:223], v[144:147], v[44:47]
    s_cselect_b32 s10, s39, 0
    ds_read_b64_tr_b16 v[200:201], v193 offset:32
    v_mfma_f32_16x16x32_bf16 v[48:51], v[220:223], v[148:151], v[48:51]
    s_add_u32 s60, s60, 1
    ds_read_b64_tr_b16 v[202:203], v193 offset:5152
    s_add_u32 m0, s36, 0
    v_mfma_f32_16x16x32_bf16 v[52:55], v[220:223], v[152:155], v[52:55]
    ds_read_b64_tr_b16 v[204:205], v192 offset:64
    s_nop 0
    v_mfma_f32_16x16x32_bf16 v[56:59], v[224:227], v[136:139], v[56:59]
    ds_read_b64_tr_b16 v[206:207], v192 offset:5184
    buffer_load_dwordx4 v240, s[8:11], s44 offen offset:0 lds
    v_mfma_f32_16x16x32_bf16 v[60:63], v[224:227], v[140:143], v[60:63]
    ds_read_b64_tr_b16 v[208:209], v193 offset:96
    buffer_load_dwordx4 v241, s[8:11], s44 offen offset:1024 lds
    v_mfma_f32_16x16x32_bf16 v[64:67], v[224:227], v[144:147], v[64:67]
    ds_read_b64_tr_b16 v[210:211], v193 offset:5216
    buffer_load_dwordx4 v242, s[8:11], s44 offen offset:2048 lds
    v_mfma_f32_16x16x32_bf16 v[68:71], v[224:227], v[148:151], v[68:71]
    buffer_load_dwordx4 v243, s[8:11], s44 offen offset:3072 lds
    v_mfma_f32_16x16x32_bf16 v[72:75], v[224:227], v[152:155], v[72:75]
    s_add_u32 m0, s36, 4096
    v_mfma_f32_16x16x32_bf16 v[76:79], v[228:231], v[136:139], v[76:79]
    s_nop 0
    v_mfma_f32_16x16x32_bf16 v[80:83], v[228:231], v[140:143], v[80:83]
    buffer_load_dwordx4 v253, s[8:11], s44 offen offset:0 lds
    v_mfma_f32_16x16x32_bf16 v[84:87], v[228:231], v[144:147], v[84:87]
    v_mfma_f32_16x16x32_bf16 v[88:91], v[228:231], v[148:151], v[88:91]
    v_mfma_f32_16x16x32_bf16 v[92:95], v[228:231], v[152:155], v[92:95]
    s_waitcnt lgkmcnt(0)
    s_lshr_b32 s3, s41, 1
    ds_read_b128 v[136:139], v191 offset:0
    v_mfma_f32_16x16x32_bf16 v[16:19], v[196:199], v[116:119], v[16:19]
    s_add_u32 s3, s3, s42
    ds_read_b128 v[140:143], v191 offset:2048
    s_and_b32 s3, s3, 7
    v_mfma_f32_16x16x32_bf16 v[20:23], v[196:199], v[120:123], v[20:23]
    s_and_b32 s4, s41, 1
    ds_read_b128 v[144:147], v191 offset:4096
    v_mfma_f32_16x16x32_bf16 v[24:27], v[196:199], v[124:127], v[24:27]
    s_mul_i32 s43, s3, 40960
    ds_read_b128 v[148:151], v191 offset:6144
    s_lshl_b32 s4, s4, 11
    v_mfma_f32_16x16x32_bf16 v[28:31], v[196:199], v[128:131], v[28:31]
    s_add_u32 s43, s43, s4
    ds_read_b128 v[152:155], v191 offset:8192
    v_mfma_f32_16x16x32_bf16 v[32:35], v[196:199], v[132:135], v[32:35]
    s_cmp_lt_u32 s41, 16
    ds_read_b64_tr_b16 v[216:217], v192 offset:10240
    v_mfma_f32_16x16x32_bf16 v[36:39], v[200:203], v[116:119], v[36:39]
    s_cselect_b32 s14, 327680, 0
    s_add_u32 s41, s41, 1
    v_mfma_f32_16x16x32_bf16 v[40:43], v[200:203], v[120:123], v[40:43]
    ds_read_b64_tr_b16 v[218:219], v192 offset:15360
    s_add_u32 m0, s37, 0
    v_mfma_f32_16x16x32_bf16 v[44:47], v[200:203], v[124:127], v[44:47]
    ds_read_b64_tr_b16 v[220:221], v193 offset:10272
    s_nop 0
    v_mfma_f32_16x16x32_bf16 v[48:51], v[200:203], v[128:131], v[48:51]
    buffer_load_dwordx4 v181, s[12:15], s43 offen lds
    ds_read_b64_tr_b16 v[222:223], v193 offset:15392
    s_add_u32 m0, s37, 1024
    v_mfma_f32_16x16x32_bf16 v[52:55], v[200:203], v[132:135], v[52:55]
    ds_read_b64_tr_b16 v[224:225], v192 offset:10304
    s_nop 0
    v_mfma_f32_16x16x32_bf16 v[56:59], v[204:207], v[116:119], v[56:59]
    buffer_load_dwordx4 v182, s[12:15], s43 offen lds
    ds_read_b64_tr_b16 v[226:227], v192 offset:15424
    s_add_u32 m0, s37, 2048
    v_mfma_f32_16x16x32_bf16 v[60:63], v[204:207], v[120:123], v[60:63]
    ds_read_b64_tr_b16 v[228:229], v193 offset:10336
    s_nop 0
    v_mfma_f32_16x16x32_bf16 v[64:67], v[204:207], v[124:127], v[64:67]
    buffer_load_dwordx4 v183, s[12:15], s43 offen lds
    ds_read_b64_tr_b16 v[230:231], v193 offset:15456
    v_mfma_f32_16x16x32_bf16 v[68:71], v[204:207], v[128:131], v[68:71]
    s_add_u32 m0, s37, 3072
    s_nop 0
    v_mfma_f32_16x16x32_bf16 v[72:75], v[204:207], v[132:135], v[72:75]
    buffer_load_dwordx4 v184, s[12:15], s43 offen lds
    v_mfma_f32_16x16x32_bf16 v[76:79], v[208:211], v[116:119], v[76:79]
    s_add_u32 m0, s37, 4096
    s_nop 0
    v_mfma_f32_16x16x32_bf16 v[80:83], v[208:211], v[120:123], v[80:83]
    buffer_load_dwordx4 v185, s[12:15], s43 offen lds
    v_mfma_f32_16x16x32_bf16 v[84:87], v[208:211], v[124:127], v[84:87]
    v_mfma_f32_16x16x32_bf16 v[88:91], v[208:211], v[128:131], v[88:91]
    v_mfma_f32_16x16x32_bf16 v[92:95], v[208:211], v[132:135], v[92:95]
    s_waitcnt vmcnt(20) lgkmcnt(0)
    v_add_u32 v190, 20480, v190
    v_add_u32 v191, 20480, v191
    v_add_u32 v192, 20480, v192
    v_add_u32 v193, 20480, v193
    s_barrier
    s_lshr_b32 s3, s60, 1
    ds_read_b128 v[116:119], v190 offset:0
    v_mfma_f32_16x16x32_bf16 v[16:19], v[216:219], v[136:139], v[16:19]
    s_add_u32 s3, s3, s42
    ds_read_b128 v[120:123], v190 offset:2048
    v_mfma_f32_16x16x32_bf16 v[20:23], v[216:219], v[140:143], v[20:23]
    s_and_b32 s3, s3, 7
    ds_read_b128 v[124:127], v190 offset:4096
    v_mfma_f32_16x16x32_bf16 v[24:27], v[216:219], v[144:147], v[24:27]
    s_and_b32 s4, s60, 1
    ds_read_b128 v[128:131], v190 offset:6144
    v_mfma_f32_16x16x32_bf16 v[28:31], v[216:219], v[148:151], v[28:31]
    s_lshl_b32 s3, s3, 1
    ds_read_b128 v[132:135], v190 offset:8192
    v_mfma_f32_16x16x32_bf16 v[32:35], v[216:219], v[152:155], v[32:35]
    s_add_u32 s3, s3, s4
    ds_read_b64_tr_b16 v[196:197], v192 offset:0
    v_mfma_f32_16x16x32_bf16 v[36:39], v[220:223], v[136:139], v[36:39]
    s_mul_i32 s44, s3, 73728
    v_mfma_f32_16x16x32_bf16 v[40:43], v[220:223], v[140:143], v[40:43]
    ds_read_b64_tr_b16 v[198:199], v192 offset:5120
    s_cmp_lt_u32 s60, 16
    v_mfma_f32_16x16x32_bf16 v[44:47], v[220:223], v[144:147], v[44:47]
    s_cselect_b32 s10, s39, 0
    ds_read_b64_tr_b16 v[200:201], v193 offset:32
    v_mfma_f32_16x16x32_bf16 v[48:51], v[220:223], v[148:151], v[48:51]
    s_add_u32 s60, s60, 1
    ds_read_b64_tr_b16 v[202:203], v193 offset:5152
    s_add_u32 m0, s36, 20480
    v_mfma_f32_16x16x32_bf16 v[52:55], v[220:223], v[152:155], v[52:55]
    ds_read_b64_tr_b16 v[204:205], v192 offset:64
    s_nop 0
    v_mfma_f32_16x16x32_bf16 v[56:59], v[224:227], v[136:139], v[56:59]
    ds_read_b64_tr_b16 v[206:207], v192 offset:5184
    buffer_load_dwordx4 v240, s[8:11], s44 offen offset:0 lds
    v_mfma_f32_16x16x32_bf16 v[60:63], v[224:227], v[140:143], v[60:63]
    ds_read_b64_tr_b16 v[208:209], v193 offset:96
    buffer_load_dwordx4 v241, s[8:11], s44 offen offset:1024 lds
    v_mfma_f32_16x16x32_bf16 v[64:67], v[224:227], v[144:147], v[64:67]
    ds_read_b64_tr_b16 v[210:211], v193 offset:5216
    buffer_load_dwordx4 v242, s[8:11], s44 offen offset:2048 lds
    v_mfma_f32_16x16x32_bf16 v[68:71], v[224:227], v[148:151], v[68:71]
    buffer_load_dwordx4 v243, s[8:11], s44 offen offset:3072 lds
    v_mfma_f32_16x16x32_bf16 v[72:75], v[224:227], v[152:155], v[72:75]
    s_add_u32 m0, s36, 24576
    v_mfma_f32_16x16x32_bf16 v[76:79], v[228:231], v[136:139], v[76:79]
    s_nop 0
    v_mfma_f32_16x16x32_bf16 v[80:83], v[228:231], v[140:143], v[80:83]
    buffer_load_dwordx4 v253, s[8:11], s44 offen offset:0 lds
    v_mfma_f32_16x16x32_bf16 v[84:87], v[228:231], v[144:147], v[84:87]
    v_mfma_f32_16x16x32_bf16 v[88:91], v[228:231], v[148:151], v[88:91]
    v_mfma_f32_16x16x32_bf16 v[92:95], v[228:231], v[152:155], v[92:95]
    s_waitcnt lgkmcnt(0)
    s_lshr_b32 s3, s41, 1
    ds_read_b128 v[136:139], v191 offset:0
    v_mfma_f32_16x16x32_bf16 v[16:19], v[196:199], v[116:119], v[16:19]
    s_add_u32 s3, s3, s42
    ds_read_b128 v[140:143], v191 offset:2048
    s_and_b32 s3, s3, 7
    v_mfma_f32_16x16x32_bf16 v[20:23], v[196:199], v[120:123], v[20:23]
    s_and_b32 s4, s41, 1
    ds_read_b128 v[144:147], v191 offset:4096
    v_mfma_f32_16x16x32_bf16 v[24:27], v[196:199], v[124:127], v[24:27]
    s_mul_i32 s43, s3, 40960
    ds_read_b128 v[148:151], v191 offset:6144
    s_lshl_b32 s4, s4, 11
    v_mfma_f32_16x16x32_bf16 v[28:31], v[196:199], v[128:131], v[28:31]
    s_add_u32 s43, s43, s4
    ds_read_b128 v[152:155], v191 offset:8192
    v_mfma_f32_16x16x32_bf16 v[32:35], v[196:199], v[132:135], v[32:35]
    s_cmp_lt_u32 s41, 16
    ds_read_b64_tr_b16 v[216:217], v192 offset:10240
    v_mfma_f32_16x16x32_bf16 v[36:39], v[200:203], v[116:119], v[36:39]
    s_cselect_b32 s14, 327680, 0
    s_add_u32 s41, s41, 1
    v_mfma_f32_16x16x32_bf16 v[40:43], v[200:203], v[120:123], v[40:43]
    ds_read_b64_tr_b16 v[218:219], v192 offset:15360
    s_add_u32 m0, s37, 20480
    v_mfma_f32_16x16x32_bf16 v[44:47], v[200:203], v[124:127], v[44:47]
    ds_read_b64_tr_b16 v[220:221], v193 offset:10272
    s_nop 0
    v_mfma_f32_16x16x32_bf16 v[48:51], v[200:203], v[128:131], v[48:51]
    buffer_load_dwordx4 v181, s[12:15], s43 offen lds
    ds_read_b64_tr_b16 v[222:223], v193 offset:15392
    s_add_u32 m0, s37, 21504
    v_mfma_f32_16x16x32_bf16 v[52:55], v[200:203], v[132:135], v[52:55]
    ds_read_b64_tr_b16 v[224:225], v192 offset:10304
    s_nop 0
    v_mfma_f32_16x16x32_bf16 v[56:59], v[204:207], v[116:119], v[56:59]
    buffer_load_dwordx4 v182, s[12:15], s43 offen lds
    ds_read_b64_tr_b16 v[226:227], v192 offset:15424
    s_add_u32 m0, s37, 22528
    v_mfma_f32_16x16x32_bf16 v[60:63], v[204:207], v[120:123], v[60:63]
    ds_read_b64_tr_b16 v[228:229], v193 offset:10336
    s_nop 0
    v_mfma_f32_16x16x32_bf16 v[64:67], v[204:207], v[124:127], v[64:67]
    buffer_load_dwordx4 v183, s[12:15], s43 offen lds
    ds_read_b64_tr_b16 v[230:231], v193 offset:15456
    v_mfma_f32_16x16x32_bf16 v[68:71], v[204:207], v[128:131], v[68:71]
    s_add_u32 m0, s37, 23552
    s_nop 0
    v_mfma_f32_16x16x32_bf16 v[72:75], v[204:207], v[132:135], v[72:75]
    buffer_load_dwordx4 v184, s[12:15], s43 offen lds
    v_mfma_f32_16x16x32_bf16 v[76:79], v[208:211], v[116:119], v[76:79]
    s_add_u32 m0, s37, 24576
    s_nop 0
    v_mfma_f32_16x16x32_bf16 v[80:83], v[208:211], v[120:123], v[80:83]
    buffer_load_dwordx4 v185, s[12:15], s43 offen lds
    v_mfma_f32_16x16x32_bf16 v[84:87], v[208:211], v[124:127], v[84:87]
    v_mfma_f32_16x16x32_bf16 v[88:91], v[208:211], v[128:131], v[88:91]
    v_mfma_f32_16x16x32_bf16 v[92:95], v[208:211], v[132:135], v[92:95]
    s_waitcnt vmcnt(20) lgkmcnt(0)
    v_add_u32 v190, 20480, v190
    v_add_u32 v191, 20480, v191
    v_add_u32 v192, 20480, v192
    v_add_u32 v193, 20480, v193
    s_barrier
    s_lshr_b32 s3, s60, 1
    ds_read_b128 v[116:119], v190 offset:0
    v_mfma_f32_16x16x32_bf16 v[16:19], v[216:219], v[136:139], v[16:19]
    s_add_u32 s3, s3, s42
    ds_read_b128 v[120:123], v190 offset:2048
    v_mfma_f32_16x16x32_bf16 v[20:23], v[216:219], v[140:143], v[20:23]
    s_and_b32 s3, s3, 7
    ds_read_b128 v[124:127], v190 offset:4096
    v_mfma_f32_16x16x32_bf16 v[24:27], v[216:219], v[144:147], v[24:27]
    s_and_b32 s4, s60, 1
    ds_read_b128 v[128:131], v190 offset:6144
    v_mfma_f32_16x16x32_bf16 v[28:31], v[216:219], v[148:151], v[28:31]
    s_lshl_b32 s3, s3, 1
    ds_read_b128 v[132:135], v190 offset:8192
    v_mfma_f32_16x16x32_bf16 v[32:35], v[216:219], v[152:155], v[32:35]
    s_add_u32 s3, s3, s4
    ds_read_b64_tr_b16 v[196:197], v192 offset:0
    v_mfma_f32_16x16x32_bf16 v[36:39], v[220:223], v[136:139], v[36:39]
    s_mul_i32 s44, s3, 73728
    v_mfma_f32_16x16x32_bf16 v[40:43], v[220:223], v[140:143], v[40:43]
    ds_read_b64_tr_b16 v[198:199], v192 offset:5120
    s_cmp_lt_u32 s60, 16
    v_mfma_f32_16x16x32_bf16 v[44:47], v[220:223], v[144:147], v[44:47]
    s_cselect_b32 s10, s39, 0
    ds_read_b64_tr_b16 v[200:201], v193 offset:32
    v_mfma_f32_16x16x32_bf16 v[48:51], v[220:223], v[148:151], v[48:51]
    s_add_u32 s60, s60, 1
    ds_read_b64_tr_b16 v[202:203], v193 offset:5152
    s_add_u32 m0, s36, 40960
    v_mfma_f32_16x16x32_bf16 v[52:55], v[220:223], v[152:155], v[52:55]
    ds_read_b64_tr_b16 v[204:205], v192 offset:64
    s_nop 0
    v_mfma_f32_16x16x32_bf16 v[56:59], v[224:227], v[136:139], v[56:59]
    ds_read_b64_tr_b16 v[206:207], v192 offset:5184
    buffer_load_dwordx4 v240, s[8:11], s44 offen offset:0 lds
    v_mfma_f32_16x16x32_bf16 v[60:63], v[224:227], v[140:143], v[60:63]
    ds_read_b64_tr_b16 v[208:209], v193 offset:96
    buffer_load_dwordx4 v241, s[8:11], s44 offen offset:1024 lds
    v_mfma_f32_16x16x32_bf16 v[64:67], v[224:227], v[144:147], v[64:67]
    ds_read_b64_tr_b16 v[210:211], v193 offset:5216
    buffer_load_dwordx4 v242, s[8:11], s44 offen offset:2048 lds
    v_mfma_f32_16x16x32_bf16 v[68:71], v[224:227], v[148:151], v[68:71]
    buffer_load_dwordx4 v243, s[8:11], s44 offen offset:3072 lds
    v_mfma_f32_16x16x32_bf16 v[72:75], v[224:227], v[152:155], v[72:75]
    s_add_u32 m0, s36, 45056
    v_mfma_f32_16x16x32_bf16 v[76:79], v[228:231], v[136:139], v[76:79]
    s_nop 0
    v_mfma_f32_16x16x32_bf16 v[80:83], v[228:231], v[140:143], v[80:83]
    buffer_load_dwordx4 v253, s[8:11], s44 offen offset:0 lds
    v_mfma_f32_16x16x32_bf16 v[84:87], v[228:231], v[144:147], v[84:87]
    v_mfma_f32_16x16x32_bf16 v[88:91], v[228:231], v[148:151], v[88:91]
    v_mfma_f32_16x16x32_bf16 v[92:95], v[228:231], v[152:155], v[92:95]
    s_add_u32 s45, s45, 1
    s_cmp_lt_u32 s45, 3
    s_cbranch_scc1 KF_L1
    s_nop 7
    v_lshlrev_b32 v4, 3, v1
    s_lshl_b32 s3, s68, 2
    s_add_u32 s3, s3, s32
    s_mul_i32 s38, s3, 12800
    s_cmp_eq_u32 s68, 0
    s_cbranch_scc1 KF_SA_62
    s_add_u32 s4, s38, 0
    v_cvt_pk_bf16_f32 v16, v16, v17
    v_cvt_pk_bf16_f32 v17, v18, v19
    buffer_store_dwordx2 v[16:17], v4, s[16:19], s4 offen sc0 sc1
    s_add_u32 s4, s38, 2048
    v_cvt_pk_bf16_f32 v32, v32, v33
    v_cvt_pk_bf16_f32 v33, v34, v35
    buffer_store_dwordx2 v[32:33], v4, s[16:19], s4 offen sc0 sc1
    s_add_u32 s4, s38, 4096
    v_cvt_pk_bf16_f32 v48, v48, v49
    v_cvt_pk_bf16_f32 v49, v50, v51
    buffer_store_dwordx2 v[48:49], v4, s[16:19], s4 offen sc0 sc1
    s_add_u32 s4, s38, 6144
    v_cvt_pk_bf16_f32 v64, v64, v65
    v_cvt_pk_bf16_f32 v65, v66, v67
    buffer_store_dwordx2 v[64:65], v4, s[16:19], s4 offen sc0 sc1
    s_add_u32 s4, s38, 8192
    v_cvt_pk_bf16_f32 v80, v80, v81
    v_cvt_pk_bf16_f32 v81, v82, v83
    buffer_store_dwordx2 v[80:81], v4, s[16:19], s4 offen sc0 sc1
KF_SA_62:
    s_cmp_eq_u32 s68, 1
    s_cbranch_scc1 KF_SA_63
    s_add_u32 s4, s38, 512
    v_cvt_pk_bf16_f32 v20, v20, v21
    v_cvt_pk_bf16_f32 v21, v22, v23
    buffer_store_dwordx2 v[20:21], v4, s[16:19], s4 offen sc0 sc1
    s_add_u32 s4, s38, 2560
    v_cvt_pk_bf16_f32 v36, v36, v37
    v_cvt_pk_bf16_f32 v37, v38, v39
    buffer_store_dwordx2 v[36:37], v4, s[16:19], s4 offen sc0 sc1
    s_add_u32 s4, s38, 4608
    v_cvt_pk_bf16_f32 v52, v52, v53
    v_cvt_pk_bf16_f32 v53, v54, v55
    buffer_store_dwordx2 v[52:53], v4, s[16:19], s4 offen sc0 sc1
    s_add_u32 s4, s38, 6656
    v_cvt_pk_bf16_f32 v68, v68, v69
    v_cvt_pk_bf16_f32 v69, v70, v71
    buffer_store_dwordx2 v[68:69], v4, s[16:19], s4 offen sc0 sc1
    s_add_u32 s4, s38, 8704
    v_cvt_pk_bf16_f32 v84, v84, v85
    v_cvt_pk_bf16_f32 v85, v86, v87
    buffer_store_dwordx2 v[84:85], v4, s[16:19], s4 offen sc0 sc1
KF_SA_63:
    s_cmp_eq_u32 s68, 2
    s_cbranch_scc1 KF_SA_64
    s_add_u32 s4, s38, 1024
    v_cvt_pk_bf16_f32 v24, v24, v25
    v_cvt_pk_bf16_f32 v25, v26, v27
    buffer_store_dwordx2 v[24:25], v4, s[16:19], s4 offen sc0 sc1
    s_add_u32 s4, s38, 3072
    v_cvt_pk_bf16_f32 v40, v40, v41
    v_cvt_pk_bf16_f32 v41, v42, v43
    buffer_store_dwordx2 v[40:41], v4, s[16:19], s4 offen sc0 sc1
    s_add_u32 s4, s38, 5120
    v_cvt_pk_bf16_f32 v56, v56, v57
    v_cvt_pk_bf16_f32 v57, v58, v59
    buffer_store_dwordx2 v[56:57], v4, s[16:19], s4 offen sc0 sc1
    s_add_u32 s4, s38, 7168
    v_cvt_pk_bf16_f32 v72, v72, v73
    v_cvt_pk_bf16_f32 v73, v74, v75
    buffer_store_dwordx2 v[72:73], v4, s[16:19], s4 offen sc0 sc1
    s_add_u32 s4, s38, 9216
    v_cvt_pk_bf16_f32 v88, v88, v89
    v_cvt_pk_bf16_f32 v89, v90, v91
    buffer_store_dwordx2 v[88:89], v4, s[16:19], s4 offen sc0 sc1
KF_SA_64:
    s_cmp_eq_u32 s68, 3
    s_cbranch_scc1 KF_SA_65
    s_add_u32 s4, s38, 1536
    v_cvt_pk_bf16_f32 v28, v28, v29
    v_cvt_pk_bf16_f32 v29, v30, v31
    buffer_store_dwordx2 v[28:29], v4, s[16:19], s4 offen sc0 sc1
    s_add_u32 s4, s38, 3584
    v_cvt_pk_bf16_f32 v44, v44, v45
    v_cvt_pk_bf16_f32 v45, v46, v47
    buffer_store_dwordx2 v[44:45], v4, s[16:19], s4 offen sc0 sc1
    s_add_u32 s4, s38, 5632
    v_cvt_pk_bf16_f32 v60, v60, v61
    v_cvt_pk_bf16_f32 v61, v62, v63
    buffer_store_dwordx2 v[60:61], v4, s[16:19], s4 offen sc0 sc1
    s_add_u32 s4, s38, 7680
    v_cvt_pk_bf16_f32 v76, v76, v77
    v_cvt_pk_bf16_f32 v77, v78, v79
    buffer_store_dwordx2 v[76:77], v4, s[16:19], s4 offen sc0 sc1
    s_add_u32 s4, s38, 9728
    v_cvt_pk_bf16_f32 v92, v92, v93
    v_cvt_pk_bf16_f32 v93, v94, v95
    buffer_store_dwordx2 v[92:93], v4, s[16:19], s4 offen sc0 sc1
KF_SA_65:
    s_waitcnt vmcnt(0)
    s_barrier
    s_cmp_lg_u32 s32, 3
    s_cbranch_scc1 KF_SIG_66
    s_lshl_b32 s3, s46, 7
    s_lshl_b32 s4, s68, 2
    s_add_u32 s3, s3, s4
    s_add_u32 s3, s3, 8192
    v_mov_b32 v5, s3
    v_mov_b32 v6, s66
    v_cmp_eq_u32 vcc, 0, v1
    s_and_saveexec_b64 s[70:71], vcc
    global_store_dword v5, v6, s[58:59] sc0 sc1
    s_mov_b64 exec, s[70:71]
KF_SIG_66:
    s_cmp_lg_u32 s32, 3
    s_cbranch_scc1 KF_PD_67
    s_lshl_b32 s3, s46, 7
    s_add_u32 s3, s3, 8192
    v_mov_b32 v5, s3
    s_mov_b32 s65, 0
KF_PL_68:
    global_load_dwordx4 v[176:179], v5, s[58:59] sc0 sc1
    s_waitcnt vmcnt(0)
    s_mov_b32 s3, 0
    v_readfirstlane_b32 s4, v176
    s_nop 0
    s_cmp_eq_u32 s4, s66
    s_cselect_b32 s4, 1, 0
    s_or_b32 s3, s3, s4
    v_readfirstlane_b32 s4, v177
    s_nop 0
    s_cmp_eq_u32 s4, s66
    s_cselect_b32 s4, 2, 0
    s_or_b32 s3, s3, s4
    v_readfirstlane_b32 s4, v178
    s_nop 0
    s_cmp_eq_u32 s4, s66
    s_cselect_b32 s4, 4, 0
    s_or_b32 s3, s3, s4
    v_readfirstlane_b32 s4, v179
    s_nop 0
    s_cmp_eq_u32 s4, s66
    s_cselect_b32 s4, 8, 0
    s_or_b32 s3, s3, s4
    s_add_u32 s65, s65, 1
    s_cmp_eq_u32 s3, 15
    s_cbranch_scc1 KF_PX_69
    s_sleep 1
    s_cmp_lt_u32 s65, 0x8000
    s_cbranch_scc1 KF_PL_68
KF_PX_69:
KF_PD_67:
    s_barrier
    s_cmp_lg_u32 s68, 0
    s_cbranch_scc1 KF_SB_70
    s_mul_i32 s38, s32, 12800
    s_add_u32 s4, s38, 51200
    buffer_load_dwordx2 v[116:117], v4, s[16:19], s4 offen sc0 sc1
    s_add_u32 s4, s38, 102400
    buffer_load_dwordx2 v[118:119], v4, s[16:19], s4 offen sc0 sc1
    s_add_u32 s4, s38, 153600
    buffer_load_dwordx2 v[120:121], v4, s[16:19], s4 offen sc0 sc1
    s_add_u32 s4, s38, 53248
    buffer_load_dwordx2 v[122:123], v4, s[16:19], s4 offen sc0 sc1
    s_add_u32 s4, s38, 104448
    buffer_load_dwordx2 v[124:125], v4, s[16:19], s4 offen sc0 sc1
    s_add_u32 s4, s38, 155648
    buffer_load_dwordx2 v[126:127], v4, s[16:19], s4 offen sc0 sc1
    s_add_u32 s4, s38, 55296
    buffer_load_dwordx2 v[128:129], v4, s[16:19], s4 offen sc0 sc1
    s_add_u32 s4, s38, 106496
    buffer_load_dwordx2 v[130:131], v4, s[16:19], s4 offen sc0 sc1
    s_add_u32 s4, s38, 157696
    buffer_load_dwordx2 v[132:133], v4, s[16:19], s4 offen sc0 sc1
    s_add_u32 s4, s38, 57344
    buffer_load_dwordx2 v[134:135], v4, s[16:19], s4 offen sc0 sc1
    s_add_u32 s4, s38, 108544
    buffer_load_dwordx2 v[136:137], v4, s[16:19], s4 offen sc0 sc1
    s_add_u32 s4, s38, 159744
    buffer_load_dwordx2 v[138:139], v4, s[16:19], s4 offen sc0 sc1
    s_add_u32 s4, s38, 59392
    buffer_load_dwordx2 v[140:141], v4, s[16:19], s4 offen sc0 sc1
    s_add_u32 s4, s38, 110592
    buffer_load_dwordx2 v[142:143], v4, s[16:19], s4 offen sc0 sc1
    s_add_u32 s4, s38, 161792
    buffer_load_dwordx2 v[144:145], v4, s[16:19], s4 offen sc0 sc1
    s_waitcnt vmcnt(12)
    v_lshlrev_b32 v6, 16, v116
    v_and_b32 v7, 0xffff0000, v116
    v_add_f32 v16, v16, v6
    v_add_f32 v17, v17, v7
    v_lshlrev_b32 v6, 16, v117
    v_and_b32 v7, 0xffff0000, v117
    v_add_f32 v18, v18, v6
    v_add_f32 v19, v19, v7
    v_lshlrev_b32 v6, 16, v118
    v_and_b32 v7, 0xffff0000, v118
    v_add_f32 v16, v16, v6
    v_add_f32 v17, v17, v7
    v_lshlrev_b32 v6, 16, v119
    v_and_b32 v7, 0xffff0000, v119
    v_add_f32 v18, v18, v6
    v_add_f32 v19, v19, v7
    v_lshlrev_b32 v6, 16, v120
    v_and_b32 v7, 0xffff0000, v120
    v_add_f32 v16, v16, v6
    v_add_f32 v17, v17, v7
    v_lshlrev_b32 v6, 16, v121
    v_and_b32 v7, 0xffff0000, v121
    v_add_f32 v18, v18, v6
    v_add_f32 v19, v19, v7
    v_cvt_pk_bf16_f32 v16, v16, v17
    v_cvt_pk_bf16_f32 v17, v18, v19
    s_mov_b32 s4, 0
    buffer_store_dwordx2 v[16:17], v254, s[20:23], s4 offen nt
    s_waitcnt vmcnt(10)
    v_lshlrev_b32 v6, 16, v122
    v_and_b32 v7, 0xffff0000, v122
    v_add_f32 v32, v32, v6
    v_add_f32 v33, v33, v7
    v_lshlrev_b32 v6, 16, v123
    v_and_b32 v7, 0xffff0000, v123
    v_add_f32 v34, v34, v6
    v_add_f32 v35, v35, v7
    v_lshlrev_b32 v6, 16, v124
    v_and_b32 v7, 0xffff0000, v124
    v_add_f32 v32, v32, v6
    v_add_f32 v33, v33, v7
    v_lshlrev_b32 v6, 16, v125
    v_and_b32 v7, 0xffff0000, v125
    v_add_f32 v34, v34, v6
    v_add_f32 v35, v35, v7
    v_lshlrev_b32 v6, 16, v126
    v_and_b32 v7, 0xffff0000, v126
    v_add_f32 v32, v32, v6
    v_add_f32 v33, v33, v7
    v_lshlrev_b32 v6, 16, v127
    v_and_b32 v7, 0xffff0000, v127
    v_add_f32 v34, v34, v6
    v_add_f32 v35, v35, v7
    v_cvt_pk_bf16_f32 v32, v32, v33
    v_cvt_pk_bf16_f32 v33, v34, v35
    s_mov_b32 s4, 147456
    buffer_store_dwordx2 v[32:33], v254, s[20:23], s4 offen nt
    s_waitcnt vmcnt(8)
    v_lshlrev_b32 v6, 16, v128
    v_and_b32 v7, 0xffff0000, v128
    v_add_f32 v48, v48, v6
    v_add_f32 v49, v49, v7
    v_lshlrev_b32 v6, 16, v129
    v_and_b32 v7, 0xffff0000, v129
    v_add_f32 v50, v50, v6
    v_add_f32 v51, v51, v7
    v_lshlrev_b32 v6, 16, v130
    v_and_b32 v7, 0xffff0000, v130
    v_add_f32 v48, v48, v6
    v_add_f32 v49, v49, v7
    v_lshlrev_b32 v6, 16, v131
    v_and_b32 v7, 0xffff0000, v131
    v_add_f32 v50, v50, v6
    v_add_f32 v51, v51, v7
    v_lshlrev_b32 v6, 16, v132
    v_and_b32 v7, 0xffff0000, v132
    v_add_f32 v48, v48, v6
    v_add_f32 v49, v49, v7
    v_lshlrev_b32 v6, 16, v133
    v_and_b32 v7, 0xffff0000, v133
    v_add_f32 v50, v50, v6
    v_add_f32 v51, v51, v7
    v_cvt_pk_bf16_f32 v48, v48, v49
    v_cvt_pk_bf16_f32 v49, v50, v51
    s_mov_b32 s4, 110624
    buffer_store_dwordx2 v[48:49], v254, s[20:23], s4 offen nt
    s_waitcnt vmcnt(6)
    v_lshlrev_b32 v6, 16, v134
    v_and_b32 v7, 0xffff0000, v134
    v_add_f32 v64, v64, v6
    v_add_f32 v65, v65, v7
    v_lshlrev_b32 v6, 16, v135
    v_and_b32 v7, 0xffff0000, v135
    v_add_f32 v66, v66, v6
    v_add_f32 v67, v67, v7
    v_lshlrev_b32 v6, 16, v136
    v_and_b32 v7, 0xffff0000, v136
    v_add_f32 v64, v64, v6
    v_add_f32 v65, v65, v7
    v_lshlrev_b32 v6, 16, v137
    v_and_b32 v7, 0xffff0000, v137
    v_add_f32 v66, v66, v6
    v_add_f32 v67, v67, v7
    v_lshlrev_b32 v6, 16, v138
    v_and_b32 v7, 0xffff0000, v138
    v_add_f32 v64, v64, v6
    v_add_f32 v65, v65, v7
    v_lshlrev_b32 v6, 16, v139
    v_and_b32 v7, 0xffff0000, v139
    v_add_f32 v66, v66, v6
    v_add_f32 v67, v67, v7
    v_cvt_pk_bf16_f32 v64, v64, v65
    v_cvt_pk_bf16_f32 v65, v66, v67
    s_mov_b32 s4, 73792
    buffer_store_dwordx2 v[64:65], v254, s[20:23], s4 offen nt
    s_waitcnt vmcnt(4)
    v_lshlrev_b32 v6, 16, v140
    v_and_b32 v7, 0xffff0000, v140
    v_add_f32 v80, v80, v6
    v_add_f32 v81, v81, v7
    v_lshlrev_b32 v6, 16, v141
    v_and_b32 v7, 0xffff0000, v141
    v_add_f32 v82, v82, v6
    v_add_f32 v83, v83, v7
    v_lshlrev_b32 v6, 16, v142
    v_and_b32 v7, 0xffff0000, v142
    v_add_f32 v80, v80, v6
    v_add_f32 v81, v81, v7
    v_lshlrev_b32 v6, 16, v143
    v_and_b32 v7, 0xffff0000, v143
    v_add_f32 v82, v82, v6
    v_add_f32 v83, v83, v7
    v_lshlrev_b32 v6, 16, v144
    v_and_b32 v7, 0xffff0000, v144
    v_add_f32 v80, v80, v6
    v_add_f32 v81, v81, v7
    v_lshlrev_b32 v6, 16, v145
    v_and_b32 v7, 0xffff0000, v145
    v_add_f32 v82, v82, v6
    v_add_f32 v83, v83, v7
    v_cvt_pk_bf16_f32 v80, v80, v81
    v_cvt_pk_bf16_f32 v81, v82, v83
    s_mov_b32 s4, 36960
    buffer_store_dwordx2 v[80:81], v254, s[20:23], s4 offen nt
KF_SB_70:
    s_cmp_lg_u32 s68, 1
    s_cbranch_scc1 KF_SB_71
    s_mul_i32 s38, s32, 12800
    s_add_u32 s4, s38, 102912
    buffer_load_dwordx2 v[116:117], v4, s[16:19], s4 offen sc0 sc1
    s_add_u32 s4, s38, 154112
    buffer_load_dwordx2 v[118:119], v4, s[16:19], s4 offen sc0 sc1
    s_add_u32 s4, s38, 512
    buffer_load_dwordx2 v[120:121], v4, s[16:19], s4 offen sc0 sc1
    s_add_u32 s4, s38, 104960
    buffer_load_dwordx2 v[122:123], v4, s[16:19], s4 offen sc0 sc1
    s_add_u32 s4, s38, 156160
    buffer_load_dwordx2 v[124:125], v4, s[16:19], s4 offen sc0 sc1
    s_add_u32 s4, s38, 2560
    buffer_load_dwordx2 v[126:127], v4, s[16:19], s4 offen sc0 sc1
    s_add_u32 s4, s38, 107008
    buffer_load_dwordx2 v[128:129], v4, s[16:19], s4 offen sc0 sc1
    s_add_u32 s4, s38, 158208
    buffer_load_dwordx2 v[130:131], v4, s[16:19], s4 offen sc0 sc1
    s_add_u32 s4, s38, 4608
    buffer_load_dwordx2 v[132:133], v4, s[16:19], s4 offen sc0 sc1
    s_add_u32 s4, s38, 109056
    buffer_load_dwordx2 v[134:135], v4, s[16:19], s4 offen sc0 sc1
    s_add_u32 s4, s38, 160256
    buffer_load_dwordx2 v[136:137], v4, s[16:19], s4 offen sc0 sc1
    s_add_u32 s4, s38, 6656
    buffer_load_dwordx2 v[138:139], v4, s[16:19], s4 offen sc0 sc1
    s_add_u32 s4, s38, 111104
    buffer_load_dwordx2 v[140:141], v4, s[16:19], s4 offen sc0 sc1
    s_add_u32 s4, s38, 162304
    buffer_load_dwordx2 v[142:143], v4, s[16:19], s4 offen sc0 sc1
    s_add_u32 s4, s38, 8704
    buffer_load_dwordx2 v[144:145], v4, s[16:19], s4 offen sc0 sc1
    s_waitcnt vmcnt(12)
    v_lshlrev_b32 v6, 16, v116
    v_and_b32 v7, 0xffff0000, v116
    v_add_f32 v20, v20, v6
    v_add_f32 v21, v21, v7
    v_lshlrev_b32 v6, 16, v117
    v_and_b32 v7, 0xffff0000, v117
    v_add_f32 v22, v22, v6
    v_add_f32 v23, v23, v7
    v_lshlrev_b32 v6, 16, v118
    v_and_b32 v7, 0xffff0000, v118
    v_add_f32 v20, v20, v6
    v_add_f32 v21, v21, v7
    v_lshlrev_b32 v6, 16, v119
    v_and_b32 v7, 0xffff0000, v119
    v_add_f32 v22, v22, v6
    v_add_f32 v23, v23, v7
    v_lshlrev_b32 v6, 16, v120
    v_and_b32 v7, 0xffff0000, v120
    v_add_f32 v20, v20, v6
    v_add_f32 v21, v21, v7
    v_lshlrev_b32 v6, 16, v121
    v_and_b32 v7, 0xffff0000, v121
    v_add_f32 v22, v22, v6
    v_add_f32 v23, v23, v7
    v_cvt_pk_bf16_f32 v20, v20, v21
    v_cvt_pk_bf16_f32 v21, v22, v23
    s_mov_b32 s4, 36864
    buffer_store_dwordx2 v[20:21], v254, s[20:23], s4 offen nt
    s_waitcnt vmcnt(10)
    v_lshlrev_b32 v6, 16, v122
    v_and_b32 v7, 0xffff0000, v122
    v_add_f32 v36, v36, v6
    v_add_f32 v37, v37, v7
    v_lshlrev_b32 v6, 16, v123
    v_and_b32 v7, 0xffff0000, v123
    v_add_f32 v38, v38, v6
    v_add_f32 v39, v39, v7
    v_lshlrev_b32 v6, 16, v124
    v_and_b32 v7, 0xffff0000, v124
    v_add_f32 v36, v36, v6
    v_add_f32 v37, v37, v7
    v_lshlrev_b32 v6, 16, v125
    v_and_b32 v7, 0xffff0000, v125
    v_add_f32 v38, v38, v6
    v_add_f32 v39, v39, v7
    v_lshlrev_b32 v6, 16, v126
    v_and_b32 v7, 0xffff0000, v126
    v_add_f32 v36, v36, v6
    v_add_f32 v37, v37, v7
    v_lshlrev_b32 v6, 16, v127
    v_and_b32 v7, 0xffff0000, v127
    v_add_f32 v38, v38, v6
    v_add_f32 v39, v39, v7
    v_cvt_pk_bf16_f32 v36, v36, v37
    v_cvt_pk_bf16_f32 v37, v38, v39
    s_mov_b32 s4, 32
    buffer_store_dwordx2 v[36:37], v254, s[20:23], s4 offen nt
    s_waitcnt vmcnt(8)
    v_lshlrev_b32 v6, 16, v128
    v_and_b32 v7, 0xffff0000, v128
    v_add_f32 v52, v52, v6
    v_add_f32 v53, v53, v7
    v_lshlrev_b32 v6, 16, v129
    v_and_b32 v7, 0xffff0000, v129
    v_add_f32 v54, v54, v6
    v_add_f32 v55, v55, v7
    v_lshlrev_b32 v6, 16, v130
    v_and_b32 v7, 0xffff0000, v130
    v_add_f32 v52, v52, v6
    v_add_f32 v53, v53, v7
    v_lshlrev_b32 v6, 16, v131
    v_and_b32 v7, 0xffff0000, v131
    v_add_f32 v54, v54, v6
    v_add_f32 v55, v55, v7
    v_lshlrev_b32 v6, 16, v132
    v_and_b32 v7, 0xffff0000, v132
    v_add_f32 v52, v52, v6
    v_add_f32 v53, v53, v7
    v_lshlrev_b32 v6, 16, v133
    v_and_b32 v7, 0xffff0000, v133
    v_add_f32 v54, v54, v6
    v_add_f32 v55, v55, v7
    v_cvt_pk_bf16_f32 v52, v52, v53
    v_cvt_pk_bf16_f32 v53, v54, v55
    s_mov_b32 s4, 147488
    buffer_store_dwordx2 v[52:53], v254, s[20:23], s4 offen nt
    s_waitcnt vmcnt(6)
    v_lshlrev_b32 v6, 16, v134
    v_and_b32 v7, 0xffff0000, v134
    v_add_f32 v68, v68, v6
    v_add_f32 v69, v69, v7
    v_lshlrev_b32 v6, 16, v135
    v_and_b32 v7, 0xffff0000, v135
    v_add_f32 v70, v70, v6
    v_add_f32 v71, v71, v7
    v_lshlrev_b32 v6, 16, v136
    v_and_b32 v7, 0xffff0000, v136
    v_add_f32 v68, v68, v6
    v_add_f32 v69, v69, v7
    v_lshlrev_b32 v6, 16, v137
    v_and_b32 v7, 0xffff0000, v137
    v_add_f32 v70, v70, v6
    v_add_f32 v71, v71, v7
    v_lshlrev_b32 v6, 16, v138
    v_and_b32 v7, 0xffff0000, v138
    v_add_f32 v68, v68, v6
    v_add_f32 v69, v69, v7
    v_lshlrev_b32 v6, 16, v139
    v_and_b32 v7, 0xffff0000, v139
    v_add_f32 v70, v70, v6
    v_add_f32 v71, v71, v7
    v_cvt_pk_bf16_f32 v68, v68, v69
    v_cvt_pk_bf16_f32 v69, v70, v71
    s_mov_b32 s4, 110656
    buffer_store_dwordx2 v[68:69], v254, s[20:23], s4 offen nt
    s_waitcnt vmcnt(4)
    v_lshlrev_b32 v6, 16, v140
    v_and_b32 v7, 0xffff0000, v140
    v_add_f32 v84, v84, v6
    v_add_f32 v85, v85, v7
    v_lshlrev_b32 v6, 16, v141
    v_and_b32 v7, 0xffff0000, v141
    v_add_f32 v86, v86, v6
    v_add_f32 v87, v87, v7
    v_lshlrev_b32 v6, 16, v142
    v_and_b32 v7, 0xffff0000, v142
    v_add_f32 v84, v84, v6
    v_add_f32 v85, v85, v7
    v_lshlrev_b32 v6, 16, v143
    v_and_b32 v7, 0xffff0000, v143
    v_add_f32 v86, v86, v6
    v_add_f32 v87, v87, v7
    v_lshlrev_b32 v6, 16, v144
    v_and_b32 v7, 0xffff0000, v144
    v_add_f32 v84, v84, v6
    v_add_f32 v85, v85, v7
    v_lshlrev_b32 v6, 16, v145
    v_and_b32 v7, 0xffff0000, v145
    v_add_f32 v86, v86, v6
    v_add_f32 v87, v87, v7
    v_cvt_pk_bf16_f32 v84, v84, v85
    v_cvt_pk_bf16_f32 v85, v86, v87
    s_mov_b32 s4, 73824
    buffer_store_dwordx2 v[84:85], v254, s[20:23], s4 offen nt
KF_SB_71:
    s_cmp_lg_u32 s68, 2
    s_cbranch_scc1 KF_SB_72
    s_mul_i32 s38, s32, 12800
    s_add_u32 s4, s38, 154624
    buffer_load_dwordx2 v[116:117], v4, s[16:19], s4 offen sc0 sc1
    s_add_u32 s4, s38, 1024
    buffer_load_dwordx2 v[118:119], v4, s[16:19], s4 offen sc0 sc1
    s_add_u32 s4, s38, 52224
    buffer_load_dwordx2 v[120:121], v4, s[16:19], s4 offen sc0 sc1
    s_add_u32 s4, s38, 156672
    buffer_load_dwordx2 v[122:123], v4, s[16:19], s4 offen sc0 sc1
    s_add_u32 s4, s38, 3072
    buffer_load_dwordx2 v[124:125], v4, s[16:19], s4 offen sc0 sc1
    s_add_u32 s4, s38, 54272
    buffer_load_dwordx2 v[126:127], v4, s[16:19], s4 offen sc0 sc1
    s_add_u32 s4, s38, 158720
    buffer_load_dwordx2 v[128:129], v4, s[16:19], s4 offen sc0 sc1
    s_add_u32 s4, s38, 5120
    buffer_load_dwordx2 v[130:131], v4, s[16:19], s4 offen sc0 sc1
    s_add_u32 s4, s38, 56320
    buffer_load_dwordx2 v[132:133], v4, s[16:19], s4 offen sc0 sc1
    s_add_u32 s4, s38, 160768
    buffer_load_dwordx2 v[134:135], v4, s[16:19], s4 offen sc0 sc1
    s_add_u32 s4, s38, 7168
    buffer_load_dwordx2 v[136:137], v4, s[16:19], s4 offen sc0 sc1
    s_add_u32 s4, s38, 58368
    buffer_load_dwordx2 v[138:139], v4, s[16:19], s4 offen sc0 sc1
    s_add_u32 s4, s38, 162816
    buffer_load_dwordx2 v[140:141], v4, s[16:19], s4 offen sc0 sc1
    s_add_u32 s4, s38, 9216
    buffer_load_dwordx2 v[142:143], v4, s[16:19], s4 offen sc0 sc1
    s_add_u32 s4, s38, 60416
    buffer_load_dwordx2 v[144:145], v4, s[16:19], s4 offen sc0 sc1
    s_waitcnt vmcnt(12)
    v_lshlrev_b32 v6, 16, v116
    v_and_b32 v7, 0xffff0000, v116
    v_add_f32 v24, v24, v6
    v_add_f32 v25, v25, v7
    v_lshlrev_b32 v6, 16, v117
    v_and_b32 v7, 0xffff0000, v117
    v_add_f32 v26, v26, v6
    v_add_f32 v27, v27, v7
    v_lshlrev_b32 v6, 16, v118
    v_and_b32 v7, 0xffff0000, v118
    v_add_f32 v24, v24, v6
    v_add_f32 v25, v25, v7
    v_lshlrev_b32 v6, 16, v119
    v_and_b32 v7, 0xffff0000, v119
    v_add_f32 v26, v26, v6
    v_add_f32 v27, v27, v7
    v_lshlrev_b32 v6, 16, v120
    v_and_b32 v7, 0xffff0000, v120
    v_add_f32 v24, v24, v6
    v_add_f32 v25, v25, v7
    v_lshlrev_b32 v6, 16, v121
    v_and_b32 v7, 0xffff0000, v121
    v_add_f32 v26, v26, v6
    v_add_f32 v27, v27, v7
    v_cvt_pk_bf16_f32 v24, v24, v25
    v_cvt_pk_bf16_f32 v25, v26, v27
    s_mov_b32 s4, 73728
    buffer_store_dwordx2 v[24:25], v254, s[20:23], s4 offen nt
    s_waitcnt vmcnt(10)
    v_lshlrev_b32 v6, 16, v122
    v_and_b32 v7, 0xffff0000, v122
    v_add_f32 v40, v40, v6
    v_add_f32 v41, v41, v7
    v_lshlrev_b32 v6, 16, v123
    v_and_b32 v7, 0xffff0000, v123
    v_add_f32 v42, v42, v6
    v_add_f32 v43, v43, v7
    v_lshlrev_b32 v6, 16, v124
    v_and_b32 v7, 0xffff0000, v124
    v_add_f32 v40, v40, v6
    v_add_f32 v41, v41, v7
    v_lshlrev_b32 v6, 16, v125
    v_and_b32 v7, 0xffff0000, v125
    v_add_f32 v42, v42, v6
    v_add_f32 v43, v43, v7
    v_lshlrev_b32 v6, 16, v126
    v_and_b32 v7, 0xffff0000, v126
    v_add_f32 v40, v40, v6
    v_add_f32 v41, v41, v7
    v_lshlrev_b32 v6, 16, v127
    v_and_b32 v7, 0xffff0000, v127
    v_add_f32 v42, v42, v6
    v_add_f32 v43, v43, v7
    v_cvt_pk_bf16_f32 v40, v40, v41
    v_cvt_pk_bf16_f32 v41, v42, v43
    s_mov_b32 s4, 36896
    buffer_store_dwordx2 v[40:41], v254, s[20:23], s4 offen nt
    s_waitcnt vmcnt(8)
    v_lshlrev_b32 v6, 16, v128
    v_and_b32 v7, 0xffff0000, v128
    v_add_f32 v56, v56, v6
    v_add_f32 v57, v57, v7
    v_lshlrev_b32 v6, 16, v129
    v_and_b32 v7, 0xffff0000, v129
    v_add_f32 v58, v58, v6
    v_add_f32 v59, v59, v7
    v_lshlrev_b32 v6, 16, v130
    v_and_b32 v7, 0xffff0000, v130
    v_add_f32 v56, v56, v6
    v_add_f32 v57, v57, v7
    v_lshlrev_b32 v6, 16, v131
    v_and_b32 v7, 0xffff0000, v131
    v_add_f32 v58, v58, v6
    v_add_f32 v59, v59, v7
    v_lshlrev_b32 v6, 16, v132
    v_and_b32 v7, 0xffff0000, v132
    v_add_f32 v56, v56, v6
    v_add_f32 v57, v57, v7
    v_lshlrev_b32 v6, 16, v133
    v_and_b32 v7, 0xffff0000, v133
    v_add_f32 v58, v58, v6
    v_add_f32 v59, v59, v7
    v_cvt_pk_bf16_f32 v56, v56, v57
    v_cvt_pk_bf16_f32 v57, v58, v59
    s_mov_b32 s4, 64
    buffer_store_dwordx2 v[56:57], v254, s[20:23], s4 offen nt
    s_waitcnt vmcnt(6)
    v_lshlrev_b32 v6, 16, v134
    v_and_b32 v7, 0xffff0000, v134
    v_add_f32 v72, v72, v6
    v_add_f32 v73, v73, v7
    v_lshlrev_b32 v6, 16, v135
    v_and_b32 v7, 0xffff0000, v135
    v_add_f32 v74, v74, v6
    v_add_f32 v75, v75, v7
    v_lshlrev_b32 v6, 16, v136
    v_and_b32 v7, 0xffff0000, v136
    v_add_f32 v72, v72, v6
    v_add_f32 v73, v73, v7
    v_lshlrev_b32 v6, 16, v137
    v_and_b32 v7, 0xffff0000, v137
    v_add_f32 v74, v74, v6
    v_add_f32 v75, v75, v7
    v_lshlrev_b32 v6, 16, v138
    v_and_b32 v7, 0xffff0000, v138
    v_add_f32 v72, v72, v6
    v_add_f32 v73, v73, v7
    v_lshlrev_b32 v6, 16, v139
    v_and_b32 v7, 0xffff0000, v139
    v_add_f32 v74, v74, v6
    v_add_f32 v75, v75, v7
    v_cvt_pk_bf16_f32 v72, v72, v73
    v_cvt_pk_bf16_f32 v73, v74, v75
    s_mov_b32 s4, 147520
    buffer_store_dwordx2 v[72:73], v254, s[20:23], s4 offen nt
    s_waitcnt vmcnt(4)
    v_lshlrev_b32 v6, 16, v140
    v_and_b32 v7, 0xffff0000, v140
    v_add_f32 v88, v88, v6
    v_add_f32 v89, v89, v7
    v_lshlrev_b32 v6, 16, v141
    v_and_b32 v7, 0xffff0000, v141
    v_add_f32 v90, v90, v6
    v_add_f32 v91, v91, v7
    v_lshlrev_b32 v6, 16, v142
    v_and_b32 v7, 0xffff0000, v142
    v_add_f32 v88, v88, v6
    v_add_f32 v89, v89, v7
    v_lshlrev_b32 v6, 16, v143
    v_and_b32 v7, 0xffff0000, v143
    v_add_f32 v90, v90, v6
    v_add_f32 v91, v91, v7
    v_lshlrev_b32 v6, 16, v144
    v_and_b32 v7, 0xffff0000, v144
    v_add_f32 v88, v88, v6
    v_add_f32 v89, v89, v7
    v_lshlrev_b32 v6, 16, v145
    v_and_b32 v7, 0xffff0000, v145
    v_add_f32 v90, v90, v6
    v_add_f32 v91, v91, v7
    v_cvt_pk_bf16_f32 v88, v88, v89
    v_cvt_pk_bf16_f32 v89, v90, v91
    s_mov_b32 s4, 110688
    buffer_store_dwordx2 v[88:89], v254, s[20:23], s4 offen nt
KF_SB_72:
    s_cmp_lg_u32 s68, 3
    s_cbranch_scc1 KF_SB_73
    s_mul_i32 s38, s32, 12800
    s_add_u32 s4, s38, 1536
    buffer_load_dwordx2 v[116:117], v4, s[16:19], s4 offen sc0 sc1
    s_add_u32 s4, s38, 52736
    buffer_load_dwordx2 v[118:119], v4, s[16:19], s4 offen sc0 sc1
    s_add_u32 s4, s38, 103936
    buffer_load_dwordx2 v[120:121], v4, s[16:19], s4 offen sc0 sc1
    s_add_u32 s4, s38, 3584
    buffer_load_dwordx2 v[122:123], v4, s[16:19], s4 offen sc0 sc1
    s_add_u32 s4, s38, 54784
    buffer_load_dwordx2 v[124:125], v4, s[16:19], s4 offen sc0 sc1
    s_add_u32 s4, s38, 105984
    buffer_load_dwordx2 v[126:127], v4, s[16:19], s4 offen sc0 sc1
    s_add_u32 s4, s38, 5632
    buffer_load_dwordx2 v[128:129], v4, s[16:19], s4 offen sc0 sc1
    s_add_u32 s4, s38, 56832
    buffer_load_dwordx2 v[130:131], v4, s[16:19], s4 offen sc0 sc1
    s_add_u32 s4, s38, 108032
    buffer_load_dwordx2 v[132:133], v4, s[16:19], s4 offen sc0 sc1
    s_add_u32 s4, s38, 7680
    buffer_load_dwordx2 v[134:135], v4, s[16:19], s4 offen sc0 sc1
    s_add_u32 s4, s38, 58880
    buffer_load_dwordx2 v[136:137], v4, s[16:19], s4 offen sc0 sc1
    s_add_u32 s4, s38, 110080
    buffer_load_dwordx2 v[138:139], v4, s[16:19], s4 offen sc0 sc1
    s_add_u32 s4, s38, 9728
    buffer_load_dwordx2 v[140:141], v4, s[16:19], s4 offen sc0 sc1
    s_add_u32 s4, s38, 60928
    buffer_load_dwordx2 v[142:143], v4, s[16:19], s4 offen sc0 sc1
    s_add_u32 s4, s38, 112128
    buffer_load_dwordx2 v[144:145], v4, s[16:19], s4 offen sc0 sc1
    s_waitcnt vmcnt(12)
    v_lshlrev_b32 v6, 16, v116
    v_and_b32 v7, 0xffff0000, v116
    v_add_f32 v28, v28, v6
    v_add_f32 v29, v29, v7
    v_lshlrev_b32 v6, 16, v117
    v_and_b32 v7, 0xffff0000, v117
    v_add_f32 v30, v30, v6
    v_add_f32 v31, v31, v7
    v_lshlrev_b32 v6, 16, v118
    v_and_b32 v7, 0xffff0000, v118
    v_add_f32 v28, v28, v6
    v_add_f32 v29, v29, v7
    v_lshlrev_b32 v6, 16, v119
    v_and_b32 v7, 0xffff0000, v119
    v_add_f32 v30, v30, v6
    v_add_f32 v31, v31, v7
    v_lshlrev_b32 v6, 16, v120
    v_and_b32 v7, 0xffff0000, v120
    v_add_f32 v28, v28, v6
    v_add_f32 v29, v29, v7
    v_lshlrev_b32 v6, 16, v121
    v_and_b32 v7, 0xffff0000, v121
    v_add_f32 v30, v30, v6
    v_add_f32 v31, v31, v7
    v_cvt_pk_bf16_f32 v28, v28, v29
    v_cvt_pk_bf16_f32 v29, v30, v31
    s_mov_b32 s4, 110592
    buffer_store_dwordx2 v[28:29], v254, s[20:23], s4 offen nt
    s_waitcnt vmcnt(10)
    v_lshlrev_b32 v6, 16, v122
    v_and_b32 v7, 0xffff0000, v122
    v_add_f32 v44, v44, v6
    v_add_f32 v45, v45, v7
    v_lshlrev_b32 v6, 16, v123
    v_and_b32 v7, 0xffff0000, v123
    v_add_f32 v46, v46, v6
    v_add_f32 v47, v47, v7
    v_lshlrev_b32 v6, 16, v124
    v_and_b32 v7, 0xffff0000, v124
    v_add_f32 v44, v44, v6
    v_add_f32 v45, v45, v7
    v_lshlrev_b32 v6, 16, v125
    v_and_b32 v7, 0xffff0000, v125
    v_add_f32 v46, v46, v6
    v_add_f32 v47, v47, v7
    v_lshlrev_b32 v6, 16, v126
    v_and_b32 v7, 0xffff0000, v126
    v_add_f32 v44, v44, v6
    v_add_f32 v45, v45, v7
    v_lshlrev_b32 v6, 16, v127
    v_and_b32 v7, 0xffff0000, v127
    v_add_f32 v46, v46, v6
    v_add_f32 v47, v47, v7
    v_cvt_pk_bf16_f32 v44, v44, v45
    v_cvt_pk_bf16_f32 v45, v46, v47
    s_mov_b32 s4, 73760
    buffer_store_dwordx2 v[44:45], v254, s[20:23], s4 offen nt
    s_waitcnt vmcnt(8)
    v_lshlrev_b32 v6, 16, v128
    v_and_b32 v7, 0xffff0000, v128
    v_add_f32 v60, v60, v6
    v_add_f32 v61, v61, v7
    v_lshlrev_b32 v6, 16, v129
    v_and_b32 v7, 0xffff0000, v129
    v_add_f32 v62, v62, v6
    v_add_f32 v63, v63, v7
    v_lshlrev_b32 v6, 16, v130
    v_and_b32 v7, 0xffff0000, v130
    v_add_f32 v60, v60, v6
    v_add_f32 v61, v61, v7
    v_lshlrev_b32 v6, 16, v131
    v_and_b32 v7, 0xffff0000, v131
    v_add_f32 v62, v62, v6
    v_add_f32 v63, v63, v7
    v_lshlrev_b32 v6, 16, v132
    v_and_b32 v7, 0xffff0000, v132
    v_add_f32 v60, v60, v6
    v_add_f32 v61, v61, v7
    v_lshlrev_b32 v6, 16, v133
    v_and_b32 v7, 0xffff0000, v133
    v_add_f32 v62, v62, v6
    v_add_f32 v63, v63, v7
    v_cvt_pk_bf16_f32 v60, v60, v61
    v_cvt_pk_bf16_f32 v61, v62, v63
    s_mov_b32 s4, 36928
    buffer_store_dwordx2 v[60:61], v254, s[20:23], s4 offen nt
    s_waitcnt vmcnt(6)
    v_lshlrev_b32 v6, 16, v134
    v_and_b32 v7, 0xffff0000, v134
    v_add_f32 v76, v76, v6
    v_add_f32 v77, v77, v7
    v_lshlrev_b32 v6, 16, v135
    v_and_b32 v7, 0xffff0000, v135
    v_add_f32 v78, v78, v6
    v_add_f32 v79, v79, v7
    v_lshlrev_b32 v6, 16, v136
    v_and_b32 v7, 0xffff0000, v136
    v_add_f32 v76, v76, v6
    v_add_f32 v77, v77, v7
    v_lshlrev_b32 v6, 16, v137
    v_and_b32 v7, 0xffff0000, v137
    v_add_f32 v78, v78, v6
    v_add_f32 v79, v79, v7
    v_lshlrev_b32 v6, 16, v138
    v_and_b32 v7, 0xffff0000, v138
    v_add_f32 v76, v76, v6
    v_add_f32 v77, v77, v7
    v_lshlrev_b32 v6, 16, v139
    v_and_b32 v7, 0xffff0000, v139
    v_add_f32 v78, v78, v6
    v_add_f32 v79, v79, v7
    v_cvt_pk_bf16_f32 v76, v76, v77
    v_cvt_pk_bf16_f32 v77, v78, v79
    s_mov_b32 s4, 96
    buffer_store_dwordx2 v[76:77], v254, s[20:23], s4 offen nt
    s_waitcnt vmcnt(4)
    v_lshlrev_b32 v6, 16, v140
    v_and_b32 v7, 0xffff0000, v140
    v_add_f32 v92, v92, v6
    v_add_f32 v93, v93, v7
    v_lshlrev_b32 v6, 16, v141
    v_and_b32 v7, 0xffff0000, v141
    v_add_f32 v94, v94, v6
    v_add_f32 v95, v95, v7
    v_lshlrev_b32 v6, 16, v142
    v_and_b32 v7, 0xffff0000, v142
    v_add_f32 v92, v92, v6
    v_add_f32 v93, v93, v7
    v_lshlrev_b32 v6, 16, v143
    v_and_b32 v7, 0xffff0000, v143
    v_add_f32 v94, v94, v6
    v_add_f32 v95, v95, v7
    v_lshlrev_b32 v6, 16, v144
    v_and_b32 v7, 0xffff0000, v144
    v_add_f32 v92, v92, v6
    v_add_f32 v93, v93, v7
    v_lshlrev_b32 v6, 16, v145
    v_and_b32 v7, 0xffff0000, v145
    v_add_f32 v94, v94, v6
    v_add_f32 v95, v95, v7
    v_cvt_pk_bf16_f32 v92, v92, v93
    v_cvt_pk_bf16_f32 v93, v94, v95
    s_mov_b32 s4, 147552
    buffer_store_dwordx2 v[92:93], v254, s[20:23], s4 offen nt
KF_SB_73:
KF_DONE:
K1_END:
    s_endpgm
K1_FB0:
    s_nop 7
    s_nop 7
    v_max3_f32 v174, v16, v17, v18
    v_max3_f32 v174, v174, v19, v20
    v_max3_f32 v174, v174, v21, v22
    v_max_f32 v174, v174, v23
    v_mov_b32 v166, v174
    v_mov_b32 v167, v174
    s_nop 1
    v_permlane32_swap_b32 v166, v167
    s_nop 1
    v_max_f32 v174, v166, v167
    v_mov_b32 v166, v174
    v_mov_b32 v167, v174
    s_nop 1
    v_permlane16_swap_b32 v166, v167
    s_nop 1
    v_max_f32 v174, v166, v167
    v_max_f32 v174, 0, v174
    v_sub_f32 v175, 0, v174
    v_exp_f32 v175, v175
    v_sub_f32 v136, v136, v174
    v_sub_f32 v137, v137, v174
    v_sub_f32 v138, v138, v174
    v_sub_f32 v139, v139, v174
    v_sub_f32 v16, v16, v174
    v_sub_f32 v56, v56, v174
    v_sub_f32 v17, v17, v174
    v_sub_f32 v57, v57, v174
    v_sub_f32 v18, v18, v174
    v_sub_f32 v58, v58, v174
    v_sub_f32 v19, v19, v174
    v_sub_f32 v59, v59, v174
    v_sub_f32 v20, v20, v174
    v_sub_f32 v60, v60, v174
    v_sub_f32 v21, v21, v174
    v_sub_f32 v61, v61, v174
    v_sub_f32 v22, v22, v174
    v_sub_f32 v62, v62, v174
    v_sub_f32 v23, v23, v174
    v_sub_f32 v63, v63, v174
    v_mul_f32 v161, v161, v175
    v_accvgpr_read_b32 v166, a0
    s_nop 0
    v_mul_f32 v166, v166, v175
    s_nop 0
    v_accvgpr_write_b32 a0, v166
    v_accvgpr_read_b32 v166, a1
    s_nop 0
    v_mul_f32 v166, v166, v175
    s_nop 0
    v_accvgpr_write_b32 a1, v166
    v_accvgpr_read_b32 v166, a2
    s_nop 0
    v_mul_f32 v166, v166, v175
    s_nop 0
    v_accvgpr_write_b32 a2, v166
    v_accvgpr_read_b32 v166, a3
    s_nop 0
    v_mul_f32 v166, v166, v175
    s_nop 0
    v_accvgpr_write_b32 a3, v166
    v_accvgpr_read_b32 v166, a20
    s_nop 0
    v_mul_f32 v166, v166, v175
    s_nop 0
    v_accvgpr_write_b32 a20, v166
    v_accvgpr_read_b32 v166, a21
    s_nop 0
    v_mul_f32 v166, v166, v175
    s_nop 0
    v_accvgpr_write_b32 a21, v166
    v_accvgpr_read_b32 v166, a22
    s_nop 0
    v_mul_f32 v166, v166, v175
    s_nop 0
    v_accvgpr_write_b32 a22, v166
    v_accvgpr_read_b32 v166, a23
    s_nop 0
    v_mul_f32 v166, v166, v175
    s_nop 0
    v_accvgpr_write_b32 a23, v166
    v_accvgpr_read_b32 v166, a40
    s_nop 0
    v_mul_f32 v166, v166, v175
    s_nop 0
    v_accvgpr_write_b32 a40, v166
    v_accvgpr_read_b32 v166, a41
    s_nop 0
    v_mul_f32 v166, v166, v175
    s_nop 0
    v_accvgpr_write_b32 a41, v166
    v_accvgpr_read_b32 v166, a42
    s_nop 0
    v_mul_f32 v166, v166, v175
    s_nop 0
    v_accvgpr_write_b32 a42, v166
    v_accvgpr_read_b32 v166, a43
    s_nop 0
    v_mul_f32 v166, v166, v175
    s_nop 0
    v_accvgpr_write_b32 a43, v166
    v_accvgpr_read_b32 v166, a60
    s_nop 0
    v_mul_f32 v166, v166, v175
    s_nop 0
    v_accvgpr_write_b32 a60, v166
    v_accvgpr_read_b32 v166, a61
    s_nop 0
    v_mul_f32 v166, v166, v175
    s_nop 0
    v_accvgpr_write_b32 a61, v166
    v_accvgpr_read_b32 v166, a62
    s_nop 0
    v_mul_f32 v166, v166, v175
    s_nop 0
    v_accvgpr_write_b32 a62, v166
    v_accvgpr_read_b32 v166, a63
    s_nop 0
    v_mul_f32 v166, v166, v175
    s_nop 0
    v_accvgpr_write_b32 a63, v166
    v_accvgpr_read_b32 v166, a80
    s_nop 0
    v_mul_f32 v166, v166, v175
    s_nop 0
    v_accvgpr_write_b32 a80, v166
    v_accvgpr_read_b32 v166, a81
    s_nop 0
    v_mul_f32 v166, v166, v175
    s_nop 0
    v_accvgpr_write_b32 a81, v166
    v_accvgpr_read_b32 v166, a82
    s_nop 0
    v_mul_f32 v166, v166, v175
    s_nop 0
    v_accvgpr_write_b32 a82, v166
    v_accvgpr_read_b32 v166, a83
    s_nop 0
    v_mul_f32 v166, v166, v175
    s_nop 0
    v_accvgpr_write_b32 a83, v166
    v_accvgpr_read_b32 v166, a100
    s_nop 0
    v_mul_f32 v166, v166, v175
    s_nop 0
    v_accvgpr_write_b32 a100, v166
    v_accvgpr_read_b32 v166, a101
    s_nop 0
    v_mul_f32 v166, v166, v175
    s_nop 0
    v_accvgpr_write_b32 a101, v166
    v_accvgpr_read_b32 v166, a102
    s_nop 0
    v_mul_f32 v166, v166, v175
    s_nop 0
    v_accvgpr_write_b32 a102, v166
    v_accvgpr_read_b32 v166, a103
    s_nop 0
    v_mul_f32 v166, v166, v175
    s_nop 0
    v_accvgpr_write_b32 a103, v166
    v_accvgpr_read_b32 v166, a120
    s_nop 0
    v_mul_f32 v166, v166, v175
    s_nop 0
    v_accvgpr_write_b32 a120, v166
    v_accvgpr_read_b32 v166, a121
    s_nop 0
    v_mul_f32 v166, v166, v175
    s_nop 0
    v_accvgpr_write_b32 a121, v166
    v_accvgpr_read_b32 v166, a122
    s_nop 0
    v_mul_f32 v166, v166, v175
    s_nop 0
    v_accvgpr_write_b32 a122, v166
    v_accvgpr_read_b32 v166, a123
    s_nop 0
    v_mul_f32 v166, v166, v175
    s_nop 0
    v_accvgpr_write_b32 a123, v166
    v_accvgpr_read_b32 v166, a140
    s_nop 0
    v_mul_f32 v166, v166, v175
    s_nop 0
    v_accvgpr_write_b32 a140, v166
    v_accvgpr_read_b32 v166, a141
    s_nop 0
    v_mul_f32 v166, v166, v175
    s_nop 0
    v_accvgpr_write_b32 a141, v166
    v_accvgpr_read_b32 v166, a142
    s_nop 0
    v_mul_f32 v166, v166, v175
    s_nop 0
    v_accvgpr_write_b32 a142, v166
    v_accvgpr_read_b32 v166, a143
    s_nop 0
    v_mul_f32 v166, v166, v175
    s_nop 0
    v_accvgpr_write_b32 a143, v166
    v_exp_f32 v166, v16
    v_exp_f32 v167, v17
    v_exp_f32 v168, v18
    v_add_f32 v156, v166, v167
    v_exp_f32 v169, v19
    v_cvt_pk_bf16_f32 v96, v166, v167
    v_add_f32 v156, v156, v168
    v_exp_f32 v170, v20
    v_add_f32 v156, v156, v169
    v_cvt_pk_bf16_f32 v97, v168, v169
    v_exp_f32 v171, v21
    v_add_f32 v156, v156, v170
    v_exp_f32 v172, v22
    v_add_f32 v156, v156, v171
    v_cvt_pk_bf16_f32 v98, v170, v171
    v_exp_f32 v173, v23
    v_add_f32 v156, v156, v172
    v_nop
    v_add_f32 v156, v156, v173
    v_cvt_pk_bf16_f32 v99, v172, v173
    v_max3_f32 v174, v24, v25, v26
    v_max3_f32 v174, v174, v27, v28
    v_max3_f32 v174, v174, v29, v30
    v_max_f32 v174, v174, v31
    v_mov_b32 v166, v174
    v_mov_b32 v167, v174
    s_nop 1
    v_permlane32_swap_b32 v166, v167
    s_nop 1
    v_max_f32 v174, v166, v167
    v_mov_b32 v166, v174
    v_mov_b32 v167, v174
    s_nop 1
    v_permlane16_swap_b32 v166, v167
    s_nop 1
    v_max_f32 v174, v166, v167
    v_max_f32 v174, 0, v174
    v_sub_f32 v175, 0, v174
    v_exp_f32 v175, v175
    v_sub_f32 v140, v140, v174
    v_sub_f32 v141, v141, v174
    v_sub_f32 v142, v142, v174
    v_sub_f32 v143, v143, v174
    v_sub_f32 v24, v24, v174
    v_sub_f32 v64, v64, v174
    v_sub_f32 v25, v25, v174
    v_sub_f32 v65, v65, v174
    v_sub_f32 v26, v26, v174
    v_sub_f32 v66, v66, v174
    v_sub_f32 v27, v27, v174
    v_sub_f32 v67, v67, v174
    v_sub_f32 v28, v28, v174
    v_sub_f32 v68, v68, v174
    v_sub_f32 v29, v29, v174
    v_sub_f32 v69, v69, v174
    v_sub_f32 v30, v30, v174
    v_sub_f32 v70, v70, v174
    v_sub_f32 v31, v31, v174
    v_sub_f32 v71, v71, v174
    v_mul_f32 v162, v162, v175
    v_accvgpr_read_b32 v166, a4
    s_nop 0
    v_mul_f32 v166, v166, v175
    s_nop 0
    v_accvgpr_write_b32 a4, v166
    v_accvgpr_read_b32 v166, a5
    s_nop 0
    v_mul_f32 v166, v166, v175
    s_nop 0
    v_accvgpr_write_b32 a5, v166
    v_accvgpr_read_b32 v166, a6
    s_nop 0
    v_mul_f32 v166, v166, v175
    s_nop 0
    v_accvgpr_write_b32 a6, v166
    v_accvgpr_read_b32 v166, a7
    s_nop 0
    v_mul_f32 v166, v166, v175
    s_nop 0
    v_accvgpr_write_b32 a7, v166
    v_accvgpr_read_b32 v166, a24
    s_nop 0
    v_mul_f32 v166, v166, v175
    s_nop 0
    v_accvgpr_write_b32 a24, v166
    v_accvgpr_read_b32 v166, a25
    s_nop 0
    v_mul_f32 v166, v166, v175
    s_nop 0
    v_accvgpr_write_b32 a25, v166
    v_accvgpr_read_b32 v166, a26
    s_nop 0
    v_mul_f32 v166, v166, v175
    s_nop 0
    v_accvgpr_write_b32 a26, v166
    v_accvgpr_read_b32 v166, a27
    s_nop 0
    v_mul_f32 v166, v166, v175
    s_nop 0
    v_accvgpr_write_b32 a27, v166
    v_accvgpr_read_b32 v166, a44
    s_nop 0
    v_mul_f32 v166, v166, v175
    s_nop 0
    v_accvgpr_write_b32 a44, v166
    v_accvgpr_read_b32 v166, a45
    s_nop 0
    v_mul_f32 v166, v166, v175
    s_nop 0
    v_accvgpr_write_b32 a45, v166
    v_accvgpr_read_b32 v166, a46
    s_nop 0
    v_mul_f32 v166, v166, v175
    s_nop 0
    v_accvgpr_write_b32 a46, v166
    v_accvgpr_read_b32 v166, a47
    s_nop 0
    v_mul_f32 v166, v166, v175
    s_nop 0
    v_accvgpr_write_b32 a47, v166
    v_accvgpr_read_b32 v166, a64
    s_nop 0
    v_mul_f32 v166, v166, v175
    s_nop 0
    v_accvgpr_write_b32 a64, v166
    v_accvgpr_read_b32 v166, a65
    s_nop 0
    v_mul_f32 v166, v166, v175
    s_nop 0
    v_accvgpr_write_b32 a65, v166
    v_accvgpr_read_b32 v166, a66
    s_nop 0
    v_mul_f32 v166, v166, v175
    s_nop 0
    v_accvgpr_write_b32 a66, v166
    v_accvgpr_read_b32 v166, a67
    s_nop 0
    v_mul_f32 v166, v166, v175
    s_nop 0
    v_accvgpr_write_b32 a67, v166
    v_accvgpr_read_b32 v166, a84
    s_nop 0
    v_mul_f32 v166, v166, v175
    s_nop 0
    v_accvgpr_write_b32 a84, v166
    v_accvgpr_read_b32 v166, a85
    s_nop 0
    v_mul_f32 v166, v166, v175
    s_nop 0
    v_accvgpr_write_b32 a85, v166
    v_accvgpr_read_b32 v166, a86
    s_nop 0
    v_mul_f32 v166, v166, v175
    s_nop 0
    v_accvgpr_write_b32 a86, v166
    v_accvgpr_read_b32 v166, a87
    s_nop 0
    v_mul_f32 v166, v166, v175
    s_nop 0
    v_accvgpr_write_b32 a87, v166
    v_accvgpr_read_b32 v166, a104
    s_nop 0
    v_mul_f32 v166, v166, v175
    s_nop 0
    v_accvgpr_write_b32 a104, v166
    v_accvgpr_read_b32 v166, a105
    s_nop 0
    v_mul_f32 v166, v166, v175
    s_nop 0
    v_accvgpr_write_b32 a105, v166
    v_accvgpr_read_b32 v166, a106
    s_nop 0
    v_mul_f32 v166, v166, v175
    s_nop 0
    v_accvgpr_write_b32 a106, v166
    v_accvgpr_read_b32 v166, a107
    s_nop 0
    v_mul_f32 v166, v166, v175
    s_nop 0
    v_accvgpr_write_b32 a107, v166
    v_accvgpr_read_b32 v166, a124
    s_nop 0
    v_mul_f32 v166, v166, v175
    s_nop 0
    v_accvgpr_write_b32 a124, v166
    v_accvgpr_read_b32 v166, a125
    s_nop 0
    v_mul_f32 v166, v166, v175
    s_nop 0
    v_accvgpr_write_b32 a125, v166
    v_accvgpr_read_b32 v166, a126
    s_nop 0
    v_mul_f32 v166, v166, v175
    s_nop 0
    v_accvgpr_write_b32 a126, v166
    v_accvgpr_read_b32 v166, a127
    s_nop 0
    v_mul_f32 v166, v166, v175
    s_nop 0
    v_accvgpr_write_b32 a127, v166
    v_accvgpr_read_b32 v166, a144
    s_nop 0
    v_mul_f32 v166, v166, v175
    s_nop 0
    v_accvgpr_write_b32 a144, v166
    v_accvgpr_read_b32 v166, a145
    s_nop 0
    v_mul_f32 v166, v166, v175
    s_nop 0
    v_accvgpr_write_b32 a145, v166
    v_accvgpr_read_b32 v166, a146
    s_nop 0
    v_mul_f32 v166, v166, v175
    s_nop 0
    v_accvgpr_write_b32 a146, v166
    v_accvgpr_read_b32 v166, a147
    s_nop 0
    v_mul_f32 v166, v166, v175
    s_nop 0
    v_accvgpr_write_b32 a147, v166
    v_exp_f32 v166, v24
    v_exp_f32 v167, v25
    v_exp_f32 v168, v26
    v_add_f32 v157, v166, v167
    v_exp_f32 v169, v27
    v_cvt_pk_bf16_f32 v100, v166, v167
    v_add_f32 v157, v157, v168
    v_exp_f32 v170, v28
    v_add_f32 v157, v157, v169
    v_cvt_pk_bf16_f32 v101, v168, v169
    v_exp_f32 v171, v29
    v_add_f32 v157, v157, v170
    v_exp_f32 v172, v30
    v_add_f32 v157, v157, v171
    v_cvt_pk_bf16_f32 v102, v170, v171
    v_exp_f32 v173, v31
    v_add_f32 v157, v157, v172
    v_nop
    v_add_f32 v157, v157, v173
    v_cvt_pk_bf16_f32 v103, v172, v173
    v_max3_f32 v174, v32, v33, v34
    v_max3_f32 v174, v174, v35, v36
    v_max3_f32 v174, v174, v37, v38
    v_max_f32 v174, v174, v39
    v_mov_b32 v166, v174
    v_mov_b32 v167, v174
    s_nop 1
    v_permlane32_swap_b32 v166, v167
    s_nop 1
    v_max_f32 v174, v166, v167
    v_mov_b32 v166, v174
    v_mov_b32 v167, v174
    s_nop 1
    v_permlane16_swap_b32 v166, v167
    s_nop 1
    v_max_f32 v174, v166, v167
    v_max_f32 v174, 0, v174
    v_sub_f32 v175, 0, v174
    v_exp_f32 v175, v175
    v_sub_f32 v144, v144, v174
    v_sub_f32 v145, v145, v174
    v_sub_f32 v146, v146, v174
    v_sub_f32 v147, v147, v174
    v_sub_f32 v32, v32, v174
    v_sub_f32 v72, v72, v174
    v_sub_f32 v33, v33, v174
    v_sub_f32 v73, v73, v174
    v_sub_f32 v34, v34, v174
    v_sub_f32 v74, v74, v174
    v_sub_f32 v35, v35, v174
    v_sub_f32 v75, v75, v174
    v_sub_f32 v36, v36, v174
    v_sub_f32 v76, v76, v174
    v_sub_f32 v37, v37, v174
    v_sub_f32 v77, v77, v174
    v_sub_f32 v38, v38, v174
    v_sub_f32 v78, v78, v174
    v_sub_f32 v39, v39, v174
    v_sub_f32 v79, v79, v174
    v_mul_f32 v163, v163, v175
    v_accvgpr_read_b32 v166, a8
    s_nop 0
    v_mul_f32 v166, v166, v175
    s_nop 0
    v_accvgpr_write_b32 a8, v166
    v_accvgpr_read_b32 v166, a9
    s_nop 0
    v_mul_f32 v166, v166, v175
    s_nop 0
    v_accvgpr_write_b32 a9, v166
    v_accvgpr_read_b32 v166, a10
    s_nop 0
    v_mul_f32 v166, v166, v175
    s_nop 0
    v_accvgpr_write_b32 a10, v166
    v_accvgpr_read_b32 v166, a11
    s_nop 0
    v_mul_f32 v166, v166, v175
    s_nop 0
    v_accvgpr_write_b32 a11, v166
    v_accvgpr_read_b32 v166, a28
    s_nop 0
    v_mul_f32 v166, v166, v175
    s_nop 0
    v_accvgpr_write_b32 a28, v166
    v_accvgpr_read_b32 v166, a29
    s_nop 0
    v_mul_f32 v166, v166, v175
    s_nop 0
    v_accvgpr_write_b32 a29, v166
    v_accvgpr_read_b32 v166, a30
    s_nop 0
    v_mul_f32 v166, v166, v175
    s_nop 0
    v_accvgpr_write_b32 a30, v166
    v_accvgpr_read_b32 v166, a31
    s_nop 0
    v_mul_f32 v166, v166, v175
    s_nop 0
    v_accvgpr_write_b32 a31, v166
    v_accvgpr_read_b32 v166, a48
    s_nop 0
    v_mul_f32 v166, v166, v175
    s_nop 0
    v_accvgpr_write_b32 a48, v166
    v_accvgpr_read_b32 v166, a49
    s_nop 0
    v_mul_f32 v166, v166, v175
    s_nop 0
    v_accvgpr_write_b32 a49, v166
    v_accvgpr_read_b32 v166, a50
    s_nop 0
    v_mul_f32 v166, v166, v175
    s_nop 0
    v_accvgpr_write_b32 a50, v166
    v_accvgpr_read_b32 v166, a51
    s_nop 0
    v_mul_f32 v166, v166, v175
    s_nop 0
    v_accvgpr_write_b32 a51, v166
    v_accvgpr_read_b32 v166, a68
    s_nop 0
    v_mul_f32 v166, v166, v175
    s_nop 0
    v_accvgpr_write_b32 a68, v166
    v_accvgpr_read_b32 v166, a69
    s_nop 0
    v_mul_f32 v166, v166, v175
    s_nop 0
    v_accvgpr_write_b32 a69, v166
    v_accvgpr_read_b32 v166, a70
    s_nop 0
    v_mul_f32 v166, v166, v175
    s_nop 0
    v_accvgpr_write_b32 a70, v166
    v_accvgpr_read_b32 v166, a71
    s_nop 0
    v_mul_f32 v166, v166, v175
    s_nop 0
    v_accvgpr_write_b32 a71, v166
    v_accvgpr_read_b32 v166, a88
    s_nop 0
    v_mul_f32 v166, v166, v175
    s_nop 0
    v_accvgpr_write_b32 a88, v166
    v_accvgpr_read_b32 v166, a89
    s_nop 0
    v_mul_f32 v166, v166, v175
    s_nop 0
    v_accvgpr_write_b32 a89, v166
    v_accvgpr_read_b32 v166, a90
    s_nop 0
    v_mul_f32 v166, v166, v175
    s_nop 0
    v_accvgpr_write_b32 a90, v166
    v_accvgpr_read_b32 v166, a91
    s_nop 0
    v_mul_f32 v166, v166, v175
    s_nop 0
    v_accvgpr_write_b32 a91, v166
    v_accvgpr_read_b32 v166, a108
    s_nop 0
    v_mul_f32 v166, v166, v175
    s_nop 0
    v_accvgpr_write_b32 a108, v166
    v_accvgpr_read_b32 v166, a109
    s_nop 0
    v_mul_f32 v166, v166, v175
    s_nop 0
    v_accvgpr_write_b32 a109, v166
    v_accvgpr_read_b32 v166, a110
    s_nop 0
    v_mul_f32 v166, v166, v175
    s_nop 0
    v_accvgpr_write_b32 a110, v166
    v_accvgpr_read_b32 v166, a111
    s_nop 0
    v_mul_f32 v166, v166, v175
    s_nop 0
    v_accvgpr_write_b32 a111, v166
    v_accvgpr_read_b32 v166, a128
    s_nop 0
    v_mul_f32 v166, v166, v175
    s_nop 0
    v_accvgpr_write_b32 a128, v166
    v_accvgpr_read_b32 v166, a129
    s_nop 0
    v_mul_f32 v166, v166, v175
    s_nop 0
    v_accvgpr_write_b32 a129, v166
    v_accvgpr_read_b32 v166, a130
    s_nop 0
    v_mul_f32 v166, v166, v175
    s_nop 0
    v_accvgpr_write_b32 a130, v166
    v_accvgpr_read_b32 v166, a131
    s_nop 0
    v_mul_f32 v166, v166, v175
    s_nop 0
    v_accvgpr_write_b32 a131, v166
    v_accvgpr_read_b32 v166, a148
    s_nop 0
    v_mul_f32 v166, v166, v175
    s_nop 0
    v_accvgpr_write_b32 a148, v166
    v_accvgpr_read_b32 v166, a149
    s_nop 0
    v_mul_f32 v166, v166, v175
    s_nop 0
    v_accvgpr_write_b32 a149, v166
    v_accvgpr_read_b32 v166, a150
    s_nop 0
    v_mul_f32 v166, v166, v175
    s_nop 0
    v_accvgpr_write_b32 a150, v166
    v_accvgpr_read_b32 v166, a151
    s_nop 0
    v_mul_f32 v166, v166, v175
    s_nop 0
    v_accvgpr_write_b32 a151, v166
    v_exp_f32 v166, v32
    v_exp_f32 v167, v33
    v_exp_f32 v168, v34
    v_add_f32 v158, v166, v167
    v_exp_f32 v169, v35
    v_cvt_pk_bf16_f32 v104, v166, v167
    v_add_f32 v158, v158, v168
    v_exp_f32 v170, v36
    v_add_f32 v158, v158, v169
    v_cvt_pk_bf16_f32 v105, v168, v169
    v_exp_f32 v171, v37
    v_add_f32 v158, v158, v170
    v_exp_f32 v172, v38
    v_add_f32 v158, v158, v171
    v_cvt_pk_bf16_f32 v106, v170, v171
    v_exp_f32 v173, v39
    v_add_f32 v158, v158, v172
    v_nop
    v_add_f32 v158, v158, v173
    v_cvt_pk_bf16_f32 v107, v172, v173
    v_max3_f32 v174, v40, v41, v42
    v_max3_f32 v174, v174, v43, v44
    v_max3_f32 v174, v174, v45, v46
    v_max_f32 v174, v174, v47
    v_mov_b32 v166, v174
    v_mov_b32 v167, v174
    s_nop 1
    v_permlane32_swap_b32 v166, v167
    s_nop 1
    v_max_f32 v174, v166, v167
    v_mov_b32 v166, v174
    v_mov_b32 v167, v174
    s_nop 1
    v_permlane16_swap_b32 v166, v167
    s_nop 1
    v_max_f32 v174, v166, v167
    v_max_f32 v174, 0, v174
    v_sub_f32 v175, 0, v174
    v_exp_f32 v175, v175
    v_sub_f32 v148, v148, v174
    v_sub_f32 v149, v149, v174
    v_sub_f32 v150, v150, v174
    v_sub_f32 v151, v151, v174
    v_sub_f32 v40, v40, v174
    v_sub_f32 v80, v80, v174
    v_sub_f32 v41, v41, v174
    v_sub_f32 v81, v81, v174
    v_sub_f32 v42, v42, v174
    v_sub_f32 v82, v82, v174
    v_sub_f32 v43, v43, v174
    v_sub_f32 v83, v83, v174
    v_sub_f32 v44, v44, v174
    v_sub_f32 v84, v84, v174
    v_sub_f32 v45, v45, v174
    v_sub_f32 v85, v85, v174
    v_sub_f32 v46, v46, v174
    v_sub_f32 v86, v86, v174
    v_sub_f32 v47, v47, v174
    v_sub_f32 v87, v87, v174
    v_mul_f32 v164, v164, v175
    v_accvgpr_read_b32 v166, a12
    s_nop 0
    v_mul_f32 v166, v166, v175
    s_nop 0
    v_accvgpr_write_b32 a12, v166
    v_accvgpr_read_b32 v166, a13
    s_nop 0
    v_mul_f32 v166, v166, v175
    s_nop 0
    v_accvgpr_write_b32 a13, v166
    v_accvgpr_read_b32 v166, a14
    s_nop 0
    v_mul_f32 v166, v166, v175
    s_nop 0
    v_accvgpr_write_b32 a14, v166
    v_accvgpr_read_b32 v166, a15
    s_nop 0
    v_mul_f32 v166, v166, v175
    s_nop 0
    v_accvgpr_write_b32 a15, v166
    v_accvgpr_read_b32 v166, a32
    s_nop 0
    v_mul_f32 v166, v166, v175
    s_nop 0
    v_accvgpr_write_b32 a32, v166
    v_accvgpr_read_b32 v166, a33
    s_nop 0
    v_mul_f32 v166, v166, v175
    s_nop 0
    v_accvgpr_write_b32 a33, v166
    v_accvgpr_read_b32 v166, a34
    s_nop 0
    v_mul_f32 v166, v166, v175
    s_nop 0
    v_accvgpr_write_b32 a34, v166
    v_accvgpr_read_b32 v166, a35
    s_nop 0
    v_mul_f32 v166, v166, v175
    s_nop 0
    v_accvgpr_write_b32 a35, v166
    v_accvgpr_read_b32 v166, a52
    s_nop 0
    v_mul_f32 v166, v166, v175
    s_nop 0
    v_accvgpr_write_b32 a52, v166
    v_accvgpr_read_b32 v166, a53
    s_nop 0
    v_mul_f32 v166, v166, v175
    s_nop 0
    v_accvgpr_write_b32 a53, v166
    v_accvgpr_read_b32 v166, a54
    s_nop 0
    v_mul_f32 v166, v166, v175
    s_nop 0
    v_accvgpr_write_b32 a54, v166
    v_accvgpr_read_b32 v166, a55
    s_nop 0
    v_mul_f32 v166, v166, v175
    s_nop 0
    v_accvgpr_write_b32 a55, v166
    v_accvgpr_read_b32 v166, a72
    s_nop 0
    v_mul_f32 v166, v166, v175
    s_nop 0
    v_accvgpr_write_b32 a72, v166
    v_accvgpr_read_b32 v166, a73
    s_nop 0
    v_mul_f32 v166, v166, v175
    s_nop 0
    v_accvgpr_write_b32 a73, v166
    v_accvgpr_read_b32 v166, a74
    s_nop 0
    v_mul_f32 v166, v166, v175
    s_nop 0
    v_accvgpr_write_b32 a74, v166
    v_accvgpr_read_b32 v166, a75
    s_nop 0
    v_mul_f32 v166, v166, v175
    s_nop 0
    v_accvgpr_write_b32 a75, v166
    v_accvgpr_read_b32 v166, a92
    s_nop 0
    v_mul_f32 v166, v166, v175
    s_nop 0
    v_accvgpr_write_b32 a92, v166
    v_accvgpr_read_b32 v166, a93
    s_nop 0
    v_mul_f32 v166, v166, v175
    s_nop 0
    v_accvgpr_write_b32 a93, v166
    v_accvgpr_read_b32 v166, a94
    s_nop 0
    v_mul_f32 v166, v166, v175
    s_nop 0
    v_accvgpr_write_b32 a94, v166
    v_accvgpr_read_b32 v166, a95
    s_nop 0
    v_mul_f32 v166, v166, v175
    s_nop 0
    v_accvgpr_write_b32 a95, v166
    v_accvgpr_read_b32 v166, a112
    s_nop 0
    v_mul_f32 v166, v166, v175
    s_nop 0
    v_accvgpr_write_b32 a112, v166
    v_accvgpr_read_b32 v166, a113
    s_nop 0
    v_mul_f32 v166, v166, v175
    s_nop 0
    v_accvgpr_write_b32 a113, v166
    v_accvgpr_read_b32 v166, a114
    s_nop 0
    v_mul_f32 v166, v166, v175
    s_nop 0
    v_accvgpr_write_b32 a114, v166
    v_accvgpr_read_b32 v166, a115
    s_nop 0
    v_mul_f32 v166, v166, v175
    s_nop 0
    v_accvgpr_write_b32 a115, v166
    v_accvgpr_read_b32 v166, a132
    s_nop 0
    v_mul_f32 v166, v166, v175
    s_nop 0
    v_accvgpr_write_b32 a132, v166
    v_accvgpr_read_b32 v166, a133
    s_nop 0
    v_mul_f32 v166, v166, v175
    s_nop 0
    v_accvgpr_write_b32 a133, v166
    v_accvgpr_read_b32 v166, a134
    s_nop 0
    v_mul_f32 v166, v166, v175
    s_nop 0
    v_accvgpr_write_b32 a134, v166
    v_accvgpr_read_b32 v166, a135
    s_nop 0
    v_mul_f32 v166, v166, v175
    s_nop 0
    v_accvgpr_write_b32 a135, v166
    v_accvgpr_read_b32 v166, a152
    s_nop 0
    v_mul_f32 v166, v166, v175
    s_nop 0
    v_accvgpr_write_b32 a152, v166
    v_accvgpr_read_b32 v166, a153
    s_nop 0
    v_mul_f32 v166, v166, v175
    s_nop 0
    v_accvgpr_write_b32 a153, v166
    v_accvgpr_read_b32 v166, a154
    s_nop 0
    v_mul_f32 v166, v166, v175
    s_nop 0
    v_accvgpr_write_b32 a154, v166
    v_accvgpr_read_b32 v166, a155
    s_nop 0
    v_mul_f32 v166, v166, v175
    s_nop 0
    v_accvgpr_write_b32 a155, v166
    v_exp_f32 v166, v40
    v_exp_f32 v167, v41
    v_exp_f32 v168, v42
    v_add_f32 v159, v166, v167
    v_exp_f32 v169, v43
    v_cvt_pk_bf16_f32 v108, v166, v167
    v_add_f32 v159, v159, v168
    v_exp_f32 v170, v44
    v_add_f32 v159, v159, v169
    v_cvt_pk_bf16_f32 v109, v168, v169
    v_exp_f32 v171, v45
    v_add_f32 v159, v159, v170
    v_exp_f32 v172, v46
    v_add_f32 v159, v159, v171
    v_cvt_pk_bf16_f32 v110, v170, v171
    v_exp_f32 v173, v47
    v_add_f32 v159, v159, v172
    v_nop
    v_add_f32 v159, v159, v173
    v_cvt_pk_bf16_f32 v111, v172, v173
    v_max3_f32 v174, v48, v49, v50
    v_max3_f32 v174, v174, v51, v52
    v_max3_f32 v174, v174, v53, v54
    v_max_f32 v174, v174, v55
    v_mov_b32 v166, v174
    v_mov_b32 v167, v174
    s_nop 1
    v_permlane32_swap_b32 v166, v167
    s_nop 1
    v_max_f32 v174, v166, v167
    v_mov_b32 v166, v174
    v_mov_b32 v167, v174
    s_nop 1
    v_permlane16_swap_b32 v166, v167
    s_nop 1
    v_max_f32 v174, v166, v167
    v_max_f32 v174, 0, v174
    v_sub_f32 v175, 0, v174
    v_exp_f32 v175, v175
    v_sub_f32 v152, v152, v174
    v_sub_f32 v153, v153, v174
    v_sub_f32 v154, v154, v174
    v_sub_f32 v155, v155, v174
    v_sub_f32 v48, v48, v174
    v_sub_f32 v88, v88, v174
    v_sub_f32 v49, v49, v174
    v_sub_f32 v89, v89, v174
    v_sub_f32 v50, v50, v174
    v_sub_f32 v90, v90, v174
    v_sub_f32 v51, v51, v174
    v_sub_f32 v91, v91, v174
    v_sub_f32 v52, v52, v174
    v_sub_f32 v92, v92, v174
    v_sub_f32 v53, v53, v174
    v_sub_f32 v93, v93, v174
    v_sub_f32 v54, v54, v174
    v_sub_f32 v94, v94, v174
    v_sub_f32 v55, v55, v174
    v_sub_f32 v95, v95, v174
    v_mul_f32 v165, v165, v175
    v_accvgpr_read_b32 v166, a16
    s_nop 0
    v_mul_f32 v166, v166, v175
    s_nop 0
    v_accvgpr_write_b32 a16, v166
    v_accvgpr_read_b32 v166, a17
    s_nop 0
    v_mul_f32 v166, v166, v175
    s_nop 0
    v_accvgpr_write_b32 a17, v166
    v_accvgpr_read_b32 v166, a18
    s_nop 0
    v_mul_f32 v166, v166, v175
    s_nop 0
    v_accvgpr_write_b32 a18, v166
    v_accvgpr_read_b32 v166, a19
    s_nop 0
    v_mul_f32 v166, v166, v175
    s_nop 0
    v_accvgpr_write_b32 a19, v166
    v_accvgpr_read_b32 v166, a36
    s_nop 0
    v_mul_f32 v166, v166, v175
    s_nop 0
    v_accvgpr_write_b32 a36, v166
    v_accvgpr_read_b32 v166, a37
    s_nop 0
    v_mul_f32 v166, v166, v175
    s_nop 0
    v_accvgpr_write_b32 a37, v166
    v_accvgpr_read_b32 v166, a38
    s_nop 0
    v_mul_f32 v166, v166, v175
    s_nop 0
    v_accvgpr_write_b32 a38, v166
    v_accvgpr_read_b32 v166, a39
    s_nop 0
    v_mul_f32 v166, v166, v175
    s_nop 0
    v_accvgpr_write_b32 a39, v166
    v_accvgpr_read_b32 v166, a56
    s_nop 0
    v_mul_f32 v166, v166, v175
    s_nop 0
    v_accvgpr_write_b32 a56, v166
    v_accvgpr_read_b32 v166, a57
    s_nop 0
    v_mul_f32 v166, v166, v175
    s_nop 0
    v_accvgpr_write_b32 a57, v166
    v_accvgpr_read_b32 v166, a58
    s_nop 0
    v_mul_f32 v166, v166, v175
    s_nop 0
    v_accvgpr_write_b32 a58, v166
    v_accvgpr_read_b32 v166, a59
    s_nop 0
    v_mul_f32 v166, v166, v175
    s_nop 0
    v_accvgpr_write_b32 a59, v166
    v_accvgpr_read_b32 v166, a76
    s_nop 0
    v_mul_f32 v166, v166, v175
    s_nop 0
    v_accvgpr_write_b32 a76, v166
    v_accvgpr_read_b32 v166, a77
    s_nop 0
    v_mul_f32 v166, v166, v175
    s_nop 0
    v_accvgpr_write_b32 a77, v166
    v_accvgpr_read_b32 v166, a78
    s_nop 0
    v_mul_f32 v166, v166, v175
    s_nop 0
    v_accvgpr_write_b32 a78, v166
    v_accvgpr_read_b32 v166, a79
    s_nop 0
    v_mul_f32 v166, v166, v175
    s_nop 0
    v_accvgpr_write_b32 a79, v166
    v_accvgpr_read_b32 v166, a96
    s_nop 0
    v_mul_f32 v166, v166, v175
    s_nop 0
    v_accvgpr_write_b32 a96, v166
    v_accvgpr_read_b32 v166, a97
    s_nop 0
    v_mul_f32 v166, v166, v175
    s_nop 0
    v_accvgpr_write_b32 a97, v166
    v_accvgpr_read_b32 v166, a98
    s_nop 0
    v_mul_f32 v166, v166, v175
    s_nop 0
    v_accvgpr_write_b32 a98, v166
    v_accvgpr_read_b32 v166, a99
    s_nop 0
    v_mul_f32 v166, v166, v175
    s_nop 0
    v_accvgpr_write_b32 a99, v166
    v_accvgpr_read_b32 v166, a116
    s_nop 0
    v_mul_f32 v166, v166, v175
    s_nop 0
    v_accvgpr_write_b32 a116, v166
    v_accvgpr_read_b32 v166, a117
    s_nop 0
    v_mul_f32 v166, v166, v175
    s_nop 0
    v_accvgpr_write_b32 a117, v166
    v_accvgpr_read_b32 v166, a118
    s_nop 0
    v_mul_f32 v166, v166, v175
    s_nop 0
    v_accvgpr_write_b32 a118, v166
    v_accvgpr_read_b32 v166, a119
    s_nop 0
    v_mul_f32 v166, v166, v175
    s_nop 0
    v_accvgpr_write_b32 a119, v166
    v_accvgpr_read_b32 v166, a136
    s_nop 0
    v_mul_f32 v166, v166, v175
    s_nop 0
    v_accvgpr_write_b32 a136, v166
    v_accvgpr_read_b32 v166, a137
    s_nop 0
    v_mul_f32 v166, v166, v175
    s_nop 0
    v_accvgpr_write_b32 a137, v166
    v_accvgpr_read_b32 v166, a138
    s_nop 0
    v_mul_f32 v166, v166, v175
    s_nop 0
    v_accvgpr_write_b32 a138, v166
    v_accvgpr_read_b32 v166, a139
    s_nop 0
    v_mul_f32 v166, v166, v175
    s_nop 0
    v_accvgpr_write_b32 a139, v166
    v_accvgpr_read_b32 v166, a156
    s_nop 0
    v_mul_f32 v166, v166, v175
    s_nop 0
    v_accvgpr_write_b32 a156, v166
    v_accvgpr_read_b32 v166, a157
    s_nop 0
    v_mul_f32 v166, v166, v175
    s_nop 0
    v_accvgpr_write_b32 a157, v166
    v_accvgpr_read_b32 v166, a158
    s_nop 0
    v_mul_f32 v166, v166, v175
    s_nop 0
    v_accvgpr_write_b32 a158, v166
    v_accvgpr_read_b32 v166, a159
    s_nop 0
    v_mul_f32 v166, v166, v175
    s_nop 0
    v_accvgpr_write_b32 a159, v166
    v_exp_f32 v166, v48
    v_exp_f32 v167, v49
    v_exp_f32 v168, v50
    v_add_f32 v160, v166, v167
    v_exp_f32 v169, v51
    v_cvt_pk_bf16_f32 v112, v166, v167
    v_add_f32 v160, v160, v168
    v_exp_f32 v170, v52
    v_add_f32 v160, v160, v169
    v_cvt_pk_bf16_f32 v113, v168, v169
    v_exp_f32 v171, v53
    v_add_f32 v160, v160, v170
    v_exp_f32 v172, v54
    v_add_f32 v160, v160, v171
    v_cvt_pk_bf16_f32 v114, v170, v171
    v_exp_f32 v173, v55
    v_add_f32 v160, v160, v172
    v_nop
    v_add_f32 v160, v160, v173
    v_cvt_pk_bf16_f32 v115, v172, v173
    s_nop 3
    s_setpc_b64 s[52:53]
K1_FB1:
    s_nop 7
    s_nop 7
    v_max3_f32 v174, v56, v57, v58
    v_max3_f32 v174, v174, v59, v60
    v_max3_f32 v174, v174, v61, v62
    v_max_f32 v174, v174, v63
    v_mov_b32 v166, v174
    v_mov_b32 v167, v174
    s_nop 1
    v_permlane32_swap_b32 v166, v167
    s_nop 1
    v_max_f32 v174, v166, v167
    v_mov_b32 v166, v174
    v_mov_b32 v167, v174
    s_nop 1
    v_permlane16_swap_b32 v166, v167
    s_nop 1
    v_max_f32 v174, v166, v167
    v_max_f32 v174, 0, v174
    v_sub_f32 v175, 0, v174
    v_exp_f32 v175, v175
    v_sub_f32 v136, v136, v174
    v_sub_f32 v137, v137, v174
    v_sub_f32 v138, v138, v174
    v_sub_f32 v139, v139, v174
    v_sub_f32 v56, v56, v174
    v_sub_f32 v16, v16, v174
    v_sub_f32 v57, v57, v174
    v_sub_f32 v17, v17, v174
    v_sub_f32 v58, v58, v174
    v_sub_f32 v18, v18, v174
    v_sub_f32 v59, v59, v174
    v_sub_f32 v19, v19, v174
    v_sub_f32 v60, v60, v174
    v_sub_f32 v20, v20, v174
    v_sub_f32 v61, v61, v174
    v_sub_f32 v21, v21, v174
    v_sub_f32 v62, v62, v174
    v_sub_f32 v22, v22, v174
    v_sub_f32 v63, v63, v174
    v_sub_f32 v23, v23, v174
    v_mul_f32 v161, v161, v175
    v_accvgpr_read_b32 v166, a0
    s_nop 0
    v_mul_f32 v166, v166, v175
    s_nop 0
    v_accvgpr_write_b32 a0, v166
    v_accvgpr_read_b32 v166, a1
    s_nop 0
    v_mul_f32 v166, v166, v175
    s_nop 0
    v_accvgpr_write_b32 a1, v166
    v_accvgpr_read_b32 v166, a2
    s_nop 0
    v_mul_f32 v166, v166, v175
    s_nop 0
    v_accvgpr_write_b32 a2, v166
    v_accvgpr_read_b32 v166, a3
    s_nop 0
    v_mul_f32 v166, v166, v175
    s_nop 0
    v_accvgpr_write_b32 a3, v166
    v_accvgpr_read_b32 v166, a20
    s_nop 0
    v_mul_f32 v166, v166, v175
    s_nop 0
    v_accvgpr_write_b32 a20, v166
    v_accvgpr_read_b32 v166, a21
    s_nop 0
    v_mul_f32 v166, v166, v175
    s_nop 0
    v_accvgpr_write_b32 a21, v166
    v_accvgpr_read_b32 v166, a22
    s_nop 0
    v_mul_f32 v166, v166, v175
    s_nop 0
    v_accvgpr_write_b32 a22, v166
    v_accvgpr_read_b32 v166, a23
    s_nop 0
    v_mul_f32 v166, v166, v175
    s_nop 0
    v_accvgpr_write_b32 a23, v166
    v_accvgpr_read_b32 v166, a40
    s_nop 0
    v_mul_f32 v166, v166, v175
    s_nop 0
    v_accvgpr_write_b32 a40, v166
    v_accvgpr_read_b32 v166, a41
    s_nop 0
    v_mul_f32 v166, v166, v175
    s_nop 0
    v_accvgpr_write_b32 a41, v166
    v_accvgpr_read_b32 v166, a42
    s_nop 0
    v_mul_f32 v166, v166, v175
    s_nop 0
    v_accvgpr_write_b32 a42, v166
    v_accvgpr_read_b32 v166, a43
    s_nop 0
    v_mul_f32 v166, v166, v175
    s_nop 0
    v_accvgpr_write_b32 a43, v166
    v_accvgpr_read_b32 v166, a60
    s_nop 0
    v_mul_f32 v166, v166, v175
    s_nop 0
    v_accvgpr_write_b32 a60, v166
    v_accvgpr_read_b32 v166, a61
    s_nop 0
    v_mul_f32 v166, v166, v175
    s_nop 0
    v_accvgpr_write_b32 a61, v166
    v_accvgpr_read_b32 v166, a62
    s_nop 0
    v_mul_f32 v166, v166, v175
    s_nop 0
    v_accvgpr_write_b32 a62, v166
    v_accvgpr_read_b32 v166, a63
    s_nop 0
    v_mul_f32 v166, v166, v175
    s_nop 0
    v_accvgpr_write_b32 a63, v166
    v_accvgpr_read_b32 v166, a80
    s_nop 0
    v_mul_f32 v166, v166, v175
    s_nop 0
    v_accvgpr_write_b32 a80, v166
    v_accvgpr_read_b32 v166, a81
    s_nop 0
    v_mul_f32 v166, v166, v175
    s_nop 0
    v_accvgpr_write_b32 a81, v166
    v_accvgpr_read_b32 v166, a82
    s_nop 0
    v_mul_f32 v166, v166, v175
    s_nop 0
    v_accvgpr_write_b32 a82, v166
    v_accvgpr_read_b32 v166, a83
    s_nop 0
    v_mul_f32 v166, v166, v175
    s_nop 0
    v_accvgpr_write_b32 a83, v166
    v_accvgpr_read_b32 v166, a100
    s_nop 0
    v_mul_f32 v166, v166, v175
    s_nop 0
    v_accvgpr_write_b32 a100, v166
    v_accvgpr_read_b32 v166, a101
    s_nop 0
    v_mul_f32 v166, v166, v175
    s_nop 0
    v_accvgpr_write_b32 a101, v166
    v_accvgpr_read_b32 v166, a102
    s_nop 0
    v_mul_f32 v166, v166, v175
    s_nop 0
    v_accvgpr_write_b32 a102, v166
    v_accvgpr_read_b32 v166, a103
    s_nop 0
    v_mul_f32 v166, v166, v175
    s_nop 0
    v_accvgpr_write_b32 a103, v166
    v_accvgpr_read_b32 v166, a120
    s_nop 0
    v_mul_f32 v166, v166, v175
    s_nop 0
    v_accvgpr_write_b32 a120, v166
    v_accvgpr_read_b32 v166, a121
    s_nop 0
    v_mul_f32 v166, v166, v175
    s_nop 0
    v_accvgpr_write_b32 a121, v166
    v_accvgpr_read_b32 v166, a122
    s_nop 0
    v_mul_f32 v166, v166, v175
    s_nop 0
    v_accvgpr_write_b32 a122, v166
    v_accvgpr_read_b32 v166, a123
    s_nop 0
    v_mul_f32 v166, v166, v175
    s_nop 0
    v_accvgpr_write_b32 a123, v166
    v_accvgpr_read_b32 v166, a140
    s_nop 0
    v_mul_f32 v166, v166, v175
    s_nop 0
    v_accvgpr_write_b32 a140, v166
    v_accvgpr_read_b32 v166, a141
    s_nop 0
    v_mul_f32 v166, v166, v175
    s_nop 0
    v_accvgpr_write_b32 a141, v166
    v_accvgpr_read_b32 v166, a142
    s_nop 0
    v_mul_f32 v166, v166, v175
    s_nop 0
    v_accvgpr_write_b32 a142, v166
    v_accvgpr_read_b32 v166, a143
    s_nop 0
    v_mul_f32 v166, v166, v175
    s_nop 0
    v_accvgpr_write_b32 a143, v166
    v_exp_f32 v166, v56
    v_exp_f32 v167, v57
    v_exp_f32 v168, v58
    v_add_f32 v156, v166, v167
    v_exp_f32 v169, v59
    v_cvt_pk_bf16_f32 v116, v166, v167
    v_add_f32 v156, v156, v168
    v_exp_f32 v170, v60
    v_add_f32 v156, v156, v169
    v_cvt_pk_bf16_f32 v117, v168, v169
    v_exp_f32 v171, v61
    v_add_f32 v156, v156, v170
    v_exp_f32 v172, v62
    v_add_f32 v156, v156, v171
    v_cvt_pk_bf16_f32 v118, v170, v171
    v_exp_f32 v173, v63
    v_add_f32 v156, v156, v172
    v_nop
    v_add_f32 v156, v156, v173
    v_cvt_pk_bf16_f32 v119, v172, v173
    v_max3_f32 v174, v64, v65, v66
    v_max3_f32 v174, v174, v67, v68
    v_max3_f32 v174, v174, v69, v70
    v_max_f32 v174, v174, v71
    v_mov_b32 v166, v174
    v_mov_b32 v167, v174
    s_nop 1
    v_permlane32_swap_b32 v166, v167
    s_nop 1
    v_max_f32 v174, v166, v167
    v_mov_b32 v166, v174
    v_mov_b32 v167, v174
    s_nop 1
    v_permlane16_swap_b32 v166, v167
    s_nop 1
    v_max_f32 v174, v166, v167
    v_max_f32 v174, 0, v174
    v_sub_f32 v175, 0, v174
    v_exp_f32 v175, v175
    v_sub_f32 v140, v140, v174
    v_sub_f32 v141, v141, v174
    v_sub_f32 v142, v142, v174
    v_sub_f32 v143, v143, v174
    v_sub_f32 v64, v64, v174
    v_sub_f32 v24, v24, v174
    v_sub_f32 v65, v65, v174
    v_sub_f32 v25, v25, v174
    v_sub_f32 v66, v66, v174
    v_sub_f32 v26, v26, v174
    v_sub_f32 v67, v67, v174
    v_sub_f32 v27, v27, v174
    v_sub_f32 v68, v68, v174
    v_sub_f32 v28, v28, v174
    v_sub_f32 v69, v69, v174
    v_sub_f32 v29, v29, v174
    v_sub_f32 v70, v70, v174
    v_sub_f32 v30, v30, v174
    v_sub_f32 v71, v71, v174
    v_sub_f32 v31, v31, v174
    v_mul_f32 v162, v162, v175
    v_accvgpr_read_b32 v166, a4
    s_nop 0
    v_mul_f32 v166, v166, v175
    s_nop 0
    v_accvgpr_write_b32 a4, v166
    v_accvgpr_read_b32 v166, a5
    s_nop 0
    v_mul_f32 v166, v166, v175
    s_nop 0
    v_accvgpr_write_b32 a5, v166
    v_accvgpr_read_b32 v166, a6
    s_nop 0
    v_mul_f32 v166, v166, v175
    s_nop 0
    v_accvgpr_write_b32 a6, v166
    v_accvgpr_read_b32 v166, a7
    s_nop 0
    v_mul_f32 v166, v166, v175
    s_nop 0
    v_accvgpr_write_b32 a7, v166
    v_accvgpr_read_b32 v166, a24
    s_nop 0
    v_mul_f32 v166, v166, v175
    s_nop 0
    v_accvgpr_write_b32 a24, v166
    v_accvgpr_read_b32 v166, a25
    s_nop 0
    v_mul_f32 v166, v166, v175
    s_nop 0
    v_accvgpr_write_b32 a25, v166
    v_accvgpr_read_b32 v166, a26
    s_nop 0
    v_mul_f32 v166, v166, v175
    s_nop 0
    v_accvgpr_write_b32 a26, v166
    v_accvgpr_read_b32 v166, a27
    s_nop 0
    v_mul_f32 v166, v166, v175
    s_nop 0
    v_accvgpr_write_b32 a27, v166
    v_accvgpr_read_b32 v166, a44
    s_nop 0
    v_mul_f32 v166, v166, v175
    s_nop 0
    v_accvgpr_write_b32 a44, v166
    v_accvgpr_read_b32 v166, a45
    s_nop 0
    v_mul_f32 v166, v166, v175
    s_nop 0
    v_accvgpr_write_b32 a45, v166
    v_accvgpr_read_b32 v166, a46
    s_nop 0
    v_mul_f32 v166, v166, v175
    s_nop 0
    v_accvgpr_write_b32 a46, v166
    v_accvgpr_read_b32 v166, a47
    s_nop 0
    v_mul_f32 v166, v166, v175
    s_nop 0
    v_accvgpr_write_b32 a47, v166
    v_accvgpr_read_b32 v166, a64
    s_nop 0
    v_mul_f32 v166, v166, v175
    s_nop 0
    v_accvgpr_write_b32 a64, v166
    v_accvgpr_read_b32 v166, a65
    s_nop 0
    v_mul_f32 v166, v166, v175
    s_nop 0
    v_accvgpr_write_b32 a65, v166
    v_accvgpr_read_b32 v166, a66
    s_nop 0
    v_mul_f32 v166, v166, v175
    s_nop 0
    v_accvgpr_write_b32 a66, v166
    v_accvgpr_read_b32 v166, a67
    s_nop 0
    v_mul_f32 v166, v166, v175
    s_nop 0
    v_accvgpr_write_b32 a67, v166
    v_accvgpr_read_b32 v166, a84
    s_nop 0
    v_mul_f32 v166, v166, v175
    s_nop 0
    v_accvgpr_write_b32 a84, v166
    v_accvgpr_read_b32 v166, a85
    s_nop 0
    v_mul_f32 v166, v166, v175
    s_nop 0
    v_accvgpr_write_b32 a85, v166
    v_accvgpr_read_b32 v166, a86
    s_nop 0
    v_mul_f32 v166, v166, v175
    s_nop 0
    v_accvgpr_write_b32 a86, v166
    v_accvgpr_read_b32 v166, a87
    s_nop 0
    v_mul_f32 v166, v166, v175
    s_nop 0
    v_accvgpr_write_b32 a87, v166
    v_accvgpr_read_b32 v166, a104
    s_nop 0
    v_mul_f32 v166, v166, v175
    s_nop 0
    v_accvgpr_write_b32 a104, v166
    v_accvgpr_read_b32 v166, a105
    s_nop 0
    v_mul_f32 v166, v166, v175
    s_nop 0
    v_accvgpr_write_b32 a105, v166
    v_accvgpr_read_b32 v166, a106
    s_nop 0
    v_mul_f32 v166, v166, v175
    s_nop 0
    v_accvgpr_write_b32 a106, v166
    v_accvgpr_read_b32 v166, a107
    s_nop 0
    v_mul_f32 v166, v166, v175
    s_nop 0
    v_accvgpr_write_b32 a107, v166
    v_accvgpr_read_b32 v166, a124
    s_nop 0
    v_mul_f32 v166, v166, v175
    s_nop 0
    v_accvgpr_write_b32 a124, v166
    v_accvgpr_read_b32 v166, a125
    s_nop 0
    v_mul_f32 v166, v166, v175
    s_nop 0
    v_accvgpr_write_b32 a125, v166
    v_accvgpr_read_b32 v166, a126
    s_nop 0
    v_mul_f32 v166, v166, v175
    s_nop 0
    v_accvgpr_write_b32 a126, v166
    v_accvgpr_read_b32 v166, a127
    s_nop 0
    v_mul_f32 v166, v166, v175
    s_nop 0
    v_accvgpr_write_b32 a127, v166
    v_accvgpr_read_b32 v166, a144
    s_nop 0
    v_mul_f32 v166, v166, v175
    s_nop 0
    v_accvgpr_write_b32 a144, v166
    v_accvgpr_read_b32 v166, a145
    s_nop 0
    v_mul_f32 v166, v166, v175
    s_nop 0
    v_accvgpr_write_b32 a145, v166
    v_accvgpr_read_b32 v166, a146
    s_nop 0
    v_mul_f32 v166, v166, v175
    s_nop 0
    v_accvgpr_write_b32 a146, v166
    v_accvgpr_read_b32 v166, a147
    s_nop 0
    v_mul_f32 v166, v166, v175
    s_nop 0
    v_accvgpr_write_b32 a147, v166
    v_exp_f32 v166, v64
    v_exp_f32 v167, v65
    v_exp_f32 v168, v66
    v_add_f32 v157, v166, v167
    v_exp_f32 v169, v67
    v_cvt_pk_bf16_f32 v120, v166, v167
    v_add_f32 v157, v157, v168
    v_exp_f32 v170, v68
    v_add_f32 v157, v157, v169
    v_cvt_pk_bf16_f32 v121, v168, v169
    v_exp_f32 v171, v69
    v_add_f32 v157, v157, v170
    v_exp_f32 v172, v70
    v_add_f32 v157, v157, v171
    v_cvt_pk_bf16_f32 v122, v170, v171
    v_exp_f32 v173, v71
    v_add_f32 v157, v157, v172
    v_nop
    v_add_f32 v157, v157, v173
    v_cvt_pk_bf16_f32 v123, v172, v173
    v_max3_f32 v174, v72, v73, v74
    v_max3_f32 v174, v174, v75, v76
    v_max3_f32 v174, v174, v77, v78
    v_max_f32 v174, v174, v79
    v_mov_b32 v166, v174
    v_mov_b32 v167, v174
    s_nop 1
    v_permlane32_swap_b32 v166, v167
    s_nop 1
    v_max_f32 v174, v166, v167
    v_mov_b32 v166, v174
    v_mov_b32 v167, v174
    s_nop 1
    v_permlane16_swap_b32 v166, v167
    s_nop 1
    v_max_f32 v174, v166, v167
    v_max_f32 v174, 0, v174
    v_sub_f32 v175, 0, v174
    v_exp_f32 v175, v175
    v_sub_f32 v144, v144, v174
    v_sub_f32 v145, v145, v174
    v_sub_f32 v146, v146, v174
    v_sub_f32 v147, v147, v174
    v_sub_f32 v72, v72, v174
    v_sub_f32 v32, v32, v174
    v_sub_f32 v73, v73, v174
    v_sub_f32 v33, v33, v174
    v_sub_f32 v74, v74, v174
    v_sub_f32 v34, v34, v174
    v_sub_f32 v75, v75, v174
    v_sub_f32 v35, v35, v174
    v_sub_f32 v76, v76, v174
    v_sub_f32 v36, v36, v174
    v_sub_f32 v77, v77, v174
    v_sub_f32 v37, v37, v174
    v_sub_f32 v78, v78, v174
    v_sub_f32 v38, v38, v174
    v_sub_f32 v79, v79, v174
    v_sub_f32 v39, v39, v174
    v_mul_f32 v163, v163, v175
    v_accvgpr_read_b32 v166, a8
    s_nop 0
    v_mul_f32 v166, v166, v175
    s_nop 0
    v_accvgpr_write_b32 a8, v166
    v_accvgpr_read_b32 v166, a9
    s_nop 0
    v_mul_f32 v166, v166, v175
    s_nop 0
    v_accvgpr_write_b32 a9, v166
    v_accvgpr_read_b32 v166, a10
    s_nop 0
    v_mul_f32 v166, v166, v175
    s_nop 0
    v_accvgpr_write_b32 a10, v166
    v_accvgpr_read_b32 v166, a11
    s_nop 0
    v_mul_f32 v166, v166, v175
    s_nop 0
    v_accvgpr_write_b32 a11, v166
    v_accvgpr_read_b32 v166, a28
    s_nop 0
    v_mul_f32 v166, v166, v175
    s_nop 0
    v_accvgpr_write_b32 a28, v166
    v_accvgpr_read_b32 v166, a29
    s_nop 0
    v_mul_f32 v166, v166, v175
    s_nop 0
    v_accvgpr_write_b32 a29, v166
    v_accvgpr_read_b32 v166, a30
    s_nop 0
    v_mul_f32 v166, v166, v175
    s_nop 0
    v_accvgpr_write_b32 a30, v166
    v_accvgpr_read_b32 v166, a31
    s_nop 0
    v_mul_f32 v166, v166, v175
    s_nop 0
    v_accvgpr_write_b32 a31, v166
    v_accvgpr_read_b32 v166, a48
    s_nop 0
    v_mul_f32 v166, v166, v175
    s_nop 0
    v_accvgpr_write_b32 a48, v166
    v_accvgpr_read_b32 v166, a49
    s_nop 0
    v_mul_f32 v166, v166, v175
    s_nop 0
    v_accvgpr_write_b32 a49, v166
    v_accvgpr_read_b32 v166, a50
    s_nop 0
    v_mul_f32 v166, v166, v175
    s_nop 0
    v_accvgpr_write_b32 a50, v166
    v_accvgpr_read_b32 v166, a51
    s_nop 0
    v_mul_f32 v166, v166, v175
    s_nop 0
    v_accvgpr_write_b32 a51, v166
    v_accvgpr_read_b32 v166, a68
    s_nop 0
    v_mul_f32 v166, v166, v175
    s_nop 0
    v_accvgpr_write_b32 a68, v166
    v_accvgpr_read_b32 v166, a69
    s_nop 0
    v_mul_f32 v166, v166, v175
    s_nop 0
    v_accvgpr_write_b32 a69, v166
    v_accvgpr_read_b32 v166, a70
    s_nop 0
    v_mul_f32 v166, v166, v175
    s_nop 0
    v_accvgpr_write_b32 a70, v166
    v_accvgpr_read_b32 v166, a71
    s_nop 0
    v_mul_f32 v166, v166, v175
    s_nop 0
    v_accvgpr_write_b32 a71, v166
    v_accvgpr_read_b32 v166, a88
    s_nop 0
    v_mul_f32 v166, v166, v175
    s_nop 0
    v_accvgpr_write_b32 a88, v166
    v_accvgpr_read_b32 v166, a89
    s_nop 0
    v_mul_f32 v166, v166, v175
    s_nop 0
    v_accvgpr_write_b32 a89, v166
    v_accvgpr_read_b32 v166, a90
    s_nop 0
    v_mul_f32 v166, v166, v175
    s_nop 0
    v_accvgpr_write_b32 a90, v166
    v_accvgpr_read_b32 v166, a91
    s_nop 0
    v_mul_f32 v166, v166, v175
    s_nop 0
    v_accvgpr_write_b32 a91, v166
    v_accvgpr_read_b32 v166, a108
    s_nop 0
    v_mul_f32 v166, v166, v175
    s_nop 0
    v_accvgpr_write_b32 a108, v166
    v_accvgpr_read_b32 v166, a109
    s_nop 0
    v_mul_f32 v166, v166, v175
    s_nop 0
    v_accvgpr_write_b32 a109, v166
    v_accvgpr_read_b32 v166, a110
    s_nop 0
    v_mul_f32 v166, v166, v175
    s_nop 0
    v_accvgpr_write_b32 a110, v166
    v_accvgpr_read_b32 v166, a111
    s_nop 0
    v_mul_f32 v166, v166, v175
    s_nop 0
    v_accvgpr_write_b32 a111, v166
    v_accvgpr_read_b32 v166, a128
    s_nop 0
    v_mul_f32 v166, v166, v175
    s_nop 0
    v_accvgpr_write_b32 a128, v166
    v_accvgpr_read_b32 v166, a129
    s_nop 0
    v_mul_f32 v166, v166, v175
    s_nop 0
    v_accvgpr_write_b32 a129, v166
    v_accvgpr_read_b32 v166, a130
    s_nop 0
    v_mul_f32 v166, v166, v175
    s_nop 0
    v_accvgpr_write_b32 a130, v166
    v_accvgpr_read_b32 v166, a131
    s_nop 0
    v_mul_f32 v166, v166, v175
    s_nop 0
    v_accvgpr_write_b32 a131, v166
    v_accvgpr_read_b32 v166, a148
    s_nop 0
    v_mul_f32 v166, v166, v175
    s_nop 0
    v_accvgpr_write_b32 a148, v166
    v_accvgpr_read_b32 v166, a149
    s_nop 0
    v_mul_f32 v166, v166, v175
    s_nop 0
    v_accvgpr_write_b32 a149, v166
    v_accvgpr_read_b32 v166, a150
    s_nop 0
    v_mul_f32 v166, v166, v175
    s_nop 0
    v_accvgpr_write_b32 a150, v166
    v_accvgpr_read_b32 v166, a151
    s_nop 0
    v_mul_f32 v166, v166, v175
    s_nop 0
    v_accvgpr_write_b32 a151, v166
    v_exp_f32 v166, v72
    v_exp_f32 v167, v73
    v_exp_f32 v168, v74
    v_add_f32 v158, v166, v167
    v_exp_f32 v169, v75
    v_cvt_pk_bf16_f32 v124, v166, v167
    v_add_f32 v158, v158, v168
    v_exp_f32 v170, v76
    v_add_f32 v158, v158, v169
    v_cvt_pk_bf16_f32 v125, v168, v169
    v_exp_f32 v171, v77
    v_add_f32 v158, v158, v170
    v_exp_f32 v172, v78
    v_add_f32 v158, v158, v171
    v_cvt_pk_bf16_f32 v126, v170, v171
    v_exp_f32 v173, v79
    v_add_f32 v158, v158, v172
    v_nop
    v_add_f32 v158, v158, v173
    v_cvt_pk_bf16_f32 v127, v172, v173
    v_max3_f32 v174, v80, v81, v82
    v_max3_f32 v174, v174, v83, v84
    v_max3_f32 v174, v174, v85, v86
    v_max_f32 v174, v174, v87
    v_mov_b32 v166, v174
    v_mov_b32 v167, v174
    s_nop 1
    v_permlane32_swap_b32 v166, v167
    s_nop 1
    v_max_f32 v174, v166, v167
    v_mov_b32 v166, v174
    v_mov_b32 v167, v174
    s_nop 1
    v_permlane16_swap_b32 v166, v167
    s_nop 1
    v_max_f32 v174, v166, v167
    v_max_f32 v174, 0, v174
    v_sub_f32 v175, 0, v174
    v_exp_f32 v175, v175
    v_sub_f32 v148, v148, v174
    v_sub_f32 v149, v149, v174
    v_sub_f32 v150, v150, v174
    v_sub_f32 v151, v151, v174
    v_sub_f32 v80, v80, v174
    v_sub_f32 v40, v40, v174
    v_sub_f32 v81, v81, v174
    v_sub_f32 v41, v41, v174
    v_sub_f32 v82, v82, v174
    v_sub_f32 v42, v42, v174
    v_sub_f32 v83, v83, v174
    v_sub_f32 v43, v43, v174
    v_sub_f32 v84, v84, v174
    v_sub_f32 v44, v44, v174
    v_sub_f32 v85, v85, v174
    v_sub_f32 v45, v45, v174
    v_sub_f32 v86, v86, v174
    v_sub_f32 v46, v46, v174
    v_sub_f32 v87, v87, v174
    v_sub_f32 v47, v47, v174
    v_mul_f32 v164, v164, v175
    v_accvgpr_read_b32 v166, a12
    s_nop 0
    v_mul_f32 v166, v166, v175
    s_nop 0
    v_accvgpr_write_b32 a12, v166
    v_accvgpr_read_b32 v166, a13
    s_nop 0
    v_mul_f32 v166, v166, v175
    s_nop 0
    v_accvgpr_write_b32 a13, v166
    v_accvgpr_read_b32 v166, a14
    s_nop 0
    v_mul_f32 v166, v166, v175
    s_nop 0
    v_accvgpr_write_b32 a14, v166
    v_accvgpr_read_b32 v166, a15
    s_nop 0
    v_mul_f32 v166, v166, v175
    s_nop 0
    v_accvgpr_write_b32 a15, v166
    v_accvgpr_read_b32 v166, a32
    s_nop 0
    v_mul_f32 v166, v166, v175
    s_nop 0
    v_accvgpr_write_b32 a32, v166
    v_accvgpr_read_b32 v166, a33
    s_nop 0
    v_mul_f32 v166, v166, v175
    s_nop 0
    v_accvgpr_write_b32 a33, v166
    v_accvgpr_read_b32 v166, a34
    s_nop 0
    v_mul_f32 v166, v166, v175
    s_nop 0
    v_accvgpr_write_b32 a34, v166
    v_accvgpr_read_b32 v166, a35
    s_nop 0
    v_mul_f32 v166, v166, v175
    s_nop 0
    v_accvgpr_write_b32 a35, v166
    v_accvgpr_read_b32 v166, a52
    s_nop 0
    v_mul_f32 v166, v166, v175
    s_nop 0
    v_accvgpr_write_b32 a52, v166
    v_accvgpr_read_b32 v166, a53
    s_nop 0
    v_mul_f32 v166, v166, v175
    s_nop 0
    v_accvgpr_write_b32 a53, v166
    v_accvgpr_read_b32 v166, a54
    s_nop 0
    v_mul_f32 v166, v166, v175
    s_nop 0
    v_accvgpr_write_b32 a54, v166
    v_accvgpr_read_b32 v166, a55
    s_nop 0
    v_mul_f32 v166, v166, v175
    s_nop 0
    v_accvgpr_write_b32 a55, v166
    v_accvgpr_read_b32 v166, a72
    s_nop 0
    v_mul_f32 v166, v166, v175
    s_nop 0
    v_accvgpr_write_b32 a72, v166
    v_accvgpr_read_b32 v166, a73
    s_nop 0
    v_mul_f32 v166, v166, v175
    s_nop 0
    v_accvgpr_write_b32 a73, v166
    v_accvgpr_read_b32 v166, a74
    s_nop 0
    v_mul_f32 v166, v166, v175
    s_nop 0
    v_accvgpr_write_b32 a74, v166
    v_accvgpr_read_b32 v166, a75
    s_nop 0
    v_mul_f32 v166, v166, v175
    s_nop 0
    v_accvgpr_write_b32 a75, v166
    v_accvgpr_read_b32 v166, a92
    s_nop 0
    v_mul_f32 v166, v166, v175
    s_nop 0
    v_accvgpr_write_b32 a92, v166
    v_accvgpr_read_b32 v166, a93
    s_nop 0
    v_mul_f32 v166, v166, v175
    s_nop 0
    v_accvgpr_write_b32 a93, v166
    v_accvgpr_read_b32 v166, a94
    s_nop 0
    v_mul_f32 v166, v166, v175
    s_nop 0
    v_accvgpr_write_b32 a94, v166
    v_accvgpr_read_b32 v166, a95
    s_nop 0
    v_mul_f32 v166, v166, v175
    s_nop 0
    v_accvgpr_write_b32 a95, v166
    v_accvgpr_read_b32 v166, a112
    s_nop 0
    v_mul_f32 v166, v166, v175
    s_nop 0
    v_accvgpr_write_b32 a112, v166
    v_accvgpr_read_b32 v166, a113
    s_nop 0
    v_mul_f32 v166, v166, v175
    s_nop 0
    v_accvgpr_write_b32 a113, v166
    v_accvgpr_read_b32 v166, a114
    s_nop 0
    v_mul_f32 v166, v166, v175
    s_nop 0
    v_accvgpr_write_b32 a114, v166
    v_accvgpr_read_b32 v166, a115
    s_nop 0
    v_mul_f32 v166, v166, v175
    s_nop 0
    v_accvgpr_write_b32 a115, v166
    v_accvgpr_read_b32 v166, a132
    s_nop 0
    v_mul_f32 v166, v166, v175
    s_nop 0
    v_accvgpr_write_b32 a132, v166
    v_accvgpr_read_b32 v166, a133
    s_nop 0
    v_mul_f32 v166, v166, v175
    s_nop 0
    v_accvgpr_write_b32 a133, v166
    v_accvgpr_read_b32 v166, a134
    s_nop 0
    v_mul_f32 v166, v166, v175
    s_nop 0
    v_accvgpr_write_b32 a134, v166
    v_accvgpr_read_b32 v166, a135
    s_nop 0
    v_mul_f32 v166, v166, v175
    s_nop 0
    v_accvgpr_write_b32 a135, v166
    v_accvgpr_read_b32 v166, a152
    s_nop 0
    v_mul_f32 v166, v166, v175
    s_nop 0
    v_accvgpr_write_b32 a152, v166
    v_accvgpr_read_b32 v166, a153
    s_nop 0
    v_mul_f32 v166, v166, v175
    s_nop 0
    v_accvgpr_write_b32 a153, v166
    v_accvgpr_read_b32 v166, a154
    s_nop 0
    v_mul_f32 v166, v166, v175
    s_nop 0
    v_accvgpr_write_b32 a154, v166
    v_accvgpr_read_b32 v166, a155
    s_nop 0
    v_mul_f32 v166, v166, v175
    s_nop 0
    v_accvgpr_write_b32 a155, v166
    v_exp_f32 v166, v80
    v_exp_f32 v167, v81
    v_exp_f32 v168, v82
    v_add_f32 v159, v166, v167
    v_exp_f32 v169, v83
    v_cvt_pk_bf16_f32 v128, v166, v167
    v_add_f32 v159, v159, v168
    v_exp_f32 v170, v84
    v_add_f32 v159, v159, v169
    v_cvt_pk_bf16_f32 v129, v168, v169
    v_exp_f32 v171, v85
    v_add_f32 v159, v159, v170
    v_exp_f32 v172, v86
    v_add_f32 v159, v159, v171
    v_cvt_pk_bf16_f32 v130, v170, v171
    v_exp_f32 v173, v87
    v_add_f32 v159, v159, v172
    v_nop
    v_add_f32 v159, v159, v173
    v_cvt_pk_bf16_f32 v131, v172, v173
    v_max3_f32 v174, v88, v89, v90
    v_max3_f32 v174, v174, v91, v92
    v_max3_f32 v174, v174, v93, v94
    v_max_f32 v174, v174, v95
    v_mov_b32 v166, v174
    v_mov_b32 v167, v174
    s_nop 1
    v_permlane32_swap_b32 v166, v167
    s_nop 1
    v_max_f32 v174, v166, v167
    v_mov_b32 v166, v174
    v_mov_b32 v167, v174
    s_nop 1
    v_permlane16_swap_b32 v166, v167
    s_nop 1
    v_max_f32 v174, v166, v167
    v_max_f32 v174, 0, v174
    v_sub_f32 v175, 0, v174
    v_exp_f32 v175, v175
    v_sub_f32 v152, v152, v174
    v_sub_f32 v153, v153, v174
    v_sub_f32 v154, v154, v174
    v_sub_f32 v155, v155, v174
    v_sub_f32 v88, v88, v174
    v_sub_f32 v48, v48, v174
    v_sub_f32 v89, v89, v174
    v_sub_f32 v49, v49, v174
    v_sub_f32 v90, v90, v174
    v_sub_f32 v50, v50, v174
    v_sub_f32 v91, v91, v174
    v_sub_f32 v51, v51, v174
    v_sub_f32 v92, v92, v174
    v_sub_f32 v52, v52, v174
    v_sub_f32 v93, v93, v174
    v_sub_f32 v53, v53, v174
    v_sub_f32 v94, v94, v174
    v_sub_f32 v54, v54, v174
    v_sub_f32 v95, v95, v174
    v_sub_f32 v55, v55, v174
    v_mul_f32 v165, v165, v175
    v_accvgpr_read_b32 v166, a16
    s_nop 0
    v_mul_f32 v166, v166, v175
    s_nop 0
    v_accvgpr_write_b32 a16, v166
    v_accvgpr_read_b32 v166, a17
    s_nop 0
    v_mul_f32 v166, v166, v175
    s_nop 0
    v_accvgpr_write_b32 a17, v166
    v_accvgpr_read_b32 v166, a18
    s_nop 0
    v_mul_f32 v166, v166, v175
    s_nop 0
    v_accvgpr_write_b32 a18, v166
    v_accvgpr_read_b32 v166, a19
    s_nop 0
    v_mul_f32 v166, v166, v175
    s_nop 0
    v_accvgpr_write_b32 a19, v166
    v_accvgpr_read_b32 v166, a36
    s_nop 0
    v_mul_f32 v166, v166, v175
    s_nop 0
    v_accvgpr_write_b32 a36, v166
    v_accvgpr_read_b32 v166, a37
    s_nop 0
    v_mul_f32 v166, v166, v175
    s_nop 0
    v_accvgpr_write_b32 a37, v166
    v_accvgpr_read_b32 v166, a38
    s_nop 0
    v_mul_f32 v166, v166, v175
    s_nop 0
    v_accvgpr_write_b32 a38, v166
    v_accvgpr_read_b32 v166, a39
    s_nop 0
    v_mul_f32 v166, v166, v175
    s_nop 0
    v_accvgpr_write_b32 a39, v166
    v_accvgpr_read_b32 v166, a56
    s_nop 0
    v_mul_f32 v166, v166, v175
    s_nop 0
    v_accvgpr_write_b32 a56, v166
    v_accvgpr_read_b32 v166, a57
    s_nop 0
    v_mul_f32 v166, v166, v175
    s_nop 0
    v_accvgpr_write_b32 a57, v166
    v_accvgpr_read_b32 v166, a58
    s_nop 0
    v_mul_f32 v166, v166, v175
    s_nop 0
    v_accvgpr_write_b32 a58, v166
    v_accvgpr_read_b32 v166, a59
    s_nop 0
    v_mul_f32 v166, v166, v175
    s_nop 0
    v_accvgpr_write_b32 a59, v166
    v_accvgpr_read_b32 v166, a76
    s_nop 0
    v_mul_f32 v166, v166, v175
    s_nop 0
    v_accvgpr_write_b32 a76, v166
    v_accvgpr_read_b32 v166, a77
    s_nop 0
    v_mul_f32 v166, v166, v175
    s_nop 0
    v_accvgpr_write_b32 a77, v166
    v_accvgpr_read_b32 v166, a78
    s_nop 0
    v_mul_f32 v166, v166, v175
    s_nop 0
    v_accvgpr_write_b32 a78, v166
    v_accvgpr_read_b32 v166, a79
    s_nop 0
    v_mul_f32 v166, v166, v175
    s_nop 0
    v_accvgpr_write_b32 a79, v166
    v_accvgpr_read_b32 v166, a96
    s_nop 0
    v_mul_f32 v166, v166, v175
    s_nop 0
    v_accvgpr_write_b32 a96, v166
    v_accvgpr_read_b32 v166, a97
    s_nop 0
    v_mul_f32 v166, v166, v175
    s_nop 0
    v_accvgpr_write_b32 a97, v166
    v_accvgpr_read_b32 v166, a98
    s_nop 0
    v_mul_f32 v166, v166, v175
    s_nop 0
    v_accvgpr_write_b32 a98, v166
    v_accvgpr_read_b32 v166, a99
    s_nop 0
    v_mul_f32 v166, v166, v175
    s_nop 0
    v_accvgpr_write_b32 a99, v166
    v_accvgpr_read_b32 v166, a116
    s_nop 0
    v_mul_f32 v166, v166, v175
    s_nop 0
    v_accvgpr_write_b32 a116, v166
    v_accvgpr_read_b32 v166, a117
    s_nop 0
    v_mul_f32 v166, v166, v175
    s_nop 0
    v_accvgpr_write_b32 a117, v166
    v_accvgpr_read_b32 v166, a118
    s_nop 0
    v_mul_f32 v166, v166, v175
    s_nop 0
    v_accvgpr_write_b32 a118, v166
    v_accvgpr_read_b32 v166, a119
    s_nop 0
    v_mul_f32 v166, v166, v175
    s_nop 0
    v_accvgpr_write_b32 a119, v166
    v_accvgpr_read_b32 v166, a136
    s_nop 0
    v_mul_f32 v166, v166, v175
    s_nop 0
    v_accvgpr_write_b32 a136, v166
    v_accvgpr_read_b32 v166, a137
    s_nop 0
    v_mul_f32 v166, v166, v175
    s_nop 0
    v_accvgpr_write_b32 a137, v166
    v_accvgpr_read_b32 v166, a138
    s_nop 0
    v_mul_f32 v166, v166, v175
    s_nop 0
    v_accvgpr_write_b32 a138, v166
    v_accvgpr_read_b32 v166, a139
    s_nop 0
    v_mul_f32 v166, v166, v175
    s_nop 0
    v_accvgpr_write_b32 a139, v166
    v_accvgpr_read_b32 v166, a156
    s_nop 0
    v_mul_f32 v166, v166, v175
    s_nop 0
    v_accvgpr_write_b32 a156, v166
    v_accvgpr_read_b32 v166, a157
    s_nop 0
    v_mul_f32 v166, v166, v175
    s_nop 0
    v_accvgpr_write_b32 a157, v166
    v_accvgpr_read_b32 v166, a158
    s_nop 0
    v_mul_f32 v166, v166, v175
    s_nop 0
    v_accvgpr_write_b32 a158, v166
    v_accvgpr_read_b32 v166, a159
    s_nop 0
    v_mul_f32 v166, v166, v175
    s_nop 0
    v_accvgpr_write_b32 a159, v166
    v_exp_f32 v166, v88
    v_exp_f32 v167, v89
    v_exp_f32 v168, v90
    v_add_f32 v160, v166, v167
    v_exp_f32 v169, v91
    v_cvt_pk_bf16_f32 v132, v166, v167
    v_add_f32 v160, v160, v168
    v_exp_f32 v170, v92
    v_add_f32 v160, v160, v169
    v_cvt_pk_bf16_f32 v133, v168, v169
    v_exp_f32 v171, v93
    v_add_f32 v160, v160, v170
    v_exp_f32 v172, v94
    v_add_f32 v160, v160, v171
    v_cvt_pk_bf16_f32 v134, v170, v171
    v_exp_f32 v173, v95
    v_add_f32 v160, v160, v172
    v_nop
    v_add_f32 v160, v160, v173
    v_cvt_pk_bf16_f32 v135, v172, v173
    s_nop 3
    s_setpc_b64 s[52:53]
K1_FB2:
    s_nop 7
    s_nop 7
    v_max3_f32 v174, v16, v17, v18
    v_max3_f32 v174, v174, v19, v20
    v_max3_f32 v174, v174, v21, v22
    v_max_f32 v174, v174, v23
    v_mov_b32 v166, v174
    v_mov_b32 v167, v174
    s_nop 1
    v_permlane32_swap_b32 v166, v167
    s_nop 1
    v_max_f32 v174, v166, v167
    v_mov_b32 v166, v174
    v_mov_b32 v167, v174
    s_nop 1
    v_permlane16_swap_b32 v166, v167
    s_nop 1
    v_max_f32 v174, v166, v167
    v_max_f32 v174, 0, v174
    v_sub_f32 v175, 0, v174
    v_exp_f32 v175, v175
    v_sub_f32 v136, v136, v174
    v_sub_f32 v137, v137, v174
    v_sub_f32 v138, v138, v174
    v_sub_f32 v139, v139, v174
    v_sub_f32 v16, v16, v174
    v_sub_f32 v17, v17, v174
    v_sub_f32 v18, v18, v174
    v_sub_f32 v19, v19, v174
    v_sub_f32 v20, v20, v174
    v_sub_f32 v21, v21, v174
    v_sub_f32 v22, v22, v174
    v_sub_f32 v23, v23, v174
    v_mul_f32 v161, v161, v175
    v_accvgpr_read_b32 v166, a0
    s_nop 0
    v_mul_f32 v166, v166, v175
    s_nop 0
    v_accvgpr_write_b32 a0, v166
    v_accvgpr_read_b32 v166, a1
    s_nop 0
    v_mul_f32 v166, v166, v175
    s_nop 0
    v_accvgpr_write_b32 a1, v166
    v_accvgpr_read_b32 v166, a2
    s_nop 0
    v_mul_f32 v166, v166, v175
    s_nop 0
    v_accvgpr_write_b32 a2, v166
    v_accvgpr_read_b32 v166, a3
    s_nop 0
    v_mul_f32 v166, v166, v175
    s_nop 0
    v_accvgpr_write_b32 a3, v166
    v_accvgpr_read_b32 v166, a20
    s_nop 0
    v_mul_f32 v166, v166, v175
    s_nop 0
    v_accvgpr_write_b32 a20, v166
    v_accvgpr_read_b32 v166, a21
    s_nop 0
    v_mul_f32 v166, v166, v175
    s_nop 0
    v_accvgpr_write_b32 a21, v166
    v_accvgpr_read_b32 v166, a22
    s_nop 0
    v_mul_f32 v166, v166, v175
    s_nop 0
    v_accvgpr_write_b32 a22, v166
    v_accvgpr_read_b32 v166, a23
    s_nop 0
    v_mul_f32 v166, v166, v175
    s_nop 0
    v_accvgpr_write_b32 a23, v166
    v_accvgpr_read_b32 v166, a40
    s_nop 0
    v_mul_f32 v166, v166, v175
    s_nop 0
    v_accvgpr_write_b32 a40, v166
    v_accvgpr_read_b32 v166, a41
    s_nop 0
    v_mul_f32 v166, v166, v175
    s_nop 0
    v_accvgpr_write_b32 a41, v166
    v_accvgpr_read_b32 v166, a42
    s_nop 0
    v_mul_f32 v166, v166, v175
    s_nop 0
    v_accvgpr_write_b32 a42, v166
    v_accvgpr_read_b32 v166, a43
    s_nop 0
    v_mul_f32 v166, v166, v175
    s_nop 0
    v_accvgpr_write_b32 a43, v166
    v_accvgpr_read_b32 v166, a60
    s_nop 0
    v_mul_f32 v166, v166, v175
    s_nop 0
    v_accvgpr_write_b32 a60, v166
    v_accvgpr_read_b32 v166, a61
    s_nop 0
    v_mul_f32 v166, v166, v175
    s_nop 0
    v_accvgpr_write_b32 a61, v166
    v_accvgpr_read_b32 v166, a62
    s_nop 0
    v_mul_f32 v166, v166, v175
    s_nop 0
    v_accvgpr_write_b32 a62, v166
    v_accvgpr_read_b32 v166, a63
    s_nop 0
    v_mul_f32 v166, v166, v175
    s_nop 0
    v_accvgpr_write_b32 a63, v166
    v_accvgpr_read_b32 v166, a80
    s_nop 0
    v_mul_f32 v166, v166, v175
    s_nop 0
    v_accvgpr_write_b32 a80, v166
    v_accvgpr_read_b32 v166, a81
    s_nop 0
    v_mul_f32 v166, v166, v175
    s_nop 0
    v_accvgpr_write_b32 a81, v166
    v_accvgpr_read_b32 v166, a82
    s_nop 0
    v_mul_f32 v166, v166, v175
    s_nop 0
    v_accvgpr_write_b32 a82, v166
    v_accvgpr_read_b32 v166, a83
    s_nop 0
    v_mul_f32 v166, v166, v175
    s_nop 0
    v_accvgpr_write_b32 a83, v166
    v_accvgpr_read_b32 v166, a100
    s_nop 0
    v_mul_f32 v166, v166, v175
    s_nop 0
    v_accvgpr_write_b32 a100, v166
    v_accvgpr_read_b32 v166, a101
    s_nop 0
    v_mul_f32 v166, v166, v175
    s_nop 0
    v_accvgpr_write_b32 a101, v166
    v_accvgpr_read_b32 v166, a102
    s_nop 0
    v_mul_f32 v166, v166, v175
    s_nop 0
    v_accvgpr_write_b32 a102, v166
    v_accvgpr_read_b32 v166, a103
    s_nop 0
    v_mul_f32 v166, v166, v175
    s_nop 0
    v_accvgpr_write_b32 a103, v166
    v_accvgpr_read_b32 v166, a120
    s_nop 0
    v_mul_f32 v166, v166, v175
    s_nop 0
    v_accvgpr_write_b32 a120, v166
    v_accvgpr_read_b32 v166, a121
    s_nop 0
    v_mul_f32 v166, v166, v175
    s_nop 0
    v_accvgpr_write_b32 a121, v166
    v_accvgpr_read_b32 v166, a122
    s_nop 0
    v_mul_f32 v166, v166, v175
    s_nop 0
    v_accvgpr_write_b32 a122, v166
    v_accvgpr_read_b32 v166, a123
    s_nop 0
    v_mul_f32 v166, v166, v175
    s_nop 0
    v_accvgpr_write_b32 a123, v166
    v_accvgpr_read_b32 v166, a140
    s_nop 0
    v_mul_f32 v166, v166, v175
    s_nop 0
    v_accvgpr_write_b32 a140, v166
    v_accvgpr_read_b32 v166, a141
    s_nop 0
    v_mul_f32 v166, v166, v175
    s_nop 0
    v_accvgpr_write_b32 a141, v166
    v_accvgpr_read_b32 v166, a142
    s_nop 0
    v_mul_f32 v166, v166, v175
    s_nop 0
    v_accvgpr_write_b32 a142, v166
    v_accvgpr_read_b32 v166, a143
    s_nop 0
    v_mul_f32 v166, v166, v175
    s_nop 0
    v_accvgpr_write_b32 a143, v166
    v_exp_f32 v166, v16
    v_exp_f32 v167, v17
    v_exp_f32 v168, v18
    v_add_f32 v156, v166, v167
    v_exp_f32 v169, v19
    v_cvt_pk_bf16_f32 v96, v166, v167
    v_add_f32 v156, v156, v168
    v_exp_f32 v170, v20
    v_add_f32 v156, v156, v169
    v_cvt_pk_bf16_f32 v97, v168, v169
    v_exp_f32 v171, v21
    v_add_f32 v156, v156, v170
    v_exp_f32 v172, v22
    v_add_f32 v156, v156, v171
    v_cvt_pk_bf16_f32 v98, v170, v171
    v_exp_f32 v173, v23
    v_add_f32 v156, v156, v172
    v_nop
    v_add_f32 v156, v156, v173
    v_cvt_pk_bf16_f32 v99, v172, v173
    v_max3_f32 v174, v24, v25, v26
    v_max3_f32 v174, v174, v27, v28
    v_max3_f32 v174, v174, v29, v30
    v_max_f32 v174, v174, v31
    v_mov_b32 v166, v174
    v_mov_b32 v167, v174
    s_nop 1
    v_permlane32_swap_b32 v166, v167
    s_nop 1
    v_max_f32 v174, v166, v167
    v_mov_b32 v166, v174
    v_mov_b32 v167, v174
    s_nop 1
    v_permlane16_swap_b32 v166, v167
    s_nop 1
    v_max_f32 v174, v166, v167
    v_max_f32 v174, 0, v174
    v_sub_f32 v175, 0, v174
    v_exp_f32 v175, v175
    v_sub_f32 v140, v140, v174
    v_sub_f32 v141, v141, v174
    v_sub_f32 v142, v142, v174
    v_sub_f32 v143, v143, v174
    v_sub_f32 v24, v24, v174
    v_sub_f32 v25, v25, v174
    v_sub_f32 v26, v26, v174
    v_sub_f32 v27, v27, v174
    v_sub_f32 v28, v28, v174
    v_sub_f32 v29, v29, v174
    v_sub_f32 v30, v30, v174
    v_sub_f32 v31, v31, v174
    v_mul_f32 v162, v162, v175
    v_accvgpr_read_b32 v166, a4
    s_nop 0
    v_mul_f32 v166, v166, v175
    s_nop 0
    v_accvgpr_write_b32 a4, v166
    v_accvgpr_read_b32 v166, a5
    s_nop 0
    v_mul_f32 v166, v166, v175
    s_nop 0
    v_accvgpr_write_b32 a5, v166
    v_accvgpr_read_b32 v166, a6
    s_nop 0
    v_mul_f32 v166, v166, v175
    s_nop 0
    v_accvgpr_write_b32 a6, v166
    v_accvgpr_read_b32 v166, a7
    s_nop 0
    v_mul_f32 v166, v166, v175
    s_nop 0
    v_accvgpr_write_b32 a7, v166
    v_accvgpr_read_b32 v166, a24
    s_nop 0
    v_mul_f32 v166, v166, v175
    s_nop 0
    v_accvgpr_write_b32 a24, v166
    v_accvgpr_read_b32 v166, a25
    s_nop 0
    v_mul_f32 v166, v166, v175
    s_nop 0
    v_accvgpr_write_b32 a25, v166
    v_accvgpr_read_b32 v166, a26
    s_nop 0
    v_mul_f32 v166, v166, v175
    s_nop 0
    v_accvgpr_write_b32 a26, v166
    v_accvgpr_read_b32 v166, a27
    s_nop 0
    v_mul_f32 v166, v166, v175
    s_nop 0
    v_accvgpr_write_b32 a27, v166
    v_accvgpr_read_b32 v166, a44
    s_nop 0
    v_mul_f32 v166, v166, v175
    s_nop 0
    v_accvgpr_write_b32 a44, v166
    v_accvgpr_read_b32 v166, a45
    s_nop 0
    v_mul_f32 v166, v166, v175
    s_nop 0
    v_accvgpr_write_b32 a45, v166
    v_accvgpr_read_b32 v166, a46
    s_nop 0
    v_mul_f32 v166, v166, v175
    s_nop 0
    v_accvgpr_write_b32 a46, v166
    v_accvgpr_read_b32 v166, a47
    s_nop 0
    v_mul_f32 v166, v166, v175
    s_nop 0
    v_accvgpr_write_b32 a47, v166
    v_accvgpr_read_b32 v166, a64
    s_nop 0
    v_mul_f32 v166, v166, v175
    s_nop 0
    v_accvgpr_write_b32 a64, v166
    v_accvgpr_read_b32 v166, a65
    s_nop 0
    v_mul_f32 v166, v166, v175
    s_nop 0
    v_accvgpr_write_b32 a65, v166
    v_accvgpr_read_b32 v166, a66
    s_nop 0
    v_mul_f32 v166, v166, v175
    s_nop 0
    v_accvgpr_write_b32 a66, v166
    v_accvgpr_read_b32 v166, a67
    s_nop 0
    v_mul_f32 v166, v166, v175
    s_nop 0
    v_accvgpr_write_b32 a67, v166
    v_accvgpr_read_b32 v166, a84
    s_nop 0
    v_mul_f32 v166, v166, v175
    s_nop 0
    v_accvgpr_write_b32 a84, v166
    v_accvgpr_read_b32 v166, a85
    s_nop 0
    v_mul_f32 v166, v166, v175
    s_nop 0
    v_accvgpr_write_b32 a85, v166
    v_accvgpr_read_b32 v166, a86
    s_nop 0
    v_mul_f32 v166, v166, v175
    s_nop 0
    v_accvgpr_write_b32 a86, v166
    v_accvgpr_read_b32 v166, a87
    s_nop 0
    v_mul_f32 v166, v166, v175
    s_nop 0
    v_accvgpr_write_b32 a87, v166
    v_accvgpr_read_b32 v166, a104
    s_nop 0
    v_mul_f32 v166, v166, v175
    s_nop 0
    v_accvgpr_write_b32 a104, v166
    v_accvgpr_read_b32 v166, a105
    s_nop 0
    v_mul_f32 v166, v166, v175
    s_nop 0
    v_accvgpr_write_b32 a105, v166
    v_accvgpr_read_b32 v166, a106
    s_nop 0
    v_mul_f32 v166, v166, v175
    s_nop 0
    v_accvgpr_write_b32 a106, v166
    v_accvgpr_read_b32 v166, a107
    s_nop 0
    v_mul_f32 v166, v166, v175
    s_nop 0
    v_accvgpr_write_b32 a107, v166
    v_accvgpr_read_b32 v166, a124
    s_nop 0
    v_mul_f32 v166, v166, v175
    s_nop 0
    v_accvgpr_write_b32 a124, v166
    v_accvgpr_read_b32 v166, a125
    s_nop 0
    v_mul_f32 v166, v166, v175
    s_nop 0
    v_accvgpr_write_b32 a125, v166
    v_accvgpr_read_b32 v166, a126
    s_nop 0
    v_mul_f32 v166, v166, v175
    s_nop 0
    v_accvgpr_write_b32 a126, v166
    v_accvgpr_read_b32 v166, a127
    s_nop 0
    v_mul_f32 v166, v166, v175
    s_nop 0
    v_accvgpr_write_b32 a127, v166
    v_accvgpr_read_b32 v166, a144
    s_nop 0
    v_mul_f32 v166, v166, v175
    s_nop 0
    v_accvgpr_write_b32 a144, v166
    v_accvgpr_read_b32 v166, a145
    s_nop 0
    v_mul_f32 v166, v166, v175
    s_nop 0
    v_accvgpr_write_b32 a145, v166
    v_accvgpr_read_b32 v166, a146
    s_nop 0
    v_mul_f32 v166, v166, v175
    s_nop 0
    v_accvgpr_write_b32 a146, v166
    v_accvgpr_read_b32 v166, a147
    s_nop 0
    v_mul_f32 v166, v166, v175
    s_nop 0
    v_accvgpr_write_b32 a147, v166
    v_exp_f32 v166, v24
    v_exp_f32 v167, v25
    v_exp_f32 v168, v26
    v_add_f32 v157, v166, v167
    v_exp_f32 v169, v27
    v_cvt_pk_bf16_f32 v100, v166, v167
    v_add_f32 v157, v157, v168
    v_exp_f32 v170, v28
    v_add_f32 v157, v157, v169
    v_cvt_pk_bf16_f32 v101, v168, v169
    v_exp_f32 v171, v29
    v_add_f32 v157, v157, v170
    v_exp_f32 v172, v30
    v_add_f32 v157, v157, v171
    v_cvt_pk_bf16_f32 v102, v170, v171
    v_exp_f32 v173, v31
    v_add_f32 v157, v157, v172
    v_nop
    v_add_f32 v157, v157, v173
    v_cvt_pk_bf16_f32 v103, v172, v173
    v_max3_f32 v174, v32, v33, v34
    v_max3_f32 v174, v174, v35, v36
    v_max3_f32 v174, v174, v37, v38
    v_max_f32 v174, v174, v39
    v_mov_b32 v166, v174
    v_mov_b32 v167, v174
    s_nop 1
    v_permlane32_swap_b32 v166, v167
    s_nop 1
    v_max_f32 v174, v166, v167
    v_mov_b32 v166, v174
    v_mov_b32 v167, v174
    s_nop 1
    v_permlane16_swap_b32 v166, v167
    s_nop 1
    v_max_f32 v174, v166, v167
    v_max_f32 v174, 0, v174
    v_sub_f32 v175, 0, v174
    v_exp_f32 v175, v175
    v_sub_f32 v144, v144, v174
    v_sub_f32 v145, v145, v174
    v_sub_f32 v146, v146, v174
    v_sub_f32 v147, v147, v174
    v_sub_f32 v32, v32, v174
    v_sub_f32 v33, v33, v174
    v_sub_f32 v34, v34, v174
    v_sub_f32 v35, v35, v174
    v_sub_f32 v36, v36, v174
    v_sub_f32 v37, v37, v174
    v_sub_f32 v38, v38, v174
    v_sub_f32 v39, v39, v174
    v_mul_f32 v163, v163, v175
    v_accvgpr_read_b32 v166, a8
    s_nop 0
    v_mul_f32 v166, v166, v175
    s_nop 0
    v_accvgpr_write_b32 a8, v166
    v_accvgpr_read_b32 v166, a9
    s_nop 0
    v_mul_f32 v166, v166, v175
    s_nop 0
    v_accvgpr_write_b32 a9, v166
    v_accvgpr_read_b32 v166, a10
    s_nop 0
    v_mul_f32 v166, v166, v175
    s_nop 0
    v_accvgpr_write_b32 a10, v166
    v_accvgpr_read_b32 v166, a11
    s_nop 0
    v_mul_f32 v166, v166, v175
    s_nop 0
    v_accvgpr_write_b32 a11, v166
    v_accvgpr_read_b32 v166, a28
    s_nop 0
    v_mul_f32 v166, v166, v175
    s_nop 0
    v_accvgpr_write_b32 a28, v166
    v_accvgpr_read_b32 v166, a29
    s_nop 0
    v_mul_f32 v166, v166, v175
    s_nop 0
    v_accvgpr_write_b32 a29, v166
    v_accvgpr_read_b32 v166, a30
    s_nop 0
    v_mul_f32 v166, v166, v175
    s_nop 0
    v_accvgpr_write_b32 a30, v166
    v_accvgpr_read_b32 v166, a31
    s_nop 0
    v_mul_f32 v166, v166, v175
    s_nop 0
    v_accvgpr_write_b32 a31, v166
    v_accvgpr_read_b32 v166, a48
    s_nop 0
    v_mul_f32 v166, v166, v175
    s_nop 0
    v_accvgpr_write_b32 a48, v166
    v_accvgpr_read_b32 v166, a49
    s_nop 0
    v_mul_f32 v166, v166, v175
    s_nop 0
    v_accvgpr_write_b32 a49, v166
    v_accvgpr_read_b32 v166, a50
    s_nop 0
    v_mul_f32 v166, v166, v175
    s_nop 0
    v_accvgpr_write_b32 a50, v166
    v_accvgpr_read_b32 v166, a51
    s_nop 0
    v_mul_f32 v166, v166, v175
    s_nop 0
    v_accvgpr_write_b32 a51, v166
    v_accvgpr_read_b32 v166, a68
    s_nop 0
    v_mul_f32 v166, v166, v175
    s_nop 0
    v_accvgpr_write_b32 a68, v166
    v_accvgpr_read_b32 v166, a69
    s_nop 0
    v_mul_f32 v166, v166, v175
    s_nop 0
    v_accvgpr_write_b32 a69, v166
    v_accvgpr_read_b32 v166, a70
    s_nop 0
    v_mul_f32 v166, v166, v175
    s_nop 0
    v_accvgpr_write_b32 a70, v166
    v_accvgpr_read_b32 v166, a71
    s_nop 0
    v_mul_f32 v166, v166, v175
    s_nop 0
    v_accvgpr_write_b32 a71, v166
    v_accvgpr_read_b32 v166, a88
    s_nop 0
    v_mul_f32 v166, v166, v175
    s_nop 0
    v_accvgpr_write_b32 a88, v166
    v_accvgpr_read_b32 v166, a89
    s_nop 0
    v_mul_f32 v166, v166, v175
    s_nop 0
    v_accvgpr_write_b32 a89, v166
    v_accvgpr_read_b32 v166, a90
    s_nop 0
    v_mul_f32 v166, v166, v175
    s_nop 0
    v_accvgpr_write_b32 a90, v166
    v_accvgpr_read_b32 v166, a91
    s_nop 0
    v_mul_f32 v166, v166, v175
    s_nop 0
    v_accvgpr_write_b32 a91, v166
    v_accvgpr_read_b32 v166, a108
    s_nop 0
    v_mul_f32 v166, v166, v175
    s_nop 0
    v_accvgpr_write_b32 a108, v166
    v_accvgpr_read_b32 v166, a109
    s_nop 0
    v_mul_f32 v166, v166, v175
    s_nop 0
    v_accvgpr_write_b32 a109, v166
    v_accvgpr_read_b32 v166, a110
    s_nop 0
    v_mul_f32 v166, v166, v175
    s_nop 0
    v_accvgpr_write_b32 a110, v166
    v_accvgpr_read_b32 v166, a111
    s_nop 0
    v_mul_f32 v166, v166, v175
    s_nop 0
    v_accvgpr_write_b32 a111, v166
    v_accvgpr_read_b32 v166, a128
    s_nop 0
    v_mul_f32 v166, v166, v175
    s_nop 0
    v_accvgpr_write_b32 a128, v166
    v_accvgpr_read_b32 v166, a129
    s_nop 0
    v_mul_f32 v166, v166, v175
    s_nop 0
    v_accvgpr_write_b32 a129, v166
    v_accvgpr_read_b32 v166, a130
    s_nop 0
    v_mul_f32 v166, v166, v175
    s_nop 0
    v_accvgpr_write_b32 a130, v166
    v_accvgpr_read_b32 v166, a131
    s_nop 0
    v_mul_f32 v166, v166, v175
    s_nop 0
    v_accvgpr_write_b32 a131, v166
    v_accvgpr_read_b32 v166, a148
    s_nop 0
    v_mul_f32 v166, v166, v175
    s_nop 0
    v_accvgpr_write_b32 a148, v166
    v_accvgpr_read_b32 v166, a149
    s_nop 0
    v_mul_f32 v166, v166, v175
    s_nop 0
    v_accvgpr_write_b32 a149, v166
    v_accvgpr_read_b32 v166, a150
    s_nop 0
    v_mul_f32 v166, v166, v175
    s_nop 0
    v_accvgpr_write_b32 a150, v166
    v_accvgpr_read_b32 v166, a151
    s_nop 0
    v_mul_f32 v166, v166, v175
    s_nop 0
    v_accvgpr_write_b32 a151, v166
    v_exp_f32 v166, v32
    v_exp_f32 v167, v33
    v_exp_f32 v168, v34
    v_add_f32 v158, v166, v167
    v_exp_f32 v169, v35
    v_cvt_pk_bf16_f32 v104, v166, v167
    v_add_f32 v158, v158, v168
    v_exp_f32 v170, v36
    v_add_f32 v158, v158, v169
    v_cvt_pk_bf16_f32 v105, v168, v169
    v_exp_f32 v171, v37
    v_add_f32 v158, v158, v170
    v_exp_f32 v172, v38
    v_add_f32 v158, v158, v171
    v_cvt_pk_bf16_f32 v106, v170, v171
    v_exp_f32 v173, v39
    v_add_f32 v158, v158, v172
    v_nop
    v_add_f32 v158, v158, v173
    v_cvt_pk_bf16_f32 v107, v172, v173
    v_max3_f32 v174, v40, v41, v42
    v_max3_f32 v174, v174, v43, v44
    v_max3_f32 v174, v174, v45, v46
    v_max_f32 v174, v174, v47
    v_mov_b32 v166, v174
    v_mov_b32 v167, v174
    s_nop 1
    v_permlane32_swap_b32 v166, v167
    s_nop 1
    v_max_f32 v174, v166, v167
    v_mov_b32 v166, v174
    v_mov_b32 v167, v174
    s_nop 1
    v_permlane16_swap_b32 v166, v167
    s_nop 1
    v_max_f32 v174, v166, v167
    v_max_f32 v174, 0, v174
    v_sub_f32 v175, 0, v174
    v_exp_f32 v175, v175
    v_sub_f32 v148, v148, v174
    v_sub_f32 v149, v149, v174
    v_sub_f32 v150, v150, v174
    v_sub_f32 v151, v151, v174
    v_sub_f32 v40, v40, v174
    v_sub_f32 v41, v41, v174
    v_sub_f32 v42, v42, v174
    v_sub_f32 v43, v43, v174
    v_sub_f32 v44, v44, v174
    v_sub_f32 v45, v45, v174
    v_sub_f32 v46, v46, v174
    v_sub_f32 v47, v47, v174
    v_mul_f32 v164, v164, v175
    v_accvgpr_read_b32 v166, a12
    s_nop 0
    v_mul_f32 v166, v166, v175
    s_nop 0
    v_accvgpr_write_b32 a12, v166
    v_accvgpr_read_b32 v166, a13
    s_nop 0
    v_mul_f32 v166, v166, v175
    s_nop 0
    v_accvgpr_write_b32 a13, v166
    v_accvgpr_read_b32 v166, a14
    s_nop 0
    v_mul_f32 v166, v166, v175
    s_nop 0
    v_accvgpr_write_b32 a14, v166
    v_accvgpr_read_b32 v166, a15
    s_nop 0
    v_mul_f32 v166, v166, v175
    s_nop 0
    v_accvgpr_write_b32 a15, v166
    v_accvgpr_read_b32 v166, a32
    s_nop 0
    v_mul_f32 v166, v166, v175
    s_nop 0
    v_accvgpr_write_b32 a32, v166
    v_accvgpr_read_b32 v166, a33
    s_nop 0
    v_mul_f32 v166, v166, v175
    s_nop 0
    v_accvgpr_write_b32 a33, v166
    v_accvgpr_read_b32 v166, a34
    s_nop 0
    v_mul_f32 v166, v166, v175
    s_nop 0
    v_accvgpr_write_b32 a34, v166
    v_accvgpr_read_b32 v166, a35
    s_nop 0
    v_mul_f32 v166, v166, v175
    s_nop 0
    v_accvgpr_write_b32 a35, v166
    v_accvgpr_read_b32 v166, a52
    s_nop 0
    v_mul_f32 v166, v166, v175
    s_nop 0
    v_accvgpr_write_b32 a52, v166
    v_accvgpr_read_b32 v166, a53
    s_nop 0
    v_mul_f32 v166, v166, v175
    s_nop 0
    v_accvgpr_write_b32 a53, v166
    v_accvgpr_read_b32 v166, a54
    s_nop 0
    v_mul_f32 v166, v166, v175
    s_nop 0
    v_accvgpr_write_b32 a54, v166
    v_accvgpr_read_b32 v166, a55
    s_nop 0
    v_mul_f32 v166, v166, v175
    s_nop 0
    v_accvgpr_write_b32 a55, v166
    v_accvgpr_read_b32 v166, a72
    s_nop 0
    v_mul_f32 v166, v166, v175
    s_nop 0
    v_accvgpr_write_b32 a72, v166
    v_accvgpr_read_b32 v166, a73
    s_nop 0
    v_mul_f32 v166, v166, v175
    s_nop 0
    v_accvgpr_write_b32 a73, v166
    v_accvgpr_read_b32 v166, a74
    s_nop 0
    v_mul_f32 v166, v166, v175
    s_nop 0
    v_accvgpr_write_b32 a74, v166
    v_accvgpr_read_b32 v166, a75
    s_nop 0
    v_mul_f32 v166, v166, v175
    s_nop 0
    v_accvgpr_write_b32 a75, v166
    v_accvgpr_read_b32 v166, a92
    s_nop 0
    v_mul_f32 v166, v166, v175
    s_nop 0
    v_accvgpr_write_b32 a92, v166
    v_accvgpr_read_b32 v166, a93
    s_nop 0
    v_mul_f32 v166, v166, v175
    s_nop 0
    v_accvgpr_write_b32 a93, v166
    v_accvgpr_read_b32 v166, a94
    s_nop 0
    v_mul_f32 v166, v166, v175
    s_nop 0
    v_accvgpr_write_b32 a94, v166
    v_accvgpr_read_b32 v166, a95
    s_nop 0
    v_mul_f32 v166, v166, v175
    s_nop 0
    v_accvgpr_write_b32 a95, v166
    v_accvgpr_read_b32 v166, a112
    s_nop 0
    v_mul_f32 v166, v166, v175
    s_nop 0
    v_accvgpr_write_b32 a112, v166
    v_accvgpr_read_b32 v166, a113
    s_nop 0
    v_mul_f32 v166, v166, v175
    s_nop 0
    v_accvgpr_write_b32 a113, v166
    v_accvgpr_read_b32 v166, a114
    s_nop 0
    v_mul_f32 v166, v166, v175
    s_nop 0
    v_accvgpr_write_b32 a114, v166
    v_accvgpr_read_b32 v166, a115
    s_nop 0
    v_mul_f32 v166, v166, v175
    s_nop 0
    v_accvgpr_write_b32 a115, v166
    v_accvgpr_read_b32 v166, a132
    s_nop 0
    v_mul_f32 v166, v166, v175
    s_nop 0
    v_accvgpr_write_b32 a132, v166
    v_accvgpr_read_b32 v166, a133
    s_nop 0
    v_mul_f32 v166, v166, v175
    s_nop 0
    v_accvgpr_write_b32 a133, v166
    v_accvgpr_read_b32 v166, a134
    s_nop 0
    v_mul_f32 v166, v166, v175
    s_nop 0
    v_accvgpr_write_b32 a134, v166
    v_accvgpr_read_b32 v166, a135
    s_nop 0
    v_mul_f32 v166, v166, v175
    s_nop 0
    v_accvgpr_write_b32 a135, v166
    v_accvgpr_read_b32 v166, a152
    s_nop 0
    v_mul_f32 v166, v166, v175
    s_nop 0
    v_accvgpr_write_b32 a152, v166
    v_accvgpr_read_b32 v166, a153
    s_nop 0
    v_mul_f32 v166, v166, v175
    s_nop 0
    v_accvgpr_write_b32 a153, v166
    v_accvgpr_read_b32 v166, a154
    s_nop 0
    v_mul_f32 v166, v166, v175
    s_nop 0
    v_accvgpr_write_b32 a154, v166
    v_accvgpr_read_b32 v166, a155
    s_nop 0
    v_mul_f32 v166, v166, v175
    s_nop 0
    v_accvgpr_write_b32 a155, v166
    v_exp_f32 v166, v40
    v_exp_f32 v167, v41
    v_exp_f32 v168, v42
    v_add_f32 v159, v166, v167
    v_exp_f32 v169, v43
    v_cvt_pk_bf16_f32 v108, v166, v167
    v_add_f32 v159, v159, v168
    v_exp_f32 v170, v44
    v_add_f32 v159, v159, v169
    v_cvt_pk_bf16_f32 v109, v168, v169
    v_exp_f32 v171, v45
    v_add_f32 v159, v159, v170
    v_exp_f32 v172, v46
    v_add_f32 v159, v159, v171
    v_cvt_pk_bf16_f32 v110, v170, v171
    v_exp_f32 v173, v47
    v_add_f32 v159, v159, v172
    v_nop
    v_add_f32 v159, v159, v173
    v_cvt_pk_bf16_f32 v111, v172, v173
    v_max3_f32 v174, v48, v49, v50
    v_max3_f32 v174, v174, v51, v52
    v_max3_f32 v174, v174, v53, v54
    v_max_f32 v174, v174, v55
    v_mov_b32 v166, v174
    v_mov_b32 v167, v174
    s_nop 1
    v_permlane32_swap_b32 v166, v167
    s_nop 1
    v_max_f32 v174, v166, v167
    v_mov_b32 v166, v174
    v_mov_b32 v167, v174
    s_nop 1
    v_permlane16_swap_b32 v166, v167
    s_nop 1
    v_max_f32 v174, v166, v167
    v_max_f32 v174, 0, v174
    v_sub_f32 v175, 0, v174
    v_exp_f32 v175, v175
    v_sub_f32 v152, v152, v174
    v_sub_f32 v153, v153, v174
    v_sub_f32 v154, v154, v174
    v_sub_f32 v155, v155, v174
    v_sub_f32 v48, v48, v174
    v_sub_f32 v49, v49, v174
    v_sub_f32 v50, v50, v174
    v_sub_f32 v51, v51, v174
    v_sub_f32 v52, v52, v174
    v_sub_f32 v53, v53, v174
    v_sub_f32 v54, v54, v174
    v_sub_f32 v55, v55, v174
    v_mul_f32 v165, v165, v175
    v_accvgpr_read_b32 v166, a16
    s_nop 0
    v_mul_f32 v166, v166, v175
    s_nop 0
    v_accvgpr_write_b32 a16, v166
    v_accvgpr_read_b32 v166, a17
    s_nop 0
    v_mul_f32 v166, v166, v175
    s_nop 0
    v_accvgpr_write_b32 a17, v166
    v_accvgpr_read_b32 v166, a18
    s_nop 0
    v_mul_f32 v166, v166, v175
    s_nop 0
    v_accvgpr_write_b32 a18, v166
    v_accvgpr_read_b32 v166, a19
    s_nop 0
    v_mul_f32 v166, v166, v175
    s_nop 0
    v_accvgpr_write_b32 a19, v166
    v_accvgpr_read_b32 v166, a36
    s_nop 0
    v_mul_f32 v166, v166, v175
    s_nop 0
    v_accvgpr_write_b32 a36, v166
    v_accvgpr_read_b32 v166, a37
    s_nop 0
    v_mul_f32 v166, v166, v175
    s_nop 0
    v_accvgpr_write_b32 a37, v166
    v_accvgpr_read_b32 v166, a38
    s_nop 0
    v_mul_f32 v166, v166, v175
    s_nop 0
    v_accvgpr_write_b32 a38, v166
    v_accvgpr_read_b32 v166, a39
    s_nop 0
    v_mul_f32 v166, v166, v175
    s_nop 0
    v_accvgpr_write_b32 a39, v166
    v_accvgpr_read_b32 v166, a56
    s_nop 0
    v_mul_f32 v166, v166, v175
    s_nop 0
    v_accvgpr_write_b32 a56, v166
    v_accvgpr_read_b32 v166, a57
    s_nop 0
    v_mul_f32 v166, v166, v175
    s_nop 0
    v_accvgpr_write_b32 a57, v166
    v_accvgpr_read_b32 v166, a58
    s_nop 0
    v_mul_f32 v166, v166, v175
    s_nop 0
    v_accvgpr_write_b32 a58, v166
    v_accvgpr_read_b32 v166, a59
    s_nop 0
    v_mul_f32 v166, v166, v175
    s_nop 0
    v_accvgpr_write_b32 a59, v166
    v_accvgpr_read_b32 v166, a76
    s_nop 0
    v_mul_f32 v166, v166, v175
    s_nop 0
    v_accvgpr_write_b32 a76, v166
    v_accvgpr_read_b32 v166, a77
    s_nop 0
    v_mul_f32 v166, v166, v175
    s_nop 0
    v_accvgpr_write_b32 a77, v166
    v_accvgpr_read_b32 v166, a78
    s_nop 0
    v_mul_f32 v166, v166, v175
    s_nop 0
    v_accvgpr_write_b32 a78, v166
    v_accvgpr_read_b32 v166, a79
    s_nop 0
    v_mul_f32 v166, v166, v175
    s_nop 0
    v_accvgpr_write_b32 a79, v166
    v_accvgpr_read_b32 v166, a96
    s_nop 0
    v_mul_f32 v166, v166, v175
    s_nop 0
    v_accvgpr_write_b32 a96, v166
    v_accvgpr_read_b32 v166, a97
    s_nop 0
    v_mul_f32 v166, v166, v175
    s_nop 0
    v_accvgpr_write_b32 a97, v166
    v_accvgpr_read_b32 v166, a98
    s_nop 0
    v_mul_f32 v166, v166, v175
    s_nop 0
    v_accvgpr_write_b32 a98, v166
    v_accvgpr_read_b32 v166, a99
    s_nop 0
    v_mul_f32 v166, v166, v175
    s_nop 0
    v_accvgpr_write_b32 a99, v166
    v_accvgpr_read_b32 v166, a116
    s_nop 0
    v_mul_f32 v166, v166, v175
    s_nop 0
    v_accvgpr_write_b32 a116, v166
    v_accvgpr_read_b32 v166, a117
    s_nop 0
    v_mul_f32 v166, v166, v175
    s_nop 0
    v_accvgpr_write_b32 a117, v166
    v_accvgpr_read_b32 v166, a118
    s_nop 0
    v_mul_f32 v166, v166, v175
    s_nop 0
    v_accvgpr_write_b32 a118, v166
    v_accvgpr_read_b32 v166, a119
    s_nop 0
    v_mul_f32 v166, v166, v175
    s_nop 0
    v_accvgpr_write_b32 a119, v166
    v_accvgpr_read_b32 v166, a136
    s_nop 0
    v_mul_f32 v166, v166, v175
    s_nop 0
    v_accvgpr_write_b32 a136, v166
    v_accvgpr_read_b32 v166, a137
    s_nop 0
    v_mul_f32 v166, v166, v175
    s_nop 0
    v_accvgpr_write_b32 a137, v166
    v_accvgpr_read_b32 v166, a138
    s_nop 0
    v_mul_f32 v166, v166, v175
    s_nop 0
    v_accvgpr_write_b32 a138, v166
    v_accvgpr_read_b32 v166, a139
    s_nop 0
    v_mul_f32 v166, v166, v175
    s_nop 0
    v_accvgpr_write_b32 a139, v166
    v_accvgpr_read_b32 v166, a156
    s_nop 0
    v_mul_f32 v166, v166, v175
    s_nop 0
    v_accvgpr_write_b32 a156, v166
    v_accvgpr_read_b32 v166, a157
    s_nop 0
    v_mul_f32 v166, v166, v175
    s_nop 0
    v_accvgpr_write_b32 a157, v166
    v_accvgpr_read_b32 v166, a158
    s_nop 0
    v_mul_f32 v166, v166, v175
    s_nop 0
    v_accvgpr_write_b32 a158, v166
    v_accvgpr_read_b32 v166, a159
    s_nop 0
    v_mul_f32 v166, v166, v175
    s_nop 0
    v_accvgpr_write_b32 a159, v166
    v_exp_f32 v166, v48
    v_exp_f32 v167, v49
    v_exp_f32 v168, v50
    v_add_f32 v160, v166, v167
    v_exp_f32 v169, v51
    v_cvt_pk_bf16_f32 v112, v166, v167
    v_add_f32 v160, v160, v168
    v_exp_f32 v170, v52
    v_add_f32 v160, v160, v169
    v_cvt_pk_bf16_f32 v113, v168, v169
    v_exp_f32 v171, v53
    v_add_f32 v160, v160, v170
    v_exp_f32 v172, v54
    v_add_f32 v160, v160, v171
    v_cvt_pk_bf16_f32 v114, v170, v171
    v_exp_f32 v173, v55
    v_add_f32 v160, v160, v172
    v_nop
    v_add_f32 v160, v160, v173
    v_cvt_pk_bf16_f32 v115, v172, v173
    s_nop 3
    s_setpc_b64 s[52:53]
K1_FB3:
    s_nop 7
    s_nop 7
    v_max3_f32 v174, v56, v57, v58
    v_max3_f32 v174, v174, v59, v60
    v_max3_f32 v174, v174, v61, v62
    v_max_f32 v174, v174, v63
    v_mov_b32 v166, v174
    v_mov_b32 v167, v174
    s_nop 1
    v_permlane32_swap_b32 v166, v167
    s_nop 1
    v_max_f32 v174, v166, v167
    v_mov_b32 v166, v174
    v_mov_b32 v167, v174
    s_nop 1
    v_permlane16_swap_b32 v166, v167
    s_nop 1
    v_max_f32 v174, v166, v167
    v_max_f32 v174, 0, v174
    v_sub_f32 v175, 0, v174
    v_exp_f32 v175, v175
    v_sub_f32 v136, v136, v174
    v_sub_f32 v137, v137, v174
    v_sub_f32 v138, v138, v174
    v_sub_f32 v139, v139, v174
    v_sub_f32 v56, v56, v174
    v_sub_f32 v57, v57, v174
    v_sub_f32 v58, v58, v174
    v_sub_f32 v59, v59, v174
    v_sub_f32 v60, v60, v174
    v_sub_f32 v61, v61, v174
    v_sub_f32 v62, v62, v174
    v_sub_f32 v63, v63, v174
    v_mul_f32 v161, v161, v175
    v_accvgpr_read_b32 v166, a0
    s_nop 0
    v_mul_f32 v166, v166, v175
    s_nop 0
    v_accvgpr_write_b32 a0, v166
    v_accvgpr_read_b32 v166, a1
    s_nop 0
    v_mul_f32 v166, v166, v175
    s_nop 0
    v_accvgpr_write_b32 a1, v166
    v_accvgpr_read_b32 v166, a2
    s_nop 0
    v_mul_f32 v166, v166, v175
    s_nop 0
    v_accvgpr_write_b32 a2, v166
    v_accvgpr_read_b32 v166, a3
    s_nop 0
    v_mul_f32 v166, v166, v175
    s_nop 0
    v_accvgpr_write_b32 a3, v166
    v_accvgpr_read_b32 v166, a20
    s_nop 0
    v_mul_f32 v166, v166, v175
    s_nop 0
    v_accvgpr_write_b32 a20, v166
    v_accvgpr_read_b32 v166, a21
    s_nop 0
    v_mul_f32 v166, v166, v175
    s_nop 0
    v_accvgpr_write_b32 a21, v166
    v_accvgpr_read_b32 v166, a22
    s_nop 0
    v_mul_f32 v166, v166, v175
    s_nop 0
    v_accvgpr_write_b32 a22, v166
    v_accvgpr_read_b32 v166, a23
    s_nop 0
    v_mul_f32 v166, v166, v175
    s_nop 0
    v_accvgpr_write_b32 a23, v166
    v_accvgpr_read_b32 v166, a40
    s_nop 0
    v_mul_f32 v166, v166, v175
    s_nop 0
    v_accvgpr_write_b32 a40, v166
    v_accvgpr_read_b32 v166, a41
    s_nop 0
    v_mul_f32 v166, v166, v175
    s_nop 0
    v_accvgpr_write_b32 a41, v166
    v_accvgpr_read_b32 v166, a42
    s_nop 0
    v_mul_f32 v166, v166, v175
    s_nop 0
    v_accvgpr_write_b32 a42, v166
    v_accvgpr_read_b32 v166, a43
    s_nop 0
    v_mul_f32 v166, v166, v175
    s_nop 0
    v_accvgpr_write_b32 a43, v166
    v_accvgpr_read_b32 v166, a60
    s_nop 0
    v_mul_f32 v166, v166, v175
    s_nop 0
    v_accvgpr_write_b32 a60, v166
    v_accvgpr_read_b32 v166, a61
    s_nop 0
    v_mul_f32 v166, v166, v175
    s_nop 0
    v_accvgpr_write_b32 a61, v166
    v_accvgpr_read_b32 v166, a62
    s_nop 0
    v_mul_f32 v166, v166, v175
    s_nop 0
    v_accvgpr_write_b32 a62, v166
    v_accvgpr_read_b32 v166, a63
    s_nop 0
    v_mul_f32 v166, v166, v175
    s_nop 0
    v_accvgpr_write_b32 a63, v166
    v_accvgpr_read_b32 v166, a80
    s_nop 0
    v_mul_f32 v166, v166, v175
    s_nop 0
    v_accvgpr_write_b32 a80, v166
    v_accvgpr_read_b32 v166, a81
    s_nop 0
    v_mul_f32 v166, v166, v175
    s_nop 0
    v_accvgpr_write_b32 a81, v166
    v_accvgpr_read_b32 v166, a82
    s_nop 0
    v_mul_f32 v166, v166, v175
    s_nop 0
    v_accvgpr_write_b32 a82, v166
    v_accvgpr_read_b32 v166, a83
    s_nop 0
    v_mul_f32 v166, v166, v175
    s_nop 0
    v_accvgpr_write_b32 a83, v166
    v_accvgpr_read_b32 v166, a100
    s_nop 0
    v_mul_f32 v166, v166, v175
    s_nop 0
    v_accvgpr_write_b32 a100, v166
    v_accvgpr_read_b32 v166, a101
    s_nop 0
    v_mul_f32 v166, v166, v175
    s_nop 0
    v_accvgpr_write_b32 a101, v166
    v_accvgpr_read_b32 v166, a102
    s_nop 0
    v_mul_f32 v166, v166, v175
    s_nop 0
    v_accvgpr_write_b32 a102, v166
    v_accvgpr_read_b32 v166, a103
    s_nop 0
    v_mul_f32 v166, v166, v175
    s_nop 0
    v_accvgpr_write_b32 a103, v166
    v_accvgpr_read_b32 v166, a120
    s_nop 0
    v_mul_f32 v166, v166, v175
    s_nop 0
    v_accvgpr_write_b32 a120, v166
    v_accvgpr_read_b32 v166, a121
    s_nop 0
    v_mul_f32 v166, v166, v175
    s_nop 0
    v_accvgpr_write_b32 a121, v166
    v_accvgpr_read_b32 v166, a122
    s_nop 0
    v_mul_f32 v166, v166, v175
    s_nop 0
    v_accvgpr_write_b32 a122, v166
    v_accvgpr_read_b32 v166, a123
    s_nop 0
    v_mul_f32 v166, v166, v175
    s_nop 0
    v_accvgpr_write_b32 a123, v166
    v_accvgpr_read_b32 v166, a140
    s_nop 0
    v_mul_f32 v166, v166, v175
    s_nop 0
    v_accvgpr_write_b32 a140, v166
    v_accvgpr_read_b32 v166, a141
    s_nop 0
    v_mul_f32 v166, v166, v175
    s_nop 0
    v_accvgpr_write_b32 a141, v166
    v_accvgpr_read_b32 v166, a142
    s_nop 0
    v_mul_f32 v166, v166, v175
    s_nop 0
    v_accvgpr_write_b32 a142, v166
    v_accvgpr_read_b32 v166, a143
    s_nop 0
    v_mul_f32 v166, v166, v175
    s_nop 0
    v_accvgpr_write_b32 a143, v166
    v_exp_f32 v166, v56
    v_exp_f32 v167, v57
    v_exp_f32 v168, v58
    v_add_f32 v156, v166, v167
    v_exp_f32 v169, v59
    v_cvt_pk_bf16_f32 v116, v166, v167
    v_add_f32 v156, v156, v168
    v_exp_f32 v170, v60
    v_add_f32 v156, v156, v169
    v_cvt_pk_bf16_f32 v117, v168, v169
    v_exp_f32 v171, v61
    v_add_f32 v156, v156, v170
    v_exp_f32 v172, v62
    v_add_f32 v156, v156, v171
    v_cvt_pk_bf16_f32 v118, v170, v171
    v_exp_f32 v173, v63
    v_add_f32 v156, v156, v172
    v_nop
    v_add_f32 v156, v156, v173
    v_cvt_pk_bf16_f32 v119, v172, v173
    v_max3_f32 v174, v64, v65, v66
    v_max3_f32 v174, v174, v67, v68
    v_max3_f32 v174, v174, v69, v70
    v_max_f32 v174, v174, v71
    v_mov_b32 v166, v174
    v_mov_b32 v167, v174
    s_nop 1
    v_permlane32_swap_b32 v166, v167
    s_nop 1
    v_max_f32 v174, v166, v167
    v_mov_b32 v166, v174
    v_mov_b32 v167, v174
    s_nop 1
    v_permlane16_swap_b32 v166, v167
    s_nop 1
    v_max_f32 v174, v166, v167
    v_max_f32 v174, 0, v174
    v_sub_f32 v175, 0, v174
    v_exp_f32 v175, v175
    v_sub_f32 v140, v140, v174
    v_sub_f32 v141, v141, v174
    v_sub_f32 v142, v142, v174
    v_sub_f32 v143, v143, v174
    v_sub_f32 v64, v64, v174
    v_sub_f32 v65, v65, v174
    v_sub_f32 v66, v66, v174
    v_sub_f32 v67, v67, v174
    v_sub_f32 v68, v68, v174
    v_sub_f32 v69, v69, v174
    v_sub_f32 v70, v70, v174
    v_sub_f32 v71, v71, v174
    v_mul_f32 v162, v162, v175
    v_accvgpr_read_b32 v166, a4
    s_nop 0
    v_mul_f32 v166, v166, v175
    s_nop 0
    v_accvgpr_write_b32 a4, v166
    v_accvgpr_read_b32 v166, a5
    s_nop 0
    v_mul_f32 v166, v166, v175
    s_nop 0
    v_accvgpr_write_b32 a5, v166
    v_accvgpr_read_b32 v166, a6
    s_nop 0
    v_mul_f32 v166, v166, v175
    s_nop 0
    v_accvgpr_write_b32 a6, v166
    v_accvgpr_read_b32 v166, a7
    s_nop 0
    v_mul_f32 v166, v166, v175
    s_nop 0
    v_accvgpr_write_b32 a7, v166
    v_accvgpr_read_b32 v166, a24
    s_nop 0
    v_mul_f32 v166, v166, v175
    s_nop 0
    v_accvgpr_write_b32 a24, v166
    v_accvgpr_read_b32 v166, a25
    s_nop 0
    v_mul_f32 v166, v166, v175
    s_nop 0
    v_accvgpr_write_b32 a25, v166
    v_accvgpr_read_b32 v166, a26
    s_nop 0
    v_mul_f32 v166, v166, v175
    s_nop 0
    v_accvgpr_write_b32 a26, v166
    v_accvgpr_read_b32 v166, a27
    s_nop 0
    v_mul_f32 v166, v166, v175
    s_nop 0
    v_accvgpr_write_b32 a27, v166
    v_accvgpr_read_b32 v166, a44
    s_nop 0
    v_mul_f32 v166, v166, v175
    s_nop 0
    v_accvgpr_write_b32 a44, v166
    v_accvgpr_read_b32 v166, a45
    s_nop 0
    v_mul_f32 v166, v166, v175
    s_nop 0
    v_accvgpr_write_b32 a45, v166
    v_accvgpr_read_b32 v166, a46
    s_nop 0
    v_mul_f32 v166, v166, v175
    s_nop 0
    v_accvgpr_write_b32 a46, v166
    v_accvgpr_read_b32 v166, a47
    s_nop 0
    v_mul_f32 v166, v166, v175
    s_nop 0
    v_accvgpr_write_b32 a47, v166
    v_accvgpr_read_b32 v166, a64
    s_nop 0
    v_mul_f32 v166, v166, v175
    s_nop 0
    v_accvgpr_write_b32 a64, v166
    v_accvgpr_read_b32 v166, a65
    s_nop 0
    v_mul_f32 v166, v166, v175
    s_nop 0
    v_accvgpr_write_b32 a65, v166
    v_accvgpr_read_b32 v166, a66
    s_nop 0
    v_mul_f32 v166, v166, v175
    s_nop 0
    v_accvgpr_write_b32 a66, v166
    v_accvgpr_read_b32 v166, a67
    s_nop 0
    v_mul_f32 v166, v166, v175
    s_nop 0
    v_accvgpr_write_b32 a67, v166
    v_accvgpr_read_b32 v166, a84
    s_nop 0
    v_mul_f32 v166, v166, v175
    s_nop 0
    v_accvgpr_write_b32 a84, v166
    v_accvgpr_read_b32 v166, a85
    s_nop 0
    v_mul_f32 v166, v166, v175
    s_nop 0
    v_accvgpr_write_b32 a85, v166
    v_accvgpr_read_b32 v166, a86
    s_nop 0
    v_mul_f32 v166, v166, v175
    s_nop 0
    v_accvgpr_write_b32 a86, v166
    v_accvgpr_read_b32 v166, a87
    s_nop 0
    v_mul_f32 v166, v166, v175
    s_nop 0
    v_accvgpr_write_b32 a87, v166
    v_accvgpr_read_b32 v166, a104
    s_nop 0
    v_mul_f32 v166, v166, v175
    s_nop 0
    v_accvgpr_write_b32 a104, v166
    v_accvgpr_read_b32 v166, a105
    s_nop 0
    v_mul_f32 v166, v166, v175
    s_nop 0
    v_accvgpr_write_b32 a105, v166
    v_accvgpr_read_b32 v166, a106
    s_nop 0
    v_mul_f32 v166, v166, v175
    s_nop 0
    v_accvgpr_write_b32 a106, v166
    v_accvgpr_read_b32 v166, a107
    s_nop 0
    v_mul_f32 v166, v166, v175
    s_nop 0
    v_accvgpr_write_b32 a107, v166
    v_accvgpr_read_b32 v166, a124
    s_nop 0
    v_mul_f32 v166, v166, v175
    s_nop 0
    v_accvgpr_write_b32 a124, v166
    v_accvgpr_read_b32 v166, a125
    s_nop 0
    v_mul_f32 v166, v166, v175
    s_nop 0
    v_accvgpr_write_b32 a125, v166
    v_accvgpr_read_b32 v166, a126
    s_nop 0
    v_mul_f32 v166, v166, v175
    s_nop 0
    v_accvgpr_write_b32 a126, v166
    v_accvgpr_read_b32 v166, a127
    s_nop 0
    v_mul_f32 v166, v166, v175
    s_nop 0
    v_accvgpr_write_b32 a127, v166
    v_accvgpr_read_b32 v166, a144
    s_nop 0
    v_mul_f32 v166, v166, v175
    s_nop 0
    v_accvgpr_write_b32 a144, v166
    v_accvgpr_read_b32 v166, a145
    s_nop 0
    v_mul_f32 v166, v166, v175
    s_nop 0
    v_accvgpr_write_b32 a145, v166
    v_accvgpr_read_b32 v166, a146
    s_nop 0
    v_mul_f32 v166, v166, v175
    s_nop 0
    v_accvgpr_write_b32 a146, v166
    v_accvgpr_read_b32 v166, a147
    s_nop 0
    v_mul_f32 v166, v166, v175
    s_nop 0
    v_accvgpr_write_b32 a147, v166
    v_exp_f32 v166, v64
    v_exp_f32 v167, v65
    v_exp_f32 v168, v66
    v_add_f32 v157, v166, v167
    v_exp_f32 v169, v67
    v_cvt_pk_bf16_f32 v120, v166, v167
    v_add_f32 v157, v157, v168
    v_exp_f32 v170, v68
    v_add_f32 v157, v157, v169
    v_cvt_pk_bf16_f32 v121, v168, v169
    v_exp_f32 v171, v69
    v_add_f32 v157, v157, v170
    v_exp_f32 v172, v70
    v_add_f32 v157, v157, v171
    v_cvt_pk_bf16_f32 v122, v170, v171
    v_exp_f32 v173, v71
    v_add_f32 v157, v157, v172
    v_nop
    v_add_f32 v157, v157, v173
    v_cvt_pk_bf16_f32 v123, v172, v173
    v_max3_f32 v174, v72, v73, v74
    v_max3_f32 v174, v174, v75, v76
    v_max3_f32 v174, v174, v77, v78
    v_max_f32 v174, v174, v79
    v_mov_b32 v166, v174
    v_mov_b32 v167, v174
    s_nop 1
    v_permlane32_swap_b32 v166, v167
    s_nop 1
    v_max_f32 v174, v166, v167
    v_mov_b32 v166, v174
    v_mov_b32 v167, v174
    s_nop 1
    v_permlane16_swap_b32 v166, v167
    s_nop 1
    v_max_f32 v174, v166, v167
    v_max_f32 v174, 0, v174
    v_sub_f32 v175, 0, v174
    v_exp_f32 v175, v175
    v_sub_f32 v144, v144, v174
    v_sub_f32 v145, v145, v174
    v_sub_f32 v146, v146, v174
    v_sub_f32 v147, v147, v174
    v_sub_f32 v72, v72, v174
    v_sub_f32 v73, v73, v174
    v_sub_f32 v74, v74, v174
    v_sub_f32 v75, v75, v174
    v_sub_f32 v76, v76, v174
    v_sub_f32 v77, v77, v174
    v_sub_f32 v78, v78, v174
    v_sub_f32 v79, v79, v174
    v_mul_f32 v163, v163, v175
    v_accvgpr_read_b32 v166, a8
    s_nop 0
    v_mul_f32 v166, v166, v175
    s_nop 0
    v_accvgpr_write_b32 a8, v166
    v_accvgpr_read_b32 v166, a9
    s_nop 0
    v_mul_f32 v166, v166, v175
    s_nop 0
    v_accvgpr_write_b32 a9, v166
    v_accvgpr_read_b32 v166, a10
    s_nop 0
    v_mul_f32 v166, v166, v175
    s_nop 0
    v_accvgpr_write_b32 a10, v166
    v_accvgpr_read_b32 v166, a11
    s_nop 0
    v_mul_f32 v166, v166, v175
    s_nop 0
    v_accvgpr_write_b32 a11, v166
    v_accvgpr_read_b32 v166, a28
    s_nop 0
    v_mul_f32 v166, v166, v175
    s_nop 0
    v_accvgpr_write_b32 a28, v166
    v_accvgpr_read_b32 v166, a29
    s_nop 0
    v_mul_f32 v166, v166, v175
    s_nop 0
    v_accvgpr_write_b32 a29, v166
    v_accvgpr_read_b32 v166, a30
    s_nop 0
    v_mul_f32 v166, v166, v175
    s_nop 0
    v_accvgpr_write_b32 a30, v166
    v_accvgpr_read_b32 v166, a31
    s_nop 0
    v_mul_f32 v166, v166, v175
    s_nop 0
    v_accvgpr_write_b32 a31, v166
    v_accvgpr_read_b32 v166, a48
    s_nop 0
    v_mul_f32 v166, v166, v175
    s_nop 0
    v_accvgpr_write_b32 a48, v166
    v_accvgpr_read_b32 v166, a49
    s_nop 0
    v_mul_f32 v166, v166, v175
    s_nop 0
    v_accvgpr_write_b32 a49, v166
    v_accvgpr_read_b32 v166, a50
    s_nop 0
    v_mul_f32 v166, v166, v175
    s_nop 0
    v_accvgpr_write_b32 a50, v166
    v_accvgpr_read_b32 v166, a51
    s_nop 0
    v_mul_f32 v166, v166, v175
    s_nop 0
    v_accvgpr_write_b32 a51, v166
    v_accvgpr_read_b32 v166, a68
    s_nop 0
    v_mul_f32 v166, v166, v175
    s_nop 0
    v_accvgpr_write_b32 a68, v166
    v_accvgpr_read_b32 v166, a69
    s_nop 0
    v_mul_f32 v166, v166, v175
    s_nop 0
    v_accvgpr_write_b32 a69, v166
    v_accvgpr_read_b32 v166, a70
    s_nop 0
    v_mul_f32 v166, v166, v175
    s_nop 0
    v_accvgpr_write_b32 a70, v166
    v_accvgpr_read_b32 v166, a71
    s_nop 0
    v_mul_f32 v166, v166, v175
    s_nop 0
    v_accvgpr_write_b32 a71, v166
    v_accvgpr_read_b32 v166, a88
    s_nop 0
    v_mul_f32 v166, v166, v175
    s_nop 0
    v_accvgpr_write_b32 a88, v166
    v_accvgpr_read_b32 v166, a89
    s_nop 0
    v_mul_f32 v166, v166, v175
    s_nop 0
    v_accvgpr_write_b32 a89, v166
    v_accvgpr_read_b32 v166, a90
    s_nop 0
    v_mul_f32 v166, v166, v175
    s_nop 0
    v_accvgpr_write_b32 a90, v166
    v_accvgpr_read_b32 v166, a91
    s_nop 0
    v_mul_f32 v166, v166, v175
    s_nop 0
    v_accvgpr_write_b32 a91, v166
    v_accvgpr_read_b32 v166, a108
    s_nop 0
    v_mul_f32 v166, v166, v175
    s_nop 0
    v_accvgpr_write_b32 a108, v166
    v_accvgpr_read_b32 v166, a109
    s_nop 0
    v_mul_f32 v166, v166, v175
    s_nop 0
    v_accvgpr_write_b32 a109, v166
    v_accvgpr_read_b32 v166, a110
    s_nop 0
    v_mul_f32 v166, v166, v175
    s_nop 0
    v_accvgpr_write_b32 a110, v166
    v_accvgpr_read_b32 v166, a111
    s_nop 0
    v_mul_f32 v166, v166, v175
    s_nop 0
    v_accvgpr_write_b32 a111, v166
    v_accvgpr_read_b32 v166, a128
    s_nop 0
    v_mul_f32 v166, v166, v175
    s_nop 0
    v_accvgpr_write_b32 a128, v166
    v_accvgpr_read_b32 v166, a129
    s_nop 0
    v_mul_f32 v166, v166, v175
    s_nop 0
    v_accvgpr_write_b32 a129, v166
    v_accvgpr_read_b32 v166, a130
    s_nop 0
    v_mul_f32 v166, v166, v175
    s_nop 0
    v_accvgpr_write_b32 a130, v166
    v_accvgpr_read_b32 v166, a131
    s_nop 0
    v_mul_f32 v166, v166, v175
    s_nop 0
    v_accvgpr_write_b32 a131, v166
    v_accvgpr_read_b32 v166, a148
    s_nop 0
    v_mul_f32 v166, v166, v175
    s_nop 0
    v_accvgpr_write_b32 a148, v166
    v_accvgpr_read_b32 v166, a149
    s_nop 0
    v_mul_f32 v166, v166, v175
    s_nop 0
    v_accvgpr_write_b32 a149, v166
    v_accvgpr_read_b32 v166, a150
    s_nop 0
    v_mul_f32 v166, v166, v175
    s_nop 0
    v_accvgpr_write_b32 a150, v166
    v_accvgpr_read_b32 v166, a151
    s_nop 0
    v_mul_f32 v166, v166, v175
    s_nop 0
    v_accvgpr_write_b32 a151, v166
    v_exp_f32 v166, v72
    v_exp_f32 v167, v73
    v_exp_f32 v168, v74
    v_add_f32 v158, v166, v167
    v_exp_f32 v169, v75
    v_cvt_pk_bf16_f32 v124, v166, v167
    v_add_f32 v158, v158, v168
    v_exp_f32 v170, v76
    v_add_f32 v158, v158, v169
    v_cvt_pk_bf16_f32 v125, v168, v169
    v_exp_f32 v171, v77
    v_add_f32 v158, v158, v170
    v_exp_f32 v172, v78
    v_add_f32 v158, v158, v171
    v_cvt_pk_bf16_f32 v126, v170, v171
    v_exp_f32 v173, v79
    v_add_f32 v158, v158, v172
    v_nop
    v_add_f32 v158, v158, v173
    v_cvt_pk_bf16_f32 v127, v172, v173
    v_max3_f32 v174, v80, v81, v82
    v_max3_f32 v174, v174, v83, v84
    v_max3_f32 v174, v174, v85, v86
    v_max_f32 v174, v174, v87
    v_mov_b32 v166, v174
    v_mov_b32 v167, v174
    s_nop 1
    v_permlane32_swap_b32 v166, v167
    s_nop 1
    v_max_f32 v174, v166, v167
    v_mov_b32 v166, v174
    v_mov_b32 v167, v174
    s_nop 1
    v_permlane16_swap_b32 v166, v167
    s_nop 1
    v_max_f32 v174, v166, v167
    v_max_f32 v174, 0, v174
    v_sub_f32 v175, 0, v174
    v_exp_f32 v175, v175
    v_sub_f32 v148, v148, v174
    v_sub_f32 v149, v149, v174
    v_sub_f32 v150, v150, v174
    v_sub_f32 v151, v151, v174
    v_sub_f32 v80, v80, v174
    v_sub_f32 v81, v81, v174
    v_sub_f32 v82, v82, v174
    v_sub_f32 v83, v83, v174
    v_sub_f32 v84, v84, v174
    v_sub_f32 v85, v85, v174
    v_sub_f32 v86, v86, v174
    v_sub_f32 v87, v87, v174
    v_mul_f32 v164, v164, v175
    v_accvgpr_read_b32 v166, a12
    s_nop 0
    v_mul_f32 v166, v166, v175
    s_nop 0
    v_accvgpr_write_b32 a12, v166
    v_accvgpr_read_b32 v166, a13
    s_nop 0
    v_mul_f32 v166, v166, v175
    s_nop 0
    v_accvgpr_write_b32 a13, v166
    v_accvgpr_read_b32 v166, a14
    s_nop 0
    v_mul_f32 v166, v166, v175
    s_nop 0
    v_accvgpr_write_b32 a14, v166
    v_accvgpr_read_b32 v166, a15
    s_nop 0
    v_mul_f32 v166, v166, v175
    s_nop 0
    v_accvgpr_write_b32 a15, v166
    v_accvgpr_read_b32 v166, a32
    s_nop 0
    v_mul_f32 v166, v166, v175
    s_nop 0
    v_accvgpr_write_b32 a32, v166
    v_accvgpr_read_b32 v166, a33
    s_nop 0
    v_mul_f32 v166, v166, v175
    s_nop 0
    v_accvgpr_write_b32 a33, v166
    v_accvgpr_read_b32 v166, a34
    s_nop 0
    v_mul_f32 v166, v166, v175
    s_nop 0
    v_accvgpr_write_b32 a34, v166
    v_accvgpr_read_b32 v166, a35
    s_nop 0
    v_mul_f32 v166, v166, v175
    s_nop 0
    v_accvgpr_write_b32 a35, v166
    v_accvgpr_read_b32 v166, a52
    s_nop 0
    v_mul_f32 v166, v166, v175
    s_nop 0
    v_accvgpr_write_b32 a52, v166
    v_accvgpr_read_b32 v166, a53
    s_nop 0
    v_mul_f32 v166, v166, v175
    s_nop 0
    v_accvgpr_write_b32 a53, v166
    v_accvgpr_read_b32 v166, a54
    s_nop 0
    v_mul_f32 v166, v166, v175
    s_nop 0
    v_accvgpr_write_b32 a54, v166
    v_accvgpr_read_b32 v166, a55
    s_nop 0
    v_mul_f32 v166, v166, v175
    s_nop 0
    v_accvgpr_write_b32 a55, v166
    v_accvgpr_read_b32 v166, a72
    s_nop 0
    v_mul_f32 v166, v166, v175
    s_nop 0
    v_accvgpr_write_b32 a72, v166
    v_accvgpr_read_b32 v166, a73
    s_nop 0
    v_mul_f32 v166, v166, v175
    s_nop 0
    v_accvgpr_write_b32 a73, v166
    v_accvgpr_read_b32 v166, a74
    s_nop 0
    v_mul_f32 v166, v166, v175
    s_nop 0
    v_accvgpr_write_b32 a74, v166
    v_accvgpr_read_b32 v166, a75
    s_nop 0
    v_mul_f32 v166, v166, v175
    s_nop 0
    v_accvgpr_write_b32 a75, v166
    v_accvgpr_read_b32 v166, a92
    s_nop 0
    v_mul_f32 v166, v166, v175
    s_nop 0
    v_accvgpr_write_b32 a92, v166
    v_accvgpr_read_b32 v166, a93
    s_nop 0
    v_mul_f32 v166, v166, v175
    s_nop 0
    v_accvgpr_write_b32 a93, v166
    v_accvgpr_read_b32 v166, a94
    s_nop 0
    v_mul_f32 v166, v166, v175
    s_nop 0
    v_accvgpr_write_b32 a94, v166
    v_accvgpr_read_b32 v166, a95
    s_nop 0
    v_mul_f32 v166, v166, v175
    s_nop 0
    v_accvgpr_write_b32 a95, v166
    v_accvgpr_read_b32 v166, a112
    s_nop 0
    v_mul_f32 v166, v166, v175
    s_nop 0
    v_accvgpr_write_b32 a112, v166
    v_accvgpr_read_b32 v166, a113
    s_nop 0
    v_mul_f32 v166, v166, v175
    s_nop 0
    v_accvgpr_write_b32 a113, v166
    v_accvgpr_read_b32 v166, a114
    s_nop 0
    v_mul_f32 v166, v166, v175
    s_nop 0
    v_accvgpr_write_b32 a114, v166
    v_accvgpr_read_b32 v166, a115
    s_nop 0
    v_mul_f32 v166, v166, v175
    s_nop 0
    v_accvgpr_write_b32 a115, v166
    v_accvgpr_read_b32 v166, a132
    s_nop 0
    v_mul_f32 v166, v166, v175
    s_nop 0
    v_accvgpr_write_b32 a132, v166
    v_accvgpr_read_b32 v166, a133
    s_nop 0
    v_mul_f32 v166, v166, v175
    s_nop 0
    v_accvgpr_write_b32 a133, v166
    v_accvgpr_read_b32 v166, a134
    s_nop 0
    v_mul_f32 v166, v166, v175
    s_nop 0
    v_accvgpr_write_b32 a134, v166
    v_accvgpr_read_b32 v166, a135
    s_nop 0
    v_mul_f32 v166, v166, v175
    s_nop 0
    v_accvgpr_write_b32 a135, v166
    v_accvgpr_read_b32 v166, a152
    s_nop 0
    v_mul_f32 v166, v166, v175
    s_nop 0
    v_accvgpr_write_b32 a152, v166
    v_accvgpr_read_b32 v166, a153
    s_nop 0
    v_mul_f32 v166, v166, v175
    s_nop 0
    v_accvgpr_write_b32 a153, v166
    v_accvgpr_read_b32 v166, a154
    s_nop 0
    v_mul_f32 v166, v166, v175
    s_nop 0
    v_accvgpr_write_b32 a154, v166
    v_accvgpr_read_b32 v166, a155
    s_nop 0
    v_mul_f32 v166, v166, v175
    s_nop 0
    v_accvgpr_write_b32 a155, v166
    v_exp_f32 v166, v80
    v_exp_f32 v167, v81
    v_exp_f32 v168, v82
    v_add_f32 v159, v166, v167
    v_exp_f32 v169, v83
    v_cvt_pk_bf16_f32 v128, v166, v167
    v_add_f32 v159, v159, v168
    v_exp_f32 v170, v84
    v_add_f32 v159, v159, v169
    v_cvt_pk_bf16_f32 v129, v168, v169
    v_exp_f32 v171, v85
    v_add_f32 v159, v159, v170
    v_exp_f32 v172, v86
    v_add_f32 v159, v159, v171
    v_cvt_pk_bf16_f32 v130, v170, v171
    v_exp_f32 v173, v87
    v_add_f32 v159, v159, v172
    v_nop
    v_add_f32 v159, v159, v173
    v_cvt_pk_bf16_f32 v131, v172, v173
    v_max3_f32 v174, v88, v89, v90
    v_max3_f32 v174, v174, v91, v92
    v_max3_f32 v174, v174, v93, v94
    v_max_f32 v174, v174, v95
    v_mov_b32 v166, v174
    v_mov_b32 v167, v174
    s_nop 1
    v_permlane32_swap_b32 v166, v167
    s_nop 1
    v_max_f32 v174, v166, v167
    v_mov_b32 v166, v174
    v_mov_b32 v167, v174
    s_nop 1
    v_permlane16_swap_b32 v166, v167
    s_nop 1
    v_max_f32 v174, v166, v167
    v_max_f32 v174, 0, v174
    v_sub_f32 v175, 0, v174
    v_exp_f32 v175, v175
    v_sub_f32 v152, v152, v174
    v_sub_f32 v153, v153, v174
    v_sub_f32 v154, v154, v174
    v_sub_f32 v155, v155, v174
    v_sub_f32 v88, v88, v174
    v_sub_f32 v89, v89, v174
    v_sub_f32 v90, v90, v174
    v_sub_f32 v91, v91, v174
    v_sub_f32 v92, v92, v174
    v_sub_f32 v93, v93, v174
    v_sub_f32 v94, v94, v174
    v_sub_f32 v95, v95, v174
    v_mul_f32 v165, v165, v175
    v_accvgpr_read_b32 v166, a16
    s_nop 0
    v_mul_f32 v166, v166, v175
    s_nop 0
    v_accvgpr_write_b32 a16, v166
    v_accvgpr_read_b32 v166, a17
    s_nop 0
    v_mul_f32 v166, v166, v175
    s_nop 0
    v_accvgpr_write_b32 a17, v166
    v_accvgpr_read_b32 v166, a18
    s_nop 0
    v_mul_f32 v166, v166, v175
    s_nop 0
    v_accvgpr_write_b32 a18, v166
    v_accvgpr_read_b32 v166, a19
    s_nop 0
    v_mul_f32 v166, v166, v175
    s_nop 0
    v_accvgpr_write_b32 a19, v166
    v_accvgpr_read_b32 v166, a36
    s_nop 0
    v_mul_f32 v166, v166, v175
    s_nop 0
    v_accvgpr_write_b32 a36, v166
    v_accvgpr_read_b32 v166, a37
    s_nop 0
    v_mul_f32 v166, v166, v175
    s_nop 0
    v_accvgpr_write_b32 a37, v166
    v_accvgpr_read_b32 v166, a38
    s_nop 0
    v_mul_f32 v166, v166, v175
    s_nop 0
    v_accvgpr_write_b32 a38, v166
    v_accvgpr_read_b32 v166, a39
    s_nop 0
    v_mul_f32 v166, v166, v175
    s_nop 0
    v_accvgpr_write_b32 a39, v166
    v_accvgpr_read_b32 v166, a56
    s_nop 0
    v_mul_f32 v166, v166, v175
    s_nop 0
    v_accvgpr_write_b32 a56, v166
    v_accvgpr_read_b32 v166, a57
    s_nop 0
    v_mul_f32 v166, v166, v175
    s_nop 0
    v_accvgpr_write_b32 a57, v166
    v_accvgpr_read_b32 v166, a58
    s_nop 0
    v_mul_f32 v166, v166, v175
    s_nop 0
    v_accvgpr_write_b32 a58, v166
    v_accvgpr_read_b32 v166, a59
    s_nop 0
    v_mul_f32 v166, v166, v175
    s_nop 0
    v_accvgpr_write_b32 a59, v166
    v_accvgpr_read_b32 v166, a76
    s_nop 0
    v_mul_f32 v166, v166, v175
    s_nop 0
    v_accvgpr_write_b32 a76, v166
    v_accvgpr_read_b32 v166, a77
    s_nop 0
    v_mul_f32 v166, v166, v175
    s_nop 0
    v_accvgpr_write_b32 a77, v166
    v_accvgpr_read_b32 v166, a78
    s_nop 0
    v_mul_f32 v166, v166, v175
    s_nop 0
    v_accvgpr_write_b32 a78, v166
    v_accvgpr_read_b32 v166, a79
    s_nop 0
    v_mul_f32 v166, v166, v175
    s_nop 0
    v_accvgpr_write_b32 a79, v166
    v_accvgpr_read_b32 v166, a96
    s_nop 0
    v_mul_f32 v166, v166, v175
    s_nop 0
    v_accvgpr_write_b32 a96, v166
    v_accvgpr_read_b32 v166, a97
    s_nop 0
    v_mul_f32 v166, v166, v175
    s_nop 0
    v_accvgpr_write_b32 a97, v166
    v_accvgpr_read_b32 v166, a98
    s_nop 0
    v_mul_f32 v166, v166, v175
    s_nop 0
    v_accvgpr_write_b32 a98, v166
    v_accvgpr_read_b32 v166, a99
    s_nop 0
    v_mul_f32 v166, v166, v175
    s_nop 0
    v_accvgpr_write_b32 a99, v166
    v_accvgpr_read_b32 v166, a116
    s_nop 0
    v_mul_f32 v166, v166, v175
    s_nop 0
    v_accvgpr_write_b32 a116, v166
    v_accvgpr_read_b32 v166, a117
    s_nop 0
    v_mul_f32 v166, v166, v175
    s_nop 0
    v_accvgpr_write_b32 a117, v166
    v_accvgpr_read_b32 v166, a118
    s_nop 0
    v_mul_f32 v166, v166, v175
    s_nop 0
    v_accvgpr_write_b32 a118, v166
    v_accvgpr_read_b32 v166, a119
    s_nop 0
    v_mul_f32 v166, v166, v175
    s_nop 0
    v_accvgpr_write_b32 a119, v166
    v_accvgpr_read_b32 v166, a136
    s_nop 0
    v_mul_f32 v166, v166, v175
    s_nop 0
    v_accvgpr_write_b32 a136, v166
    v_accvgpr_read_b32 v166, a137
    s_nop 0
    v_mul_f32 v166, v166, v175
    s_nop 0
    v_accvgpr_write_b32 a137, v166
    v_accvgpr_read_b32 v166, a138
    s_nop 0
    v_mul_f32 v166, v166, v175
    s_nop 0
    v_accvgpr_write_b32 a138, v166
    v_accvgpr_read_b32 v166, a139
    s_nop 0
    v_mul_f32 v166, v166, v175
    s_nop 0
    v_accvgpr_write_b32 a139, v166
    v_accvgpr_read_b32 v166, a156
    s_nop 0
    v_mul_f32 v166, v166, v175
    s_nop 0
    v_accvgpr_write_b32 a156, v166
    v_accvgpr_read_b32 v166, a157
    s_nop 0
    v_mul_f32 v166, v166, v175
    s_nop 0
    v_accvgpr_write_b32 a157, v166
    v_accvgpr_read_b32 v166, a158
    s_nop 0
    v_mul_f32 v166, v166, v175
    s_nop 0
    v_accvgpr_write_b32 a158, v166
    v_accvgpr_read_b32 v166, a159
    s_nop 0
    v_mul_f32 v166, v166, v175
    s_nop 0
    v_accvgpr_write_b32 a159, v166
    v_exp_f32 v166, v88
    v_exp_f32 v167, v89
    v_exp_f32 v168, v90
    v_add_f32 v160, v166, v167
    v_exp_f32 v169, v91
    v_cvt_pk_bf16_f32 v132, v166, v167
    v_add_f32 v160, v160, v168
    v_exp_f32 v170, v92
    v_add_f32 v160, v160, v169
    v_cvt_pk_bf16_f32 v133, v168, v169
    v_exp_f32 v171, v93
    v_add_f32 v160, v160, v170
    v_exp_f32 v172, v94
    v_add_f32 v160, v160, v171
    v_cvt_pk_bf16_f32 v134, v170, v171
    v_exp_f32 v173, v95
    v_add_f32 v160, v160, v172
    v_nop
    v_add_f32 v160, v160, v173
    v_cvt_pk_bf16_f32 v135, v172, v173
    s_nop 3
    s_setpc_b64 s[52:53]
.section .rodata,"a"
.p2align 6
.amdhsa_kernel concat_heads__mha_block_cached__gqa_block_cached__near_ridge_kernel
  .amdhsa_next_free_vgpr 512
  .amdhsa_next_free_sgpr 102
  .amdhsa_accum_offset 256
  .amdhsa_group_segment_fixed_size 0
  .amdhsa_kernarg_size 104
  .amdhsa_user_sgpr_count 2
  .amdhsa_user_sgpr_kernarg_segment_ptr 1
  .amdhsa_system_sgpr_workgroup_id_x 1
  .amdhsa_float_denorm_mode_32 3
  .amdhsa_float_denorm_mode_16_64 3
.end_amdhsa_kernel
```
